```python
import torch

def _softmax(x, axis=-1):
    return torch.softmax(x, dim=axis)

def _gelu(x):
    return torch.nn.functional.gelu(x, approximate='tanh')

def _silu(x):
    return torch.nn.functional.silu(x)

def _sigmoid(x):
    return torch.sigmoid(x)

def _layernorm(x, axis=-1, eps=1e-05):
    m = x.mean(dim=axis, keepdim=True)
    v = x.var(dim=axis, keepdim=True, unbiased=False)
    return (x - m) / torch.sqrt(v + eps)

def _scatter_add(tgt, idx, src, axis=0):
    return tgt.clone().index_add_(axis, idx, src)

def _segment_sum(src, seg, n):
    out = torch.zeros((n,) + src.shape[1:], dtype=src.dtype)
    return out.index_add_(0, seg, src)

def _pad(x, pw):
    flat = tuple((v for pair in reversed(pw) for v in pair))
    return torch.nn.functional.pad(x, flat)
kernel_name = 'interleave_layers__memory_aug_recurrent_mem_tr__dense_activation_silu__prompt'

def setup_inputs():

    _w = lambda a: (lambda t: t.to(torch.bfloat16) if t.is_floating_point() else t)(torch.as_tensor(a))

    def _A_setup():
        B, S, Dm = (1, 2048, 512)
        H, Dh = (32, 128)
        M, seg = (8, 32)
        seg = min(seg, S)
        S = S // seg * seg
        return {'x': _w((lambda *s: torch.randn(*s, dtype=torch.bfloat16) * 0.05)(B, S, Dm)), 'mem0': _w((lambda *s: torch.randn(*s, dtype=torch.bfloat16) * 0.2)(B, M, Dm)), 'Wq': _w((lambda *s: torch.randn(*s, dtype=torch.bfloat16) * 1.6)(Dm, H, Dh) * Dm ** (-0.5)), 'Wk': _w((lambda *s: torch.randn(*s, dtype=torch.bfloat16) * 1.6)(Dm, H, Dh) * Dm ** (-0.5)), 'Wv': _w((lambda *s: torch.randn(*s, dtype=torch.bfloat16) * 0.2)(Dm, H, Dh) * Dm ** (-0.5)), 'Wo': _w((lambda *s: torch.randn(*s, dtype=torch.bfloat16) * 0.2)(H, Dh, Dm) * (H * Dh) ** (-0.5)), 'seg_len': seg}
    _A_in = _A_setup()

    def _B_setup():
        B, S, D, F = (1, 2048, 512, 1376)
        return {'x': _w((lambda *s: torch.randn(*s, dtype=torch.bfloat16) * 0.05)(B, S, D)), 'w1': _w((lambda *s: torch.randn(*s, dtype=torch.bfloat16) * 0.4)(D, F) * D ** (-0.5)), 'w2': _w((lambda *s: torch.randn(*s, dtype=torch.bfloat16) * 0.1)(F, D) * F ** (-0.5))}
    _B_in = _B_setup()
    return {'A_x': _A_in['x'], 'A_mem0': _A_in['mem0'], 'A_Wq': _A_in['Wq'], 'A_Wk': _A_in['Wk'], 'A_Wv': _A_in['Wv'], 'A_Wo': _A_in['Wo'], 'A_seg_len': _A_in['seg_len'], 'B_x': _B_in['x'], 'B_w1': _B_in['w1'], 'B_w2': _B_in['w2']}

def reference(A_x, A_mem0, A_Wq, A_Wk, A_Wv, A_Wo, A_seg_len, B_x, B_w1, B_w2):

    def _A_ref(x, mem0, Wq, Wk, Wv, Wo, seg_len):
        B, S, Dm = x.shape
        H, Dh = (Wq.shape[1], Wq.shape[2])
        M = mem0.shape[1]
        scale = Dh ** (-0.5)
        n_seg = S // seg_len
        L = M + seg_len
        idx = torch.arange(L)
        mask = (idx[:, None] < M) | (idx[:, None] >= idx[None, :])
        mem = mem0
        outs = []
        for s in range(n_seg):
            xs = x[:, s * seg_len:(s + 1) * seg_len, :].clone()
            h = torch.concatenate([mem, xs], axis=1)
            q = torch.einsum('btd,dhe->bhte', h, Wq)
            k = torch.einsum('btd,dhe->bhte', h, Wk)
            v = torch.einsum('btd,dhe->bhte', h, Wv)
            scores = torch.einsum('bhqe,bhke->bhqk', q, k) * scale
            scores = torch.where(mask[None, None], scores, -1000000000.0)
            p = _softmax(scores, axis=-1)
            o = torch.einsum('bhqk,bhke->bhqe', p, v)
            o = torch.einsum('bhte,hed->btd', o, Wo)
            mem = o[:, :M, :].clone()
            outs.append(o[:, M:, :])
        return torch.concatenate(outs, axis=1)

    def _B_ref(x, w1, w2):
        h = torch.einsum('bsd,df->bsf', x, w1)
        h = _silu(h)
        out = torch.einsum('bsf,fd->bsd', h, w2)
        return out
    x = A_x
    x = x + _A_ref(_layernorm(x, axis=-1), A_mem0, A_Wq, A_Wk, A_Wv, A_Wo, A_seg_len)
    x = x + _B_ref(_layernorm(x, axis=-1), B_w1, B_w2)
    x = x + _A_ref(_layernorm(x, axis=-1), A_mem0, A_Wq, A_Wk, A_Wv, A_Wo, A_seg_len)
    x = x + _B_ref(_layernorm(x, axis=-1), B_w1, B_w2)
    return x
```

```asm
; @launch kernel=main_kernel grid=(256,1,1) block=(256,1,1) lds=163840
.amdgcn_target "amdgcn-amd-amdhsa--gfx950"
.text
.globl main_kernel
.p2align 8
.type main_kernel,@function
main_kernel:
    s_cmp_ge_u32 s2, 256
    s_cbranch_scc1 MAIN_END
    s_memrealtime s[28:29]
    s_load_dwordx2 s[4:5], s[0:1], 96
    s_mov_b32 s6, 268435456
    s_mov_b32 s7, 0x00020000
    s_waitcnt lgkmcnt(0)
    s_load_dwordx2 s[12:13], s[0:1], 88
    s_mov_b32 s14, 256
    s_mov_b32 s15, 0x00020000
    s_waitcnt lgkmcnt(0)
    s_getreg_b32 s42, hwreg(HW_REG_XCC_ID, 0, 3)
    v_and_b32 v1, 63, v0
    v_mov_b32 v2, 0
    v_lshrrev_b32 v5, 6, v0
    s_nop 0
    v_readfirstlane_b32 s16, v5
    s_mov_b32 s31, 0x05040100
    s_mov_b32 s32, 0x07060302
    s_and_b32 s43, s42, 3
    s_lshl_b32 s43, s43, 6
    s_and_b32 s44, s42, 4
    s_add_u32 s43, s43, s44
    v_mov_b32 v6, 163776
    s_cmp_lg_u32 s16, 0
    s_cbranch_scc1 D_1
    v_mov_b32 v60, 1
    s_mov_b64 exec, 1
    buffer_atomic_add v60, v2, s[12:15], s43 offen sc0
    s_waitcnt vmcnt(0)
    ds_write_b32 v6, v60 offset:16
    s_mov_b64 exec, -1
    s_waitcnt lgkmcnt(0)
D_1:
    s_barrier
    ds_read_b32 v5, v6 offset:16
    s_waitcnt lgkmcnt(0)
    v_readfirstlane_b32 s43, v5
    s_lshl_b32 s44, s42, 5
    s_add_u32 s44, s44, s43
    s_cmp_lt_u32 s43, 32
    s_cbranch_scc1 D_ROLE
    v_and_b32 v6, 63, v0
    v_lshlrev_b32 v6, 2, v6
Ldw_1:
    buffer_load_dword v5, v6, s[12:15], 0 offen sc1
    s_waitcnt vmcnt(0)
    s_mov_b32 s24, 0
    v_readlane_b32 s25, v5, 0
    s_add_u32 s24, s24, s25
    v_readlane_b32 s25, v5, 16
    s_add_u32 s24, s24, s25
    v_readlane_b32 s25, v5, 32
    s_add_u32 s24, s24, s25
    v_readlane_b32 s25, v5, 48
    s_add_u32 s24, s24, s25
    v_readlane_b32 s25, v5, 1
    s_add_u32 s24, s24, s25
    v_readlane_b32 s25, v5, 17
    s_add_u32 s24, s24, s25
    v_readlane_b32 s25, v5, 33
    s_add_u32 s24, s24, s25
    v_readlane_b32 s25, v5, 49
    s_add_u32 s24, s24, s25
    s_cmp_ge_u32 s24, 256
    s_cbranch_scc1 Ldw_2
    s_sleep 4
    s_memrealtime s[36:37]
    s_waitcnt lgkmcnt(0)
    s_sub_u32 s36, s36, s28
    s_cmp_gt_u32 s36, 3000000
    s_cbranch_scc1 MAIN_END
    s_branch Ldw_1
Ldw_2:
    buffer_load_dword v5, v6, s[12:15], 0 offen sc1
    s_waitcnt vmcnt(0)
    s_sub_u32 s43, s43, 32
    v_readlane_b32 s24, v5, 0
    s_max_u32 s24, s24, 32
    s_sub_u32 s24, s24, 32
    s_cmp_gt_u32 s42, 0
    s_cselect_b32 s24, s24, 0
    s_add_u32 s43, s43, s24
    v_readlane_b32 s24, v5, 16
    s_max_u32 s24, s24, 32
    s_sub_u32 s24, s24, 32
    s_cmp_gt_u32 s42, 1
    s_cselect_b32 s24, s24, 0
    s_add_u32 s43, s43, s24
    v_readlane_b32 s24, v5, 32
    s_max_u32 s24, s24, 32
    s_sub_u32 s24, s24, 32
    s_cmp_gt_u32 s42, 2
    s_cselect_b32 s24, s24, 0
    s_add_u32 s43, s43, s24
    v_readlane_b32 s24, v5, 48
    s_max_u32 s24, s24, 32
    s_sub_u32 s24, s24, 32
    s_cmp_gt_u32 s42, 3
    s_cselect_b32 s24, s24, 0
    s_add_u32 s43, s43, s24
    v_readlane_b32 s24, v5, 1
    s_max_u32 s24, s24, 32
    s_sub_u32 s24, s24, 32
    s_cmp_gt_u32 s42, 4
    s_cselect_b32 s24, s24, 0
    s_add_u32 s43, s43, s24
    v_readlane_b32 s24, v5, 17
    s_max_u32 s24, s24, 32
    s_sub_u32 s24, s24, 32
    s_cmp_gt_u32 s42, 5
    s_cselect_b32 s24, s24, 0
    s_add_u32 s43, s43, s24
    v_readlane_b32 s24, v5, 33
    s_max_u32 s24, s24, 32
    s_sub_u32 s24, s24, 32
    s_cmp_gt_u32 s42, 6
    s_cselect_b32 s24, s24, 0
    s_add_u32 s43, s43, s24
    v_readlane_b32 s24, v5, 49
    s_max_u32 s24, s24, 32
    s_sub_u32 s24, s24, 32
    s_cmp_gt_u32 s42, 7
    s_cselect_b32 s24, s24, 0
    s_add_u32 s43, s43, s24
    v_readlane_b32 s24, v5, 0
    s_min_u32 s24, s24, 32
    s_add_u32 s44, s24, 0
    s_add_u32 s44, s44, s43
    s_sub_u32 s24, 32, s24
    s_cmp_lt_u32 s43, s24
    s_cbranch_scc1 D_ROLE
    s_sub_u32 s43, s43, s24
    v_readlane_b32 s24, v5, 16
    s_min_u32 s24, s24, 32
    s_add_u32 s44, s24, 32
    s_add_u32 s44, s44, s43
    s_sub_u32 s24, 32, s24
    s_cmp_lt_u32 s43, s24
    s_cbranch_scc1 D_ROLE
    s_sub_u32 s43, s43, s24
    v_readlane_b32 s24, v5, 32
    s_min_u32 s24, s24, 32
    s_add_u32 s44, s24, 64
    s_add_u32 s44, s44, s43
    s_sub_u32 s24, 32, s24
    s_cmp_lt_u32 s43, s24
    s_cbranch_scc1 D_ROLE
    s_sub_u32 s43, s43, s24
    v_readlane_b32 s24, v5, 48
    s_min_u32 s24, s24, 32
    s_add_u32 s44, s24, 96
    s_add_u32 s44, s44, s43
    s_sub_u32 s24, 32, s24
    s_cmp_lt_u32 s43, s24
    s_cbranch_scc1 D_ROLE
    s_sub_u32 s43, s43, s24
    v_readlane_b32 s24, v5, 1
    s_min_u32 s24, s24, 32
    s_add_u32 s44, s24, 128
    s_add_u32 s44, s44, s43
    s_sub_u32 s24, 32, s24
    s_cmp_lt_u32 s43, s24
    s_cbranch_scc1 D_ROLE
    s_sub_u32 s43, s43, s24
    v_readlane_b32 s24, v5, 17
    s_min_u32 s24, s24, 32
    s_add_u32 s44, s24, 160
    s_add_u32 s44, s44, s43
    s_sub_u32 s24, 32, s24
    s_cmp_lt_u32 s43, s24
    s_cbranch_scc1 D_ROLE
    s_sub_u32 s43, s43, s24
    v_readlane_b32 s24, v5, 33
    s_min_u32 s24, s24, 32
    s_add_u32 s44, s24, 192
    s_add_u32 s44, s44, s43
    s_sub_u32 s24, 32, s24
    s_cmp_lt_u32 s43, s24
    s_cbranch_scc1 D_ROLE
    s_sub_u32 s43, s43, s24
    v_readlane_b32 s24, v5, 49
    s_min_u32 s24, s24, 32
    s_add_u32 s44, s24, 224
    s_add_u32 s44, s44, s43
    s_sub_u32 s24, 32, s24
    s_cmp_lt_u32 s43, s24
    s_cbranch_scc1 D_ROLE
    s_sub_u32 s43, s43, s24
    s_branch MAIN_END
D_ROLE:
    s_cmp_lt_u32 s44, 64
    s_cbranch_scc1 J_ENG
    s_sub_u32 s44, s44, 64
    s_cmp_lt_u32 s44, 96
    s_cbranch_scc1 J_QKV
    s_sub_u32 s44, s44, 96
    s_mov_b32 s2, s44
    s_load_dwordx2 s[8:9], s[0:1], 0
    s_mov_b32 s10, 2097152
    s_mov_b32 s11, 0x00020000
    s_waitcnt lgkmcnt(0)
    v_lshrrev_b32 v5, 4, v1
    v_bfe_u32 v6, v1, 3, 1
    v_and_b32 v10, 7, v1
    v_lshlrev_b32 v7, 8, v5
    v_lshl_add_u32 v7, v6, 10, v7
    v_lshl_add_u32 v7, v10, 4, v7
    s_lshl_b32 s24, s16, 12
    v_add_u32 v7, s24, v7
    v_lshlrev_b32 v8, 6, v5
    v_lshl_add_u32 v8, v6, 4, v8
    v_lshl_add_u32 v8, v10, 10, v8
    s_lshl_b32 s24, s16, 8
    v_add_u32 v8, s24, v8
    v_lshlrev_b32 v10, 2, v10
    s_lshl_b32 s24, s16, 5
    v_add_u32 v9, s24, v10
INIT_LOOP:
    s_lshl_b32 s24, s2, 13
    buffer_load_dwordx4 v[12:15], v8, s[8:11], s24 offen
    buffer_load_dwordx4 v[16:19], v8, s[8:11], s24 offen offset:32
    v_mov_b32 v40, 0
    v_mov_b32 v41, 0
    v_mov_b32 v42, 0
    v_mov_b32 v43, 0
    v_lshlrev_b32 v44, 4, v1
    s_lshl_b32 s25, s2, 10
    s_cmp_eq_u32 s16, 1
    s_cselect_b32 s26, 262144, 0
    s_cmp_eq_u32 s16, 2
    s_cselect_b32 s26, 589824, s26
    s_add_u32 s25, s25, s26
    s_cmp_eq_u32 s16, 3
    s_cbranch_scc1 INIT_W3
    s_cmp_lg_u32 s16, 0
    s_cbranch_scc1 INIT_ST
    s_sub_u32 s26, s2, 128
    s_cmp_ge_u32 s26, 16
    s_cbranch_scc1 INIT_ST
    v_and_b32 v45, 15, v1
    v_cmp_eq_u32 vcc, 0, v45
    s_nop 1
    v_cndmask_b32 v40, 0, 4, vcc
    s_branch INIT_ST
INIT_W3:
    s_waitcnt vmcnt(0)
    s_cmp_ge_u32 s2, 48
    s_cbranch_scc1 INIT_NOST
    v_mov_b32 v40, -1
    v_mov_b32 v41, -1
    v_mov_b32 v42, -1
    v_mov_b32 v43, -1
    s_lshl_b32 s25, s2, 10
    s_add_u32 s26, s25, 827392
    s_add_u32 s25, s25, 524288
    s_cmp_ge_u32 s2, 24
    s_cselect_b32 s25, s26, s25
INIT_ST:
    buffer_store_dwordx4 v[40:43], v44, s[4:7], s25 offen sc1
INIT_NOST:
    s_waitcnt vmcnt(1)
    s_lshr_b32 s33, s2, 2
    s_mul_i32 s33, s33, 32768
    s_bfe_u32 s24, s2, 0x10001
    s_lshl_b32 s24, s24, 14
    s_add_u32 s33, s33, s24
    s_and_b32 s24, s2, 1
    s_lshl_b32 s24, s24, 7
    s_add_u32 s33, s33, s24
    s_add_u32 s24, s33, 2097152
    buffer_store_dwordx4 v[12:15], v7, s[4:7], s24 offen sc1
    buffer_store_dwordx4 v[16:19], v7, s[4:7], s24 offen offset:2048 sc1
    v_lshlrev_b32 v20, 16, v12
    v_and_b32 v21, 0xffff0000, v12
    v_lshlrev_b32 v22, 16, v13
    v_and_b32 v23, 0xffff0000, v13
    v_lshlrev_b32 v24, 16, v14
    v_and_b32 v25, 0xffff0000, v14
    v_lshlrev_b32 v26, 16, v15
    v_and_b32 v27, 0xffff0000, v15
    v_lshlrev_b32 v28, 16, v16
    v_and_b32 v29, 0xffff0000, v16
    v_lshlrev_b32 v30, 16, v17
    v_and_b32 v31, 0xffff0000, v17
    v_lshlrev_b32 v32, 16, v18
    v_and_b32 v33, 0xffff0000, v18
    v_lshlrev_b32 v34, 16, v19
    v_and_b32 v35, 0xffff0000, v19
    v_add_f32 v36, v20, v21
    v_add_f32 v36, v36, v22
    v_add_f32 v36, v36, v23
    v_add_f32 v36, v36, v24
    v_add_f32 v36, v36, v25
    v_add_f32 v36, v36, v26
    v_add_f32 v36, v36, v27
    v_add_f32 v36, v36, v28
    v_add_f32 v36, v36, v29
    v_add_f32 v36, v36, v30
    v_add_f32 v36, v36, v31
    v_add_f32 v36, v36, v32
    v_add_f32 v36, v36, v33
    v_add_f32 v36, v36, v34
    v_add_f32 v36, v36, v35
    s_nop 1
    v_add_f32_dpp v36, v36, v36 row_ror:8 row_mask:0xf bank_mask:0xf
    v_mov_b32 v37, v36
    s_nop 1
    v_permlane16_swap_b32 v36, v37
    v_add_f32 v36, v36, v37
    v_mov_b32 v37, v36
    s_nop 1
    v_permlane32_swap_b32 v36, v37
    v_add_f32 v36, v36, v37
    ds_write_b32 v9, v36
    s_waitcnt lgkmcnt(0)
    s_barrier
    ds_read_b32 v36, v10 offset:0
    ds_read_b32 v37, v10 offset:32
    ds_read_b32 v38, v10 offset:64
    ds_read_b32 v39, v10 offset:96
    s_waitcnt lgkmcnt(0)
    v_add_f32 v36, v36, v37
    v_add_f32 v38, v38, v39
    v_add_f32 v36, v36, v38
    v_mul_f32 v36, 0x3b000000, v36
    v_sub_f32 v20, v20, v36
    v_sub_f32 v21, v21, v36
    v_sub_f32 v22, v22, v36
    v_sub_f32 v23, v23, v36
    v_sub_f32 v24, v24, v36
    v_sub_f32 v25, v25, v36
    v_sub_f32 v26, v26, v36
    v_sub_f32 v27, v27, v36
    v_sub_f32 v28, v28, v36
    v_sub_f32 v29, v29, v36
    v_sub_f32 v30, v30, v36
    v_sub_f32 v31, v31, v36
    v_sub_f32 v32, v32, v36
    v_sub_f32 v33, v33, v36
    v_sub_f32 v34, v34, v36
    v_sub_f32 v35, v35, v36
    v_mul_f32 v36, v20, v20
    v_fmac_f32 v36, v21, v21
    v_fmac_f32 v36, v22, v22
    v_fmac_f32 v36, v23, v23
    v_fmac_f32 v36, v24, v24
    v_fmac_f32 v36, v25, v25
    v_fmac_f32 v36, v26, v26
    v_fmac_f32 v36, v27, v27
    v_fmac_f32 v36, v28, v28
    v_fmac_f32 v36, v29, v29
    v_fmac_f32 v36, v30, v30
    v_fmac_f32 v36, v31, v31
    v_fmac_f32 v36, v32, v32
    v_fmac_f32 v36, v33, v33
    v_fmac_f32 v36, v34, v34
    v_fmac_f32 v36, v35, v35
    s_nop 1
    v_add_f32_dpp v36, v36, v36 row_ror:8 row_mask:0xf bank_mask:0xf
    v_mov_b32 v37, v36
    s_nop 1
    v_permlane16_swap_b32 v36, v37
    v_add_f32 v36, v36, v37
    v_mov_b32 v37, v36
    s_nop 1
    v_permlane32_swap_b32 v36, v37
    v_add_f32 v36, v36, v37
    ds_write_b32 v9, v36 offset:128
    s_waitcnt lgkmcnt(0)
    s_barrier
    ds_read_b32 v36, v10 offset:128
    ds_read_b32 v37, v10 offset:160
    ds_read_b32 v38, v10 offset:192
    ds_read_b32 v39, v10 offset:224
    s_waitcnt lgkmcnt(0)
    v_add_f32 v36, v36, v37
    v_add_f32 v38, v38, v39
    v_add_f32 v36, v36, v38
    v_mov_b32 v37, 0x3727c5ac
    v_fmac_f32 v37, 0x3b000000, v36
    v_rsq_f32 v36, v37
    s_nop 0
    v_mul_f32 v20, v20, v36
    v_mul_f32 v21, v21, v36
    v_mul_f32 v22, v22, v36
    v_mul_f32 v23, v23, v36
    v_mul_f32 v24, v24, v36
    v_mul_f32 v25, v25, v36
    v_mul_f32 v26, v26, v36
    v_mul_f32 v27, v27, v36
    v_mul_f32 v28, v28, v36
    v_mul_f32 v29, v29, v36
    v_mul_f32 v30, v30, v36
    v_mul_f32 v31, v31, v36
    v_mul_f32 v32, v32, v36
    v_mul_f32 v33, v33, v36
    v_mul_f32 v34, v34, v36
    v_mul_f32 v35, v35, v36
    v_cvt_pk_bf16_f32 v48, v20, v21
    v_cvt_pk_bf16_f32 v49, v22, v23
    v_cvt_pk_bf16_f32 v50, v24, v25
    v_cvt_pk_bf16_f32 v51, v26, v27
    v_cvt_pk_bf16_f32 v52, v28, v29
    v_cvt_pk_bf16_f32 v53, v30, v31
    v_cvt_pk_bf16_f32 v54, v32, v33
    v_cvt_pk_bf16_f32 v55, v34, v35
    s_add_u32 s24, s33, 6291456
    buffer_store_dwordx4 v[48:51], v7, s[4:7], s24 offen sc1
    buffer_store_dwordx4 v[52:55], v7, s[4:7], s24 offen offset:2048 sc1
    s_add_u32 s2, s2, 96
    s_cmp_lt_u32 s2, 256
    s_cbranch_scc1 INIT_LOOP
    s_waitcnt vmcnt(0)
    s_barrier
    s_cmp_lg_u32 s16, 0
    s_cbranch_scc1 D_2
    s_and_b32 s43, s44, 3
    s_lshl_b32 s43, s43, 6
    v_mov_b32 v60, 1
    s_mov_b64 exec, 1
    buffer_atomic_add v60, v2, s[12:15], s43 offen offset:32
    s_mov_b64 exec, -1
D_2:
    s_cmp_lt_u32 s44, 48
    s_cbranch_scc1 J_AW
    s_sub_u32 s44, s44, 48
    s_mov_b32 s96, 0
    s_mov_b32 s97, 14
D_LATE:
    s_cmp_lt_u32 s44, 22
    s_cbranch_scc1 J_FF
    s_sub_u32 s44, s44, 22
    s_mul_i32 s95, s96, 14
    s_add_u32 s95, s95, s44
    s_cmp_lt_u32 s44, s97
    s_cbranch_scc1 J_R1
    s_mul_i32 s95, s96, 12
    s_add_u32 s95, s95, s44
    s_sub_u32 s95, s95, s97
    s_branch J_R2
MAIN_END:
    s_endpgm
J_R1:
    v_lshrrev_b32 v5, 4, v1
    v_bfe_u32 v6, v1, 3, 1
    v_and_b32 v10, 7, v1
    v_lshlrev_b32 v7, 8, v5
    v_lshl_add_u32 v7, v6, 10, v7
    v_lshl_add_u32 v7, v10, 4, v7
    s_lshl_b32 s24, s16, 12
    v_add_u32 v7, s24, v7
    v_lshlrev_b32 v8, 6, v5
    v_lshl_add_u32 v8, v6, 4, v8
    v_lshl_add_u32 v8, v10, 10, v8
    s_lshl_b32 s24, s16, 8
    v_add_u32 v8, s24, v8
    v_lshlrev_b32 v10, 2, v10
    s_lshl_b32 s24, s16, 5
    v_add_u32 v9, s24, v10
    v_lshrrev_b32 v5, 4, v1
    v_bfe_u32 v6, v1, 2, 2
    v_cmp_eq_u32 vcc, v5, v6
    v_and_b32 v5, 1, v1
    v_lshlrev_b32 v5, 4, v5
    v_mov_b32 v6, 0x3f80
    v_lshlrev_b32 v5, v5, v6
    v_cndmask_b32 v5, 0, v5, vcc
    v_and_b32 v6, 2, v1
    v_cmp_eq_u32 vcc, 0, v6
    s_nop 1
    v_cndmask_b32 v12, 0, v5, vcc
    v_cndmask_b32 v13, v5, 0, vcc
    v_mov_b32 v14, 0
    v_mov_b32 v15, 0
    v_mov_b32 v16, 0
    v_mov_b32 v17, 0
    v_mov_b32 v18, v12
    v_mov_b32 v19, v13
    s_cmp_lg_u32 s95, 0
    s_cbranch_scc1 Lsc_4
    s_mov_b32 s18, 0
    s_mov_b32 s84, 0
    s_mov_b32 s85, 14
    s_mov_b32 s86, 14
    s_mov_b32 s87, 256
    s_mov_b32 s19, 280
    s_mov_b32 s88, 0
    s_mov_b32 s89, 28
    s_mov_b32 s90, 28
    s_mov_b32 s91, 256
    s_branch Lsc_3
Lsc_4:
    s_cmp_lg_u32 s95, 1
    s_cbranch_scc1 Lsc_5
    s_mov_b32 s18, 1
    s_mov_b32 s84, 0
    s_mov_b32 s85, 14
    s_mov_b32 s86, 14
    s_mov_b32 s87, 256
    s_mov_b32 s19, 281
    s_mov_b32 s88, 0
    s_mov_b32 s89, 28
    s_mov_b32 s90, 28
    s_mov_b32 s91, 256
    s_branch Lsc_3
Lsc_5:
    s_cmp_lg_u32 s95, 2
    s_cbranch_scc1 Lsc_6
    s_mov_b32 s18, 2
    s_mov_b32 s84, 0
    s_mov_b32 s85, 14
    s_mov_b32 s86, 14
    s_mov_b32 s87, 256
    s_mov_b32 s19, 282
    s_mov_b32 s88, 0
    s_mov_b32 s89, 28
    s_mov_b32 s90, 28
    s_mov_b32 s91, 256
    s_branch Lsc_3
Lsc_6:
    s_cmp_lg_u32 s95, 3
    s_cbranch_scc1 Lsc_7
    s_mov_b32 s18, 3
    s_mov_b32 s84, 0
    s_mov_b32 s85, 14
    s_mov_b32 s86, 14
    s_mov_b32 s87, 256
    s_mov_b32 s19, 283
    s_mov_b32 s88, 0
    s_mov_b32 s89, 28
    s_mov_b32 s90, 28
    s_mov_b32 s91, 256
    s_branch Lsc_3
Lsc_7:
    s_cmp_lg_u32 s95, 4
    s_cbranch_scc1 Lsc_8
    s_mov_b32 s18, 4
    s_mov_b32 s84, 0
    s_mov_b32 s85, 14
    s_mov_b32 s86, 14
    s_mov_b32 s87, 256
    s_mov_b32 s19, 284
    s_mov_b32 s88, 0
    s_mov_b32 s89, 28
    s_mov_b32 s90, 28
    s_mov_b32 s91, 256
    s_branch Lsc_3
Lsc_8:
    s_cmp_lg_u32 s95, 5
    s_cbranch_scc1 Lsc_9
    s_mov_b32 s18, 5
    s_mov_b32 s84, 0
    s_mov_b32 s85, 14
    s_mov_b32 s86, 14
    s_mov_b32 s87, 256
    s_mov_b32 s19, 285
    s_mov_b32 s88, 0
    s_mov_b32 s89, 28
    s_mov_b32 s90, 28
    s_mov_b32 s91, 256
    s_branch Lsc_3
Lsc_9:
    s_cmp_lg_u32 s95, 6
    s_cbranch_scc1 Lsc_10
    s_mov_b32 s18, 6
    s_mov_b32 s84, 0
    s_mov_b32 s85, 14
    s_mov_b32 s86, 14
    s_mov_b32 s87, 256
    s_mov_b32 s19, 286
    s_mov_b32 s88, 0
    s_mov_b32 s89, 28
    s_mov_b32 s90, 28
    s_mov_b32 s91, 256
    s_branch Lsc_3
Lsc_10:
    s_cmp_lg_u32 s95, 7
    s_cbranch_scc1 Lsc_11
    s_mov_b32 s18, 7
    s_mov_b32 s84, 0
    s_mov_b32 s85, 14
    s_mov_b32 s86, 14
    s_mov_b32 s87, 256
    s_mov_b32 s19, 287
    s_mov_b32 s88, 0
    s_mov_b32 s89, 28
    s_mov_b32 s90, 28
    s_mov_b32 s91, 256
    s_branch Lsc_3
Lsc_11:
    s_cmp_lg_u32 s95, 8
    s_cbranch_scc1 Lsc_12
    s_mov_b32 s18, 8
    s_mov_b32 s84, 0
    s_mov_b32 s85, 14
    s_mov_b32 s86, 14
    s_mov_b32 s87, 256
    s_mov_b32 s19, 288
    s_mov_b32 s88, 0
    s_mov_b32 s89, 28
    s_mov_b32 s90, 28
    s_mov_b32 s91, 256
    s_branch Lsc_3
Lsc_12:
    s_cmp_lg_u32 s95, 9
    s_cbranch_scc1 Lsc_13
    s_mov_b32 s18, 9
    s_mov_b32 s84, 0
    s_mov_b32 s85, 14
    s_mov_b32 s86, 14
    s_mov_b32 s87, 256
    s_mov_b32 s19, 289
    s_mov_b32 s88, 0
    s_mov_b32 s89, 28
    s_mov_b32 s90, 28
    s_mov_b32 s91, 256
    s_branch Lsc_3
Lsc_13:
    s_cmp_lg_u32 s95, 10
    s_cbranch_scc1 Lsc_14
    s_mov_b32 s18, 10
    s_mov_b32 s84, 0
    s_mov_b32 s85, 14
    s_mov_b32 s86, 14
    s_mov_b32 s87, 256
    s_mov_b32 s19, 290
    s_mov_b32 s88, 0
    s_mov_b32 s89, 28
    s_mov_b32 s90, 28
    s_mov_b32 s91, 256
    s_branch Lsc_3
Lsc_14:
    s_cmp_lg_u32 s95, 11
    s_cbranch_scc1 Lsc_15
    s_mov_b32 s18, 11
    s_mov_b32 s84, 0
    s_mov_b32 s85, 14
    s_mov_b32 s86, 14
    s_mov_b32 s87, 256
    s_mov_b32 s19, 291
    s_mov_b32 s88, 0
    s_mov_b32 s89, 28
    s_mov_b32 s90, 28
    s_mov_b32 s91, 256
    s_branch Lsc_3
Lsc_15:
    s_cmp_lg_u32 s95, 12
    s_cbranch_scc1 Lsc_16
    s_mov_b32 s18, 12
    s_mov_b32 s84, 0
    s_mov_b32 s85, 14
    s_mov_b32 s86, 14
    s_mov_b32 s87, 256
    s_mov_b32 s19, 292
    s_mov_b32 s88, 0
    s_mov_b32 s89, 28
    s_mov_b32 s90, 28
    s_mov_b32 s91, 256
    s_branch Lsc_3
Lsc_16:
    s_cmp_lg_u32 s95, 13
    s_cbranch_scc1 Lsc_17
    s_mov_b32 s18, 13
    s_mov_b32 s84, 0
    s_mov_b32 s85, 14
    s_mov_b32 s86, 14
    s_mov_b32 s87, 256
    s_mov_b32 s19, 293
    s_mov_b32 s88, 0
    s_mov_b32 s89, 28
    s_mov_b32 s90, 28
    s_mov_b32 s91, 256
    s_branch Lsc_3
Lsc_17:
    s_cmp_lg_u32 s95, 14
    s_cbranch_scc1 Lsc_18
    s_mov_b32 s18, 256
    s_mov_b32 s84, 0
    s_mov_b32 s85, 1
    s_mov_b32 s86, 1
    s_mov_b32 s87, 256
    s_mov_b32 s19, 0
    s_mov_b32 s88, 266
    s_mov_b32 s89, 14
    s_mov_b32 s90, 28
    s_mov_b32 s91, 256
    s_branch Lsc_3
Lsc_18:
    s_cmp_lg_u32 s95, 15
    s_cbranch_scc1 Lsc_19
    s_mov_b32 s18, 256
    s_mov_b32 s84, 0
    s_mov_b32 s85, 1
    s_mov_b32 s86, 1
    s_mov_b32 s87, 256
    s_mov_b32 s19, 1
    s_mov_b32 s88, 266
    s_mov_b32 s89, 14
    s_mov_b32 s90, 28
    s_mov_b32 s91, 256
    s_branch Lsc_3
Lsc_19:
    s_cmp_lg_u32 s95, 16
    s_cbranch_scc1 Lsc_20
    s_mov_b32 s18, 256
    s_mov_b32 s84, 0
    s_mov_b32 s85, 1
    s_mov_b32 s86, 1
    s_mov_b32 s87, 256
    s_mov_b32 s19, 2
    s_mov_b32 s88, 266
    s_mov_b32 s89, 14
    s_mov_b32 s90, 28
    s_mov_b32 s91, 256
    s_branch Lsc_3
Lsc_20:
    s_cmp_lg_u32 s95, 17
    s_cbranch_scc1 Lsc_21
    s_mov_b32 s18, 256
    s_mov_b32 s84, 0
    s_mov_b32 s85, 1
    s_mov_b32 s86, 1
    s_mov_b32 s87, 256
    s_mov_b32 s19, 3
    s_mov_b32 s88, 266
    s_mov_b32 s89, 14
    s_mov_b32 s90, 28
    s_mov_b32 s91, 256
    s_branch Lsc_3
Lsc_21:
    s_cmp_lg_u32 s95, 18
    s_cbranch_scc1 Lsc_22
    s_mov_b32 s18, 256
    s_mov_b32 s84, 0
    s_mov_b32 s85, 1
    s_mov_b32 s86, 1
    s_mov_b32 s87, 256
    s_mov_b32 s19, 4
    s_mov_b32 s88, 266
    s_mov_b32 s89, 14
    s_mov_b32 s90, 28
    s_mov_b32 s91, 256
    s_branch Lsc_3
Lsc_22:
    s_cmp_lg_u32 s95, 19
    s_cbranch_scc1 Lsc_23
    s_mov_b32 s18, 256
    s_mov_b32 s84, 0
    s_mov_b32 s85, 1
    s_mov_b32 s86, 1
    s_mov_b32 s87, 256
    s_mov_b32 s19, 5
    s_mov_b32 s88, 266
    s_mov_b32 s89, 14
    s_mov_b32 s90, 28
    s_mov_b32 s91, 256
    s_branch Lsc_3
Lsc_23:
    s_cmp_lg_u32 s95, 20
    s_cbranch_scc1 Lsc_24
    s_mov_b32 s18, 256
    s_mov_b32 s84, 0
    s_mov_b32 s85, 1
    s_mov_b32 s86, 1
    s_mov_b32 s87, 256
    s_mov_b32 s19, 6
    s_mov_b32 s88, 266
    s_mov_b32 s89, 14
    s_mov_b32 s90, 28
    s_mov_b32 s91, 256
    s_branch Lsc_3
Lsc_24:
    s_cmp_lg_u32 s95, 21
    s_cbranch_scc1 Lsc_25
    s_mov_b32 s18, 256
    s_mov_b32 s84, 0
    s_mov_b32 s85, 1
    s_mov_b32 s86, 1
    s_mov_b32 s87, 256
    s_mov_b32 s19, 7
    s_mov_b32 s88, 266
    s_mov_b32 s89, 14
    s_mov_b32 s90, 28
    s_mov_b32 s91, 256
    s_branch Lsc_3
Lsc_25:
    s_cmp_lg_u32 s95, 22
    s_cbranch_scc1 Lsc_26
    s_mov_b32 s18, 256
    s_mov_b32 s84, 0
    s_mov_b32 s85, 1
    s_mov_b32 s86, 1
    s_mov_b32 s87, 256
    s_mov_b32 s19, 8
    s_mov_b32 s88, 266
    s_mov_b32 s89, 14
    s_mov_b32 s90, 28
    s_mov_b32 s91, 256
    s_branch Lsc_3
Lsc_26:
    s_cmp_lg_u32 s95, 23
    s_cbranch_scc1 Lsc_27
    s_mov_b32 s18, 256
    s_mov_b32 s84, 0
    s_mov_b32 s85, 1
    s_mov_b32 s86, 1
    s_mov_b32 s87, 256
    s_mov_b32 s19, 9
    s_mov_b32 s88, 266
    s_mov_b32 s89, 14
    s_mov_b32 s90, 28
    s_mov_b32 s91, 256
    s_branch Lsc_3
Lsc_27:
    s_cmp_lg_u32 s95, 24
    s_cbranch_scc1 Lsc_28
    s_mov_b32 s18, 256
    s_mov_b32 s84, 0
    s_mov_b32 s85, 1
    s_mov_b32 s86, 1
    s_mov_b32 s87, 256
    s_mov_b32 s19, 10
    s_mov_b32 s88, 266
    s_mov_b32 s89, 14
    s_mov_b32 s90, 28
    s_mov_b32 s91, 256
    s_branch Lsc_3
Lsc_28:
    s_cmp_lg_u32 s95, 25
    s_cbranch_scc1 Lsc_29
    s_mov_b32 s18, 256
    s_mov_b32 s84, 0
    s_mov_b32 s85, 1
    s_mov_b32 s86, 1
    s_mov_b32 s87, 256
    s_mov_b32 s19, 11
    s_mov_b32 s88, 266
    s_mov_b32 s89, 14
    s_mov_b32 s90, 28
    s_mov_b32 s91, 256
    s_branch Lsc_3
Lsc_29:
    s_cmp_lg_u32 s95, 26
    s_cbranch_scc1 Lsc_30
    s_mov_b32 s18, 256
    s_mov_b32 s84, 0
    s_mov_b32 s85, 1
    s_mov_b32 s86, 1
    s_mov_b32 s87, 256
    s_mov_b32 s19, 12
    s_mov_b32 s88, 266
    s_mov_b32 s89, 14
    s_mov_b32 s90, 28
    s_mov_b32 s91, 256
    s_branch Lsc_3
Lsc_30:
    s_cmp_lg_u32 s95, 27
    s_cbranch_scc1 Lsc_31
    s_mov_b32 s18, 256
    s_mov_b32 s84, 0
    s_mov_b32 s85, 1
    s_mov_b32 s86, 1
    s_mov_b32 s87, 256
    s_mov_b32 s19, 13
    s_mov_b32 s88, 266
    s_mov_b32 s89, 14
    s_mov_b32 s90, 28
    s_mov_b32 s91, 256
    s_branch Lsc_3
Lsc_31:
Lsc_3:
    s_cmp_lg_u32 s16, 0
    s_cbranch_scc1 RR1_DW
    v_and_b32 v4, 63, v0
    v_lshlrev_b32 v4, 2, v4
Ldw_32:
    buffer_load_dword v3, v4, s[12:15], 0 offen sc1
    s_waitcnt vmcnt(0)
    s_mov_b32 s24, 0
    v_readlane_b32 s25, v3, 8
    s_add_u32 s24, s24, s25
    v_readlane_b32 s25, v3, 24
    s_add_u32 s24, s24, s25
    v_readlane_b32 s25, v3, 40
    s_add_u32 s24, s24, s25
    v_readlane_b32 s25, v3, 56
    s_add_u32 s24, s24, s25
    s_cmp_ge_u32 s24, 96
    s_cbranch_scc1 Ldw_33
    s_sleep 4
    s_memrealtime s[36:37]
    s_waitcnt lgkmcnt(0)
    s_sub_u32 s36, s36, s28
    s_cmp_gt_u32 s36, 3000000
    s_cbranch_scc1 RR1_DW
    s_branch Ldw_32
Ldw_33:
RR1_DW:
    s_mov_b32 s22, -1
    s_mov_b32 s20, -1
    s_mov_b32 s30, 0
RR1_B1:
    s_min_u32 s24, s18, s19
    s_cmp_ge_u32 s24, 256
    s_cbranch_scc1 E_R1
    s_cmp_lg_u32 s16, 0
    s_cbranch_scc1 RR1_B3
RR1_B2:
    s_min_u32 s25, s18, 255
    s_lshr_b32 s24, s25, 2
    s_lshl_b32 s24, s24, 8
    s_add_u32 s24, s24, 131136
    buffer_load_dword v3, v2, s[4:7], s24 offen sc1
    s_min_u32 s25, s19, 255
    s_lshr_b32 s24, s25, 2
    s_lshl_b32 s24, s24, 8
    s_add_u32 s24, s24, 147520
    buffer_load_dword v4, v2, s[4:7], s24 offen sc1
    s_waitcnt vmcnt(0)
    v_readfirstlane_b32 s25, v3
    v_readfirstlane_b32 s26, v4
    s_mov_b32 s24, -1
    s_cmp_ge_u32 s19, 256
    s_cbranch_scc1 Lsk_34
    s_cmp_lg_u32 s26, 16
    s_cbranch_scc1 Lsk_34
    s_add_u32 s24, s19, 256
Lsk_34:
    s_cmp_ge_u32 s18, 256
    s_cbranch_scc1 Lsk_35
    s_cmp_lg_u32 s25, 16
    s_cbranch_scc1 Lsk_35
    s_add_u32 s24, s18, 0
Lsk_35:
    s_cmp_lg_u32 s24, -1
    s_cbranch_scc1 RR1_B2x
    s_sleep 2
    s_memrealtime s[36:37]
    s_waitcnt lgkmcnt(0)
    s_sub_u32 s36, s36, s28
    s_cmp_gt_u32 s36, 3000000
    s_cbranch_scc1 RR1_B2x
    s_branch RR1_B2
RR1_B2x:
    v_mov_b32 v5, s24
    v_mov_b32 v6, 163776
    ds_write_b32 v6, v5 offset:8
    s_waitcnt lgkmcnt(0)
RR1_B3:
    s_barrier
    v_mov_b32 v6, 163776
    ds_read_b32 v5, v6 offset:8
    s_waitcnt lgkmcnt(0)
    v_readfirstlane_b32 s20, v5
    s_cmp_eq_u32 s20, -1
    s_cbranch_scc1 E_R1
RR1_GO:
    s_cmp_ge_u32 s20, 256
    s_cbranch_scc1 Lad_36
    s_cmp_ge_u32 s18, s84
    s_cselect_b32 s24, s86, s85
    s_add_u32 s18, s18, s24
    s_cmp_ge_u32 s18, s87
    s_cselect_b32 s18, 256, s18
    s_branch Lad_37
Lad_36:
    s_cmp_ge_u32 s19, s88
    s_cselect_b32 s24, s90, s89
    s_add_u32 s19, s19, s24
    s_cmp_ge_u32 s19, s91
    s_cselect_b32 s19, 256, s19
Lad_37:
    s_min_u32 s25, s18, 255
    s_lshr_b32 s24, s25, 2
    s_lshl_b32 s24, s24, 8
    s_add_u32 s24, s24, 131136
    buffer_load_dword v3, v2, s[4:7], s24 offen sc1
    s_min_u32 s25, s19, 255
    s_lshr_b32 s24, s25, 2
    s_lshl_b32 s24, s24, 8
    s_add_u32 s24, s24, 147520
    buffer_load_dword v4, v2, s[4:7], s24 offen sc1
    s_lshr_b32 s92, s20, 2
    s_mul_i32 s92, s92, 32768
    s_bfe_u32 s94, s20, 0x10001
    s_lshl_b32 s94, s94, 14
    s_add_u32 s92, s92, s94
    s_and_b32 s94, s20, 1
    s_lshl_b32 s94, s94, 7
    s_add_u32 s92, s92, s94
    s_add_u32 s92, s92, 2097152
    s_lshr_b32 s93, s20, 2
    s_mul_i32 s93, s93, 524288
    s_bfe_u32 s94, s20, 0x10001
    s_lshl_b32 s94, s94, 14
    s_add_u32 s93, s93, s94
    s_and_b32 s94, s20, 1
    s_lshl_b32 s94, s94, 7
    s_add_u32 s93, s93, s94
    s_add_u32 s93, s93, 136282112
    buffer_load_dwordx4 v[64:67], v7, s[4:7], s92 offen offset:0 sc1
    buffer_load_dwordx4 v[68:71], v7, s[4:7], s92 offen offset:2048 sc1
    s_add_u32 s93, s93, 32768
    buffer_load_dwordx4 v[72:75], v7, s[4:7], s93 offen offset:0 sc1
    buffer_load_dwordx4 v[76:79], v7, s[4:7], s93 offen offset:2048 sc1
    s_add_u32 s93, s93, 32768
    buffer_load_dwordx4 v[80:83], v7, s[4:7], s93 offen offset:0 sc1
    buffer_load_dwordx4 v[84:87], v7, s[4:7], s93 offen offset:2048 sc1
    s_add_u32 s93, s93, 32768
    buffer_load_dwordx4 v[88:91], v7, s[4:7], s93 offen offset:0 sc1
    buffer_load_dwordx4 v[92:95], v7, s[4:7], s93 offen offset:2048 sc1
    s_cmp_eq_u32 s22, -1
    s_cbranch_scc1 RR1_G1
    s_waitcnt vmcnt(10)
    s_barrier
    s_cmp_lg_u32 s16, 0
    s_cbranch_scc1 Lsg_38
    s_lshr_b32 s24, s22, 2
    s_lshl_b32 s24, s24, 8
    s_add_u32 s24, s24, 131200
    v_mov_b32 v5, 1
    s_mov_b64 s[38:39], exec
    s_mov_b64 exec, 1
    buffer_atomic_add v5, v2, s[4:7], s24 offen
    s_mov_b64 exec, s[38:39]
Lsg_38:
    s_mov_b32 s22, -1
RR1_G1:
    s_add_u32 s93, s93, 32768
    buffer_load_dwordx4 v[96:99], v7, s[4:7], s93 offen offset:0 sc1
    buffer_load_dwordx4 v[100:103], v7, s[4:7], s93 offen offset:2048 sc1
    s_add_u32 s93, s93, 32768
    buffer_load_dwordx4 v[104:107], v7, s[4:7], s93 offen offset:0 sc1
    buffer_load_dwordx4 v[108:111], v7, s[4:7], s93 offen offset:2048 sc1
    s_add_u32 s93, s93, 32768
    buffer_load_dwordx4 v[112:115], v7, s[4:7], s93 offen offset:0 sc1
    buffer_load_dwordx4 v[116:119], v7, s[4:7], s93 offen offset:2048 sc1
    s_add_u32 s93, s93, 32768
    buffer_load_dwordx4 v[120:123], v7, s[4:7], s93 offen offset:0 sc1
    buffer_load_dwordx4 v[124:127], v7, s[4:7], s93 offen offset:2048 sc1
    s_add_u32 s93, s93, 32768
    buffer_load_dwordx4 v[128:131], v7, s[4:7], s93 offen offset:0 sc1
    buffer_load_dwordx4 v[132:135], v7, s[4:7], s93 offen offset:2048 sc1
    s_add_u32 s93, s93, 32768
    buffer_load_dwordx4 v[136:139], v7, s[4:7], s93 offen offset:0 sc1
    buffer_load_dwordx4 v[140:143], v7, s[4:7], s93 offen offset:2048 sc1
    s_add_u32 s93, s93, 32768
    buffer_load_dwordx4 v[144:147], v7, s[4:7], s93 offen offset:0 sc1
    buffer_load_dwordx4 v[148:151], v7, s[4:7], s93 offen offset:2048 sc1
    s_add_u32 s93, s93, 32768
    buffer_load_dwordx4 v[152:155], v7, s[4:7], s93 offen offset:0 sc1
    buffer_load_dwordx4 v[156:159], v7, s[4:7], s93 offen offset:2048 sc1
    s_add_u32 s93, s93, 32768
    buffer_load_dwordx4 v[160:163], v7, s[4:7], s93 offen offset:0 sc1
    buffer_load_dwordx4 v[164:167], v7, s[4:7], s93 offen offset:2048 sc1
    s_add_u32 s93, s93, 32768
    buffer_load_dwordx4 v[168:171], v7, s[4:7], s93 offen offset:0 sc1
    buffer_load_dwordx4 v[172:175], v7, s[4:7], s93 offen offset:2048 sc1
    s_add_u32 s93, s93, 32768
    buffer_load_dwordx4 v[176:179], v7, s[4:7], s93 offen offset:0 sc1
    buffer_load_dwordx4 v[180:183], v7, s[4:7], s93 offen offset:2048 sc1
    s_add_u32 s93, s93, 32768
    buffer_load_dwordx4 v[184:187], v7, s[4:7], s93 offen offset:0 sc1
    buffer_load_dwordx4 v[188:191], v7, s[4:7], s93 offen offset:2048 sc1
    s_add_u32 s93, s93, 32768
    buffer_load_dwordx4 v[192:195], v7, s[4:7], s93 offen offset:0 sc1
    buffer_load_dwordx4 v[196:199], v7, s[4:7], s93 offen offset:2048 sc1
    s_waitcnt vmcnt(34)
    s_xor_b32 s30, s30, 1
    s_cmp_lg_u32 s16, 0
    s_cbranch_scc1 Lw0_39
    v_readfirstlane_b32 s25, v3
    v_readfirstlane_b32 s26, v4
    s_mov_b32 s24, -1
    s_cmp_ge_u32 s19, 256
    s_cbranch_scc1 Lsk_40
    s_cmp_lg_u32 s26, 16
    s_cbranch_scc1 Lsk_40
    s_add_u32 s24, s19, 256
Lsk_40:
    s_cmp_ge_u32 s18, 256
    s_cbranch_scc1 Lsk_41
    s_cmp_lg_u32 s25, 16
    s_cbranch_scc1 Lsk_41
    s_add_u32 s24, s18, 0
Lsk_41:
    v_mov_b32 v5, s24
    v_mov_b32 v6, 163776
    ds_write_b32 v6, v5 offset:0
Lw0_39:
    s_waitcnt vmcnt(33)
    v_mfma_f32_16x16x32_bf16 v[20:23], v[12:15], v[64:67], 0
    v_mfma_f32_16x16x32_bf16 v[24:27], v[16:19], v[64:67], 0
    s_waitcnt vmcnt(32)
    v_mfma_f32_16x16x32_bf16 v[28:31], v[12:15], v[68:71], 0
    v_mfma_f32_16x16x32_bf16 v[32:35], v[16:19], v[68:71], 0
    s_waitcnt vmcnt(31)
    v_mfma_f32_16x16x32_bf16 v[20:23], v[12:15], v[72:75], v[20:23]
    v_mfma_f32_16x16x32_bf16 v[24:27], v[16:19], v[72:75], v[24:27]
    s_waitcnt vmcnt(30)
    v_mfma_f32_16x16x32_bf16 v[28:31], v[12:15], v[76:79], v[28:31]
    v_mfma_f32_16x16x32_bf16 v[32:35], v[16:19], v[76:79], v[32:35]
    s_waitcnt vmcnt(29)
    v_mfma_f32_16x16x32_bf16 v[20:23], v[12:15], v[80:83], v[20:23]
    v_mfma_f32_16x16x32_bf16 v[24:27], v[16:19], v[80:83], v[24:27]
    s_waitcnt vmcnt(28)
    v_mfma_f32_16x16x32_bf16 v[28:31], v[12:15], v[84:87], v[28:31]
    v_mfma_f32_16x16x32_bf16 v[32:35], v[16:19], v[84:87], v[32:35]
    s_waitcnt vmcnt(27)
    v_mfma_f32_16x16x32_bf16 v[20:23], v[12:15], v[88:91], v[20:23]
    v_mfma_f32_16x16x32_bf16 v[24:27], v[16:19], v[88:91], v[24:27]
    s_waitcnt vmcnt(26)
    v_mfma_f32_16x16x32_bf16 v[28:31], v[12:15], v[92:95], v[28:31]
    v_mfma_f32_16x16x32_bf16 v[32:35], v[16:19], v[92:95], v[32:35]
    s_waitcnt vmcnt(25)
    v_mfma_f32_16x16x32_bf16 v[20:23], v[12:15], v[96:99], v[20:23]
    v_mfma_f32_16x16x32_bf16 v[24:27], v[16:19], v[96:99], v[24:27]
    s_waitcnt vmcnt(24)
    v_mfma_f32_16x16x32_bf16 v[28:31], v[12:15], v[100:103], v[28:31]
    v_mfma_f32_16x16x32_bf16 v[32:35], v[16:19], v[100:103], v[32:35]
    s_waitcnt vmcnt(23)
    v_mfma_f32_16x16x32_bf16 v[20:23], v[12:15], v[104:107], v[20:23]
    v_mfma_f32_16x16x32_bf16 v[24:27], v[16:19], v[104:107], v[24:27]
    s_waitcnt vmcnt(22)
    v_mfma_f32_16x16x32_bf16 v[28:31], v[12:15], v[108:111], v[28:31]
    v_mfma_f32_16x16x32_bf16 v[32:35], v[16:19], v[108:111], v[32:35]
    s_waitcnt vmcnt(21)
    v_mfma_f32_16x16x32_bf16 v[20:23], v[12:15], v[112:115], v[20:23]
    v_mfma_f32_16x16x32_bf16 v[24:27], v[16:19], v[112:115], v[24:27]
    s_waitcnt vmcnt(20)
    v_mfma_f32_16x16x32_bf16 v[28:31], v[12:15], v[116:119], v[28:31]
    v_mfma_f32_16x16x32_bf16 v[32:35], v[16:19], v[116:119], v[32:35]
    s_waitcnt vmcnt(19)
    v_mfma_f32_16x16x32_bf16 v[20:23], v[12:15], v[120:123], v[20:23]
    v_mfma_f32_16x16x32_bf16 v[24:27], v[16:19], v[120:123], v[24:27]
    s_waitcnt vmcnt(18)
    v_mfma_f32_16x16x32_bf16 v[28:31], v[12:15], v[124:127], v[28:31]
    v_mfma_f32_16x16x32_bf16 v[32:35], v[16:19], v[124:127], v[32:35]
    s_waitcnt vmcnt(17)
    v_mfma_f32_16x16x32_bf16 v[20:23], v[12:15], v[128:131], v[20:23]
    v_mfma_f32_16x16x32_bf16 v[24:27], v[16:19], v[128:131], v[24:27]
    s_waitcnt vmcnt(16)
    v_mfma_f32_16x16x32_bf16 v[28:31], v[12:15], v[132:135], v[28:31]
    v_mfma_f32_16x16x32_bf16 v[32:35], v[16:19], v[132:135], v[32:35]
    s_waitcnt vmcnt(15)
    v_mfma_f32_16x16x32_bf16 v[20:23], v[12:15], v[136:139], v[20:23]
    v_mfma_f32_16x16x32_bf16 v[24:27], v[16:19], v[136:139], v[24:27]
    s_waitcnt vmcnt(14)
    v_mfma_f32_16x16x32_bf16 v[28:31], v[12:15], v[140:143], v[28:31]
    v_mfma_f32_16x16x32_bf16 v[32:35], v[16:19], v[140:143], v[32:35]
    s_waitcnt vmcnt(13)
    v_mfma_f32_16x16x32_bf16 v[20:23], v[12:15], v[144:147], v[20:23]
    v_mfma_f32_16x16x32_bf16 v[24:27], v[16:19], v[144:147], v[24:27]
    s_waitcnt vmcnt(12)
    v_mfma_f32_16x16x32_bf16 v[28:31], v[12:15], v[148:151], v[28:31]
    v_mfma_f32_16x16x32_bf16 v[32:35], v[16:19], v[148:151], v[32:35]
    s_waitcnt vmcnt(11)
    v_mfma_f32_16x16x32_bf16 v[20:23], v[12:15], v[152:155], v[20:23]
    v_mfma_f32_16x16x32_bf16 v[24:27], v[16:19], v[152:155], v[24:27]
    s_waitcnt vmcnt(10)
    v_mfma_f32_16x16x32_bf16 v[28:31], v[12:15], v[156:159], v[28:31]
    v_mfma_f32_16x16x32_bf16 v[32:35], v[16:19], v[156:159], v[32:35]
    s_waitcnt vmcnt(9)
    v_mfma_f32_16x16x32_bf16 v[20:23], v[12:15], v[160:163], v[20:23]
    v_mfma_f32_16x16x32_bf16 v[24:27], v[16:19], v[160:163], v[24:27]
    s_waitcnt vmcnt(8)
    v_mfma_f32_16x16x32_bf16 v[28:31], v[12:15], v[164:167], v[28:31]
    v_mfma_f32_16x16x32_bf16 v[32:35], v[16:19], v[164:167], v[32:35]
    s_waitcnt vmcnt(7)
    v_mfma_f32_16x16x32_bf16 v[20:23], v[12:15], v[168:171], v[20:23]
    v_mfma_f32_16x16x32_bf16 v[24:27], v[16:19], v[168:171], v[24:27]
    s_waitcnt vmcnt(6)
    v_mfma_f32_16x16x32_bf16 v[28:31], v[12:15], v[172:175], v[28:31]
    v_mfma_f32_16x16x32_bf16 v[32:35], v[16:19], v[172:175], v[32:35]
    s_waitcnt vmcnt(5)
    v_mfma_f32_16x16x32_bf16 v[20:23], v[12:15], v[176:179], v[20:23]
    v_mfma_f32_16x16x32_bf16 v[24:27], v[16:19], v[176:179], v[24:27]
    s_waitcnt vmcnt(4)
    v_mfma_f32_16x16x32_bf16 v[28:31], v[12:15], v[180:183], v[28:31]
    v_mfma_f32_16x16x32_bf16 v[32:35], v[16:19], v[180:183], v[32:35]
    s_waitcnt vmcnt(3)
    v_mfma_f32_16x16x32_bf16 v[20:23], v[12:15], v[184:187], v[20:23]
    v_mfma_f32_16x16x32_bf16 v[24:27], v[16:19], v[184:187], v[24:27]
    s_waitcnt vmcnt(2)
    v_mfma_f32_16x16x32_bf16 v[28:31], v[12:15], v[188:191], v[28:31]
    v_mfma_f32_16x16x32_bf16 v[32:35], v[16:19], v[188:191], v[32:35]
    s_waitcnt vmcnt(1)
    v_mfma_f32_16x16x32_bf16 v[20:23], v[12:15], v[192:195], v[20:23]
    v_mfma_f32_16x16x32_bf16 v[24:27], v[16:19], v[192:195], v[24:27]
    s_waitcnt vmcnt(0)
    v_mfma_f32_16x16x32_bf16 v[28:31], v[12:15], v[196:199], v[28:31]
    v_mfma_f32_16x16x32_bf16 v[32:35], v[16:19], v[196:199], v[32:35]
    s_nop 3
    v_cvt_pk_bf16_f32 v44, v20, v21
    v_cvt_pk_bf16_f32 v45, v22, v23
    v_cvt_pk_bf16_f32 v46, v24, v25
    v_cvt_pk_bf16_f32 v47, v26, v27
    v_cvt_pk_bf16_f32 v48, v28, v29
    v_cvt_pk_bf16_f32 v49, v30, v31
    v_cvt_pk_bf16_f32 v50, v32, v33
    v_cvt_pk_bf16_f32 v51, v34, v35
    v_lshlrev_b32 v20, 16, v44
    v_and_b32 v21, 0xffff0000, v44
    v_lshlrev_b32 v22, 16, v45
    v_and_b32 v23, 0xffff0000, v45
    v_lshlrev_b32 v24, 16, v46
    v_and_b32 v25, 0xffff0000, v46
    v_lshlrev_b32 v26, 16, v47
    v_and_b32 v27, 0xffff0000, v47
    v_lshlrev_b32 v28, 16, v48
    v_and_b32 v29, 0xffff0000, v48
    v_lshlrev_b32 v30, 16, v49
    v_and_b32 v31, 0xffff0000, v49
    v_lshlrev_b32 v32, 16, v50
    v_and_b32 v33, 0xffff0000, v50
    v_lshlrev_b32 v34, 16, v51
    v_and_b32 v35, 0xffff0000, v51
    v_add_f32 v36, v20, v21
    v_add_f32 v36, v36, v22
    v_add_f32 v36, v36, v23
    v_add_f32 v36, v36, v24
    v_add_f32 v36, v36, v25
    v_add_f32 v36, v36, v26
    v_add_f32 v36, v36, v27
    v_add_f32 v36, v36, v28
    v_add_f32 v36, v36, v29
    v_add_f32 v36, v36, v30
    v_add_f32 v36, v36, v31
    v_add_f32 v36, v36, v32
    v_add_f32 v36, v36, v33
    v_add_f32 v36, v36, v34
    v_add_f32 v36, v36, v35
    s_nop 1
    v_add_f32_dpp v36, v36, v36 row_ror:8 row_mask:0xf bank_mask:0xf
    v_mov_b32 v37, v36
    s_nop 1
    v_permlane16_swap_b32 v36, v37
    v_add_f32 v36, v36, v37
    v_mov_b32 v37, v36
    s_nop 1
    v_permlane32_swap_b32 v36, v37
    v_add_f32 v36, v36, v37
    ds_write_b32 v9, v36
    s_branch RR1_S1
RR1_TOP:
    s_xor_b32 s30, s30, 1
    s_cmp_lg_u32 s16, 0
    s_cbranch_scc1 Lw0_42
    v_readfirstlane_b32 s25, v3
    v_readfirstlane_b32 s26, v4
    s_mov_b32 s24, -1
    s_cmp_ge_u32 s19, 256
    s_cbranch_scc1 Lsk_43
    s_cmp_lg_u32 s26, 16
    s_cbranch_scc1 Lsk_43
    s_add_u32 s24, s19, 256
Lsk_43:
    s_cmp_ge_u32 s18, 256
    s_cbranch_scc1 Lsk_44
    s_cmp_lg_u32 s25, 16
    s_cbranch_scc1 Lsk_44
    s_add_u32 s24, s18, 0
Lsk_44:
    v_mov_b32 v5, s24
    v_mov_b32 v6, 163776
    ds_write_b32 v6, v5 offset:0
Lw0_42:
    v_mfma_f32_16x16x32_bf16 v[20:23], v[12:15], v[64:67], 0
    v_mfma_f32_16x16x32_bf16 v[24:27], v[16:19], v[64:67], 0
    v_mfma_f32_16x16x32_bf16 v[28:31], v[12:15], v[68:71], 0
    v_mfma_f32_16x16x32_bf16 v[32:35], v[16:19], v[68:71], 0
    v_mfma_f32_16x16x32_bf16 v[20:23], v[12:15], v[72:75], v[20:23]
    v_mfma_f32_16x16x32_bf16 v[24:27], v[16:19], v[72:75], v[24:27]
    v_mfma_f32_16x16x32_bf16 v[28:31], v[12:15], v[76:79], v[28:31]
    v_mfma_f32_16x16x32_bf16 v[32:35], v[16:19], v[76:79], v[32:35]
    v_mfma_f32_16x16x32_bf16 v[20:23], v[12:15], v[80:83], v[20:23]
    v_mfma_f32_16x16x32_bf16 v[24:27], v[16:19], v[80:83], v[24:27]
    v_mfma_f32_16x16x32_bf16 v[28:31], v[12:15], v[84:87], v[28:31]
    v_mfma_f32_16x16x32_bf16 v[32:35], v[16:19], v[84:87], v[32:35]
    v_mfma_f32_16x16x32_bf16 v[20:23], v[12:15], v[88:91], v[20:23]
    v_mfma_f32_16x16x32_bf16 v[24:27], v[16:19], v[88:91], v[24:27]
    v_mfma_f32_16x16x32_bf16 v[28:31], v[12:15], v[92:95], v[28:31]
    v_mfma_f32_16x16x32_bf16 v[32:35], v[16:19], v[92:95], v[32:35]
    v_mfma_f32_16x16x32_bf16 v[20:23], v[12:15], v[96:99], v[20:23]
    v_mfma_f32_16x16x32_bf16 v[24:27], v[16:19], v[96:99], v[24:27]
    v_mfma_f32_16x16x32_bf16 v[28:31], v[12:15], v[100:103], v[28:31]
    v_mfma_f32_16x16x32_bf16 v[32:35], v[16:19], v[100:103], v[32:35]
    v_mfma_f32_16x16x32_bf16 v[20:23], v[12:15], v[104:107], v[20:23]
    v_mfma_f32_16x16x32_bf16 v[24:27], v[16:19], v[104:107], v[24:27]
    v_mfma_f32_16x16x32_bf16 v[28:31], v[12:15], v[108:111], v[28:31]
    v_mfma_f32_16x16x32_bf16 v[32:35], v[16:19], v[108:111], v[32:35]
    v_mfma_f32_16x16x32_bf16 v[20:23], v[12:15], v[112:115], v[20:23]
    v_mfma_f32_16x16x32_bf16 v[24:27], v[16:19], v[112:115], v[24:27]
    v_mfma_f32_16x16x32_bf16 v[28:31], v[12:15], v[116:119], v[28:31]
    v_mfma_f32_16x16x32_bf16 v[32:35], v[16:19], v[116:119], v[32:35]
    v_mfma_f32_16x16x32_bf16 v[20:23], v[12:15], v[120:123], v[20:23]
    v_mfma_f32_16x16x32_bf16 v[24:27], v[16:19], v[120:123], v[24:27]
    v_mfma_f32_16x16x32_bf16 v[28:31], v[12:15], v[124:127], v[28:31]
    v_mfma_f32_16x16x32_bf16 v[32:35], v[16:19], v[124:127], v[32:35]
    v_mfma_f32_16x16x32_bf16 v[20:23], v[12:15], v[128:131], v[20:23]
    v_mfma_f32_16x16x32_bf16 v[24:27], v[16:19], v[128:131], v[24:27]
    v_mfma_f32_16x16x32_bf16 v[28:31], v[12:15], v[132:135], v[28:31]
    v_mfma_f32_16x16x32_bf16 v[32:35], v[16:19], v[132:135], v[32:35]
    v_mfma_f32_16x16x32_bf16 v[20:23], v[12:15], v[136:139], v[20:23]
    v_mfma_f32_16x16x32_bf16 v[24:27], v[16:19], v[136:139], v[24:27]
    v_mfma_f32_16x16x32_bf16 v[28:31], v[12:15], v[140:143], v[28:31]
    v_mfma_f32_16x16x32_bf16 v[32:35], v[16:19], v[140:143], v[32:35]
    v_mfma_f32_16x16x32_bf16 v[20:23], v[12:15], v[144:147], v[20:23]
    v_mfma_f32_16x16x32_bf16 v[24:27], v[16:19], v[144:147], v[24:27]
    v_mfma_f32_16x16x32_bf16 v[28:31], v[12:15], v[148:151], v[28:31]
    v_mfma_f32_16x16x32_bf16 v[32:35], v[16:19], v[148:151], v[32:35]
    v_mfma_f32_16x16x32_bf16 v[20:23], v[12:15], v[152:155], v[20:23]
    v_mfma_f32_16x16x32_bf16 v[24:27], v[16:19], v[152:155], v[24:27]
    v_mfma_f32_16x16x32_bf16 v[28:31], v[12:15], v[156:159], v[28:31]
    v_mfma_f32_16x16x32_bf16 v[32:35], v[16:19], v[156:159], v[32:35]
    v_mfma_f32_16x16x32_bf16 v[20:23], v[12:15], v[160:163], v[20:23]
    v_mfma_f32_16x16x32_bf16 v[24:27], v[16:19], v[160:163], v[24:27]
    v_mfma_f32_16x16x32_bf16 v[28:31], v[12:15], v[164:167], v[28:31]
    v_mfma_f32_16x16x32_bf16 v[32:35], v[16:19], v[164:167], v[32:35]
    v_mfma_f32_16x16x32_bf16 v[20:23], v[12:15], v[168:171], v[20:23]
    v_mfma_f32_16x16x32_bf16 v[24:27], v[16:19], v[168:171], v[24:27]
    v_mfma_f32_16x16x32_bf16 v[28:31], v[12:15], v[172:175], v[28:31]
    v_mfma_f32_16x16x32_bf16 v[32:35], v[16:19], v[172:175], v[32:35]
    v_mfma_f32_16x16x32_bf16 v[20:23], v[12:15], v[176:179], v[20:23]
    v_mfma_f32_16x16x32_bf16 v[24:27], v[16:19], v[176:179], v[24:27]
    v_mfma_f32_16x16x32_bf16 v[28:31], v[12:15], v[180:183], v[28:31]
    v_mfma_f32_16x16x32_bf16 v[32:35], v[16:19], v[180:183], v[32:35]
    v_mfma_f32_16x16x32_bf16 v[20:23], v[12:15], v[184:187], v[20:23]
    v_mfma_f32_16x16x32_bf16 v[24:27], v[16:19], v[184:187], v[24:27]
    v_mfma_f32_16x16x32_bf16 v[28:31], v[12:15], v[188:191], v[28:31]
    v_mfma_f32_16x16x32_bf16 v[32:35], v[16:19], v[188:191], v[32:35]
    v_mfma_f32_16x16x32_bf16 v[20:23], v[12:15], v[192:195], v[20:23]
    v_mfma_f32_16x16x32_bf16 v[24:27], v[16:19], v[192:195], v[24:27]
    v_mfma_f32_16x16x32_bf16 v[28:31], v[12:15], v[196:199], v[28:31]
    v_mfma_f32_16x16x32_bf16 v[32:35], v[16:19], v[196:199], v[32:35]
    s_nop 4
    v_cvt_pk_bf16_f32 v44, v20, v21
    v_cvt_pk_bf16_f32 v45, v22, v23
    v_cvt_pk_bf16_f32 v46, v24, v25
    v_cvt_pk_bf16_f32 v47, v26, v27
    v_cvt_pk_bf16_f32 v48, v28, v29
    v_cvt_pk_bf16_f32 v49, v30, v31
    v_cvt_pk_bf16_f32 v50, v32, v33
    v_cvt_pk_bf16_f32 v51, v34, v35
    v_lshlrev_b32 v20, 16, v44
    v_and_b32 v21, 0xffff0000, v44
    v_lshlrev_b32 v22, 16, v45
    v_and_b32 v23, 0xffff0000, v45
    v_lshlrev_b32 v24, 16, v46
    v_and_b32 v25, 0xffff0000, v46
    v_lshlrev_b32 v26, 16, v47
    v_and_b32 v27, 0xffff0000, v47
    v_lshlrev_b32 v28, 16, v48
    v_and_b32 v29, 0xffff0000, v48
    v_lshlrev_b32 v30, 16, v49
    v_and_b32 v31, 0xffff0000, v49
    v_lshlrev_b32 v32, 16, v50
    v_and_b32 v33, 0xffff0000, v50
    v_lshlrev_b32 v34, 16, v51
    v_and_b32 v35, 0xffff0000, v51
    v_add_f32 v36, v20, v21
    v_add_f32 v36, v36, v22
    v_add_f32 v36, v36, v23
    v_add_f32 v36, v36, v24
    v_add_f32 v36, v36, v25
    v_add_f32 v36, v36, v26
    v_add_f32 v36, v36, v27
    v_add_f32 v36, v36, v28
    v_add_f32 v36, v36, v29
    v_add_f32 v36, v36, v30
    v_add_f32 v36, v36, v31
    v_add_f32 v36, v36, v32
    v_add_f32 v36, v36, v33
    v_add_f32 v36, v36, v34
    v_add_f32 v36, v36, v35
    s_nop 1
    v_add_f32_dpp v36, v36, v36 row_ror:8 row_mask:0xf bank_mask:0xf
    v_mov_b32 v37, v36
    s_nop 1
    v_permlane16_swap_b32 v36, v37
    v_add_f32 v36, v36, v37
    v_mov_b32 v37, v36
    s_nop 1
    v_permlane32_swap_b32 v36, v37
    v_add_f32 v36, v36, v37
    ds_write_b32 v9, v36
RR1_S1:
    s_waitcnt lgkmcnt(0)
    s_barrier
    v_mov_b32 v6, 163776
    ds_read_b32 v5, v6 offset:0
    s_waitcnt lgkmcnt(0)
    v_readfirstlane_b32 s21, v5
    s_cmp_eq_u32 s21, -1
    s_cbranch_scc1 RR1_T1
    s_cmp_ge_u32 s21, 256
    s_cbranch_scc1 Lad_45
    s_cmp_ge_u32 s18, s84
    s_cselect_b32 s24, s86, s85
    s_add_u32 s18, s18, s24
    s_cmp_ge_u32 s18, s87
    s_cselect_b32 s18, 256, s18
    s_branch Lad_46
Lad_45:
    s_cmp_ge_u32 s19, s88
    s_cselect_b32 s24, s90, s89
    s_add_u32 s19, s19, s24
    s_cmp_ge_u32 s19, s91
    s_cselect_b32 s19, 256, s19
Lad_46:
    s_lshr_b32 s92, s21, 2
    s_mul_i32 s92, s92, 32768
    s_bfe_u32 s94, s21, 0x10001
    s_lshl_b32 s94, s94, 14
    s_add_u32 s92, s92, s94
    s_and_b32 s94, s21, 1
    s_lshl_b32 s94, s94, 7
    s_add_u32 s92, s92, s94
    s_add_u32 s92, s92, 2097152
    s_lshr_b32 s93, s21, 2
    s_mul_i32 s93, s93, 524288
    s_bfe_u32 s94, s21, 0x10001
    s_lshl_b32 s94, s94, 14
    s_add_u32 s93, s93, s94
    s_and_b32 s94, s21, 1
    s_lshl_b32 s94, s94, 7
    s_add_u32 s93, s93, s94
    s_add_u32 s93, s93, 136282112
    ds_read_b32 v36, v10 offset:0
    ds_read_b32 v37, v10 offset:32
    ds_read_b32 v38, v10 offset:64
    ds_read_b32 v39, v10 offset:96
    s_waitcnt lgkmcnt(0)
    v_add_f32 v36, v36, v37
    v_add_f32 v38, v38, v39
    v_add_f32 v36, v36, v38
    v_mul_f32 v36, 0x3b000000, v36
    v_sub_f32 v20, v20, v36
    v_sub_f32 v21, v21, v36
    v_sub_f32 v22, v22, v36
    v_sub_f32 v23, v23, v36
    v_sub_f32 v24, v24, v36
    v_sub_f32 v25, v25, v36
    v_sub_f32 v26, v26, v36
    v_sub_f32 v27, v27, v36
    v_sub_f32 v28, v28, v36
    v_sub_f32 v29, v29, v36
    v_sub_f32 v30, v30, v36
    v_sub_f32 v31, v31, v36
    v_sub_f32 v32, v32, v36
    v_sub_f32 v33, v33, v36
    v_sub_f32 v34, v34, v36
    v_sub_f32 v35, v35, v36
    v_mul_f32 v36, v20, v20
    v_fmac_f32 v36, v21, v21
    v_fmac_f32 v36, v22, v22
    v_fmac_f32 v36, v23, v23
    v_fmac_f32 v36, v24, v24
    v_fmac_f32 v36, v25, v25
    v_fmac_f32 v36, v26, v26
    v_fmac_f32 v36, v27, v27
    v_fmac_f32 v36, v28, v28
    v_fmac_f32 v36, v29, v29
    v_fmac_f32 v36, v30, v30
    v_fmac_f32 v36, v31, v31
    v_fmac_f32 v36, v32, v32
    v_fmac_f32 v36, v33, v33
    v_fmac_f32 v36, v34, v34
    v_fmac_f32 v36, v35, v35
    s_nop 1
    v_add_f32_dpp v36, v36, v36 row_ror:8 row_mask:0xf bank_mask:0xf
    v_mov_b32 v37, v36
    s_nop 1
    v_permlane16_swap_b32 v36, v37
    v_add_f32 v36, v36, v37
    v_mov_b32 v37, v36
    s_nop 1
    v_permlane32_swap_b32 v36, v37
    v_add_f32 v36, v36, v37
    ds_write_b32 v9, v36 offset:128
    buffer_load_dwordx4 v[64:67], v7, s[4:7], s92 offen offset:0 sc1
    buffer_load_dwordx4 v[68:71], v7, s[4:7], s92 offen offset:2048 sc1
    s_add_u32 s93, s93, 32768
    buffer_load_dwordx4 v[72:75], v7, s[4:7], s93 offen offset:0 sc1
    buffer_load_dwordx4 v[76:79], v7, s[4:7], s93 offen offset:2048 sc1
    s_add_u32 s93, s93, 32768
    buffer_load_dwordx4 v[80:83], v7, s[4:7], s93 offen offset:0 sc1
    buffer_load_dwordx4 v[84:87], v7, s[4:7], s93 offen offset:2048 sc1
    s_add_u32 s93, s93, 32768
    buffer_load_dwordx4 v[88:91], v7, s[4:7], s93 offen offset:0 sc1
    buffer_load_dwordx4 v[92:95], v7, s[4:7], s93 offen offset:2048 sc1
    s_add_u32 s93, s93, 32768
    buffer_load_dwordx4 v[96:99], v7, s[4:7], s93 offen offset:0 sc1
    buffer_load_dwordx4 v[100:103], v7, s[4:7], s93 offen offset:2048 sc1
    s_add_u32 s93, s93, 32768
    buffer_load_dwordx4 v[104:107], v7, s[4:7], s93 offen offset:0 sc1
    buffer_load_dwordx4 v[108:111], v7, s[4:7], s93 offen offset:2048 sc1
    s_add_u32 s93, s93, 32768
    buffer_load_dwordx4 v[112:115], v7, s[4:7], s93 offen offset:0 sc1
    buffer_load_dwordx4 v[116:119], v7, s[4:7], s93 offen offset:2048 sc1
    s_add_u32 s93, s93, 32768
    buffer_load_dwordx4 v[120:123], v7, s[4:7], s93 offen offset:0 sc1
    buffer_load_dwordx4 v[124:127], v7, s[4:7], s93 offen offset:2048 sc1
    s_add_u32 s93, s93, 32768
    buffer_load_dwordx4 v[128:131], v7, s[4:7], s93 offen offset:0 sc1
    buffer_load_dwordx4 v[132:135], v7, s[4:7], s93 offen offset:2048 sc1
    s_add_u32 s93, s93, 32768
    buffer_load_dwordx4 v[136:139], v7, s[4:7], s93 offen offset:0 sc1
    buffer_load_dwordx4 v[140:143], v7, s[4:7], s93 offen offset:2048 sc1
    s_add_u32 s93, s93, 32768
    buffer_load_dwordx4 v[144:147], v7, s[4:7], s93 offen offset:0 sc1
    buffer_load_dwordx4 v[148:151], v7, s[4:7], s93 offen offset:2048 sc1
    s_add_u32 s93, s93, 32768
    buffer_load_dwordx4 v[152:155], v7, s[4:7], s93 offen offset:0 sc1
    buffer_load_dwordx4 v[156:159], v7, s[4:7], s93 offen offset:2048 sc1
    s_add_u32 s93, s93, 32768
    buffer_load_dwordx4 v[160:163], v7, s[4:7], s93 offen offset:0 sc1
    buffer_load_dwordx4 v[164:167], v7, s[4:7], s93 offen offset:2048 sc1
    s_add_u32 s93, s93, 32768
    buffer_load_dwordx4 v[168:171], v7, s[4:7], s93 offen offset:0 sc1
    buffer_load_dwordx4 v[172:175], v7, s[4:7], s93 offen offset:2048 sc1
    s_add_u32 s93, s93, 32768
    buffer_load_dwordx4 v[176:179], v7, s[4:7], s93 offen offset:0 sc1
    buffer_load_dwordx4 v[180:183], v7, s[4:7], s93 offen offset:2048 sc1
    s_add_u32 s93, s93, 32768
    buffer_load_dwordx4 v[184:187], v7, s[4:7], s93 offen offset:0 sc1
    buffer_load_dwordx4 v[188:191], v7, s[4:7], s93 offen offset:2048 sc1
    s_add_u32 s93, s93, 32768
    buffer_load_dwordx4 v[192:195], v7, s[4:7], s93 offen offset:0 sc1
    buffer_load_dwordx4 v[196:199], v7, s[4:7], s93 offen offset:2048 sc1
    s_waitcnt vmcnt(34) lgkmcnt(0)
    s_barrier
    s_branch RR1_T4
RR1_T1:
    ds_read_b32 v36, v10 offset:0
    ds_read_b32 v37, v10 offset:32
    ds_read_b32 v38, v10 offset:64
    ds_read_b32 v39, v10 offset:96
    s_waitcnt lgkmcnt(0)
    v_add_f32 v36, v36, v37
    v_add_f32 v38, v38, v39
    v_add_f32 v36, v36, v38
    v_mul_f32 v36, 0x3b000000, v36
    v_sub_f32 v20, v20, v36
    v_sub_f32 v21, v21, v36
    v_sub_f32 v22, v22, v36
    v_sub_f32 v23, v23, v36
    v_sub_f32 v24, v24, v36
    v_sub_f32 v25, v25, v36
    v_sub_f32 v26, v26, v36
    v_sub_f32 v27, v27, v36
    v_sub_f32 v28, v28, v36
    v_sub_f32 v29, v29, v36
    v_sub_f32 v30, v30, v36
    v_sub_f32 v31, v31, v36
    v_sub_f32 v32, v32, v36
    v_sub_f32 v33, v33, v36
    v_sub_f32 v34, v34, v36
    v_sub_f32 v35, v35, v36
    v_mul_f32 v36, v20, v20
    v_fmac_f32 v36, v21, v21
    v_fmac_f32 v36, v22, v22
    v_fmac_f32 v36, v23, v23
    v_fmac_f32 v36, v24, v24
    v_fmac_f32 v36, v25, v25
    v_fmac_f32 v36, v26, v26
    v_fmac_f32 v36, v27, v27
    v_fmac_f32 v36, v28, v28
    v_fmac_f32 v36, v29, v29
    v_fmac_f32 v36, v30, v30
    v_fmac_f32 v36, v31, v31
    v_fmac_f32 v36, v32, v32
    v_fmac_f32 v36, v33, v33
    v_fmac_f32 v36, v34, v34
    v_fmac_f32 v36, v35, v35
    s_nop 1
    v_add_f32_dpp v36, v36, v36 row_ror:8 row_mask:0xf bank_mask:0xf
    v_mov_b32 v37, v36
    s_nop 1
    v_permlane16_swap_b32 v36, v37
    v_add_f32 v36, v36, v37
    v_mov_b32 v37, v36
    s_nop 1
    v_permlane32_swap_b32 v36, v37
    v_add_f32 v36, v36, v37
    ds_write_b32 v9, v36 offset:128
    s_waitcnt vmcnt(0)
    s_waitcnt lgkmcnt(0)
    s_barrier
RR1_T4:
    s_cmp_eq_u32 s22, -1
    s_cbranch_scc1 Lms_47
    s_cmp_lg_u32 s16, 0
    s_cbranch_scc1 Lsg_48
    s_lshr_b32 s24, s22, 2
    s_lshl_b32 s24, s24, 8
    s_add_u32 s24, s24, 131200
    v_mov_b32 v5, 1
    s_mov_b64 s[38:39], exec
    s_mov_b64 exec, 1
    buffer_atomic_add v5, v2, s[4:7], s24 offen
    s_mov_b64 exec, s[38:39]
Lsg_48:
    s_mov_b32 s22, -1
Lms_47:
    s_min_u32 s25, s18, 255
    s_lshr_b32 s24, s25, 2
    s_lshl_b32 s24, s24, 8
    s_add_u32 s24, s24, 131136
    buffer_load_dword v3, v2, s[4:7], s24 offen sc1
    s_min_u32 s25, s19, 255
    s_lshr_b32 s24, s25, 2
    s_lshl_b32 s24, s24, 8
    s_add_u32 s24, s24, 147520
    buffer_load_dword v4, v2, s[4:7], s24 offen sc1
    ds_read_b32 v36, v10 offset:128
    ds_read_b32 v37, v10 offset:160
    ds_read_b32 v38, v10 offset:192
    ds_read_b32 v39, v10 offset:224
    s_waitcnt lgkmcnt(0)
    v_add_f32 v36, v36, v37
    v_add_f32 v38, v38, v39
    v_add_f32 v36, v36, v38
    v_mov_b32 v37, 0x3727c5ac
    v_fmac_f32 v37, 0x3b000000, v36
    v_rsq_f32 v36, v37
    s_nop 0
    v_mul_f32 v20, v20, v36
    v_mul_f32 v21, v21, v36
    v_mul_f32 v22, v22, v36
    v_mul_f32 v23, v23, v36
    v_mul_f32 v24, v24, v36
    v_mul_f32 v25, v25, v36
    v_mul_f32 v26, v26, v36
    v_mul_f32 v27, v27, v36
    v_mul_f32 v28, v28, v36
    v_mul_f32 v29, v29, v36
    v_mul_f32 v30, v30, v36
    v_mul_f32 v31, v31, v36
    v_mul_f32 v32, v32, v36
    v_mul_f32 v33, v33, v36
    v_mul_f32 v34, v34, v36
    v_mul_f32 v35, v35, v36
    v_cvt_pk_bf16_f32 v52, v20, v21
    v_cvt_pk_bf16_f32 v53, v22, v23
    v_cvt_pk_bf16_f32 v54, v24, v25
    v_cvt_pk_bf16_f32 v55, v26, v27
    v_cvt_pk_bf16_f32 v56, v28, v29
    v_cvt_pk_bf16_f32 v57, v30, v31
    v_cvt_pk_bf16_f32 v58, v32, v33
    v_cvt_pk_bf16_f32 v59, v34, v35
RR1_T6:
    s_lshr_b32 s24, s20, 2
    s_mul_i32 s24, s24, 32768
    s_bfe_u32 s25, s20, 0x10001
    s_lshl_b32 s25, s25, 14
    s_add_u32 s24, s24, s25
    s_and_b32 s25, s20, 1
    s_lshl_b32 s25, s25, 7
    s_add_u32 s24, s24, s25
    s_add_u32 s25, s24, 14680064
    buffer_store_dwordx4 v[52:55], v7, s[4:7], s25 offen offset:0 sc1
    buffer_store_dwordx4 v[56:59], v7, s[4:7], s25 offen offset:2048 sc1
    s_add_u32 s25, s24, 10485760
    buffer_store_dwordx4 v[44:47], v7, s[4:7], s25 offen offset:0 sc1
    buffer_store_dwordx4 v[48:51], v7, s[4:7], s25 offen offset:2048 sc1
    s_mov_b32 s22, s20
    s_mov_b32 s20, s21
    s_waitcnt vmcnt(4)
    s_cmp_lg_u32 s21, -1
    s_nop 5
    s_cbranch_scc1 RR1_TOP
    s_cmp_lg_u32 s16, 0
    s_cbranch_scc1 Lw0_49
    v_readfirstlane_b32 s25, v3
    v_readfirstlane_b32 s26, v4
    s_mov_b32 s24, -1
    s_cmp_ge_u32 s19, 256
    s_cbranch_scc1 Lsk_50
    s_cmp_lg_u32 s26, 16
    s_cbranch_scc1 Lsk_50
    s_add_u32 s24, s19, 256
Lsk_50:
    s_cmp_ge_u32 s18, 256
    s_cbranch_scc1 Lsk_51
    s_cmp_lg_u32 s25, 16
    s_cbranch_scc1 Lsk_51
    s_add_u32 s24, s18, 0
Lsk_51:
    v_mov_b32 v5, s24
    v_mov_b32 v6, 163776
    ds_write_b32 v6, v5 offset:8
Lw0_49:
    s_waitcnt lgkmcnt(0)
    s_barrier
    v_mov_b32 v6, 163776
    ds_read_b32 v5, v6 offset:8
    s_waitcnt lgkmcnt(0)
    v_readfirstlane_b32 s20, v5
    s_cmp_lg_u32 s20, -1
    s_cbranch_scc1 RR1_GO
    s_waitcnt vmcnt(0)
    s_barrier
    s_cmp_lg_u32 s16, 0
    s_cbranch_scc1 Lsg_52
    s_lshr_b32 s24, s22, 2
    s_lshl_b32 s24, s24, 8
    s_add_u32 s24, s24, 131200
    v_mov_b32 v5, 1
    s_mov_b64 s[38:39], exec
    s_mov_b64 exec, 1
    buffer_atomic_add v5, v2, s[4:7], s24 offen
    s_mov_b64 exec, s[38:39]
Lsg_52:
    s_mov_b32 s22, -1
    s_branch RR1_B1
E_R1:
    s_endpgm
J_R2:
    s_load_dwordx2 s[8:9], s[0:1], 80
    s_mov_b32 s10, 2097152
    s_mov_b32 s11, 0x00020000
    s_waitcnt lgkmcnt(0)
    v_lshrrev_b32 v5, 4, v1
    v_bfe_u32 v6, v1, 3, 1
    v_and_b32 v10, 7, v1
    v_lshlrev_b32 v7, 8, v5
    v_lshl_add_u32 v7, v6, 10, v7
    v_lshl_add_u32 v7, v10, 4, v7
    s_lshl_b32 s24, s16, 12
    v_add_u32 v7, s24, v7
    v_lshlrev_b32 v8, 6, v5
    v_lshl_add_u32 v8, v6, 4, v8
    v_lshl_add_u32 v8, v10, 10, v8
    s_lshl_b32 s24, s16, 8
    v_add_u32 v8, s24, v8
    v_lshlrev_b32 v10, 2, v10
    s_lshl_b32 s24, s16, 5
    v_add_u32 v9, s24, v10
    v_lshrrev_b32 v5, 4, v1
    v_bfe_u32 v6, v1, 2, 2
    v_cmp_eq_u32 vcc, v5, v6
    v_and_b32 v5, 1, v1
    v_lshlrev_b32 v5, 4, v5
    v_mov_b32 v6, 0x3f80
    v_lshlrev_b32 v5, v5, v6
    v_cndmask_b32 v5, 0, v5, vcc
    v_and_b32 v6, 2, v1
    v_cmp_eq_u32 vcc, 0, v6
    s_nop 1
    v_cndmask_b32 v12, 0, v5, vcc
    v_cndmask_b32 v13, v5, 0, vcc
    v_mov_b32 v14, 0
    v_mov_b32 v15, 0
    v_mov_b32 v16, 0
    v_mov_b32 v17, 0
    v_mov_b32 v18, v12
    v_mov_b32 v19, v13
    s_cmp_lg_u32 s95, 0
    s_cbranch_scc1 Lsc_54
    s_mov_b32 s18, 0
    s_mov_b32 s84, 0
    s_mov_b32 s85, 12
    s_mov_b32 s86, 12
    s_mov_b32 s87, 256
    s_mov_b32 s19, 276
    s_mov_b32 s88, 0
    s_mov_b32 s89, 24
    s_mov_b32 s90, 24
    s_mov_b32 s91, 256
    s_branch Lsc_53
Lsc_54:
    s_cmp_lg_u32 s95, 1
    s_cbranch_scc1 Lsc_55
    s_mov_b32 s18, 1
    s_mov_b32 s84, 0
    s_mov_b32 s85, 12
    s_mov_b32 s86, 12
    s_mov_b32 s87, 256
    s_mov_b32 s19, 277
    s_mov_b32 s88, 0
    s_mov_b32 s89, 24
    s_mov_b32 s90, 24
    s_mov_b32 s91, 256
    s_branch Lsc_53
Lsc_55:
    s_cmp_lg_u32 s95, 2
    s_cbranch_scc1 Lsc_56
    s_mov_b32 s18, 2
    s_mov_b32 s84, 0
    s_mov_b32 s85, 12
    s_mov_b32 s86, 12
    s_mov_b32 s87, 256
    s_mov_b32 s19, 278
    s_mov_b32 s88, 0
    s_mov_b32 s89, 24
    s_mov_b32 s90, 24
    s_mov_b32 s91, 256
    s_branch Lsc_53
Lsc_56:
    s_cmp_lg_u32 s95, 3
    s_cbranch_scc1 Lsc_57
    s_mov_b32 s18, 3
    s_mov_b32 s84, 0
    s_mov_b32 s85, 12
    s_mov_b32 s86, 12
    s_mov_b32 s87, 256
    s_mov_b32 s19, 279
    s_mov_b32 s88, 0
    s_mov_b32 s89, 24
    s_mov_b32 s90, 24
    s_mov_b32 s91, 256
    s_branch Lsc_53
Lsc_57:
    s_cmp_lg_u32 s95, 4
    s_cbranch_scc1 Lsc_58
    s_mov_b32 s18, 4
    s_mov_b32 s84, 0
    s_mov_b32 s85, 12
    s_mov_b32 s86, 12
    s_mov_b32 s87, 256
    s_mov_b32 s19, 280
    s_mov_b32 s88, 0
    s_mov_b32 s89, 24
    s_mov_b32 s90, 24
    s_mov_b32 s91, 256
    s_branch Lsc_53
Lsc_58:
    s_cmp_lg_u32 s95, 5
    s_cbranch_scc1 Lsc_59
    s_mov_b32 s18, 5
    s_mov_b32 s84, 0
    s_mov_b32 s85, 12
    s_mov_b32 s86, 12
    s_mov_b32 s87, 256
    s_mov_b32 s19, 281
    s_mov_b32 s88, 0
    s_mov_b32 s89, 24
    s_mov_b32 s90, 24
    s_mov_b32 s91, 256
    s_branch Lsc_53
Lsc_59:
    s_cmp_lg_u32 s95, 6
    s_cbranch_scc1 Lsc_60
    s_mov_b32 s18, 6
    s_mov_b32 s84, 0
    s_mov_b32 s85, 12
    s_mov_b32 s86, 12
    s_mov_b32 s87, 256
    s_mov_b32 s19, 282
    s_mov_b32 s88, 0
    s_mov_b32 s89, 24
    s_mov_b32 s90, 24
    s_mov_b32 s91, 256
    s_branch Lsc_53
Lsc_60:
    s_cmp_lg_u32 s95, 7
    s_cbranch_scc1 Lsc_61
    s_mov_b32 s18, 7
    s_mov_b32 s84, 0
    s_mov_b32 s85, 12
    s_mov_b32 s86, 12
    s_mov_b32 s87, 256
    s_mov_b32 s19, 283
    s_mov_b32 s88, 0
    s_mov_b32 s89, 24
    s_mov_b32 s90, 24
    s_mov_b32 s91, 256
    s_branch Lsc_53
Lsc_61:
    s_cmp_lg_u32 s95, 8
    s_cbranch_scc1 Lsc_62
    s_mov_b32 s18, 8
    s_mov_b32 s84, 0
    s_mov_b32 s85, 12
    s_mov_b32 s86, 12
    s_mov_b32 s87, 256
    s_mov_b32 s19, 284
    s_mov_b32 s88, 0
    s_mov_b32 s89, 24
    s_mov_b32 s90, 24
    s_mov_b32 s91, 256
    s_branch Lsc_53
Lsc_62:
    s_cmp_lg_u32 s95, 9
    s_cbranch_scc1 Lsc_63
    s_mov_b32 s18, 9
    s_mov_b32 s84, 0
    s_mov_b32 s85, 12
    s_mov_b32 s86, 12
    s_mov_b32 s87, 256
    s_mov_b32 s19, 285
    s_mov_b32 s88, 0
    s_mov_b32 s89, 24
    s_mov_b32 s90, 24
    s_mov_b32 s91, 256
    s_branch Lsc_53
Lsc_63:
    s_cmp_lg_u32 s95, 10
    s_cbranch_scc1 Lsc_64
    s_mov_b32 s18, 10
    s_mov_b32 s84, 0
    s_mov_b32 s85, 12
    s_mov_b32 s86, 12
    s_mov_b32 s87, 256
    s_mov_b32 s19, 286
    s_mov_b32 s88, 0
    s_mov_b32 s89, 24
    s_mov_b32 s90, 24
    s_mov_b32 s91, 256
    s_branch Lsc_53
Lsc_64:
    s_cmp_lg_u32 s95, 11
    s_cbranch_scc1 Lsc_65
    s_mov_b32 s18, 11
    s_mov_b32 s84, 0
    s_mov_b32 s85, 12
    s_mov_b32 s86, 12
    s_mov_b32 s87, 256
    s_mov_b32 s19, 287
    s_mov_b32 s88, 0
    s_mov_b32 s89, 24
    s_mov_b32 s90, 24
    s_mov_b32 s91, 256
    s_branch Lsc_53
Lsc_65:
    s_cmp_lg_u32 s95, 12
    s_cbranch_scc1 Lsc_66
    s_mov_b32 s18, 256
    s_mov_b32 s84, 0
    s_mov_b32 s85, 1
    s_mov_b32 s86, 1
    s_mov_b32 s87, 256
    s_mov_b32 s19, 0
    s_mov_b32 s88, 264
    s_mov_b32 s89, 12
    s_mov_b32 s90, 24
    s_mov_b32 s91, 256
    s_branch Lsc_53
Lsc_66:
    s_cmp_lg_u32 s95, 13
    s_cbranch_scc1 Lsc_67
    s_mov_b32 s18, 256
    s_mov_b32 s84, 0
    s_mov_b32 s85, 1
    s_mov_b32 s86, 1
    s_mov_b32 s87, 256
    s_mov_b32 s19, 1
    s_mov_b32 s88, 264
    s_mov_b32 s89, 12
    s_mov_b32 s90, 24
    s_mov_b32 s91, 256
    s_branch Lsc_53
Lsc_67:
    s_cmp_lg_u32 s95, 14
    s_cbranch_scc1 Lsc_68
    s_mov_b32 s18, 256
    s_mov_b32 s84, 0
    s_mov_b32 s85, 1
    s_mov_b32 s86, 1
    s_mov_b32 s87, 256
    s_mov_b32 s19, 2
    s_mov_b32 s88, 264
    s_mov_b32 s89, 12
    s_mov_b32 s90, 24
    s_mov_b32 s91, 256
    s_branch Lsc_53
Lsc_68:
    s_cmp_lg_u32 s95, 15
    s_cbranch_scc1 Lsc_69
    s_mov_b32 s18, 256
    s_mov_b32 s84, 0
    s_mov_b32 s85, 1
    s_mov_b32 s86, 1
    s_mov_b32 s87, 256
    s_mov_b32 s19, 3
    s_mov_b32 s88, 264
    s_mov_b32 s89, 12
    s_mov_b32 s90, 24
    s_mov_b32 s91, 256
    s_branch Lsc_53
Lsc_69:
    s_cmp_lg_u32 s95, 16
    s_cbranch_scc1 Lsc_70
    s_mov_b32 s18, 256
    s_mov_b32 s84, 0
    s_mov_b32 s85, 1
    s_mov_b32 s86, 1
    s_mov_b32 s87, 256
    s_mov_b32 s19, 4
    s_mov_b32 s88, 264
    s_mov_b32 s89, 12
    s_mov_b32 s90, 24
    s_mov_b32 s91, 256
    s_branch Lsc_53
Lsc_70:
    s_cmp_lg_u32 s95, 17
    s_cbranch_scc1 Lsc_71
    s_mov_b32 s18, 256
    s_mov_b32 s84, 0
    s_mov_b32 s85, 1
    s_mov_b32 s86, 1
    s_mov_b32 s87, 256
    s_mov_b32 s19, 5
    s_mov_b32 s88, 264
    s_mov_b32 s89, 12
    s_mov_b32 s90, 24
    s_mov_b32 s91, 256
    s_branch Lsc_53
Lsc_71:
    s_cmp_lg_u32 s95, 18
    s_cbranch_scc1 Lsc_72
    s_mov_b32 s18, 256
    s_mov_b32 s84, 0
    s_mov_b32 s85, 1
    s_mov_b32 s86, 1
    s_mov_b32 s87, 256
    s_mov_b32 s19, 6
    s_mov_b32 s88, 264
    s_mov_b32 s89, 12
    s_mov_b32 s90, 24
    s_mov_b32 s91, 256
    s_branch Lsc_53
Lsc_72:
    s_cmp_lg_u32 s95, 19
    s_cbranch_scc1 Lsc_73
    s_mov_b32 s18, 256
    s_mov_b32 s84, 0
    s_mov_b32 s85, 1
    s_mov_b32 s86, 1
    s_mov_b32 s87, 256
    s_mov_b32 s19, 7
    s_mov_b32 s88, 264
    s_mov_b32 s89, 12
    s_mov_b32 s90, 24
    s_mov_b32 s91, 256
    s_branch Lsc_53
Lsc_73:
    s_cmp_lg_u32 s95, 20
    s_cbranch_scc1 Lsc_74
    s_mov_b32 s18, 256
    s_mov_b32 s84, 0
    s_mov_b32 s85, 1
    s_mov_b32 s86, 1
    s_mov_b32 s87, 256
    s_mov_b32 s19, 8
    s_mov_b32 s88, 264
    s_mov_b32 s89, 12
    s_mov_b32 s90, 24
    s_mov_b32 s91, 256
    s_branch Lsc_53
Lsc_74:
    s_cmp_lg_u32 s95, 21
    s_cbranch_scc1 Lsc_75
    s_mov_b32 s18, 256
    s_mov_b32 s84, 0
    s_mov_b32 s85, 1
    s_mov_b32 s86, 1
    s_mov_b32 s87, 256
    s_mov_b32 s19, 9
    s_mov_b32 s88, 264
    s_mov_b32 s89, 12
    s_mov_b32 s90, 24
    s_mov_b32 s91, 256
    s_branch Lsc_53
Lsc_75:
    s_cmp_lg_u32 s95, 22
    s_cbranch_scc1 Lsc_76
    s_mov_b32 s18, 256
    s_mov_b32 s84, 0
    s_mov_b32 s85, 1
    s_mov_b32 s86, 1
    s_mov_b32 s87, 256
    s_mov_b32 s19, 10
    s_mov_b32 s88, 264
    s_mov_b32 s89, 12
    s_mov_b32 s90, 24
    s_mov_b32 s91, 256
    s_branch Lsc_53
Lsc_76:
    s_cmp_lg_u32 s95, 23
    s_cbranch_scc1 Lsc_77
    s_mov_b32 s18, 256
    s_mov_b32 s84, 0
    s_mov_b32 s85, 1
    s_mov_b32 s86, 1
    s_mov_b32 s87, 256
    s_mov_b32 s19, 11
    s_mov_b32 s88, 264
    s_mov_b32 s89, 12
    s_mov_b32 s90, 24
    s_mov_b32 s91, 256
    s_branch Lsc_53
Lsc_77:
Lsc_53:
    s_cmp_lg_u32 s16, 0
    s_cbranch_scc1 RR2_DW
    v_and_b32 v4, 63, v0
    v_lshlrev_b32 v4, 2, v4
Ldw_78:
    buffer_load_dword v3, v4, s[12:15], 0 offen sc1
    s_waitcnt vmcnt(0)
    s_mov_b32 s24, 0
    v_readlane_b32 s25, v3, 8
    s_add_u32 s24, s24, s25
    v_readlane_b32 s25, v3, 24
    s_add_u32 s24, s24, s25
    v_readlane_b32 s25, v3, 40
    s_add_u32 s24, s24, s25
    v_readlane_b32 s25, v3, 56
    s_add_u32 s24, s24, s25
    s_cmp_ge_u32 s24, 96
    s_cbranch_scc1 Ldw_79
    s_sleep 4
    s_memrealtime s[36:37]
    s_waitcnt lgkmcnt(0)
    s_sub_u32 s36, s36, s28
    s_cmp_gt_u32 s36, 3000000
    s_cbranch_scc1 RR2_DW
    s_branch Ldw_78
Ldw_79:
RR2_DW:
    s_mov_b32 s22, -1
    s_mov_b32 s20, -1
    s_mov_b32 s30, 0
RR2_B1:
    s_min_u32 s24, s18, s19
    s_cmp_ge_u32 s24, 256
    s_cbranch_scc1 E_R2
    s_cmp_lg_u32 s16, 0
    s_cbranch_scc1 RR2_B3
RR2_B2:
    s_min_u32 s25, s18, 255
    s_lshr_b32 s24, s25, 2
    s_lshl_b32 s24, s24, 8
    s_add_u32 s24, s24, 131264
    buffer_load_dword v3, v2, s[4:7], s24 offen sc1
    s_min_u32 s25, s19, 255
    s_lshr_b32 s24, s25, 2
    s_lshl_b32 s24, s24, 8
    s_add_u32 s24, s24, 147648
    buffer_load_dword v4, v2, s[4:7], s24 offen sc1
    s_waitcnt vmcnt(0)
    v_readfirstlane_b32 s25, v3
    v_readfirstlane_b32 s26, v4
    s_mov_b32 s24, -1
    s_cmp_ge_u32 s19, 256
    s_cbranch_scc1 Lsk_80
    s_cmp_lg_u32 s26, 11
    s_cbranch_scc1 Lsk_80
    s_add_u32 s24, s19, 256
Lsk_80:
    s_cmp_ge_u32 s18, 256
    s_cbranch_scc1 Lsk_81
    s_cmp_lg_u32 s25, 11
    s_cbranch_scc1 Lsk_81
    s_add_u32 s24, s18, 0
Lsk_81:
    s_cmp_lg_u32 s24, -1
    s_cbranch_scc1 RR2_B2x
    s_sleep 2
    s_memrealtime s[36:37]
    s_waitcnt lgkmcnt(0)
    s_sub_u32 s36, s36, s28
    s_cmp_gt_u32 s36, 3000000
    s_cbranch_scc1 RR2_B2x
    s_branch RR2_B2
RR2_B2x:
    v_mov_b32 v5, s24
    v_mov_b32 v6, 163776
    ds_write_b32 v6, v5 offset:8
    s_waitcnt lgkmcnt(0)
RR2_B3:
    s_barrier
    v_mov_b32 v6, 163776
    ds_read_b32 v5, v6 offset:8
    s_waitcnt lgkmcnt(0)
    v_readfirstlane_b32 s20, v5
    s_cmp_eq_u32 s20, -1
    s_cbranch_scc1 E_R2
RR2_GO:
    s_cmp_ge_u32 s20, 256
    s_cbranch_scc1 Lad_82
    s_cmp_ge_u32 s18, s84
    s_cselect_b32 s24, s86, s85
    s_add_u32 s18, s18, s24
    s_cmp_ge_u32 s18, s87
    s_cselect_b32 s18, 256, s18
    s_branch Lad_83
Lad_82:
    s_cmp_ge_u32 s19, s88
    s_cselect_b32 s24, s90, s89
    s_add_u32 s19, s19, s24
    s_cmp_ge_u32 s19, s91
    s_cselect_b32 s19, 256, s19
Lad_83:
    s_min_u32 s25, s18, 255
    s_lshr_b32 s24, s25, 2
    s_lshl_b32 s24, s24, 8
    s_add_u32 s24, s24, 131264
    buffer_load_dword v3, v2, s[4:7], s24 offen sc1
    s_min_u32 s25, s19, 255
    s_lshr_b32 s24, s25, 2
    s_lshl_b32 s24, s24, 8
    s_add_u32 s24, s24, 147648
    buffer_load_dword v4, v2, s[4:7], s24 offen sc1
    s_lshr_b32 s92, s20, 2
    s_mul_i32 s92, s92, 32768
    s_bfe_u32 s94, s20, 0x10001
    s_lshl_b32 s94, s94, 14
    s_add_u32 s92, s92, s94
    s_and_b32 s94, s20, 1
    s_lshl_b32 s94, s94, 7
    s_add_u32 s92, s92, s94
    s_add_u32 s92, s92, 10485760
    s_lshr_b32 s93, s20, 2
    s_mul_i32 s93, s93, 360448
    s_bfe_u32 s94, s20, 0x10001
    s_lshl_b32 s94, s94, 14
    s_add_u32 s93, s93, s94
    s_and_b32 s94, s20, 1
    s_lshl_b32 s94, s94, 7
    s_add_u32 s93, s93, s94
    s_add_u32 s93, s93, 203390976
    buffer_load_dwordx4 v[64:67], v7, s[4:7], s92 offen offset:0 sc1
    buffer_load_dwordx4 v[68:71], v7, s[4:7], s92 offen offset:2048 sc1
    s_add_u32 s93, s93, 32768
    buffer_load_dwordx4 v[72:75], v7, s[4:7], s93 offen offset:0 sc1
    buffer_load_dwordx4 v[76:79], v7, s[4:7], s93 offen offset:2048 sc1
    s_add_u32 s93, s93, 32768
    buffer_load_dwordx4 v[80:83], v7, s[4:7], s93 offen offset:0 sc1
    buffer_load_dwordx4 v[84:87], v7, s[4:7], s93 offen offset:2048 sc1
    s_add_u32 s93, s93, 32768
    buffer_load_dwordx4 v[88:91], v7, s[4:7], s93 offen offset:0 sc1
    buffer_load_dwordx4 v[92:95], v7, s[4:7], s93 offen offset:2048 sc1
    s_cmp_eq_u32 s22, -1
    s_cbranch_scc1 RR2_G1
    s_waitcnt vmcnt(10)
    s_barrier
    s_cmp_lg_u32 s16, 0
    s_cbranch_scc1 Lsg_84
    s_cmp_ge_u32 s22, 256
    s_cbranch_scc1 Lsg_84
    s_lshr_b32 s24, s22, 2
    s_lshl_b32 s24, s24, 8
    s_add_u32 s24, s24, 147456
    v_mov_b32 v5, 1
    s_mov_b64 s[38:39], exec
    s_mov_b64 exec, 1
    buffer_atomic_add v5, v2, s[4:7], s24 offen
    s_mov_b64 exec, s[38:39]
Lsg_84:
    s_mov_b32 s22, -1
RR2_G1:
    s_add_u32 s93, s93, 32768
    buffer_load_dwordx4 v[96:99], v7, s[4:7], s93 offen offset:0 sc1
    buffer_load_dwordx4 v[100:103], v7, s[4:7], s93 offen offset:2048 sc1
    s_add_u32 s93, s93, 32768
    buffer_load_dwordx4 v[104:107], v7, s[4:7], s93 offen offset:0 sc1
    buffer_load_dwordx4 v[108:111], v7, s[4:7], s93 offen offset:2048 sc1
    s_add_u32 s93, s93, 32768
    buffer_load_dwordx4 v[112:115], v7, s[4:7], s93 offen offset:0 sc1
    buffer_load_dwordx4 v[116:119], v7, s[4:7], s93 offen offset:2048 sc1
    s_add_u32 s93, s93, 32768
    buffer_load_dwordx4 v[120:123], v7, s[4:7], s93 offen offset:0 sc1
    buffer_load_dwordx4 v[124:127], v7, s[4:7], s93 offen offset:2048 sc1
    s_add_u32 s93, s93, 32768
    buffer_load_dwordx4 v[128:131], v7, s[4:7], s93 offen offset:0 sc1
    buffer_load_dwordx4 v[132:135], v7, s[4:7], s93 offen offset:2048 sc1
    s_add_u32 s93, s93, 32768
    buffer_load_dwordx4 v[136:139], v7, s[4:7], s93 offen offset:0 sc1
    buffer_load_dwordx4 v[140:143], v7, s[4:7], s93 offen offset:2048 sc1
    s_add_u32 s93, s93, 32768
    buffer_load_dwordx4 v[144:147], v7, s[4:7], s93 offen offset:0 sc1
    buffer_load_dwordx4 v[148:151], v7, s[4:7], s93 offen offset:2048 sc1
    s_add_u32 s93, s93, 32768
    buffer_load_dwordx4 v[152:155], v7, s[4:7], s93 offen offset:0 sc1
    buffer_load_dwordx4 v[156:159], v7, s[4:7], s93 offen offset:2048 sc1
    s_waitcnt vmcnt(24)
    s_xor_b32 s30, s30, 1
    s_cmp_lg_u32 s16, 0
    s_cbranch_scc1 Lw0_85
    v_readfirstlane_b32 s25, v3
    v_readfirstlane_b32 s26, v4
    s_mov_b32 s24, -1
    s_cmp_ge_u32 s19, 256
    s_cbranch_scc1 Lsk_86
    s_cmp_lg_u32 s26, 11
    s_cbranch_scc1 Lsk_86
    s_add_u32 s24, s19, 256
Lsk_86:
    s_cmp_ge_u32 s18, 256
    s_cbranch_scc1 Lsk_87
    s_cmp_lg_u32 s25, 11
    s_cbranch_scc1 Lsk_87
    s_add_u32 s24, s18, 0
Lsk_87:
    v_mov_b32 v5, s24
    v_mov_b32 v6, 163776
    ds_write_b32 v6, v5 offset:0
Lw0_85:
    s_waitcnt vmcnt(23)
    v_mfma_f32_16x16x32_bf16 v[20:23], v[12:15], v[64:67], 0
    v_mfma_f32_16x16x32_bf16 v[24:27], v[16:19], v[64:67], 0
    s_waitcnt vmcnt(22)
    v_mfma_f32_16x16x32_bf16 v[28:31], v[12:15], v[68:71], 0
    v_mfma_f32_16x16x32_bf16 v[32:35], v[16:19], v[68:71], 0
    s_waitcnt vmcnt(21)
    v_mfma_f32_16x16x32_bf16 v[20:23], v[12:15], v[72:75], v[20:23]
    v_mfma_f32_16x16x32_bf16 v[24:27], v[16:19], v[72:75], v[24:27]
    s_waitcnt vmcnt(20)
    v_mfma_f32_16x16x32_bf16 v[28:31], v[12:15], v[76:79], v[28:31]
    v_mfma_f32_16x16x32_bf16 v[32:35], v[16:19], v[76:79], v[32:35]
    s_waitcnt vmcnt(19)
    v_mfma_f32_16x16x32_bf16 v[20:23], v[12:15], v[80:83], v[20:23]
    v_mfma_f32_16x16x32_bf16 v[24:27], v[16:19], v[80:83], v[24:27]
    s_waitcnt vmcnt(18)
    v_mfma_f32_16x16x32_bf16 v[28:31], v[12:15], v[84:87], v[28:31]
    v_mfma_f32_16x16x32_bf16 v[32:35], v[16:19], v[84:87], v[32:35]
    s_waitcnt vmcnt(17)
    v_mfma_f32_16x16x32_bf16 v[20:23], v[12:15], v[88:91], v[20:23]
    v_mfma_f32_16x16x32_bf16 v[24:27], v[16:19], v[88:91], v[24:27]
    s_waitcnt vmcnt(16)
    v_mfma_f32_16x16x32_bf16 v[28:31], v[12:15], v[92:95], v[28:31]
    v_mfma_f32_16x16x32_bf16 v[32:35], v[16:19], v[92:95], v[32:35]
    s_waitcnt vmcnt(15)
    v_mfma_f32_16x16x32_bf16 v[20:23], v[12:15], v[96:99], v[20:23]
    v_mfma_f32_16x16x32_bf16 v[24:27], v[16:19], v[96:99], v[24:27]
    s_waitcnt vmcnt(14)
    v_mfma_f32_16x16x32_bf16 v[28:31], v[12:15], v[100:103], v[28:31]
    v_mfma_f32_16x16x32_bf16 v[32:35], v[16:19], v[100:103], v[32:35]
    s_waitcnt vmcnt(13)
    v_mfma_f32_16x16x32_bf16 v[20:23], v[12:15], v[104:107], v[20:23]
    v_mfma_f32_16x16x32_bf16 v[24:27], v[16:19], v[104:107], v[24:27]
    s_waitcnt vmcnt(12)
    v_mfma_f32_16x16x32_bf16 v[28:31], v[12:15], v[108:111], v[28:31]
    v_mfma_f32_16x16x32_bf16 v[32:35], v[16:19], v[108:111], v[32:35]
    s_waitcnt vmcnt(11)
    v_mfma_f32_16x16x32_bf16 v[20:23], v[12:15], v[112:115], v[20:23]
    v_mfma_f32_16x16x32_bf16 v[24:27], v[16:19], v[112:115], v[24:27]
    s_waitcnt vmcnt(10)
    v_mfma_f32_16x16x32_bf16 v[28:31], v[12:15], v[116:119], v[28:31]
    v_mfma_f32_16x16x32_bf16 v[32:35], v[16:19], v[116:119], v[32:35]
    s_waitcnt vmcnt(9)
    v_mfma_f32_16x16x32_bf16 v[20:23], v[12:15], v[120:123], v[20:23]
    v_mfma_f32_16x16x32_bf16 v[24:27], v[16:19], v[120:123], v[24:27]
    s_waitcnt vmcnt(8)
    v_mfma_f32_16x16x32_bf16 v[28:31], v[12:15], v[124:127], v[28:31]
    v_mfma_f32_16x16x32_bf16 v[32:35], v[16:19], v[124:127], v[32:35]
    s_waitcnt vmcnt(7)
    v_mfma_f32_16x16x32_bf16 v[20:23], v[12:15], v[128:131], v[20:23]
    v_mfma_f32_16x16x32_bf16 v[24:27], v[16:19], v[128:131], v[24:27]
    s_waitcnt vmcnt(6)
    v_mfma_f32_16x16x32_bf16 v[28:31], v[12:15], v[132:135], v[28:31]
    v_mfma_f32_16x16x32_bf16 v[32:35], v[16:19], v[132:135], v[32:35]
    s_waitcnt vmcnt(5)
    v_mfma_f32_16x16x32_bf16 v[20:23], v[12:15], v[136:139], v[20:23]
    v_mfma_f32_16x16x32_bf16 v[24:27], v[16:19], v[136:139], v[24:27]
    s_waitcnt vmcnt(4)
    v_mfma_f32_16x16x32_bf16 v[28:31], v[12:15], v[140:143], v[28:31]
    v_mfma_f32_16x16x32_bf16 v[32:35], v[16:19], v[140:143], v[32:35]
    s_waitcnt vmcnt(3)
    v_mfma_f32_16x16x32_bf16 v[20:23], v[12:15], v[144:147], v[20:23]
    v_mfma_f32_16x16x32_bf16 v[24:27], v[16:19], v[144:147], v[24:27]
    s_waitcnt vmcnt(2)
    v_mfma_f32_16x16x32_bf16 v[28:31], v[12:15], v[148:151], v[28:31]
    v_mfma_f32_16x16x32_bf16 v[32:35], v[16:19], v[148:151], v[32:35]
    s_waitcnt vmcnt(1)
    v_mfma_f32_16x16x32_bf16 v[20:23], v[12:15], v[152:155], v[20:23]
    v_mfma_f32_16x16x32_bf16 v[24:27], v[16:19], v[152:155], v[24:27]
    s_waitcnt vmcnt(0)
    v_mfma_f32_16x16x32_bf16 v[28:31], v[12:15], v[156:159], v[28:31]
    v_mfma_f32_16x16x32_bf16 v[32:35], v[16:19], v[156:159], v[32:35]
    s_nop 3
    v_cvt_pk_bf16_f32 v44, v20, v21
    v_cvt_pk_bf16_f32 v45, v22, v23
    v_cvt_pk_bf16_f32 v46, v24, v25
    v_cvt_pk_bf16_f32 v47, v26, v27
    v_cvt_pk_bf16_f32 v48, v28, v29
    v_cvt_pk_bf16_f32 v49, v30, v31
    v_cvt_pk_bf16_f32 v50, v32, v33
    v_cvt_pk_bf16_f32 v51, v34, v35
    v_lshlrev_b32 v20, 16, v44
    v_and_b32 v21, 0xffff0000, v44
    v_lshlrev_b32 v22, 16, v45
    v_and_b32 v23, 0xffff0000, v45
    v_lshlrev_b32 v24, 16, v46
    v_and_b32 v25, 0xffff0000, v46
    v_lshlrev_b32 v26, 16, v47
    v_and_b32 v27, 0xffff0000, v47
    v_lshlrev_b32 v28, 16, v48
    v_and_b32 v29, 0xffff0000, v48
    v_lshlrev_b32 v30, 16, v49
    v_and_b32 v31, 0xffff0000, v49
    v_lshlrev_b32 v32, 16, v50
    v_and_b32 v33, 0xffff0000, v50
    v_lshlrev_b32 v34, 16, v51
    v_and_b32 v35, 0xffff0000, v51
    v_add_f32 v36, v20, v21
    v_add_f32 v36, v36, v22
    v_add_f32 v36, v36, v23
    v_add_f32 v36, v36, v24
    v_add_f32 v36, v36, v25
    v_add_f32 v36, v36, v26
    v_add_f32 v36, v36, v27
    v_add_f32 v36, v36, v28
    v_add_f32 v36, v36, v29
    v_add_f32 v36, v36, v30
    v_add_f32 v36, v36, v31
    v_add_f32 v36, v36, v32
    v_add_f32 v36, v36, v33
    v_add_f32 v36, v36, v34
    v_add_f32 v36, v36, v35
    s_nop 1
    v_add_f32_dpp v36, v36, v36 row_ror:8 row_mask:0xf bank_mask:0xf
    v_mov_b32 v37, v36
    s_nop 1
    v_permlane16_swap_b32 v36, v37
    v_add_f32 v36, v36, v37
    v_mov_b32 v37, v36
    s_nop 1
    v_permlane32_swap_b32 v36, v37
    v_add_f32 v36, v36, v37
    ds_write_b32 v9, v36
    s_branch RR2_S1
RR2_TOP:
    s_xor_b32 s30, s30, 1
    s_cmp_lg_u32 s16, 0
    s_cbranch_scc1 Lw0_88
    v_readfirstlane_b32 s25, v3
    v_readfirstlane_b32 s26, v4
    s_mov_b32 s24, -1
    s_cmp_ge_u32 s19, 256
    s_cbranch_scc1 Lsk_89
    s_cmp_lg_u32 s26, 11
    s_cbranch_scc1 Lsk_89
    s_add_u32 s24, s19, 256
Lsk_89:
    s_cmp_ge_u32 s18, 256
    s_cbranch_scc1 Lsk_90
    s_cmp_lg_u32 s25, 11
    s_cbranch_scc1 Lsk_90
    s_add_u32 s24, s18, 0
Lsk_90:
    v_mov_b32 v5, s24
    v_mov_b32 v6, 163776
    ds_write_b32 v6, v5 offset:0
Lw0_88:
    v_mfma_f32_16x16x32_bf16 v[20:23], v[12:15], v[64:67], 0
    v_mfma_f32_16x16x32_bf16 v[24:27], v[16:19], v[64:67], 0
    v_mfma_f32_16x16x32_bf16 v[28:31], v[12:15], v[68:71], 0
    v_mfma_f32_16x16x32_bf16 v[32:35], v[16:19], v[68:71], 0
    v_mfma_f32_16x16x32_bf16 v[20:23], v[12:15], v[72:75], v[20:23]
    v_mfma_f32_16x16x32_bf16 v[24:27], v[16:19], v[72:75], v[24:27]
    v_mfma_f32_16x16x32_bf16 v[28:31], v[12:15], v[76:79], v[28:31]
    v_mfma_f32_16x16x32_bf16 v[32:35], v[16:19], v[76:79], v[32:35]
    v_mfma_f32_16x16x32_bf16 v[20:23], v[12:15], v[80:83], v[20:23]
    v_mfma_f32_16x16x32_bf16 v[24:27], v[16:19], v[80:83], v[24:27]
    v_mfma_f32_16x16x32_bf16 v[28:31], v[12:15], v[84:87], v[28:31]
    v_mfma_f32_16x16x32_bf16 v[32:35], v[16:19], v[84:87], v[32:35]
    v_mfma_f32_16x16x32_bf16 v[20:23], v[12:15], v[88:91], v[20:23]
    v_mfma_f32_16x16x32_bf16 v[24:27], v[16:19], v[88:91], v[24:27]
    v_mfma_f32_16x16x32_bf16 v[28:31], v[12:15], v[92:95], v[28:31]
    v_mfma_f32_16x16x32_bf16 v[32:35], v[16:19], v[92:95], v[32:35]
    v_mfma_f32_16x16x32_bf16 v[20:23], v[12:15], v[96:99], v[20:23]
    v_mfma_f32_16x16x32_bf16 v[24:27], v[16:19], v[96:99], v[24:27]
    v_mfma_f32_16x16x32_bf16 v[28:31], v[12:15], v[100:103], v[28:31]
    v_mfma_f32_16x16x32_bf16 v[32:35], v[16:19], v[100:103], v[32:35]
    v_mfma_f32_16x16x32_bf16 v[20:23], v[12:15], v[104:107], v[20:23]
    v_mfma_f32_16x16x32_bf16 v[24:27], v[16:19], v[104:107], v[24:27]
    v_mfma_f32_16x16x32_bf16 v[28:31], v[12:15], v[108:111], v[28:31]
    v_mfma_f32_16x16x32_bf16 v[32:35], v[16:19], v[108:111], v[32:35]
    v_mfma_f32_16x16x32_bf16 v[20:23], v[12:15], v[112:115], v[20:23]
    v_mfma_f32_16x16x32_bf16 v[24:27], v[16:19], v[112:115], v[24:27]
    v_mfma_f32_16x16x32_bf16 v[28:31], v[12:15], v[116:119], v[28:31]
    v_mfma_f32_16x16x32_bf16 v[32:35], v[16:19], v[116:119], v[32:35]
    v_mfma_f32_16x16x32_bf16 v[20:23], v[12:15], v[120:123], v[20:23]
    v_mfma_f32_16x16x32_bf16 v[24:27], v[16:19], v[120:123], v[24:27]
    v_mfma_f32_16x16x32_bf16 v[28:31], v[12:15], v[124:127], v[28:31]
    v_mfma_f32_16x16x32_bf16 v[32:35], v[16:19], v[124:127], v[32:35]
    v_mfma_f32_16x16x32_bf16 v[20:23], v[12:15], v[128:131], v[20:23]
    v_mfma_f32_16x16x32_bf16 v[24:27], v[16:19], v[128:131], v[24:27]
    v_mfma_f32_16x16x32_bf16 v[28:31], v[12:15], v[132:135], v[28:31]
    v_mfma_f32_16x16x32_bf16 v[32:35], v[16:19], v[132:135], v[32:35]
    v_mfma_f32_16x16x32_bf16 v[20:23], v[12:15], v[136:139], v[20:23]
    v_mfma_f32_16x16x32_bf16 v[24:27], v[16:19], v[136:139], v[24:27]
    v_mfma_f32_16x16x32_bf16 v[28:31], v[12:15], v[140:143], v[28:31]
    v_mfma_f32_16x16x32_bf16 v[32:35], v[16:19], v[140:143], v[32:35]
    v_mfma_f32_16x16x32_bf16 v[20:23], v[12:15], v[144:147], v[20:23]
    v_mfma_f32_16x16x32_bf16 v[24:27], v[16:19], v[144:147], v[24:27]
    v_mfma_f32_16x16x32_bf16 v[28:31], v[12:15], v[148:151], v[28:31]
    v_mfma_f32_16x16x32_bf16 v[32:35], v[16:19], v[148:151], v[32:35]
    v_mfma_f32_16x16x32_bf16 v[20:23], v[12:15], v[152:155], v[20:23]
    v_mfma_f32_16x16x32_bf16 v[24:27], v[16:19], v[152:155], v[24:27]
    v_mfma_f32_16x16x32_bf16 v[28:31], v[12:15], v[156:159], v[28:31]
    v_mfma_f32_16x16x32_bf16 v[32:35], v[16:19], v[156:159], v[32:35]
    s_nop 4
    v_cvt_pk_bf16_f32 v44, v20, v21
    v_cvt_pk_bf16_f32 v45, v22, v23
    v_cvt_pk_bf16_f32 v46, v24, v25
    v_cvt_pk_bf16_f32 v47, v26, v27
    v_cvt_pk_bf16_f32 v48, v28, v29
    v_cvt_pk_bf16_f32 v49, v30, v31
    v_cvt_pk_bf16_f32 v50, v32, v33
    v_cvt_pk_bf16_f32 v51, v34, v35
    v_lshlrev_b32 v20, 16, v44
    v_and_b32 v21, 0xffff0000, v44
    v_lshlrev_b32 v22, 16, v45
    v_and_b32 v23, 0xffff0000, v45
    v_lshlrev_b32 v24, 16, v46
    v_and_b32 v25, 0xffff0000, v46
    v_lshlrev_b32 v26, 16, v47
    v_and_b32 v27, 0xffff0000, v47
    v_lshlrev_b32 v28, 16, v48
    v_and_b32 v29, 0xffff0000, v48
    v_lshlrev_b32 v30, 16, v49
    v_and_b32 v31, 0xffff0000, v49
    v_lshlrev_b32 v32, 16, v50
    v_and_b32 v33, 0xffff0000, v50
    v_lshlrev_b32 v34, 16, v51
    v_and_b32 v35, 0xffff0000, v51
    v_add_f32 v36, v20, v21
    v_add_f32 v36, v36, v22
    v_add_f32 v36, v36, v23
    v_add_f32 v36, v36, v24
    v_add_f32 v36, v36, v25
    v_add_f32 v36, v36, v26
    v_add_f32 v36, v36, v27
    v_add_f32 v36, v36, v28
    v_add_f32 v36, v36, v29
    v_add_f32 v36, v36, v30
    v_add_f32 v36, v36, v31
    v_add_f32 v36, v36, v32
    v_add_f32 v36, v36, v33
    v_add_f32 v36, v36, v34
    v_add_f32 v36, v36, v35
    s_nop 1
    v_add_f32_dpp v36, v36, v36 row_ror:8 row_mask:0xf bank_mask:0xf
    v_mov_b32 v37, v36
    s_nop 1
    v_permlane16_swap_b32 v36, v37
    v_add_f32 v36, v36, v37
    v_mov_b32 v37, v36
    s_nop 1
    v_permlane32_swap_b32 v36, v37
    v_add_f32 v36, v36, v37
    ds_write_b32 v9, v36
RR2_S1:
    s_waitcnt lgkmcnt(0)
    s_barrier
    v_mov_b32 v6, 163776
    ds_read_b32 v5, v6 offset:0
    s_waitcnt lgkmcnt(0)
    v_readfirstlane_b32 s21, v5
    s_cmp_eq_u32 s21, -1
    s_cbranch_scc1 RR2_T1
    s_cmp_ge_u32 s21, 256
    s_cbranch_scc1 Lad_91
    s_cmp_ge_u32 s18, s84
    s_cselect_b32 s24, s86, s85
    s_add_u32 s18, s18, s24
    s_cmp_ge_u32 s18, s87
    s_cselect_b32 s18, 256, s18
    s_branch Lad_92
Lad_91:
    s_cmp_ge_u32 s19, s88
    s_cselect_b32 s24, s90, s89
    s_add_u32 s19, s19, s24
    s_cmp_ge_u32 s19, s91
    s_cselect_b32 s19, 256, s19
Lad_92:
    s_lshr_b32 s92, s21, 2
    s_mul_i32 s92, s92, 32768
    s_bfe_u32 s94, s21, 0x10001
    s_lshl_b32 s94, s94, 14
    s_add_u32 s92, s92, s94
    s_and_b32 s94, s21, 1
    s_lshl_b32 s94, s94, 7
    s_add_u32 s92, s92, s94
    s_add_u32 s92, s92, 10485760
    s_lshr_b32 s93, s21, 2
    s_mul_i32 s93, s93, 360448
    s_bfe_u32 s94, s21, 0x10001
    s_lshl_b32 s94, s94, 14
    s_add_u32 s93, s93, s94
    s_and_b32 s94, s21, 1
    s_lshl_b32 s94, s94, 7
    s_add_u32 s93, s93, s94
    s_add_u32 s93, s93, 203390976
    ds_read_b32 v36, v10 offset:0
    ds_read_b32 v37, v10 offset:32
    ds_read_b32 v38, v10 offset:64
    ds_read_b32 v39, v10 offset:96
    s_waitcnt lgkmcnt(0)
    v_add_f32 v36, v36, v37
    v_add_f32 v38, v38, v39
    v_add_f32 v36, v36, v38
    v_mul_f32 v36, 0x3b000000, v36
    v_sub_f32 v20, v20, v36
    v_sub_f32 v21, v21, v36
    v_sub_f32 v22, v22, v36
    v_sub_f32 v23, v23, v36
    v_sub_f32 v24, v24, v36
    v_sub_f32 v25, v25, v36
    v_sub_f32 v26, v26, v36
    v_sub_f32 v27, v27, v36
    v_sub_f32 v28, v28, v36
    v_sub_f32 v29, v29, v36
    v_sub_f32 v30, v30, v36
    v_sub_f32 v31, v31, v36
    v_sub_f32 v32, v32, v36
    v_sub_f32 v33, v33, v36
    v_sub_f32 v34, v34, v36
    v_sub_f32 v35, v35, v36
    v_mul_f32 v36, v20, v20
    v_fmac_f32 v36, v21, v21
    v_fmac_f32 v36, v22, v22
    v_fmac_f32 v36, v23, v23
    v_fmac_f32 v36, v24, v24
    v_fmac_f32 v36, v25, v25
    v_fmac_f32 v36, v26, v26
    v_fmac_f32 v36, v27, v27
    v_fmac_f32 v36, v28, v28
    v_fmac_f32 v36, v29, v29
    v_fmac_f32 v36, v30, v30
    v_fmac_f32 v36, v31, v31
    v_fmac_f32 v36, v32, v32
    v_fmac_f32 v36, v33, v33
    v_fmac_f32 v36, v34, v34
    v_fmac_f32 v36, v35, v35
    s_nop 1
    v_add_f32_dpp v36, v36, v36 row_ror:8 row_mask:0xf bank_mask:0xf
    v_mov_b32 v37, v36
    s_nop 1
    v_permlane16_swap_b32 v36, v37
    v_add_f32 v36, v36, v37
    v_mov_b32 v37, v36
    s_nop 1
    v_permlane32_swap_b32 v36, v37
    v_add_f32 v36, v36, v37
    ds_write_b32 v9, v36 offset:128
    buffer_load_dwordx4 v[64:67], v7, s[4:7], s92 offen offset:0 sc1
    buffer_load_dwordx4 v[68:71], v7, s[4:7], s92 offen offset:2048 sc1
    s_add_u32 s93, s93, 32768
    buffer_load_dwordx4 v[72:75], v7, s[4:7], s93 offen offset:0 sc1
    buffer_load_dwordx4 v[76:79], v7, s[4:7], s93 offen offset:2048 sc1
    s_add_u32 s93, s93, 32768
    buffer_load_dwordx4 v[80:83], v7, s[4:7], s93 offen offset:0 sc1
    buffer_load_dwordx4 v[84:87], v7, s[4:7], s93 offen offset:2048 sc1
    s_add_u32 s93, s93, 32768
    buffer_load_dwordx4 v[88:91], v7, s[4:7], s93 offen offset:0 sc1
    buffer_load_dwordx4 v[92:95], v7, s[4:7], s93 offen offset:2048 sc1
    s_add_u32 s93, s93, 32768
    buffer_load_dwordx4 v[96:99], v7, s[4:7], s93 offen offset:0 sc1
    buffer_load_dwordx4 v[100:103], v7, s[4:7], s93 offen offset:2048 sc1
    s_add_u32 s93, s93, 32768
    buffer_load_dwordx4 v[104:107], v7, s[4:7], s93 offen offset:0 sc1
    buffer_load_dwordx4 v[108:111], v7, s[4:7], s93 offen offset:2048 sc1
    s_add_u32 s93, s93, 32768
    buffer_load_dwordx4 v[112:115], v7, s[4:7], s93 offen offset:0 sc1
    buffer_load_dwordx4 v[116:119], v7, s[4:7], s93 offen offset:2048 sc1
    s_add_u32 s93, s93, 32768
    buffer_load_dwordx4 v[120:123], v7, s[4:7], s93 offen offset:0 sc1
    buffer_load_dwordx4 v[124:127], v7, s[4:7], s93 offen offset:2048 sc1
    s_add_u32 s93, s93, 32768
    buffer_load_dwordx4 v[128:131], v7, s[4:7], s93 offen offset:0 sc1
    buffer_load_dwordx4 v[132:135], v7, s[4:7], s93 offen offset:2048 sc1
    s_add_u32 s93, s93, 32768
    buffer_load_dwordx4 v[136:139], v7, s[4:7], s93 offen offset:0 sc1
    buffer_load_dwordx4 v[140:143], v7, s[4:7], s93 offen offset:2048 sc1
    s_add_u32 s93, s93, 32768
    buffer_load_dwordx4 v[144:147], v7, s[4:7], s93 offen offset:0 sc1
    buffer_load_dwordx4 v[148:151], v7, s[4:7], s93 offen offset:2048 sc1
    s_add_u32 s93, s93, 32768
    buffer_load_dwordx4 v[152:155], v7, s[4:7], s93 offen offset:0 sc1
    buffer_load_dwordx4 v[156:159], v7, s[4:7], s93 offen offset:2048 sc1
    s_waitcnt vmcnt(24) lgkmcnt(0)
    s_barrier
    s_branch RR2_T4
RR2_T1:
    ds_read_b32 v36, v10 offset:0
    ds_read_b32 v37, v10 offset:32
    ds_read_b32 v38, v10 offset:64
    ds_read_b32 v39, v10 offset:96
    s_waitcnt lgkmcnt(0)
    v_add_f32 v36, v36, v37
    v_add_f32 v38, v38, v39
    v_add_f32 v36, v36, v38
    v_mul_f32 v36, 0x3b000000, v36
    v_sub_f32 v20, v20, v36
    v_sub_f32 v21, v21, v36
    v_sub_f32 v22, v22, v36
    v_sub_f32 v23, v23, v36
    v_sub_f32 v24, v24, v36
    v_sub_f32 v25, v25, v36
    v_sub_f32 v26, v26, v36
    v_sub_f32 v27, v27, v36
    v_sub_f32 v28, v28, v36
    v_sub_f32 v29, v29, v36
    v_sub_f32 v30, v30, v36
    v_sub_f32 v31, v31, v36
    v_sub_f32 v32, v32, v36
    v_sub_f32 v33, v33, v36
    v_sub_f32 v34, v34, v36
    v_sub_f32 v35, v35, v36
    v_mul_f32 v36, v20, v20
    v_fmac_f32 v36, v21, v21
    v_fmac_f32 v36, v22, v22
    v_fmac_f32 v36, v23, v23
    v_fmac_f32 v36, v24, v24
    v_fmac_f32 v36, v25, v25
    v_fmac_f32 v36, v26, v26
    v_fmac_f32 v36, v27, v27
    v_fmac_f32 v36, v28, v28
    v_fmac_f32 v36, v29, v29
    v_fmac_f32 v36, v30, v30
    v_fmac_f32 v36, v31, v31
    v_fmac_f32 v36, v32, v32
    v_fmac_f32 v36, v33, v33
    v_fmac_f32 v36, v34, v34
    v_fmac_f32 v36, v35, v35
    s_nop 1
    v_add_f32_dpp v36, v36, v36 row_ror:8 row_mask:0xf bank_mask:0xf
    v_mov_b32 v37, v36
    s_nop 1
    v_permlane16_swap_b32 v36, v37
    v_add_f32 v36, v36, v37
    v_mov_b32 v37, v36
    s_nop 1
    v_permlane32_swap_b32 v36, v37
    v_add_f32 v36, v36, v37
    ds_write_b32 v9, v36 offset:128
    s_waitcnt vmcnt(0)
    s_waitcnt lgkmcnt(0)
    s_barrier
RR2_T4:
    s_cmp_eq_u32 s22, -1
    s_cbranch_scc1 Lms_93
    s_cmp_lg_u32 s16, 0
    s_cbranch_scc1 Lsg_94
    s_cmp_ge_u32 s22, 256
    s_cbranch_scc1 Lsg_94
    s_lshr_b32 s24, s22, 2
    s_lshl_b32 s24, s24, 8
    s_add_u32 s24, s24, 147456
    v_mov_b32 v5, 1
    s_mov_b64 s[38:39], exec
    s_mov_b64 exec, 1
    buffer_atomic_add v5, v2, s[4:7], s24 offen
    s_mov_b64 exec, s[38:39]
Lsg_94:
    s_mov_b32 s22, -1
Lms_93:
    s_min_u32 s25, s18, 255
    s_lshr_b32 s24, s25, 2
    s_lshl_b32 s24, s24, 8
    s_add_u32 s24, s24, 131264
    buffer_load_dword v3, v2, s[4:7], s24 offen sc1
    s_min_u32 s25, s19, 255
    s_lshr_b32 s24, s25, 2
    s_lshl_b32 s24, s24, 8
    s_add_u32 s24, s24, 147648
    buffer_load_dword v4, v2, s[4:7], s24 offen sc1
    ds_read_b32 v36, v10 offset:128
    ds_read_b32 v37, v10 offset:160
    ds_read_b32 v38, v10 offset:192
    ds_read_b32 v39, v10 offset:224
    s_waitcnt lgkmcnt(0)
    v_add_f32 v36, v36, v37
    v_add_f32 v38, v38, v39
    v_add_f32 v36, v36, v38
    v_mov_b32 v37, 0x3727c5ac
    v_fmac_f32 v37, 0x3b000000, v36
    v_rsq_f32 v36, v37
    s_nop 0
    v_mul_f32 v20, v20, v36
    v_mul_f32 v21, v21, v36
    v_mul_f32 v22, v22, v36
    v_mul_f32 v23, v23, v36
    v_mul_f32 v24, v24, v36
    v_mul_f32 v25, v25, v36
    v_mul_f32 v26, v26, v36
    v_mul_f32 v27, v27, v36
    v_mul_f32 v28, v28, v36
    v_mul_f32 v29, v29, v36
    v_mul_f32 v30, v30, v36
    v_mul_f32 v31, v31, v36
    v_mul_f32 v32, v32, v36
    v_mul_f32 v33, v33, v36
    v_mul_f32 v34, v34, v36
    v_mul_f32 v35, v35, v36
    v_cvt_pk_bf16_f32 v52, v20, v21
    v_cvt_pk_bf16_f32 v53, v22, v23
    v_cvt_pk_bf16_f32 v54, v24, v25
    v_cvt_pk_bf16_f32 v55, v26, v27
    v_cvt_pk_bf16_f32 v56, v28, v29
    v_cvt_pk_bf16_f32 v57, v30, v31
    v_cvt_pk_bf16_f32 v58, v32, v33
    v_cvt_pk_bf16_f32 v59, v34, v35
RR2_T6:
    s_lshr_b32 s24, s20, 2
    s_mul_i32 s24, s24, 32768
    s_bfe_u32 s25, s20, 0x10001
    s_lshl_b32 s25, s25, 14
    s_add_u32 s24, s24, s25
    s_and_b32 s25, s20, 1
    s_lshl_b32 s25, s25, 7
    s_add_u32 s24, s24, s25
    s_cmp_ge_u32 s20, 256
    s_cbranch_scc1 RR2_OUT
    s_add_u32 s25, s24, 8388608
    buffer_store_dwordx4 v[52:55], v7, s[4:7], s25 offen offset:0 sc1
    buffer_store_dwordx4 v[56:59], v7, s[4:7], s25 offen offset:2048 sc1
    s_add_u32 s25, s24, 4194304
    buffer_store_dwordx4 v[44:47], v7, s[4:7], s25 offen offset:0 sc1
    buffer_store_dwordx4 v[48:51], v7, s[4:7], s25 offen offset:2048 sc1
    s_branch RR2_ST
RR2_OUT:
    s_sub_u32 s24, s20, 256
    s_lshl_b32 s24, s24, 13
    buffer_store_dwordx4 v[44:47], v8, s[8:11], s24 offen offset:0
    buffer_store_dwordx4 v[48:51], v8, s[8:11], s24 offen offset:32
RR2_ST:
    s_mov_b32 s22, s20
    s_mov_b32 s20, s21
    s_waitcnt vmcnt(2)
    s_cmp_lg_u32 s21, -1
    s_nop 5
    s_cbranch_scc1 RR2_TOP
    s_cmp_lg_u32 s16, 0
    s_cbranch_scc1 Lw0_95
    v_readfirstlane_b32 s25, v3
    v_readfirstlane_b32 s26, v4
    s_mov_b32 s24, -1
    s_cmp_ge_u32 s19, 256
    s_cbranch_scc1 Lsk_96
    s_cmp_lg_u32 s26, 11
    s_cbranch_scc1 Lsk_96
    s_add_u32 s24, s19, 256
Lsk_96:
    s_cmp_ge_u32 s18, 256
    s_cbranch_scc1 Lsk_97
    s_cmp_lg_u32 s25, 11
    s_cbranch_scc1 Lsk_97
    s_add_u32 s24, s18, 0
Lsk_97:
    v_mov_b32 v5, s24
    v_mov_b32 v6, 163776
    ds_write_b32 v6, v5 offset:8
Lw0_95:
    s_waitcnt lgkmcnt(0)
    s_barrier
    v_mov_b32 v6, 163776
    ds_read_b32 v5, v6 offset:8
    s_waitcnt lgkmcnt(0)
    v_readfirstlane_b32 s20, v5
    s_cmp_lg_u32 s20, -1
    s_cbranch_scc1 RR2_GO
    s_waitcnt vmcnt(0)
    s_barrier
    s_cmp_lg_u32 s16, 0
    s_cbranch_scc1 Lsg_98
    s_cmp_ge_u32 s22, 256
    s_cbranch_scc1 Lsg_98
    s_lshr_b32 s24, s22, 2
    s_lshl_b32 s24, s24, 8
    s_add_u32 s24, s24, 147456
    v_mov_b32 v5, 1
    s_mov_b64 s[38:39], exec
    s_mov_b64 exec, 1
    buffer_atomic_add v5, v2, s[4:7], s24 offen
    s_mov_b64 exec, s[38:39]
Lsg_98:
    s_mov_b32 s22, -1
    s_branch RR2_B1
E_R2:
    s_endpgm
J_QKV:
    s_cmp_ge_u32 s44, 48
    s_cselect_b32 s95, 1, 0
    s_cselect_b32 s24, 48, 0
    s_sub_u32 s44, s44, s24
    s_lshr_b32 s40, s44, 4
    s_and_b32 s41, s44, 15
    s_cmp_eq_u32 s40, 2
    s_cbranch_scc1 J_V
    s_cmp_eq_u32 s40, 1
    s_cbranch_scc1 J_K
    s_load_dwordx2 s[8:9], s[0:1], 16
    s_mov_b32 s10, 4194304
    s_mov_b32 s11, 0x00020000
    s_waitcnt lgkmcnt(0)
    s_branch J_QK
J_K:
    s_load_dwordx2 s[8:9], s[0:1], 24
    s_mov_b32 s10, 4194304
    s_mov_b32 s11, 0x00020000
    s_waitcnt lgkmcnt(0)
J_QK:
    v_lshlrev_b32 v7, 4, v0
    v_lshlrev_b32 v9, 4, v1
    s_lshr_b32 s25, s16, 1
    s_lshl_b32 s26, s41, 1
    s_add_u32 s25, s25, s26
    s_and_b32 s26, s16, 1
    s_lshl_b32 s33, s40, 5
    s_add_u32 s33, s33, s25
    s_lshl_b32 s33, s33, 13
    s_lshl_b32 s27, s26, 11
    s_add_u32 s33, s33, s27
    s_add_u32 s33, s33, 35651584
    s_lshl_b32 s25, s25, 8
    s_lshl_b32 s26, s26, 7
    s_add_u32 s25, s25, s26
    v_lshrrev_b32 v5, 4, v1
    v_lshlrev_b32 v5, 18, v5
    v_and_b32 v6, 15, v1
    v_lshlrev_b32 v6, 3, v6
    v_add3_u32 v8, v5, v6, s25
    s_mov_b32 s24, 0
    buffer_load_dwordx2 v[16:17], v8, s[8:11], s24 offen
    s_mov_b32 s24, 8192
    buffer_load_dwordx2 v[18:19], v8, s[8:11], s24 offen
    s_mov_b32 s24, 16384
    buffer_load_dwordx2 v[20:21], v8, s[8:11], s24 offen
    s_mov_b32 s24, 24576
    buffer_load_dwordx2 v[22:23], v8, s[8:11], s24 offen
    s_mov_b32 s24, 32768
    buffer_load_dwordx2 v[24:25], v8, s[8:11], s24 offen
    s_mov_b32 s24, 40960
    buffer_load_dwordx2 v[26:27], v8, s[8:11], s24 offen
    s_mov_b32 s24, 49152
    buffer_load_dwordx2 v[28:29], v8, s[8:11], s24 offen
    s_mov_b32 s24, 57344
    buffer_load_dwordx2 v[30:31], v8, s[8:11], s24 offen
    s_mov_b32 s24, 65536
    buffer_load_dwordx2 v[32:33], v8, s[8:11], s24 offen
    s_mov_b32 s24, 73728
    buffer_load_dwordx2 v[34:35], v8, s[8:11], s24 offen
    s_mov_b32 s24, 81920
    buffer_load_dwordx2 v[36:37], v8, s[8:11], s24 offen
    s_mov_b32 s24, 90112
    buffer_load_dwordx2 v[38:39], v8, s[8:11], s24 offen
    s_mov_b32 s24, 98304
    buffer_load_dwordx2 v[40:41], v8, s[8:11], s24 offen
    s_mov_b32 s24, 106496
    buffer_load_dwordx2 v[42:43], v8, s[8:11], s24 offen
    s_mov_b32 s24, 114688
    buffer_load_dwordx2 v[44:45], v8, s[8:11], s24 offen
    s_mov_b32 s24, 122880
    buffer_load_dwordx2 v[46:47], v8, s[8:11], s24 offen
    s_mov_b32 s24, 131072
    buffer_load_dwordx2 v[48:49], v8, s[8:11], s24 offen
    s_mov_b32 s24, 139264
    buffer_load_dwordx2 v[50:51], v8, s[8:11], s24 offen
    s_mov_b32 s24, 147456
    buffer_load_dwordx2 v[52:53], v8, s[8:11], s24 offen
    s_mov_b32 s24, 155648
    buffer_load_dwordx2 v[54:55], v8, s[8:11], s24 offen
    s_mov_b32 s24, 163840
    buffer_load_dwordx2 v[56:57], v8, s[8:11], s24 offen
    s_mov_b32 s24, 172032
    buffer_load_dwordx2 v[58:59], v8, s[8:11], s24 offen
    s_mov_b32 s24, 180224
    buffer_load_dwordx2 v[60:61], v8, s[8:11], s24 offen
    s_mov_b32 s24, 188416
    buffer_load_dwordx2 v[62:63], v8, s[8:11], s24 offen
    s_mov_b32 s24, 196608
    buffer_load_dwordx2 v[64:65], v8, s[8:11], s24 offen
    s_mov_b32 s24, 204800
    buffer_load_dwordx2 v[66:67], v8, s[8:11], s24 offen
    s_mov_b32 s24, 212992
    buffer_load_dwordx2 v[68:69], v8, s[8:11], s24 offen
    s_mov_b32 s24, 221184
    buffer_load_dwordx2 v[70:71], v8, s[8:11], s24 offen
    s_mov_b32 s24, 229376
    buffer_load_dwordx2 v[72:73], v8, s[8:11], s24 offen
    s_mov_b32 s24, 237568
    buffer_load_dwordx2 v[74:75], v8, s[8:11], s24 offen
    s_mov_b32 s24, 245760
    buffer_load_dwordx2 v[76:77], v8, s[8:11], s24 offen
    s_mov_b32 s24, 253952
    buffer_load_dwordx2 v[78:79], v8, s[8:11], s24 offen
    s_mov_b32 s24, 1048576
    buffer_load_dwordx2 v[80:81], v8, s[8:11], s24 offen
    s_mov_b32 s24, 1056768
    buffer_load_dwordx2 v[82:83], v8, s[8:11], s24 offen
    s_mov_b32 s24, 1064960
    buffer_load_dwordx2 v[84:85], v8, s[8:11], s24 offen
    s_mov_b32 s24, 1073152
    buffer_load_dwordx2 v[86:87], v8, s[8:11], s24 offen
    s_mov_b32 s24, 1081344
    buffer_load_dwordx2 v[88:89], v8, s[8:11], s24 offen
    s_mov_b32 s24, 1089536
    buffer_load_dwordx2 v[90:91], v8, s[8:11], s24 offen
    s_mov_b32 s24, 1097728
    buffer_load_dwordx2 v[92:93], v8, s[8:11], s24 offen
    s_mov_b32 s24, 1105920
    buffer_load_dwordx2 v[94:95], v8, s[8:11], s24 offen
    s_mov_b32 s24, 1114112
    buffer_load_dwordx2 v[96:97], v8, s[8:11], s24 offen
    s_mov_b32 s24, 1122304
    buffer_load_dwordx2 v[98:99], v8, s[8:11], s24 offen
    s_mov_b32 s24, 1130496
    buffer_load_dwordx2 v[100:101], v8, s[8:11], s24 offen
    s_mov_b32 s24, 1138688
    buffer_load_dwordx2 v[102:103], v8, s[8:11], s24 offen
    s_mov_b32 s24, 1146880
    buffer_load_dwordx2 v[104:105], v8, s[8:11], s24 offen
    s_mov_b32 s24, 1155072
    buffer_load_dwordx2 v[106:107], v8, s[8:11], s24 offen
    s_mov_b32 s24, 1163264
    buffer_load_dwordx2 v[108:109], v8, s[8:11], s24 offen
    s_mov_b32 s24, 1171456
    buffer_load_dwordx2 v[110:111], v8, s[8:11], s24 offen
    s_waitcnt vmcnt(40)
    v_perm_b32 v5, v18, v16, s31
    v_accvgpr_write_b32 a0, v5
    v_perm_b32 v6, v22, v20, s31
    v_accvgpr_write_b32 a1, v6
    v_perm_b32 v5, v26, v24, s31
    v_accvgpr_write_b32 a2, v5
    v_perm_b32 v6, v30, v28, s31
    v_accvgpr_write_b32 a3, v6
    v_perm_b32 v5, v18, v16, s32
    v_accvgpr_write_b32 a4, v5
    v_perm_b32 v6, v22, v20, s32
    v_accvgpr_write_b32 a5, v6
    v_perm_b32 v5, v26, v24, s32
    v_accvgpr_write_b32 a6, v5
    v_perm_b32 v6, v30, v28, s32
    v_accvgpr_write_b32 a7, v6
    v_perm_b32 v5, v19, v17, s31
    v_accvgpr_write_b32 a8, v5
    v_perm_b32 v6, v23, v21, s31
    v_accvgpr_write_b32 a9, v6
    v_perm_b32 v5, v27, v25, s31
    v_accvgpr_write_b32 a10, v5
    v_perm_b32 v6, v31, v29, s31
    v_accvgpr_write_b32 a11, v6
    v_perm_b32 v5, v19, v17, s32
    v_accvgpr_write_b32 a12, v5
    v_perm_b32 v6, v23, v21, s32
    v_accvgpr_write_b32 a13, v6
    v_perm_b32 v5, v27, v25, s32
    v_accvgpr_write_b32 a14, v5
    v_perm_b32 v6, v31, v29, s32
    v_accvgpr_write_b32 a15, v6
    s_mov_b32 s24, 1179648
    buffer_load_dwordx2 v[16:17], v8, s[8:11], s24 offen
    s_mov_b32 s24, 1187840
    buffer_load_dwordx2 v[18:19], v8, s[8:11], s24 offen
    s_mov_b32 s24, 1196032
    buffer_load_dwordx2 v[20:21], v8, s[8:11], s24 offen
    s_mov_b32 s24, 1204224
    buffer_load_dwordx2 v[22:23], v8, s[8:11], s24 offen
    s_mov_b32 s24, 1212416
    buffer_load_dwordx2 v[24:25], v8, s[8:11], s24 offen
    s_mov_b32 s24, 1220608
    buffer_load_dwordx2 v[26:27], v8, s[8:11], s24 offen
    s_mov_b32 s24, 1228800
    buffer_load_dwordx2 v[28:29], v8, s[8:11], s24 offen
    s_mov_b32 s24, 1236992
    buffer_load_dwordx2 v[30:31], v8, s[8:11], s24 offen
    s_waitcnt vmcnt(40)
    v_perm_b32 v5, v34, v32, s31
    v_accvgpr_write_b32 a16, v5
    v_perm_b32 v6, v38, v36, s31
    v_accvgpr_write_b32 a17, v6
    v_perm_b32 v5, v42, v40, s31
    v_accvgpr_write_b32 a18, v5
    v_perm_b32 v6, v46, v44, s31
    v_accvgpr_write_b32 a19, v6
    v_perm_b32 v5, v34, v32, s32
    v_accvgpr_write_b32 a20, v5
    v_perm_b32 v6, v38, v36, s32
    v_accvgpr_write_b32 a21, v6
    v_perm_b32 v5, v42, v40, s32
    v_accvgpr_write_b32 a22, v5
    v_perm_b32 v6, v46, v44, s32
    v_accvgpr_write_b32 a23, v6
    v_perm_b32 v5, v35, v33, s31
    v_accvgpr_write_b32 a24, v5
    v_perm_b32 v6, v39, v37, s31
    v_accvgpr_write_b32 a25, v6
    v_perm_b32 v5, v43, v41, s31
    v_accvgpr_write_b32 a26, v5
    v_perm_b32 v6, v47, v45, s31
    v_accvgpr_write_b32 a27, v6
    v_perm_b32 v5, v35, v33, s32
    v_accvgpr_write_b32 a28, v5
    v_perm_b32 v6, v39, v37, s32
    v_accvgpr_write_b32 a29, v6
    v_perm_b32 v5, v43, v41, s32
    v_accvgpr_write_b32 a30, v5
    v_perm_b32 v6, v47, v45, s32
    v_accvgpr_write_b32 a31, v6
    s_mov_b32 s24, 1245184
    buffer_load_dwordx2 v[32:33], v8, s[8:11], s24 offen
    s_mov_b32 s24, 1253376
    buffer_load_dwordx2 v[34:35], v8, s[8:11], s24 offen
    s_mov_b32 s24, 1261568
    buffer_load_dwordx2 v[36:37], v8, s[8:11], s24 offen
    s_mov_b32 s24, 1269760
    buffer_load_dwordx2 v[38:39], v8, s[8:11], s24 offen
    s_mov_b32 s24, 1277952
    buffer_load_dwordx2 v[40:41], v8, s[8:11], s24 offen
    s_mov_b32 s24, 1286144
    buffer_load_dwordx2 v[42:43], v8, s[8:11], s24 offen
    s_mov_b32 s24, 1294336
    buffer_load_dwordx2 v[44:45], v8, s[8:11], s24 offen
    s_mov_b32 s24, 1302528
    buffer_load_dwordx2 v[46:47], v8, s[8:11], s24 offen
    s_waitcnt vmcnt(40)
    v_perm_b32 v5, v50, v48, s31
    v_accvgpr_write_b32 a32, v5
    v_perm_b32 v6, v54, v52, s31
    v_accvgpr_write_b32 a33, v6
    v_perm_b32 v5, v58, v56, s31
    v_accvgpr_write_b32 a34, v5
    v_perm_b32 v6, v62, v60, s31
    v_accvgpr_write_b32 a35, v6
    v_perm_b32 v5, v50, v48, s32
    v_accvgpr_write_b32 a36, v5
    v_perm_b32 v6, v54, v52, s32
    v_accvgpr_write_b32 a37, v6
    v_perm_b32 v5, v58, v56, s32
    v_accvgpr_write_b32 a38, v5
    v_perm_b32 v6, v62, v60, s32
    v_accvgpr_write_b32 a39, v6
    v_perm_b32 v5, v51, v49, s31
    v_accvgpr_write_b32 a40, v5
    v_perm_b32 v6, v55, v53, s31
    v_accvgpr_write_b32 a41, v6
    v_perm_b32 v5, v59, v57, s31
    v_accvgpr_write_b32 a42, v5
    v_perm_b32 v6, v63, v61, s31
    v_accvgpr_write_b32 a43, v6
    v_perm_b32 v5, v51, v49, s32
    v_accvgpr_write_b32 a44, v5
    v_perm_b32 v6, v55, v53, s32
    v_accvgpr_write_b32 a45, v6
    v_perm_b32 v5, v59, v57, s32
    v_accvgpr_write_b32 a46, v5
    v_perm_b32 v6, v63, v61, s32
    v_accvgpr_write_b32 a47, v6
    s_mov_b32 s24, 2097152
    buffer_load_dwordx2 v[48:49], v8, s[8:11], s24 offen
    s_mov_b32 s24, 2105344
    buffer_load_dwordx2 v[50:51], v8, s[8:11], s24 offen
    s_mov_b32 s24, 2113536
    buffer_load_dwordx2 v[52:53], v8, s[8:11], s24 offen
    s_mov_b32 s24, 2121728
    buffer_load_dwordx2 v[54:55], v8, s[8:11], s24 offen
    s_mov_b32 s24, 2129920
    buffer_load_dwordx2 v[56:57], v8, s[8:11], s24 offen
    s_mov_b32 s24, 2138112
    buffer_load_dwordx2 v[58:59], v8, s[8:11], s24 offen
    s_mov_b32 s24, 2146304
    buffer_load_dwordx2 v[60:61], v8, s[8:11], s24 offen
    s_mov_b32 s24, 2154496
    buffer_load_dwordx2 v[62:63], v8, s[8:11], s24 offen
    s_waitcnt vmcnt(40)
    v_perm_b32 v5, v66, v64, s31
    v_accvgpr_write_b32 a48, v5
    v_perm_b32 v6, v70, v68, s31
    v_accvgpr_write_b32 a49, v6
    v_perm_b32 v5, v74, v72, s31
    v_accvgpr_write_b32 a50, v5
    v_perm_b32 v6, v78, v76, s31
    v_accvgpr_write_b32 a51, v6
    v_perm_b32 v5, v66, v64, s32
    v_accvgpr_write_b32 a52, v5
    v_perm_b32 v6, v70, v68, s32
    v_accvgpr_write_b32 a53, v6
    v_perm_b32 v5, v74, v72, s32
    v_accvgpr_write_b32 a54, v5
    v_perm_b32 v6, v78, v76, s32
    v_accvgpr_write_b32 a55, v6
    v_perm_b32 v5, v67, v65, s31
    v_accvgpr_write_b32 a56, v5
    v_perm_b32 v6, v71, v69, s31
    v_accvgpr_write_b32 a57, v6
    v_perm_b32 v5, v75, v73, s31
    v_accvgpr_write_b32 a58, v5
    v_perm_b32 v6, v79, v77, s31
    v_accvgpr_write_b32 a59, v6
    v_perm_b32 v5, v67, v65, s32
    v_accvgpr_write_b32 a60, v5
    v_perm_b32 v6, v71, v69, s32
    v_accvgpr_write_b32 a61, v6
    v_perm_b32 v5, v75, v73, s32
    v_accvgpr_write_b32 a62, v5
    v_perm_b32 v6, v79, v77, s32
    v_accvgpr_write_b32 a63, v6
    s_mov_b32 s24, 2162688
    buffer_load_dwordx2 v[64:65], v8, s[8:11], s24 offen
    s_mov_b32 s24, 2170880
    buffer_load_dwordx2 v[66:67], v8, s[8:11], s24 offen
    s_mov_b32 s24, 2179072
    buffer_load_dwordx2 v[68:69], v8, s[8:11], s24 offen
    s_mov_b32 s24, 2187264
    buffer_load_dwordx2 v[70:71], v8, s[8:11], s24 offen
    s_mov_b32 s24, 2195456
    buffer_load_dwordx2 v[72:73], v8, s[8:11], s24 offen
    s_mov_b32 s24, 2203648
    buffer_load_dwordx2 v[74:75], v8, s[8:11], s24 offen
    s_mov_b32 s24, 2211840
    buffer_load_dwordx2 v[76:77], v8, s[8:11], s24 offen
    s_mov_b32 s24, 2220032
    buffer_load_dwordx2 v[78:79], v8, s[8:11], s24 offen
    s_waitcnt vmcnt(40)
    v_perm_b32 v5, v82, v80, s31
    v_accvgpr_write_b32 a64, v5
    v_perm_b32 v6, v86, v84, s31
    v_accvgpr_write_b32 a65, v6
    v_perm_b32 v5, v90, v88, s31
    v_accvgpr_write_b32 a66, v5
    v_perm_b32 v6, v94, v92, s31
    v_accvgpr_write_b32 a67, v6
    v_perm_b32 v5, v82, v80, s32
    v_accvgpr_write_b32 a68, v5
    v_perm_b32 v6, v86, v84, s32
    v_accvgpr_write_b32 a69, v6
    v_perm_b32 v5, v90, v88, s32
    v_accvgpr_write_b32 a70, v5
    v_perm_b32 v6, v94, v92, s32
    v_accvgpr_write_b32 a71, v6
    v_perm_b32 v5, v83, v81, s31
    v_accvgpr_write_b32 a72, v5
    v_perm_b32 v6, v87, v85, s31
    v_accvgpr_write_b32 a73, v6
    v_perm_b32 v5, v91, v89, s31
    v_accvgpr_write_b32 a74, v5
    v_perm_b32 v6, v95, v93, s31
    v_accvgpr_write_b32 a75, v6
    v_perm_b32 v5, v83, v81, s32
    v_accvgpr_write_b32 a76, v5
    v_perm_b32 v6, v87, v85, s32
    v_accvgpr_write_b32 a77, v6
    v_perm_b32 v5, v91, v89, s32
    v_accvgpr_write_b32 a78, v5
    v_perm_b32 v6, v95, v93, s32
    v_accvgpr_write_b32 a79, v6
    s_mov_b32 s24, 2228224
    buffer_load_dwordx2 v[80:81], v8, s[8:11], s24 offen
    s_mov_b32 s24, 2236416
    buffer_load_dwordx2 v[82:83], v8, s[8:11], s24 offen
    s_mov_b32 s24, 2244608
    buffer_load_dwordx2 v[84:85], v8, s[8:11], s24 offen
    s_mov_b32 s24, 2252800
    buffer_load_dwordx2 v[86:87], v8, s[8:11], s24 offen
    s_mov_b32 s24, 2260992
    buffer_load_dwordx2 v[88:89], v8, s[8:11], s24 offen
    s_mov_b32 s24, 2269184
    buffer_load_dwordx2 v[90:91], v8, s[8:11], s24 offen
    s_mov_b32 s24, 2277376
    buffer_load_dwordx2 v[92:93], v8, s[8:11], s24 offen
    s_mov_b32 s24, 2285568
    buffer_load_dwordx2 v[94:95], v8, s[8:11], s24 offen
    s_waitcnt vmcnt(40)
    v_perm_b32 v5, v98, v96, s31
    v_accvgpr_write_b32 a80, v5
    v_perm_b32 v6, v102, v100, s31
    v_accvgpr_write_b32 a81, v6
    v_perm_b32 v5, v106, v104, s31
    v_accvgpr_write_b32 a82, v5
    v_perm_b32 v6, v110, v108, s31
    v_accvgpr_write_b32 a83, v6
    v_perm_b32 v5, v98, v96, s32
    v_accvgpr_write_b32 a84, v5
    v_perm_b32 v6, v102, v100, s32
    v_accvgpr_write_b32 a85, v6
    v_perm_b32 v5, v106, v104, s32
    v_accvgpr_write_b32 a86, v5
    v_perm_b32 v6, v110, v108, s32
    v_accvgpr_write_b32 a87, v6
    v_perm_b32 v5, v99, v97, s31
    v_accvgpr_write_b32 a88, v5
    v_perm_b32 v6, v103, v101, s31
    v_accvgpr_write_b32 a89, v6
    v_perm_b32 v5, v107, v105, s31
    v_accvgpr_write_b32 a90, v5
    v_perm_b32 v6, v111, v109, s31
    v_accvgpr_write_b32 a91, v6
    v_perm_b32 v5, v99, v97, s32
    v_accvgpr_write_b32 a92, v5
    v_perm_b32 v6, v103, v101, s32
    v_accvgpr_write_b32 a93, v6
    v_perm_b32 v5, v107, v105, s32
    v_accvgpr_write_b32 a94, v5
    v_perm_b32 v6, v111, v109, s32
    v_accvgpr_write_b32 a95, v6
    s_mov_b32 s24, 2293760
    buffer_load_dwordx2 v[96:97], v8, s[8:11], s24 offen
    s_mov_b32 s24, 2301952
    buffer_load_dwordx2 v[98:99], v8, s[8:11], s24 offen
    s_mov_b32 s24, 2310144
    buffer_load_dwordx2 v[100:101], v8, s[8:11], s24 offen
    s_mov_b32 s24, 2318336
    buffer_load_dwordx2 v[102:103], v8, s[8:11], s24 offen
    s_mov_b32 s24, 2326528
    buffer_load_dwordx2 v[104:105], v8, s[8:11], s24 offen
    s_mov_b32 s24, 2334720
    buffer_load_dwordx2 v[106:107], v8, s[8:11], s24 offen
    s_mov_b32 s24, 2342912
    buffer_load_dwordx2 v[108:109], v8, s[8:11], s24 offen
    s_mov_b32 s24, 2351104
    buffer_load_dwordx2 v[110:111], v8, s[8:11], s24 offen
    s_waitcnt vmcnt(40)
    v_perm_b32 v5, v18, v16, s31
    v_accvgpr_write_b32 a96, v5
    v_perm_b32 v6, v22, v20, s31
    v_accvgpr_write_b32 a97, v6
    v_perm_b32 v5, v26, v24, s31
    v_accvgpr_write_b32 a98, v5
    v_perm_b32 v6, v30, v28, s31
    v_accvgpr_write_b32 a99, v6
    v_perm_b32 v5, v18, v16, s32
    v_accvgpr_write_b32 a100, v5
    v_perm_b32 v6, v22, v20, s32
    v_accvgpr_write_b32 a101, v6
    v_perm_b32 v5, v26, v24, s32
    v_accvgpr_write_b32 a102, v5
    v_perm_b32 v6, v30, v28, s32
    v_accvgpr_write_b32 a103, v6
    v_perm_b32 v5, v19, v17, s31
    v_accvgpr_write_b32 a104, v5
    v_perm_b32 v6, v23, v21, s31
    v_accvgpr_write_b32 a105, v6
    v_perm_b32 v5, v27, v25, s31
    v_accvgpr_write_b32 a106, v5
    v_perm_b32 v6, v31, v29, s31
    v_accvgpr_write_b32 a107, v6
    v_perm_b32 v5, v19, v17, s32
    v_accvgpr_write_b32 a108, v5
    v_perm_b32 v6, v23, v21, s32
    v_accvgpr_write_b32 a109, v6
    v_perm_b32 v5, v27, v25, s32
    v_accvgpr_write_b32 a110, v5
    v_perm_b32 v6, v31, v29, s32
    v_accvgpr_write_b32 a111, v6
    s_mov_b32 s24, 3145728
    buffer_load_dwordx2 v[16:17], v8, s[8:11], s24 offen
    s_mov_b32 s24, 3153920
    buffer_load_dwordx2 v[18:19], v8, s[8:11], s24 offen
    s_mov_b32 s24, 3162112
    buffer_load_dwordx2 v[20:21], v8, s[8:11], s24 offen
    s_mov_b32 s24, 3170304
    buffer_load_dwordx2 v[22:23], v8, s[8:11], s24 offen
    s_mov_b32 s24, 3178496
    buffer_load_dwordx2 v[24:25], v8, s[8:11], s24 offen
    s_mov_b32 s24, 3186688
    buffer_load_dwordx2 v[26:27], v8, s[8:11], s24 offen
    s_mov_b32 s24, 3194880
    buffer_load_dwordx2 v[28:29], v8, s[8:11], s24 offen
    s_mov_b32 s24, 3203072
    buffer_load_dwordx2 v[30:31], v8, s[8:11], s24 offen
    s_waitcnt vmcnt(40)
    v_perm_b32 v5, v34, v32, s31
    v_accvgpr_write_b32 a112, v5
    v_perm_b32 v6, v38, v36, s31
    v_accvgpr_write_b32 a113, v6
    v_perm_b32 v5, v42, v40, s31
    v_accvgpr_write_b32 a114, v5
    v_perm_b32 v6, v46, v44, s31
    v_accvgpr_write_b32 a115, v6
    v_perm_b32 v5, v34, v32, s32
    v_accvgpr_write_b32 a116, v5
    v_perm_b32 v6, v38, v36, s32
    v_accvgpr_write_b32 a117, v6
    v_perm_b32 v5, v42, v40, s32
    v_accvgpr_write_b32 a118, v5
    v_perm_b32 v6, v46, v44, s32
    v_accvgpr_write_b32 a119, v6
    v_perm_b32 v5, v35, v33, s31
    v_accvgpr_write_b32 a120, v5
    v_perm_b32 v6, v39, v37, s31
    v_accvgpr_write_b32 a121, v6
    v_perm_b32 v5, v43, v41, s31
    v_accvgpr_write_b32 a122, v5
    v_perm_b32 v6, v47, v45, s31
    v_accvgpr_write_b32 a123, v6
    v_perm_b32 v5, v35, v33, s32
    v_accvgpr_write_b32 a124, v5
    v_perm_b32 v6, v39, v37, s32
    v_accvgpr_write_b32 a125, v6
    v_perm_b32 v5, v43, v41, s32
    v_accvgpr_write_b32 a126, v5
    v_perm_b32 v6, v47, v45, s32
    v_accvgpr_write_b32 a127, v6
    s_mov_b32 s24, 3211264
    buffer_load_dwordx2 v[32:33], v8, s[8:11], s24 offen
    s_mov_b32 s24, 3219456
    buffer_load_dwordx2 v[34:35], v8, s[8:11], s24 offen
    s_mov_b32 s24, 3227648
    buffer_load_dwordx2 v[36:37], v8, s[8:11], s24 offen
    s_mov_b32 s24, 3235840
    buffer_load_dwordx2 v[38:39], v8, s[8:11], s24 offen
    s_mov_b32 s24, 3244032
    buffer_load_dwordx2 v[40:41], v8, s[8:11], s24 offen
    s_mov_b32 s24, 3252224
    buffer_load_dwordx2 v[42:43], v8, s[8:11], s24 offen
    s_mov_b32 s24, 3260416
    buffer_load_dwordx2 v[44:45], v8, s[8:11], s24 offen
    s_mov_b32 s24, 3268608
    buffer_load_dwordx2 v[46:47], v8, s[8:11], s24 offen
    s_waitcnt vmcnt(40)
    v_perm_b32 v5, v50, v48, s31
    v_accvgpr_write_b32 a128, v5
    v_perm_b32 v6, v54, v52, s31
    v_accvgpr_write_b32 a129, v6
    v_perm_b32 v5, v58, v56, s31
    v_accvgpr_write_b32 a130, v5
    v_perm_b32 v6, v62, v60, s31
    v_accvgpr_write_b32 a131, v6
    v_perm_b32 v5, v50, v48, s32
    v_accvgpr_write_b32 a132, v5
    v_perm_b32 v6, v54, v52, s32
    v_accvgpr_write_b32 a133, v6
    v_perm_b32 v5, v58, v56, s32
    v_accvgpr_write_b32 a134, v5
    v_perm_b32 v6, v62, v60, s32
    v_accvgpr_write_b32 a135, v6
    v_perm_b32 v5, v51, v49, s31
    v_accvgpr_write_b32 a136, v5
    v_perm_b32 v6, v55, v53, s31
    v_accvgpr_write_b32 a137, v6
    v_perm_b32 v5, v59, v57, s31
    v_accvgpr_write_b32 a138, v5
    v_perm_b32 v6, v63, v61, s31
    v_accvgpr_write_b32 a139, v6
    v_perm_b32 v5, v51, v49, s32
    v_accvgpr_write_b32 a140, v5
    v_perm_b32 v6, v55, v53, s32
    v_accvgpr_write_b32 a141, v6
    v_perm_b32 v5, v59, v57, s32
    v_accvgpr_write_b32 a142, v5
    v_perm_b32 v6, v63, v61, s32
    v_accvgpr_write_b32 a143, v6
    s_mov_b32 s24, 3276800
    buffer_load_dwordx2 v[48:49], v8, s[8:11], s24 offen
    s_mov_b32 s24, 3284992
    buffer_load_dwordx2 v[50:51], v8, s[8:11], s24 offen
    s_mov_b32 s24, 3293184
    buffer_load_dwordx2 v[52:53], v8, s[8:11], s24 offen
    s_mov_b32 s24, 3301376
    buffer_load_dwordx2 v[54:55], v8, s[8:11], s24 offen
    s_mov_b32 s24, 3309568
    buffer_load_dwordx2 v[56:57], v8, s[8:11], s24 offen
    s_mov_b32 s24, 3317760
    buffer_load_dwordx2 v[58:59], v8, s[8:11], s24 offen
    s_mov_b32 s24, 3325952
    buffer_load_dwordx2 v[60:61], v8, s[8:11], s24 offen
    s_mov_b32 s24, 3334144
    buffer_load_dwordx2 v[62:63], v8, s[8:11], s24 offen
    s_waitcnt vmcnt(40)
    v_perm_b32 v5, v66, v64, s31
    v_accvgpr_write_b32 a144, v5
    v_perm_b32 v6, v70, v68, s31
    v_accvgpr_write_b32 a145, v6
    v_perm_b32 v5, v74, v72, s31
    v_accvgpr_write_b32 a146, v5
    v_perm_b32 v6, v78, v76, s31
    v_accvgpr_write_b32 a147, v6
    v_perm_b32 v5, v66, v64, s32
    v_accvgpr_write_b32 a148, v5
    v_perm_b32 v6, v70, v68, s32
    v_accvgpr_write_b32 a149, v6
    v_perm_b32 v5, v74, v72, s32
    v_accvgpr_write_b32 a150, v5
    v_perm_b32 v6, v78, v76, s32
    v_accvgpr_write_b32 a151, v6
    v_perm_b32 v5, v67, v65, s31
    v_accvgpr_write_b32 a152, v5
    v_perm_b32 v6, v71, v69, s31
    v_accvgpr_write_b32 a153, v6
    v_perm_b32 v5, v75, v73, s31
    v_accvgpr_write_b32 a154, v5
    v_perm_b32 v6, v79, v77, s31
    v_accvgpr_write_b32 a155, v6
    v_perm_b32 v5, v67, v65, s32
    v_accvgpr_write_b32 a156, v5
    v_perm_b32 v6, v71, v69, s32
    v_accvgpr_write_b32 a157, v6
    v_perm_b32 v5, v75, v73, s32
    v_accvgpr_write_b32 a158, v5
    v_perm_b32 v6, v79, v77, s32
    v_accvgpr_write_b32 a159, v6
    s_mov_b32 s24, 3342336
    buffer_load_dwordx2 v[64:65], v8, s[8:11], s24 offen
    s_mov_b32 s24, 3350528
    buffer_load_dwordx2 v[66:67], v8, s[8:11], s24 offen
    s_mov_b32 s24, 3358720
    buffer_load_dwordx2 v[68:69], v8, s[8:11], s24 offen
    s_mov_b32 s24, 3366912
    buffer_load_dwordx2 v[70:71], v8, s[8:11], s24 offen
    s_mov_b32 s24, 3375104
    buffer_load_dwordx2 v[72:73], v8, s[8:11], s24 offen
    s_mov_b32 s24, 3383296
    buffer_load_dwordx2 v[74:75], v8, s[8:11], s24 offen
    s_mov_b32 s24, 3391488
    buffer_load_dwordx2 v[76:77], v8, s[8:11], s24 offen
    s_mov_b32 s24, 3399680
    buffer_load_dwordx2 v[78:79], v8, s[8:11], s24 offen
    s_waitcnt vmcnt(40)
    v_perm_b32 v5, v82, v80, s31
    v_accvgpr_write_b32 a160, v5
    v_perm_b32 v6, v86, v84, s31
    v_accvgpr_write_b32 a161, v6
    v_perm_b32 v5, v90, v88, s31
    v_accvgpr_write_b32 a162, v5
    v_perm_b32 v6, v94, v92, s31
    v_accvgpr_write_b32 a163, v6
    v_perm_b32 v5, v82, v80, s32
    v_accvgpr_write_b32 a164, v5
    v_perm_b32 v6, v86, v84, s32
    v_accvgpr_write_b32 a165, v6
    v_perm_b32 v5, v90, v88, s32
    v_accvgpr_write_b32 a166, v5
    v_perm_b32 v6, v94, v92, s32
    v_accvgpr_write_b32 a167, v6
    v_perm_b32 v5, v83, v81, s31
    v_accvgpr_write_b32 a168, v5
    v_perm_b32 v6, v87, v85, s31
    v_accvgpr_write_b32 a169, v6
    v_perm_b32 v5, v91, v89, s31
    v_accvgpr_write_b32 a170, v5
    v_perm_b32 v6, v95, v93, s31
    v_accvgpr_write_b32 a171, v6
    v_perm_b32 v5, v83, v81, s32
    v_accvgpr_write_b32 a172, v5
    v_perm_b32 v6, v87, v85, s32
    v_accvgpr_write_b32 a173, v6
    v_perm_b32 v5, v91, v89, s32
    v_accvgpr_write_b32 a174, v5
    v_perm_b32 v6, v95, v93, s32
    v_accvgpr_write_b32 a175, v6
    s_waitcnt vmcnt(32)
    v_perm_b32 v5, v98, v96, s31
    v_accvgpr_write_b32 a176, v5
    v_perm_b32 v6, v102, v100, s31
    v_accvgpr_write_b32 a177, v6
    v_perm_b32 v5, v106, v104, s31
    v_accvgpr_write_b32 a178, v5
    v_perm_b32 v6, v110, v108, s31
    v_accvgpr_write_b32 a179, v6
    v_perm_b32 v5, v98, v96, s32
    v_accvgpr_write_b32 a180, v5
    v_perm_b32 v6, v102, v100, s32
    v_accvgpr_write_b32 a181, v6
    v_perm_b32 v5, v106, v104, s32
    v_accvgpr_write_b32 a182, v5
    v_perm_b32 v6, v110, v108, s32
    v_accvgpr_write_b32 a183, v6
    v_perm_b32 v5, v99, v97, s31
    v_accvgpr_write_b32 a184, v5
    v_perm_b32 v6, v103, v101, s31
    v_accvgpr_write_b32 a185, v6
    v_perm_b32 v5, v107, v105, s31
    v_accvgpr_write_b32 a186, v5
    v_perm_b32 v6, v111, v109, s31
    v_accvgpr_write_b32 a187, v6
    v_perm_b32 v5, v99, v97, s32
    v_accvgpr_write_b32 a188, v5
    v_perm_b32 v6, v103, v101, s32
    v_accvgpr_write_b32 a189, v6
    v_perm_b32 v5, v107, v105, s32
    v_accvgpr_write_b32 a190, v5
    v_perm_b32 v6, v111, v109, s32
    v_accvgpr_write_b32 a191, v6
    s_waitcnt vmcnt(24)
    v_perm_b32 v5, v18, v16, s31
    v_accvgpr_write_b32 a192, v5
    v_perm_b32 v6, v22, v20, s31
    v_accvgpr_write_b32 a193, v6
    v_perm_b32 v5, v26, v24, s31
    v_accvgpr_write_b32 a194, v5
    v_perm_b32 v6, v30, v28, s31
    v_accvgpr_write_b32 a195, v6
    v_perm_b32 v5, v18, v16, s32
    v_accvgpr_write_b32 a196, v5
    v_perm_b32 v6, v22, v20, s32
    v_accvgpr_write_b32 a197, v6
    v_perm_b32 v5, v26, v24, s32
    v_accvgpr_write_b32 a198, v5
    v_perm_b32 v6, v30, v28, s32
    v_accvgpr_write_b32 a199, v6
    v_perm_b32 v5, v19, v17, s31
    v_accvgpr_write_b32 a200, v5
    v_perm_b32 v6, v23, v21, s31
    v_accvgpr_write_b32 a201, v6
    v_perm_b32 v5, v27, v25, s31
    v_accvgpr_write_b32 a202, v5
    v_perm_b32 v6, v31, v29, s31
    v_accvgpr_write_b32 a203, v6
    v_perm_b32 v5, v19, v17, s32
    v_accvgpr_write_b32 a204, v5
    v_perm_b32 v6, v23, v21, s32
    v_accvgpr_write_b32 a205, v6
    v_perm_b32 v5, v27, v25, s32
    v_accvgpr_write_b32 a206, v5
    v_perm_b32 v6, v31, v29, s32
    v_accvgpr_write_b32 a207, v6
    s_waitcnt vmcnt(16)
    v_perm_b32 v5, v34, v32, s31
    v_accvgpr_write_b32 a208, v5
    v_perm_b32 v6, v38, v36, s31
    v_accvgpr_write_b32 a209, v6
    v_perm_b32 v5, v42, v40, s31
    v_accvgpr_write_b32 a210, v5
    v_perm_b32 v6, v46, v44, s31
    v_accvgpr_write_b32 a211, v6
    v_perm_b32 v5, v34, v32, s32
    v_accvgpr_write_b32 a212, v5
    v_perm_b32 v6, v38, v36, s32
    v_accvgpr_write_b32 a213, v6
    v_perm_b32 v5, v42, v40, s32
    v_accvgpr_write_b32 a214, v5
    v_perm_b32 v6, v46, v44, s32
    v_accvgpr_write_b32 a215, v6
    v_perm_b32 v5, v35, v33, s31
    v_accvgpr_write_b32 a216, v5
    v_perm_b32 v6, v39, v37, s31
    v_accvgpr_write_b32 a217, v6
    v_perm_b32 v5, v43, v41, s31
    v_accvgpr_write_b32 a218, v5
    v_perm_b32 v6, v47, v45, s31
    v_accvgpr_write_b32 a219, v6
    v_perm_b32 v5, v35, v33, s32
    v_accvgpr_write_b32 a220, v5
    v_perm_b32 v6, v39, v37, s32
    v_accvgpr_write_b32 a221, v6
    v_perm_b32 v5, v43, v41, s32
    v_accvgpr_write_b32 a222, v5
    v_perm_b32 v6, v47, v45, s32
    v_accvgpr_write_b32 a223, v6
    s_waitcnt vmcnt(8)
    v_perm_b32 v5, v50, v48, s31
    v_accvgpr_write_b32 a224, v5
    v_perm_b32 v6, v54, v52, s31
    v_accvgpr_write_b32 a225, v6
    v_perm_b32 v5, v58, v56, s31
    v_accvgpr_write_b32 a226, v5
    v_perm_b32 v6, v62, v60, s31
    v_accvgpr_write_b32 a227, v6
    v_perm_b32 v5, v50, v48, s32
    v_accvgpr_write_b32 a228, v5
    v_perm_b32 v6, v54, v52, s32
    v_accvgpr_write_b32 a229, v6
    v_perm_b32 v5, v58, v56, s32
    v_accvgpr_write_b32 a230, v5
    v_perm_b32 v6, v62, v60, s32
    v_accvgpr_write_b32 a231, v6
    v_perm_b32 v5, v51, v49, s31
    v_accvgpr_write_b32 a232, v5
    v_perm_b32 v6, v55, v53, s31
    v_accvgpr_write_b32 a233, v6
    v_perm_b32 v5, v59, v57, s31
    v_accvgpr_write_b32 a234, v5
    v_perm_b32 v6, v63, v61, s31
    v_accvgpr_write_b32 a235, v6
    v_perm_b32 v5, v51, v49, s32
    v_accvgpr_write_b32 a236, v5
    v_perm_b32 v6, v55, v53, s32
    v_accvgpr_write_b32 a237, v6
    v_perm_b32 v5, v59, v57, s32
    v_accvgpr_write_b32 a238, v5
    v_perm_b32 v6, v63, v61, s32
    v_accvgpr_write_b32 a239, v6
    s_waitcnt vmcnt(0)
    v_perm_b32 v5, v66, v64, s31
    v_accvgpr_write_b32 a240, v5
    v_perm_b32 v6, v70, v68, s31
    v_accvgpr_write_b32 a241, v6
    v_perm_b32 v5, v74, v72, s31
    v_accvgpr_write_b32 a242, v5
    v_perm_b32 v6, v78, v76, s31
    v_accvgpr_write_b32 a243, v6
    v_perm_b32 v5, v66, v64, s32
    v_accvgpr_write_b32 a244, v5
    v_perm_b32 v6, v70, v68, s32
    v_accvgpr_write_b32 a245, v6
    v_perm_b32 v5, v74, v72, s32
    v_accvgpr_write_b32 a246, v5
    v_perm_b32 v6, v78, v76, s32
    v_accvgpr_write_b32 a247, v6
    v_perm_b32 v5, v67, v65, s31
    v_accvgpr_write_b32 a248, v5
    v_perm_b32 v6, v71, v69, s31
    v_accvgpr_write_b32 a249, v6
    v_perm_b32 v5, v75, v73, s31
    v_accvgpr_write_b32 a250, v5
    v_perm_b32 v6, v79, v77, s31
    v_accvgpr_write_b32 a251, v6
    v_perm_b32 v5, v67, v65, s32
    v_accvgpr_write_b32 a252, v5
    v_perm_b32 v6, v71, v69, s32
    v_accvgpr_write_b32 a253, v6
    v_perm_b32 v5, v75, v73, s32
    v_accvgpr_write_b32 a254, v5
    v_perm_b32 v6, v79, v77, s32
    v_accvgpr_write_b32 a255, v6
    s_cmp_lg_u32 s95, 0
    s_cbranch_scc1 Lsc_100
    s_mov_b32 s18, 0
    s_mov_b32 s84, 34
    s_mov_b32 s85, 2
    s_mov_b32 s86, 1
    s_mov_b32 s87, 64
    s_mov_b32 s19, 64
    s_mov_b32 s88, 0
    s_mov_b32 s89, 1
    s_mov_b32 s90, 1
    s_mov_b32 s91, 64
    s_branch Lsc_99
Lsc_100:
    s_cmp_lg_u32 s95, 1
    s_cbranch_scc1 Lsc_101
    s_mov_b32 s18, 1
    s_mov_b32 s84, 0
    s_mov_b32 s85, 2
    s_mov_b32 s86, 2
    s_mov_b32 s87, 34
    s_mov_b32 s19, 0
    s_mov_b32 s88, 0
    s_mov_b32 s89, 1
    s_mov_b32 s90, 1
    s_mov_b32 s91, 64
    s_branch Lsc_99
Lsc_101:
Lsc_99:
    s_cmp_lg_u32 s16, 0
    s_cbranch_scc1 RQK_DW
    v_and_b32 v4, 63, v0
    v_lshlrev_b32 v4, 2, v4
Ldw_102:
    buffer_load_dword v3, v4, s[12:15], 0 offen sc1
    s_waitcnt vmcnt(0)
    s_mov_b32 s24, 0
    v_readlane_b32 s25, v3, 8
    s_add_u32 s24, s24, s25
    v_readlane_b32 s25, v3, 24
    s_add_u32 s24, s24, s25
    v_readlane_b32 s25, v3, 40
    s_add_u32 s24, s24, s25
    v_readlane_b32 s25, v3, 56
    s_add_u32 s24, s24, s25
    s_cmp_ge_u32 s24, 96
    s_cbranch_scc1 Ldw_103
    s_sleep 4
    s_memrealtime s[36:37]
    s_waitcnt lgkmcnt(0)
    s_sub_u32 s36, s36, s28
    s_cmp_gt_u32 s36, 3000000
    s_cbranch_scc1 RQK_DW
    s_branch Ldw_102
Ldw_103:
RQK_DW:
    s_mov_b32 s22, -1
    s_mov_b32 s20, -1
    s_mov_b32 s30, 0
RQK_B1:
    s_min_u32 s24, s18, s19
    s_cmp_ge_u32 s24, 64
    s_cbranch_scc1 E_QKV
    s_cmp_lg_u32 s16, 0
    s_cbranch_scc1 RQK_B3
RQK_B2:
    s_min_u32 s25, s18, 63
    s_lshl_b32 s24, s25, 8
    s_add_u32 s24, s24, 131072
    buffer_load_dword v3, v2, s[4:7], s24 offen sc1
    s_min_u32 s25, s19, 63
    s_lshl_b32 s24, s25, 8
    s_add_u32 s24, s24, 147456
    buffer_load_dword v4, v2, s[4:7], s24 offen sc1
    s_waitcnt vmcnt(0)
    v_readfirstlane_b32 s25, v3
    v_readfirstlane_b32 s26, v4
    s_mov_b32 s24, -1
    s_cmp_ge_u32 s18, 64
    s_cbranch_scc1 Lsk_104
    s_cmp_lg_u32 s25, 4
    s_cbranch_scc1 Lsk_104
    s_add_u32 s24, s18, 0
Lsk_104:
    s_cmp_ge_u32 s19, 64
    s_cbranch_scc1 Lsk_105
    s_cmp_lg_u32 s26, 4
    s_cbranch_scc1 Lsk_105
    s_add_u32 s24, s19, 64
Lsk_105:
    s_cmp_lg_u32 s24, -1
    s_cbranch_scc1 RQK_B2x
    s_sleep 2
    s_memrealtime s[36:37]
    s_waitcnt lgkmcnt(0)
    s_sub_u32 s36, s36, s28
    s_cmp_gt_u32 s36, 3000000
    s_cbranch_scc1 RQK_B2x
    s_branch RQK_B2
RQK_B2x:
    v_mov_b32 v5, s24
    v_mov_b32 v6, 163776
    ds_write_b32 v6, v5 offset:8
    s_waitcnt lgkmcnt(0)
RQK_B3:
    s_barrier
    v_mov_b32 v6, 163776
    ds_read_b32 v5, v6 offset:8
    s_waitcnt lgkmcnt(0)
    v_readfirstlane_b32 s20, v5
    s_cmp_eq_u32 s20, -1
    s_cbranch_scc1 E_QKV
RQK_GO:
    s_cmp_ge_u32 s20, 64
    s_cbranch_scc1 Lad_106
    s_cmp_ge_u32 s18, s84
    s_cselect_b32 s24, s86, s85
    s_add_u32 s18, s18, s24
    s_cmp_ge_u32 s18, s87
    s_cselect_b32 s18, 64, s18
    s_branch Lad_107
Lad_106:
    s_cmp_ge_u32 s19, s88
    s_cselect_b32 s24, s90, s89
    s_add_u32 s19, s19, s24
    s_cmp_ge_u32 s19, s91
    s_cselect_b32 s19, 64, s19
Lad_107:
    s_min_u32 s25, s18, 63
    s_lshl_b32 s24, s25, 8
    s_add_u32 s24, s24, 131072
    buffer_load_dword v3, v2, s[4:7], s24 offen sc1
    s_min_u32 s25, s19, 63
    s_lshl_b32 s24, s25, 8
    s_add_u32 s24, s24, 147456
    buffer_load_dword v4, v2, s[4:7], s24 offen sc1
    s_lshl_b32 s92, s20, 15
    s_lshl_b32 s93, s16, 13
    s_add_u32 s92, s92, s93
    s_add_u32 s92, s92, 6291456
    s_xor_b32 s94, s30, 1
    s_lshl_b32 s94, s94, 15
    s_add_u32 m0, s94, s93
    s_nop 0
    buffer_load_dwordx4 v9, s[4:7], s92 offen offset:0 sc1 lds
    buffer_load_dwordx4 v9, s[4:7], s92 offen offset:1024 sc1 lds
    buffer_load_dwordx4 v9, s[4:7], s92 offen offset:2048 sc1 lds
    buffer_load_dwordx4 v9, s[4:7], s92 offen offset:3072 sc1 lds
    s_add_u32 s92, s92, 4096
    s_add_u32 m0, m0, 4096
    s_nop 0
    buffer_load_dwordx4 v9, s[4:7], s92 offen offset:0 sc1 lds
    buffer_load_dwordx4 v9, s[4:7], s92 offen offset:1024 sc1 lds
    buffer_load_dwordx4 v9, s[4:7], s92 offen offset:2048 sc1 lds
    buffer_load_dwordx4 v9, s[4:7], s92 offen offset:3072 sc1 lds
    s_cmp_eq_u32 s22, -1
    s_cbranch_scc1 RQK_G1
    s_waitcnt vmcnt(10)
    s_barrier
    s_cmp_lg_u32 s16, 0
    s_cbranch_scc1 Lsg_108
    s_lshl_b32 s24, s22, 4
    s_add_u32 s24, s24, s41
    s_lshl_b32 s24, s24, 6
    s_cmp_eq_u32 s40, 0
    s_cselect_b32 s25, 1, 0x100
    v_mov_b32 v5, s25
    s_mov_b64 s[38:39], exec
    s_mov_b64 exec, 1
    buffer_atomic_add v5, v2, s[4:7], s24 offen
    s_mov_b64 exec, s[38:39]
Lsg_108:
    s_mov_b32 s22, -1
RQK_G1:
    s_waitcnt vmcnt(0)
RQK_TOP:
    s_xor_b32 s30, s30, 1
    s_cmp_lg_u32 s16, 0
    s_cbranch_scc1 Lw0_109
    v_readfirstlane_b32 s25, v3
    v_readfirstlane_b32 s26, v4
    s_mov_b32 s24, -1
    s_cmp_ge_u32 s18, 64
    s_cbranch_scc1 Lsk_110
    s_cmp_lg_u32 s25, 4
    s_cbranch_scc1 Lsk_110
    s_add_u32 s24, s18, 0
Lsk_110:
    s_cmp_ge_u32 s19, 64
    s_cbranch_scc1 Lsk_111
    s_cmp_lg_u32 s26, 4
    s_cbranch_scc1 Lsk_111
    s_add_u32 s24, s19, 64
Lsk_111:
    v_mov_b32 v5, s24
    v_mov_b32 v6, 163776
    ds_write_b32 v6, v5 offset:0
Lw0_109:
    s_lshl_b32 s24, s30, 15
    v_add_u32 v8, s24, v9
RQK_S1:
    s_waitcnt lgkmcnt(0)
    s_barrier
    v_mov_b32 v6, 163776
    ds_read_b32 v5, v6 offset:0
    s_waitcnt lgkmcnt(0)
    v_readfirstlane_b32 s21, v5
    s_cmp_eq_u32 s21, -1
    s_cbranch_scc1 RQK_T1
    s_cmp_ge_u32 s21, 64
    s_cbranch_scc1 Lad_112
    s_cmp_ge_u32 s18, s84
    s_cselect_b32 s24, s86, s85
    s_add_u32 s18, s18, s24
    s_cmp_ge_u32 s18, s87
    s_cselect_b32 s18, 64, s18
    s_branch Lad_113
Lad_112:
    s_cmp_ge_u32 s19, s88
    s_cselect_b32 s24, s90, s89
    s_add_u32 s19, s19, s24
    s_cmp_ge_u32 s19, s91
    s_cselect_b32 s19, 64, s19
Lad_113:
    s_lshl_b32 s92, s21, 15
    s_lshl_b32 s93, s16, 13
    s_add_u32 s92, s92, s93
    s_add_u32 s92, s92, 6291456
    s_xor_b32 s94, s30, 1
    s_lshl_b32 s94, s94, 15
    s_add_u32 m0, s94, s93
    s_nop 0
    ds_read_b128 v[80:83], v8 offset:0
    ds_read_b128 v[84:87], v8 offset:16384
    ds_read_b128 v[88:91], v8 offset:1024
    ds_read_b128 v[92:95], v8 offset:17408
    ds_read_b128 v[96:99], v8 offset:2048
    ds_read_b128 v[100:103], v8 offset:18432
    s_waitcnt lgkmcnt(4)
    v_mfma_f32_16x16x32_bf16 v[48:51], a[0:3], v[80:83], 0
    v_mfma_f32_16x16x32_bf16 v[52:55], a[4:7], v[80:83], 0
    v_mfma_f32_16x16x32_bf16 v[56:59], a[8:11], v[80:83], 0
    v_mfma_f32_16x16x32_bf16 v[60:63], a[12:15], v[80:83], 0
    ds_read_b128 v[104:107], v8 offset:3072
    ds_read_b128 v[108:111], v8 offset:19456
    v_mfma_f32_16x16x32_bf16 v[64:67], a[0:3], v[84:87], 0
    v_mfma_f32_16x16x32_bf16 v[68:71], a[4:7], v[84:87], 0
    v_mfma_f32_16x16x32_bf16 v[72:75], a[8:11], v[84:87], 0
    v_mfma_f32_16x16x32_bf16 v[76:79], a[12:15], v[84:87], 0
    buffer_load_dwordx4 v9, s[4:7], s92 offen offset:0 sc1 lds
    s_waitcnt lgkmcnt(4)
    v_mfma_f32_16x16x32_bf16 v[48:51], a[16:19], v[88:91], v[48:51]
    v_mfma_f32_16x16x32_bf16 v[52:55], a[20:23], v[88:91], v[52:55]
    v_mfma_f32_16x16x32_bf16 v[56:59], a[24:27], v[88:91], v[56:59]
    v_mfma_f32_16x16x32_bf16 v[60:63], a[28:31], v[88:91], v[60:63]
    ds_read_b128 v[80:83], v8 offset:4096
    ds_read_b128 v[84:87], v8 offset:20480
    v_mfma_f32_16x16x32_bf16 v[64:67], a[16:19], v[92:95], v[64:67]
    v_mfma_f32_16x16x32_bf16 v[68:71], a[20:23], v[92:95], v[68:71]
    v_mfma_f32_16x16x32_bf16 v[72:75], a[24:27], v[92:95], v[72:75]
    v_mfma_f32_16x16x32_bf16 v[76:79], a[28:31], v[92:95], v[76:79]
    buffer_load_dwordx4 v9, s[4:7], s92 offen offset:1024 sc1 lds
    s_waitcnt lgkmcnt(4)
    v_mfma_f32_16x16x32_bf16 v[48:51], a[32:35], v[96:99], v[48:51]
    v_mfma_f32_16x16x32_bf16 v[52:55], a[36:39], v[96:99], v[52:55]
    v_mfma_f32_16x16x32_bf16 v[56:59], a[40:43], v[96:99], v[56:59]
    v_mfma_f32_16x16x32_bf16 v[60:63], a[44:47], v[96:99], v[60:63]
    v_mfma_f32_16x16x32_bf16 v[64:67], a[32:35], v[100:103], v[64:67]
    v_mfma_f32_16x16x32_bf16 v[68:71], a[36:39], v[100:103], v[68:71]
    v_mfma_f32_16x16x32_bf16 v[72:75], a[40:43], v[100:103], v[72:75]
    v_mfma_f32_16x16x32_bf16 v[76:79], a[44:47], v[100:103], v[76:79]
    buffer_load_dwordx4 v9, s[4:7], s92 offen offset:2048 sc1 lds
    s_waitcnt lgkmcnt(2)
    v_mfma_f32_16x16x32_bf16 v[48:51], a[48:51], v[104:107], v[48:51]
    v_mfma_f32_16x16x32_bf16 v[52:55], a[52:55], v[104:107], v[52:55]
    v_mfma_f32_16x16x32_bf16 v[56:59], a[56:59], v[104:107], v[56:59]
    v_mfma_f32_16x16x32_bf16 v[60:63], a[60:63], v[104:107], v[60:63]
    v_mfma_f32_16x16x32_bf16 v[64:67], a[48:51], v[108:111], v[64:67]
    v_mfma_f32_16x16x32_bf16 v[68:71], a[52:55], v[108:111], v[68:71]
    v_mfma_f32_16x16x32_bf16 v[72:75], a[56:59], v[108:111], v[72:75]
    v_mfma_f32_16x16x32_bf16 v[76:79], a[60:63], v[108:111], v[76:79]
    buffer_load_dwordx4 v9, s[4:7], s92 offen offset:3072 sc1 lds
    s_waitcnt lgkmcnt(0)
    v_mfma_f32_16x16x32_bf16 v[48:51], a[64:67], v[80:83], v[48:51]
    v_mfma_f32_16x16x32_bf16 v[52:55], a[68:71], v[80:83], v[52:55]
    v_mfma_f32_16x16x32_bf16 v[56:59], a[72:75], v[80:83], v[56:59]
    v_mfma_f32_16x16x32_bf16 v[60:63], a[76:79], v[80:83], v[60:63]
    v_mfma_f32_16x16x32_bf16 v[64:67], a[64:67], v[84:87], v[64:67]
    v_mfma_f32_16x16x32_bf16 v[68:71], a[68:71], v[84:87], v[68:71]
    v_mfma_f32_16x16x32_bf16 v[72:75], a[72:75], v[84:87], v[72:75]
    v_mfma_f32_16x16x32_bf16 v[76:79], a[76:79], v[84:87], v[76:79]
    s_add_u32 s92, s92, 4096
    s_add_u32 m0, m0, 4096
    s_nop 0
    buffer_load_dwordx4 v9, s[4:7], s92 offen offset:0 sc1 lds
    s_waitcnt vmcnt(5) lgkmcnt(0)
    s_barrier
    s_cmp_eq_u32 s22, -1
    s_cbranch_scc1 Lms_114
    s_cmp_lg_u32 s16, 0
    s_cbranch_scc1 Lsg_115
    s_lshl_b32 s24, s22, 4
    s_add_u32 s24, s24, s41
    s_lshl_b32 s24, s24, 6
    s_cmp_eq_u32 s40, 0
    s_cselect_b32 s25, 1, 0x100
    v_mov_b32 v5, s25
    s_mov_b64 s[38:39], exec
    s_mov_b64 exec, 1
    buffer_atomic_add v5, v2, s[4:7], s24 offen
    s_mov_b64 exec, s[38:39]
Lsg_115:
    s_mov_b32 s22, -1
Lms_114:
    s_min_u32 s25, s18, 63
    s_lshl_b32 s24, s25, 8
    s_add_u32 s24, s24, 131072
    buffer_load_dword v3, v2, s[4:7], s24 offen sc1
    s_min_u32 s25, s19, 63
    s_lshl_b32 s24, s25, 8
    s_add_u32 s24, s24, 147456
    buffer_load_dword v4, v2, s[4:7], s24 offen sc1
    ds_read_b128 v[88:91], v8 offset:5120
    ds_read_b128 v[92:95], v8 offset:21504
    ds_read_b128 v[96:99], v8 offset:6144
    ds_read_b128 v[100:103], v8 offset:22528
    ds_read_b128 v[104:107], v8 offset:7168
    ds_read_b128 v[108:111], v8 offset:23552
    s_waitcnt lgkmcnt(4)
    v_mfma_f32_16x16x32_bf16 v[48:51], a[80:83], v[88:91], v[48:51]
    v_mfma_f32_16x16x32_bf16 v[52:55], a[84:87], v[88:91], v[52:55]
    v_mfma_f32_16x16x32_bf16 v[56:59], a[88:91], v[88:91], v[56:59]
    v_mfma_f32_16x16x32_bf16 v[60:63], a[92:95], v[88:91], v[60:63]
    ds_read_b128 v[80:83], v8 offset:8192
    ds_read_b128 v[84:87], v8 offset:24576
    v_mfma_f32_16x16x32_bf16 v[64:67], a[80:83], v[92:95], v[64:67]
    v_mfma_f32_16x16x32_bf16 v[68:71], a[84:87], v[92:95], v[68:71]
    v_mfma_f32_16x16x32_bf16 v[72:75], a[88:91], v[92:95], v[72:75]
    v_mfma_f32_16x16x32_bf16 v[76:79], a[92:95], v[92:95], v[76:79]
    buffer_load_dwordx4 v9, s[4:7], s92 offen offset:1024 sc1 lds
    s_waitcnt lgkmcnt(4)
    v_mfma_f32_16x16x32_bf16 v[48:51], a[96:99], v[96:99], v[48:51]
    v_mfma_f32_16x16x32_bf16 v[52:55], a[100:103], v[96:99], v[52:55]
    v_mfma_f32_16x16x32_bf16 v[56:59], a[104:107], v[96:99], v[56:59]
    v_mfma_f32_16x16x32_bf16 v[60:63], a[108:111], v[96:99], v[60:63]
    ds_read_b128 v[88:91], v8 offset:9216
    ds_read_b128 v[92:95], v8 offset:25600
    v_mfma_f32_16x16x32_bf16 v[64:67], a[96:99], v[100:103], v[64:67]
    v_mfma_f32_16x16x32_bf16 v[68:71], a[100:103], v[100:103], v[68:71]
    v_mfma_f32_16x16x32_bf16 v[72:75], a[104:107], v[100:103], v[72:75]
    v_mfma_f32_16x16x32_bf16 v[76:79], a[108:111], v[100:103], v[76:79]
    buffer_load_dwordx4 v9, s[4:7], s92 offen offset:2048 sc1 lds
    s_waitcnt lgkmcnt(4)
    v_mfma_f32_16x16x32_bf16 v[48:51], a[112:115], v[104:107], v[48:51]
    v_mfma_f32_16x16x32_bf16 v[52:55], a[116:119], v[104:107], v[52:55]
    v_mfma_f32_16x16x32_bf16 v[56:59], a[120:123], v[104:107], v[56:59]
    v_mfma_f32_16x16x32_bf16 v[60:63], a[124:127], v[104:107], v[60:63]
    ds_read_b128 v[96:99], v8 offset:10240
    ds_read_b128 v[100:103], v8 offset:26624
    v_mfma_f32_16x16x32_bf16 v[64:67], a[112:115], v[108:111], v[64:67]
    v_mfma_f32_16x16x32_bf16 v[68:71], a[116:119], v[108:111], v[68:71]
    v_mfma_f32_16x16x32_bf16 v[72:75], a[120:123], v[108:111], v[72:75]
    v_mfma_f32_16x16x32_bf16 v[76:79], a[124:127], v[108:111], v[76:79]
    buffer_load_dwordx4 v9, s[4:7], s92 offen offset:3072 sc1 lds
    s_waitcnt lgkmcnt(4)
    v_mfma_f32_16x16x32_bf16 v[48:51], a[128:131], v[80:83], v[48:51]
    v_mfma_f32_16x16x32_bf16 v[52:55], a[132:135], v[80:83], v[52:55]
    v_mfma_f32_16x16x32_bf16 v[56:59], a[136:139], v[80:83], v[56:59]
    v_mfma_f32_16x16x32_bf16 v[60:63], a[140:143], v[80:83], v[60:63]
    ds_read_b128 v[104:107], v8 offset:11264
    ds_read_b128 v[108:111], v8 offset:27648
    v_mfma_f32_16x16x32_bf16 v[64:67], a[128:131], v[84:87], v[64:67]
    v_mfma_f32_16x16x32_bf16 v[68:71], a[132:135], v[84:87], v[68:71]
    v_mfma_f32_16x16x32_bf16 v[72:75], a[136:139], v[84:87], v[72:75]
    v_mfma_f32_16x16x32_bf16 v[76:79], a[140:143], v[84:87], v[76:79]
    s_waitcnt lgkmcnt(4)
    v_mfma_f32_16x16x32_bf16 v[48:51], a[144:147], v[88:91], v[48:51]
    v_mfma_f32_16x16x32_bf16 v[52:55], a[148:151], v[88:91], v[52:55]
    v_mfma_f32_16x16x32_bf16 v[56:59], a[152:155], v[88:91], v[56:59]
    v_mfma_f32_16x16x32_bf16 v[60:63], a[156:159], v[88:91], v[60:63]
    ds_read_b128 v[80:83], v8 offset:12288
    ds_read_b128 v[84:87], v8 offset:28672
    v_mfma_f32_16x16x32_bf16 v[64:67], a[144:147], v[92:95], v[64:67]
    v_mfma_f32_16x16x32_bf16 v[68:71], a[148:151], v[92:95], v[68:71]
    v_mfma_f32_16x16x32_bf16 v[72:75], a[152:155], v[92:95], v[72:75]
    v_mfma_f32_16x16x32_bf16 v[76:79], a[156:159], v[92:95], v[76:79]
    s_waitcnt lgkmcnt(4)
    v_mfma_f32_16x16x32_bf16 v[48:51], a[160:163], v[96:99], v[48:51]
    v_mfma_f32_16x16x32_bf16 v[52:55], a[164:167], v[96:99], v[52:55]
    v_mfma_f32_16x16x32_bf16 v[56:59], a[168:171], v[96:99], v[56:59]
    v_mfma_f32_16x16x32_bf16 v[60:63], a[172:175], v[96:99], v[60:63]
    ds_read_b128 v[88:91], v8 offset:13312
    ds_read_b128 v[92:95], v8 offset:29696
    v_mfma_f32_16x16x32_bf16 v[64:67], a[160:163], v[100:103], v[64:67]
    v_mfma_f32_16x16x32_bf16 v[68:71], a[164:167], v[100:103], v[68:71]
    v_mfma_f32_16x16x32_bf16 v[72:75], a[168:171], v[100:103], v[72:75]
    v_mfma_f32_16x16x32_bf16 v[76:79], a[172:175], v[100:103], v[76:79]
    s_waitcnt lgkmcnt(4)
    v_mfma_f32_16x16x32_bf16 v[48:51], a[176:179], v[104:107], v[48:51]
    v_mfma_f32_16x16x32_bf16 v[52:55], a[180:183], v[104:107], v[52:55]
    v_mfma_f32_16x16x32_bf16 v[56:59], a[184:187], v[104:107], v[56:59]
    v_mfma_f32_16x16x32_bf16 v[60:63], a[188:191], v[104:107], v[60:63]
    ds_read_b128 v[96:99], v8 offset:14336
    ds_read_b128 v[100:103], v8 offset:30720
    v_mfma_f32_16x16x32_bf16 v[64:67], a[176:179], v[108:111], v[64:67]
    v_mfma_f32_16x16x32_bf16 v[68:71], a[180:183], v[108:111], v[68:71]
    v_mfma_f32_16x16x32_bf16 v[72:75], a[184:187], v[108:111], v[72:75]
    v_mfma_f32_16x16x32_bf16 v[76:79], a[188:191], v[108:111], v[76:79]
    s_waitcnt lgkmcnt(4)
    v_mfma_f32_16x16x32_bf16 v[48:51], a[192:195], v[80:83], v[48:51]
    v_mfma_f32_16x16x32_bf16 v[52:55], a[196:199], v[80:83], v[52:55]
    v_mfma_f32_16x16x32_bf16 v[56:59], a[200:203], v[80:83], v[56:59]
    v_mfma_f32_16x16x32_bf16 v[60:63], a[204:207], v[80:83], v[60:63]
    ds_read_b128 v[104:107], v8 offset:15360
    ds_read_b128 v[108:111], v8 offset:31744
    v_mfma_f32_16x16x32_bf16 v[64:67], a[192:195], v[84:87], v[64:67]
    v_mfma_f32_16x16x32_bf16 v[68:71], a[196:199], v[84:87], v[68:71]
    v_mfma_f32_16x16x32_bf16 v[72:75], a[200:203], v[84:87], v[72:75]
    v_mfma_f32_16x16x32_bf16 v[76:79], a[204:207], v[84:87], v[76:79]
    s_waitcnt lgkmcnt(4)
    v_mfma_f32_16x16x32_bf16 v[48:51], a[208:211], v[88:91], v[48:51]
    v_mfma_f32_16x16x32_bf16 v[52:55], a[212:215], v[88:91], v[52:55]
    v_mfma_f32_16x16x32_bf16 v[56:59], a[216:219], v[88:91], v[56:59]
    v_mfma_f32_16x16x32_bf16 v[60:63], a[220:223], v[88:91], v[60:63]
    v_mfma_f32_16x16x32_bf16 v[64:67], a[208:211], v[92:95], v[64:67]
    v_mfma_f32_16x16x32_bf16 v[68:71], a[212:215], v[92:95], v[68:71]
    v_mfma_f32_16x16x32_bf16 v[72:75], a[216:219], v[92:95], v[72:75]
    v_mfma_f32_16x16x32_bf16 v[76:79], a[220:223], v[92:95], v[76:79]
    s_waitcnt lgkmcnt(2)
    v_mfma_f32_16x16x32_bf16 v[48:51], a[224:227], v[96:99], v[48:51]
    v_mfma_f32_16x16x32_bf16 v[52:55], a[228:231], v[96:99], v[52:55]
    v_mfma_f32_16x16x32_bf16 v[56:59], a[232:235], v[96:99], v[56:59]
    v_mfma_f32_16x16x32_bf16 v[60:63], a[236:239], v[96:99], v[60:63]
    v_mfma_f32_16x16x32_bf16 v[64:67], a[224:227], v[100:103], v[64:67]
    v_mfma_f32_16x16x32_bf16 v[68:71], a[228:231], v[100:103], v[68:71]
    v_mfma_f32_16x16x32_bf16 v[72:75], a[232:235], v[100:103], v[72:75]
    v_mfma_f32_16x16x32_bf16 v[76:79], a[236:239], v[100:103], v[76:79]
    s_waitcnt lgkmcnt(0)
    v_mfma_f32_16x16x32_bf16 v[48:51], a[240:243], v[104:107], v[48:51]
    v_mfma_f32_16x16x32_bf16 v[52:55], a[244:247], v[104:107], v[52:55]
    v_mfma_f32_16x16x32_bf16 v[56:59], a[248:251], v[104:107], v[56:59]
    v_mfma_f32_16x16x32_bf16 v[60:63], a[252:255], v[104:107], v[60:63]
    v_mfma_f32_16x16x32_bf16 v[64:67], a[240:243], v[108:111], v[64:67]
    v_mfma_f32_16x16x32_bf16 v[68:71], a[244:247], v[108:111], v[68:71]
    v_mfma_f32_16x16x32_bf16 v[72:75], a[248:251], v[108:111], v[72:75]
    v_mfma_f32_16x16x32_bf16 v[76:79], a[252:255], v[108:111], v[76:79]
    s_branch RQK_T6
RQK_T1:
    s_min_u32 s25, s18, 63
    s_lshl_b32 s24, s25, 8
    s_add_u32 s24, s24, 131072
    buffer_load_dword v3, v2, s[4:7], s24 offen sc1
    s_min_u32 s25, s19, 63
    s_lshl_b32 s24, s25, 8
    s_add_u32 s24, s24, 147456
    buffer_load_dword v4, v2, s[4:7], s24 offen sc1
    ds_read_b128 v[80:83], v8 offset:0
    ds_read_b128 v[84:87], v8 offset:16384
    ds_read_b128 v[88:91], v8 offset:1024
    ds_read_b128 v[92:95], v8 offset:17408
    ds_read_b128 v[96:99], v8 offset:2048
    ds_read_b128 v[100:103], v8 offset:18432
    s_waitcnt lgkmcnt(4)
    v_mfma_f32_16x16x32_bf16 v[48:51], a[0:3], v[80:83], 0
    v_mfma_f32_16x16x32_bf16 v[52:55], a[4:7], v[80:83], 0
    v_mfma_f32_16x16x32_bf16 v[56:59], a[8:11], v[80:83], 0
    v_mfma_f32_16x16x32_bf16 v[60:63], a[12:15], v[80:83], 0
    ds_read_b128 v[104:107], v8 offset:3072
    ds_read_b128 v[108:111], v8 offset:19456
    v_mfma_f32_16x16x32_bf16 v[64:67], a[0:3], v[84:87], 0
    v_mfma_f32_16x16x32_bf16 v[68:71], a[4:7], v[84:87], 0
    v_mfma_f32_16x16x32_bf16 v[72:75], a[8:11], v[84:87], 0
    v_mfma_f32_16x16x32_bf16 v[76:79], a[12:15], v[84:87], 0
    s_waitcnt lgkmcnt(4)
    v_mfma_f32_16x16x32_bf16 v[48:51], a[16:19], v[88:91], v[48:51]
    v_mfma_f32_16x16x32_bf16 v[52:55], a[20:23], v[88:91], v[52:55]
    v_mfma_f32_16x16x32_bf16 v[56:59], a[24:27], v[88:91], v[56:59]
    v_mfma_f32_16x16x32_bf16 v[60:63], a[28:31], v[88:91], v[60:63]
    ds_read_b128 v[80:83], v8 offset:4096
    ds_read_b128 v[84:87], v8 offset:20480
    v_mfma_f32_16x16x32_bf16 v[64:67], a[16:19], v[92:95], v[64:67]
    v_mfma_f32_16x16x32_bf16 v[68:71], a[20:23], v[92:95], v[68:71]
    v_mfma_f32_16x16x32_bf16 v[72:75], a[24:27], v[92:95], v[72:75]
    v_mfma_f32_16x16x32_bf16 v[76:79], a[28:31], v[92:95], v[76:79]
    s_waitcnt lgkmcnt(4)
    v_mfma_f32_16x16x32_bf16 v[48:51], a[32:35], v[96:99], v[48:51]
    v_mfma_f32_16x16x32_bf16 v[52:55], a[36:39], v[96:99], v[52:55]
    v_mfma_f32_16x16x32_bf16 v[56:59], a[40:43], v[96:99], v[56:59]
    v_mfma_f32_16x16x32_bf16 v[60:63], a[44:47], v[96:99], v[60:63]
    v_mfma_f32_16x16x32_bf16 v[64:67], a[32:35], v[100:103], v[64:67]
    v_mfma_f32_16x16x32_bf16 v[68:71], a[36:39], v[100:103], v[68:71]
    v_mfma_f32_16x16x32_bf16 v[72:75], a[40:43], v[100:103], v[72:75]
    v_mfma_f32_16x16x32_bf16 v[76:79], a[44:47], v[100:103], v[76:79]
    s_waitcnt lgkmcnt(2)
    v_mfma_f32_16x16x32_bf16 v[48:51], a[48:51], v[104:107], v[48:51]
    v_mfma_f32_16x16x32_bf16 v[52:55], a[52:55], v[104:107], v[52:55]
    v_mfma_f32_16x16x32_bf16 v[56:59], a[56:59], v[104:107], v[56:59]
    v_mfma_f32_16x16x32_bf16 v[60:63], a[60:63], v[104:107], v[60:63]
    v_mfma_f32_16x16x32_bf16 v[64:67], a[48:51], v[108:111], v[64:67]
    v_mfma_f32_16x16x32_bf16 v[68:71], a[52:55], v[108:111], v[68:71]
    v_mfma_f32_16x16x32_bf16 v[72:75], a[56:59], v[108:111], v[72:75]
    v_mfma_f32_16x16x32_bf16 v[76:79], a[60:63], v[108:111], v[76:79]
    s_waitcnt lgkmcnt(0)
    v_mfma_f32_16x16x32_bf16 v[48:51], a[64:67], v[80:83], v[48:51]
    v_mfma_f32_16x16x32_bf16 v[52:55], a[68:71], v[80:83], v[52:55]
    v_mfma_f32_16x16x32_bf16 v[56:59], a[72:75], v[80:83], v[56:59]
    v_mfma_f32_16x16x32_bf16 v[60:63], a[76:79], v[80:83], v[60:63]
    v_mfma_f32_16x16x32_bf16 v[64:67], a[64:67], v[84:87], v[64:67]
    v_mfma_f32_16x16x32_bf16 v[68:71], a[68:71], v[84:87], v[68:71]
    v_mfma_f32_16x16x32_bf16 v[72:75], a[72:75], v[84:87], v[72:75]
    v_mfma_f32_16x16x32_bf16 v[76:79], a[76:79], v[84:87], v[76:79]
    s_waitcnt vmcnt(0)
    s_cmp_lg_u32 s16, 0
    s_cbranch_scc1 Lw0_116
    v_readfirstlane_b32 s25, v3
    v_readfirstlane_b32 s26, v4
    s_mov_b32 s24, -1
    s_cmp_ge_u32 s18, 64
    s_cbranch_scc1 Lsk_117
    s_cmp_lg_u32 s25, 4
    s_cbranch_scc1 Lsk_117
    s_add_u32 s24, s18, 0
Lsk_117:
    s_cmp_ge_u32 s19, 64
    s_cbranch_scc1 Lsk_118
    s_cmp_lg_u32 s26, 4
    s_cbranch_scc1 Lsk_118
    s_add_u32 s24, s19, 64
Lsk_118:
    v_mov_b32 v5, s24
    v_mov_b32 v6, 163776
    ds_write_b32 v6, v5 offset:4
Lw0_116:
    s_waitcnt lgkmcnt(0)
    s_barrier
    v_mov_b32 v6, 163776
    ds_read_b32 v5, v6 offset:4
    s_waitcnt lgkmcnt(0)
    v_readfirstlane_b32 s21, v5
    s_cmp_eq_u32 s21, -1
    s_cbranch_scc1 RQK_T4
    s_cmp_ge_u32 s21, 64
    s_cbranch_scc1 Lad_119
    s_cmp_ge_u32 s18, s84
    s_cselect_b32 s24, s86, s85
    s_add_u32 s18, s18, s24
    s_cmp_ge_u32 s18, s87
    s_cselect_b32 s18, 64, s18
    s_branch Lad_120
Lad_119:
    s_cmp_ge_u32 s19, s88
    s_cselect_b32 s24, s90, s89
    s_add_u32 s19, s19, s24
    s_cmp_ge_u32 s19, s91
    s_cselect_b32 s19, 64, s19
Lad_120:
    s_cmp_eq_u32 s22, -1
    s_cbranch_scc1 Lms_121
    s_cmp_lg_u32 s16, 0
    s_cbranch_scc1 Lsg_122
    s_lshl_b32 s24, s22, 4
    s_add_u32 s24, s24, s41
    s_lshl_b32 s24, s24, 6
    s_cmp_eq_u32 s40, 0
    s_cselect_b32 s25, 1, 0x100
    v_mov_b32 v5, s25
    s_mov_b64 s[38:39], exec
    s_mov_b64 exec, 1
    buffer_atomic_add v5, v2, s[4:7], s24 offen
    s_mov_b64 exec, s[38:39]
Lsg_122:
    s_mov_b32 s22, -1
Lms_121:
    s_min_u32 s25, s18, 63
    s_lshl_b32 s24, s25, 8
    s_add_u32 s24, s24, 131072
    buffer_load_dword v3, v2, s[4:7], s24 offen sc1
    s_min_u32 s25, s19, 63
    s_lshl_b32 s24, s25, 8
    s_add_u32 s24, s24, 147456
    buffer_load_dword v4, v2, s[4:7], s24 offen sc1
    s_lshl_b32 s92, s21, 15
    s_lshl_b32 s93, s16, 13
    s_add_u32 s92, s92, s93
    s_add_u32 s92, s92, 6291456
    s_xor_b32 s94, s30, 1
    s_lshl_b32 s94, s94, 15
    s_add_u32 m0, s94, s93
    s_nop 0
    ds_read_b128 v[88:91], v8 offset:5120
    ds_read_b128 v[92:95], v8 offset:21504
    ds_read_b128 v[96:99], v8 offset:6144
    ds_read_b128 v[100:103], v8 offset:22528
    ds_read_b128 v[104:107], v8 offset:7168
    ds_read_b128 v[108:111], v8 offset:23552
    s_waitcnt lgkmcnt(4)
    v_mfma_f32_16x16x32_bf16 v[48:51], a[80:83], v[88:91], v[48:51]
    v_mfma_f32_16x16x32_bf16 v[52:55], a[84:87], v[88:91], v[52:55]
    v_mfma_f32_16x16x32_bf16 v[56:59], a[88:91], v[88:91], v[56:59]
    v_mfma_f32_16x16x32_bf16 v[60:63], a[92:95], v[88:91], v[60:63]
    ds_read_b128 v[80:83], v8 offset:8192
    ds_read_b128 v[84:87], v8 offset:24576
    v_mfma_f32_16x16x32_bf16 v[64:67], a[80:83], v[92:95], v[64:67]
    v_mfma_f32_16x16x32_bf16 v[68:71], a[84:87], v[92:95], v[68:71]
    v_mfma_f32_16x16x32_bf16 v[72:75], a[88:91], v[92:95], v[72:75]
    v_mfma_f32_16x16x32_bf16 v[76:79], a[92:95], v[92:95], v[76:79]
    buffer_load_dwordx4 v9, s[4:7], s92 offen offset:0 sc1 lds
    s_waitcnt lgkmcnt(4)
    v_mfma_f32_16x16x32_bf16 v[48:51], a[96:99], v[96:99], v[48:51]
    v_mfma_f32_16x16x32_bf16 v[52:55], a[100:103], v[96:99], v[52:55]
    v_mfma_f32_16x16x32_bf16 v[56:59], a[104:107], v[96:99], v[56:59]
    v_mfma_f32_16x16x32_bf16 v[60:63], a[108:111], v[96:99], v[60:63]
    ds_read_b128 v[88:91], v8 offset:9216
    ds_read_b128 v[92:95], v8 offset:25600
    v_mfma_f32_16x16x32_bf16 v[64:67], a[96:99], v[100:103], v[64:67]
    v_mfma_f32_16x16x32_bf16 v[68:71], a[100:103], v[100:103], v[68:71]
    v_mfma_f32_16x16x32_bf16 v[72:75], a[104:107], v[100:103], v[72:75]
    v_mfma_f32_16x16x32_bf16 v[76:79], a[108:111], v[100:103], v[76:79]
    buffer_load_dwordx4 v9, s[4:7], s92 offen offset:1024 sc1 lds
    s_waitcnt lgkmcnt(4)
    v_mfma_f32_16x16x32_bf16 v[48:51], a[112:115], v[104:107], v[48:51]
    v_mfma_f32_16x16x32_bf16 v[52:55], a[116:119], v[104:107], v[52:55]
    v_mfma_f32_16x16x32_bf16 v[56:59], a[120:123], v[104:107], v[56:59]
    v_mfma_f32_16x16x32_bf16 v[60:63], a[124:127], v[104:107], v[60:63]
    ds_read_b128 v[96:99], v8 offset:10240
    ds_read_b128 v[100:103], v8 offset:26624
    v_mfma_f32_16x16x32_bf16 v[64:67], a[112:115], v[108:111], v[64:67]
    v_mfma_f32_16x16x32_bf16 v[68:71], a[116:119], v[108:111], v[68:71]
    v_mfma_f32_16x16x32_bf16 v[72:75], a[120:123], v[108:111], v[72:75]
    v_mfma_f32_16x16x32_bf16 v[76:79], a[124:127], v[108:111], v[76:79]
    buffer_load_dwordx4 v9, s[4:7], s92 offen offset:2048 sc1 lds
    s_waitcnt lgkmcnt(4)
    v_mfma_f32_16x16x32_bf16 v[48:51], a[128:131], v[80:83], v[48:51]
    v_mfma_f32_16x16x32_bf16 v[52:55], a[132:135], v[80:83], v[52:55]
    v_mfma_f32_16x16x32_bf16 v[56:59], a[136:139], v[80:83], v[56:59]
    v_mfma_f32_16x16x32_bf16 v[60:63], a[140:143], v[80:83], v[60:63]
    ds_read_b128 v[104:107], v8 offset:11264
    ds_read_b128 v[108:111], v8 offset:27648
    v_mfma_f32_16x16x32_bf16 v[64:67], a[128:131], v[84:87], v[64:67]
    v_mfma_f32_16x16x32_bf16 v[68:71], a[132:135], v[84:87], v[68:71]
    v_mfma_f32_16x16x32_bf16 v[72:75], a[136:139], v[84:87], v[72:75]
    v_mfma_f32_16x16x32_bf16 v[76:79], a[140:143], v[84:87], v[76:79]
    buffer_load_dwordx4 v9, s[4:7], s92 offen offset:3072 sc1 lds
    s_waitcnt lgkmcnt(4)
    v_mfma_f32_16x16x32_bf16 v[48:51], a[144:147], v[88:91], v[48:51]
    v_mfma_f32_16x16x32_bf16 v[52:55], a[148:151], v[88:91], v[52:55]
    v_mfma_f32_16x16x32_bf16 v[56:59], a[152:155], v[88:91], v[56:59]
    v_mfma_f32_16x16x32_bf16 v[60:63], a[156:159], v[88:91], v[60:63]
    ds_read_b128 v[80:83], v8 offset:12288
    ds_read_b128 v[84:87], v8 offset:28672
    v_mfma_f32_16x16x32_bf16 v[64:67], a[144:147], v[92:95], v[64:67]
    v_mfma_f32_16x16x32_bf16 v[68:71], a[148:151], v[92:95], v[68:71]
    v_mfma_f32_16x16x32_bf16 v[72:75], a[152:155], v[92:95], v[72:75]
    v_mfma_f32_16x16x32_bf16 v[76:79], a[156:159], v[92:95], v[76:79]
    s_add_u32 s92, s92, 4096
    s_add_u32 m0, m0, 4096
    s_nop 0
    buffer_load_dwordx4 v9, s[4:7], s92 offen offset:0 sc1 lds
    s_waitcnt lgkmcnt(4)
    v_mfma_f32_16x16x32_bf16 v[48:51], a[160:163], v[96:99], v[48:51]
    v_mfma_f32_16x16x32_bf16 v[52:55], a[164:167], v[96:99], v[52:55]
    v_mfma_f32_16x16x32_bf16 v[56:59], a[168:171], v[96:99], v[56:59]
    v_mfma_f32_16x16x32_bf16 v[60:63], a[172:175], v[96:99], v[60:63]
    ds_read_b128 v[88:91], v8 offset:13312
    ds_read_b128 v[92:95], v8 offset:29696
    v_mfma_f32_16x16x32_bf16 v[64:67], a[160:163], v[100:103], v[64:67]
    v_mfma_f32_16x16x32_bf16 v[68:71], a[164:167], v[100:103], v[68:71]
    v_mfma_f32_16x16x32_bf16 v[72:75], a[168:171], v[100:103], v[72:75]
    v_mfma_f32_16x16x32_bf16 v[76:79], a[172:175], v[100:103], v[76:79]
    buffer_load_dwordx4 v9, s[4:7], s92 offen offset:1024 sc1 lds
    s_waitcnt lgkmcnt(4)
    v_mfma_f32_16x16x32_bf16 v[48:51], a[176:179], v[104:107], v[48:51]
    v_mfma_f32_16x16x32_bf16 v[52:55], a[180:183], v[104:107], v[52:55]
    v_mfma_f32_16x16x32_bf16 v[56:59], a[184:187], v[104:107], v[56:59]
    v_mfma_f32_16x16x32_bf16 v[60:63], a[188:191], v[104:107], v[60:63]
    ds_read_b128 v[96:99], v8 offset:14336
    ds_read_b128 v[100:103], v8 offset:30720
    v_mfma_f32_16x16x32_bf16 v[64:67], a[176:179], v[108:111], v[64:67]
    v_mfma_f32_16x16x32_bf16 v[68:71], a[180:183], v[108:111], v[68:71]
    v_mfma_f32_16x16x32_bf16 v[72:75], a[184:187], v[108:111], v[72:75]
    v_mfma_f32_16x16x32_bf16 v[76:79], a[188:191], v[108:111], v[76:79]
    buffer_load_dwordx4 v9, s[4:7], s92 offen offset:2048 sc1 lds
    s_waitcnt lgkmcnt(4)
    v_mfma_f32_16x16x32_bf16 v[48:51], a[192:195], v[80:83], v[48:51]
    v_mfma_f32_16x16x32_bf16 v[52:55], a[196:199], v[80:83], v[52:55]
    v_mfma_f32_16x16x32_bf16 v[56:59], a[200:203], v[80:83], v[56:59]
    v_mfma_f32_16x16x32_bf16 v[60:63], a[204:207], v[80:83], v[60:63]
    ds_read_b128 v[104:107], v8 offset:15360
    ds_read_b128 v[108:111], v8 offset:31744
    v_mfma_f32_16x16x32_bf16 v[64:67], a[192:195], v[84:87], v[64:67]
    v_mfma_f32_16x16x32_bf16 v[68:71], a[196:199], v[84:87], v[68:71]
    v_mfma_f32_16x16x32_bf16 v[72:75], a[200:203], v[84:87], v[72:75]
    v_mfma_f32_16x16x32_bf16 v[76:79], a[204:207], v[84:87], v[76:79]
    buffer_load_dwordx4 v9, s[4:7], s92 offen offset:3072 sc1 lds
    s_waitcnt lgkmcnt(4)
    v_mfma_f32_16x16x32_bf16 v[48:51], a[208:211], v[88:91], v[48:51]
    v_mfma_f32_16x16x32_bf16 v[52:55], a[212:215], v[88:91], v[52:55]
    v_mfma_f32_16x16x32_bf16 v[56:59], a[216:219], v[88:91], v[56:59]
    v_mfma_f32_16x16x32_bf16 v[60:63], a[220:223], v[88:91], v[60:63]
    v_mfma_f32_16x16x32_bf16 v[64:67], a[208:211], v[92:95], v[64:67]
    v_mfma_f32_16x16x32_bf16 v[68:71], a[212:215], v[92:95], v[68:71]
    v_mfma_f32_16x16x32_bf16 v[72:75], a[216:219], v[92:95], v[72:75]
    v_mfma_f32_16x16x32_bf16 v[76:79], a[220:223], v[92:95], v[76:79]
    s_waitcnt lgkmcnt(2)
    v_mfma_f32_16x16x32_bf16 v[48:51], a[224:227], v[96:99], v[48:51]
    v_mfma_f32_16x16x32_bf16 v[52:55], a[228:231], v[96:99], v[52:55]
    v_mfma_f32_16x16x32_bf16 v[56:59], a[232:235], v[96:99], v[56:59]
    v_mfma_f32_16x16x32_bf16 v[60:63], a[236:239], v[96:99], v[60:63]
    v_mfma_f32_16x16x32_bf16 v[64:67], a[224:227], v[100:103], v[64:67]
    v_mfma_f32_16x16x32_bf16 v[68:71], a[228:231], v[100:103], v[68:71]
    v_mfma_f32_16x16x32_bf16 v[72:75], a[232:235], v[100:103], v[72:75]
    v_mfma_f32_16x16x32_bf16 v[76:79], a[236:239], v[100:103], v[76:79]
    s_waitcnt lgkmcnt(0)
    v_mfma_f32_16x16x32_bf16 v[48:51], a[240:243], v[104:107], v[48:51]
    v_mfma_f32_16x16x32_bf16 v[52:55], a[244:247], v[104:107], v[52:55]
    v_mfma_f32_16x16x32_bf16 v[56:59], a[248:251], v[104:107], v[56:59]
    v_mfma_f32_16x16x32_bf16 v[60:63], a[252:255], v[104:107], v[60:63]
    v_mfma_f32_16x16x32_bf16 v[64:67], a[240:243], v[108:111], v[64:67]
    v_mfma_f32_16x16x32_bf16 v[68:71], a[244:247], v[108:111], v[68:71]
    v_mfma_f32_16x16x32_bf16 v[72:75], a[248:251], v[108:111], v[72:75]
    v_mfma_f32_16x16x32_bf16 v[76:79], a[252:255], v[108:111], v[76:79]
    s_branch RQK_T6
RQK_T4:
    s_cmp_eq_u32 s22, -1
    s_cbranch_scc1 Lms_123
    s_cmp_lg_u32 s16, 0
    s_cbranch_scc1 Lsg_124
    s_lshl_b32 s24, s22, 4
    s_add_u32 s24, s24, s41
    s_lshl_b32 s24, s24, 6
    s_cmp_eq_u32 s40, 0
    s_cselect_b32 s25, 1, 0x100
    v_mov_b32 v5, s25
    s_mov_b64 s[38:39], exec
    s_mov_b64 exec, 1
    buffer_atomic_add v5, v2, s[4:7], s24 offen
    s_mov_b64 exec, s[38:39]
Lsg_124:
    s_mov_b32 s22, -1
Lms_123:
    s_min_u32 s25, s18, 63
    s_lshl_b32 s24, s25, 8
    s_add_u32 s24, s24, 131072
    buffer_load_dword v3, v2, s[4:7], s24 offen sc1
    s_min_u32 s25, s19, 63
    s_lshl_b32 s24, s25, 8
    s_add_u32 s24, s24, 147456
    buffer_load_dword v4, v2, s[4:7], s24 offen sc1
    ds_read_b128 v[88:91], v8 offset:5120
    ds_read_b128 v[92:95], v8 offset:21504
    ds_read_b128 v[96:99], v8 offset:6144
    ds_read_b128 v[100:103], v8 offset:22528
    ds_read_b128 v[104:107], v8 offset:7168
    ds_read_b128 v[108:111], v8 offset:23552
    s_waitcnt lgkmcnt(4)
    v_mfma_f32_16x16x32_bf16 v[48:51], a[80:83], v[88:91], v[48:51]
    v_mfma_f32_16x16x32_bf16 v[52:55], a[84:87], v[88:91], v[52:55]
    v_mfma_f32_16x16x32_bf16 v[56:59], a[88:91], v[88:91], v[56:59]
    v_mfma_f32_16x16x32_bf16 v[60:63], a[92:95], v[88:91], v[60:63]
    ds_read_b128 v[80:83], v8 offset:8192
    ds_read_b128 v[84:87], v8 offset:24576
    v_mfma_f32_16x16x32_bf16 v[64:67], a[80:83], v[92:95], v[64:67]
    v_mfma_f32_16x16x32_bf16 v[68:71], a[84:87], v[92:95], v[68:71]
    v_mfma_f32_16x16x32_bf16 v[72:75], a[88:91], v[92:95], v[72:75]
    v_mfma_f32_16x16x32_bf16 v[76:79], a[92:95], v[92:95], v[76:79]
    s_waitcnt lgkmcnt(4)
    v_mfma_f32_16x16x32_bf16 v[48:51], a[96:99], v[96:99], v[48:51]
    v_mfma_f32_16x16x32_bf16 v[52:55], a[100:103], v[96:99], v[52:55]
    v_mfma_f32_16x16x32_bf16 v[56:59], a[104:107], v[96:99], v[56:59]
    v_mfma_f32_16x16x32_bf16 v[60:63], a[108:111], v[96:99], v[60:63]
    ds_read_b128 v[88:91], v8 offset:9216
    ds_read_b128 v[92:95], v8 offset:25600
    v_mfma_f32_16x16x32_bf16 v[64:67], a[96:99], v[100:103], v[64:67]
    v_mfma_f32_16x16x32_bf16 v[68:71], a[100:103], v[100:103], v[68:71]
    v_mfma_f32_16x16x32_bf16 v[72:75], a[104:107], v[100:103], v[72:75]
    v_mfma_f32_16x16x32_bf16 v[76:79], a[108:111], v[100:103], v[76:79]
    s_waitcnt lgkmcnt(4)
    v_mfma_f32_16x16x32_bf16 v[48:51], a[112:115], v[104:107], v[48:51]
    v_mfma_f32_16x16x32_bf16 v[52:55], a[116:119], v[104:107], v[52:55]
    v_mfma_f32_16x16x32_bf16 v[56:59], a[120:123], v[104:107], v[56:59]
    v_mfma_f32_16x16x32_bf16 v[60:63], a[124:127], v[104:107], v[60:63]
    ds_read_b128 v[96:99], v8 offset:10240
    ds_read_b128 v[100:103], v8 offset:26624
    v_mfma_f32_16x16x32_bf16 v[64:67], a[112:115], v[108:111], v[64:67]
    v_mfma_f32_16x16x32_bf16 v[68:71], a[116:119], v[108:111], v[68:71]
    v_mfma_f32_16x16x32_bf16 v[72:75], a[120:123], v[108:111], v[72:75]
    v_mfma_f32_16x16x32_bf16 v[76:79], a[124:127], v[108:111], v[76:79]
    s_waitcnt lgkmcnt(4)
    v_mfma_f32_16x16x32_bf16 v[48:51], a[128:131], v[80:83], v[48:51]
    v_mfma_f32_16x16x32_bf16 v[52:55], a[132:135], v[80:83], v[52:55]
    v_mfma_f32_16x16x32_bf16 v[56:59], a[136:139], v[80:83], v[56:59]
    v_mfma_f32_16x16x32_bf16 v[60:63], a[140:143], v[80:83], v[60:63]
    ds_read_b128 v[104:107], v8 offset:11264
    ds_read_b128 v[108:111], v8 offset:27648
    v_mfma_f32_16x16x32_bf16 v[64:67], a[128:131], v[84:87], v[64:67]
    v_mfma_f32_16x16x32_bf16 v[68:71], a[132:135], v[84:87], v[68:71]
    v_mfma_f32_16x16x32_bf16 v[72:75], a[136:139], v[84:87], v[72:75]
    v_mfma_f32_16x16x32_bf16 v[76:79], a[140:143], v[84:87], v[76:79]
    s_waitcnt lgkmcnt(4)
    v_mfma_f32_16x16x32_bf16 v[48:51], a[144:147], v[88:91], v[48:51]
    v_mfma_f32_16x16x32_bf16 v[52:55], a[148:151], v[88:91], v[52:55]
    v_mfma_f32_16x16x32_bf16 v[56:59], a[152:155], v[88:91], v[56:59]
    v_mfma_f32_16x16x32_bf16 v[60:63], a[156:159], v[88:91], v[60:63]
    ds_read_b128 v[80:83], v8 offset:12288
    ds_read_b128 v[84:87], v8 offset:28672
    v_mfma_f32_16x16x32_bf16 v[64:67], a[144:147], v[92:95], v[64:67]
    v_mfma_f32_16x16x32_bf16 v[68:71], a[148:151], v[92:95], v[68:71]
    v_mfma_f32_16x16x32_bf16 v[72:75], a[152:155], v[92:95], v[72:75]
    v_mfma_f32_16x16x32_bf16 v[76:79], a[156:159], v[92:95], v[76:79]
    s_waitcnt lgkmcnt(4)
    v_mfma_f32_16x16x32_bf16 v[48:51], a[160:163], v[96:99], v[48:51]
    v_mfma_f32_16x16x32_bf16 v[52:55], a[164:167], v[96:99], v[52:55]
    v_mfma_f32_16x16x32_bf16 v[56:59], a[168:171], v[96:99], v[56:59]
    v_mfma_f32_16x16x32_bf16 v[60:63], a[172:175], v[96:99], v[60:63]
    ds_read_b128 v[88:91], v8 offset:13312
    ds_read_b128 v[92:95], v8 offset:29696
    v_mfma_f32_16x16x32_bf16 v[64:67], a[160:163], v[100:103], v[64:67]
    v_mfma_f32_16x16x32_bf16 v[68:71], a[164:167], v[100:103], v[68:71]
    v_mfma_f32_16x16x32_bf16 v[72:75], a[168:171], v[100:103], v[72:75]
    v_mfma_f32_16x16x32_bf16 v[76:79], a[172:175], v[100:103], v[76:79]
    s_waitcnt lgkmcnt(4)
    v_mfma_f32_16x16x32_bf16 v[48:51], a[176:179], v[104:107], v[48:51]
    v_mfma_f32_16x16x32_bf16 v[52:55], a[180:183], v[104:107], v[52:55]
    v_mfma_f32_16x16x32_bf16 v[56:59], a[184:187], v[104:107], v[56:59]
    v_mfma_f32_16x16x32_bf16 v[60:63], a[188:191], v[104:107], v[60:63]
    ds_read_b128 v[96:99], v8 offset:14336
    ds_read_b128 v[100:103], v8 offset:30720
    v_mfma_f32_16x16x32_bf16 v[64:67], a[176:179], v[108:111], v[64:67]
    v_mfma_f32_16x16x32_bf16 v[68:71], a[180:183], v[108:111], v[68:71]
    v_mfma_f32_16x16x32_bf16 v[72:75], a[184:187], v[108:111], v[72:75]
    v_mfma_f32_16x16x32_bf16 v[76:79], a[188:191], v[108:111], v[76:79]
    s_waitcnt lgkmcnt(4)
    v_mfma_f32_16x16x32_bf16 v[48:51], a[192:195], v[80:83], v[48:51]
    v_mfma_f32_16x16x32_bf16 v[52:55], a[196:199], v[80:83], v[52:55]
    v_mfma_f32_16x16x32_bf16 v[56:59], a[200:203], v[80:83], v[56:59]
    v_mfma_f32_16x16x32_bf16 v[60:63], a[204:207], v[80:83], v[60:63]
    ds_read_b128 v[104:107], v8 offset:15360
    ds_read_b128 v[108:111], v8 offset:31744
    v_mfma_f32_16x16x32_bf16 v[64:67], a[192:195], v[84:87], v[64:67]
    v_mfma_f32_16x16x32_bf16 v[68:71], a[196:199], v[84:87], v[68:71]
    v_mfma_f32_16x16x32_bf16 v[72:75], a[200:203], v[84:87], v[72:75]
    v_mfma_f32_16x16x32_bf16 v[76:79], a[204:207], v[84:87], v[76:79]
    s_waitcnt lgkmcnt(4)
    v_mfma_f32_16x16x32_bf16 v[48:51], a[208:211], v[88:91], v[48:51]
    v_mfma_f32_16x16x32_bf16 v[52:55], a[212:215], v[88:91], v[52:55]
    v_mfma_f32_16x16x32_bf16 v[56:59], a[216:219], v[88:91], v[56:59]
    v_mfma_f32_16x16x32_bf16 v[60:63], a[220:223], v[88:91], v[60:63]
    v_mfma_f32_16x16x32_bf16 v[64:67], a[208:211], v[92:95], v[64:67]
    v_mfma_f32_16x16x32_bf16 v[68:71], a[212:215], v[92:95], v[68:71]
    v_mfma_f32_16x16x32_bf16 v[72:75], a[216:219], v[92:95], v[72:75]
    v_mfma_f32_16x16x32_bf16 v[76:79], a[220:223], v[92:95], v[76:79]
    s_waitcnt lgkmcnt(2)
    v_mfma_f32_16x16x32_bf16 v[48:51], a[224:227], v[96:99], v[48:51]
    v_mfma_f32_16x16x32_bf16 v[52:55], a[228:231], v[96:99], v[52:55]
    v_mfma_f32_16x16x32_bf16 v[56:59], a[232:235], v[96:99], v[56:59]
    v_mfma_f32_16x16x32_bf16 v[60:63], a[236:239], v[96:99], v[60:63]
    v_mfma_f32_16x16x32_bf16 v[64:67], a[224:227], v[100:103], v[64:67]
    v_mfma_f32_16x16x32_bf16 v[68:71], a[228:231], v[100:103], v[68:71]
    v_mfma_f32_16x16x32_bf16 v[72:75], a[232:235], v[100:103], v[72:75]
    v_mfma_f32_16x16x32_bf16 v[76:79], a[236:239], v[100:103], v[76:79]
    s_waitcnt lgkmcnt(0)
    v_mfma_f32_16x16x32_bf16 v[48:51], a[240:243], v[104:107], v[48:51]
    v_mfma_f32_16x16x32_bf16 v[52:55], a[244:247], v[104:107], v[52:55]
    v_mfma_f32_16x16x32_bf16 v[56:59], a[248:251], v[104:107], v[56:59]
    v_mfma_f32_16x16x32_bf16 v[60:63], a[252:255], v[104:107], v[60:63]
    v_mfma_f32_16x16x32_bf16 v[64:67], a[240:243], v[108:111], v[64:67]
    v_mfma_f32_16x16x32_bf16 v[68:71], a[244:247], v[108:111], v[68:71]
    v_mfma_f32_16x16x32_bf16 v[72:75], a[248:251], v[108:111], v[72:75]
    v_mfma_f32_16x16x32_bf16 v[76:79], a[252:255], v[108:111], v[76:79]
RQK_T6:
    s_mul_i32 s24, s20, 786432
    s_add_u32 s24, s24, s33
    s_add_u32 s25, s24, 4096
    v_cvt_pk_bf16_f32 v112, v48, v52
    v_cvt_pk_bf16_f32 v113, v56, v60
    v_cvt_pk_bf16_f32 v114, v49, v53
    v_cvt_pk_bf16_f32 v115, v57, v61
    buffer_store_dwordx4 v[112:115], v9, s[4:7], s24 offen offset:0 sc1
    v_cvt_pk_bf16_f32 v116, v50, v54
    v_cvt_pk_bf16_f32 v117, v58, v62
    v_cvt_pk_bf16_f32 v118, v51, v55
    v_cvt_pk_bf16_f32 v119, v59, v63
    buffer_store_dwordx4 v[116:119], v9, s[4:7], s24 offen offset:1024 sc1
    v_cvt_pk_bf16_f32 v120, v64, v68
    v_cvt_pk_bf16_f32 v121, v72, v76
    v_cvt_pk_bf16_f32 v122, v65, v69
    v_cvt_pk_bf16_f32 v123, v73, v77
    buffer_store_dwordx4 v[120:123], v9, s[4:7], s25 offen offset:0 sc1
    v_cvt_pk_bf16_f32 v124, v66, v70
    v_cvt_pk_bf16_f32 v125, v74, v78
    v_cvt_pk_bf16_f32 v126, v67, v71
    v_cvt_pk_bf16_f32 v127, v75, v79
    buffer_store_dwordx4 v[124:127], v9, s[4:7], s25 offen offset:1024 sc1
    s_mov_b32 s22, s20
    s_mov_b32 s20, s21
    s_waitcnt vmcnt(4)
    s_cmp_lg_u32 s21, -1
    s_nop 5
    s_cbranch_scc1 RQK_TOP
    s_cmp_lg_u32 s16, 0
    s_cbranch_scc1 Lw0_125
    v_readfirstlane_b32 s25, v3
    v_readfirstlane_b32 s26, v4
    s_mov_b32 s24, -1
    s_cmp_ge_u32 s18, 64
    s_cbranch_scc1 Lsk_126
    s_cmp_lg_u32 s25, 4
    s_cbranch_scc1 Lsk_126
    s_add_u32 s24, s18, 0
Lsk_126:
    s_cmp_ge_u32 s19, 64
    s_cbranch_scc1 Lsk_127
    s_cmp_lg_u32 s26, 4
    s_cbranch_scc1 Lsk_127
    s_add_u32 s24, s19, 64
Lsk_127:
    v_mov_b32 v5, s24
    v_mov_b32 v6, 163776
    ds_write_b32 v6, v5 offset:8
Lw0_125:
    s_waitcnt lgkmcnt(0)
    s_barrier
    v_mov_b32 v6, 163776
    ds_read_b32 v5, v6 offset:8
    s_waitcnt lgkmcnt(0)
    v_readfirstlane_b32 s20, v5
    s_cmp_lg_u32 s20, -1
    s_cbranch_scc1 RQK_GO
    s_waitcnt vmcnt(0)
    s_barrier
    s_cmp_lg_u32 s16, 0
    s_cbranch_scc1 Lsg_128
    s_lshl_b32 s24, s22, 4
    s_add_u32 s24, s24, s41
    s_lshl_b32 s24, s24, 6
    s_cmp_eq_u32 s40, 0
    s_cselect_b32 s25, 1, 0x100
    v_mov_b32 v5, s25
    s_mov_b64 s[38:39], exec
    s_mov_b64 exec, 1
    buffer_atomic_add v5, v2, s[4:7], s24 offen
    s_mov_b64 exec, s[38:39]
Lsg_128:
    s_mov_b32 s22, -1
    s_branch RQK_B1
J_V:
    s_load_dwordx2 s[8:9], s[0:1], 32
    s_mov_b32 s10, 4194304
    s_mov_b32 s11, 0x00020000
    s_waitcnt lgkmcnt(0)
    v_lshlrev_b32 v7, 4, v0
    v_lshlrev_b32 v9, 4, v1
    s_lshr_b32 s25, s16, 1
    s_lshl_b32 s26, s41, 1
    s_add_u32 s25, s25, s26
    s_and_b32 s26, s16, 1
    s_lshl_b32 s33, s40, 5
    s_add_u32 s33, s33, s25
    s_lshl_b32 s33, s33, 13
    s_lshl_b32 s27, s26, 12
    s_add_u32 s33, s33, s27
    s_add_u32 s33, s33, 35651584
    s_lshl_b32 s25, s25, 8
    s_lshl_b32 s26, s26, 7
    s_add_u32 s25, s25, s26
    v_lshrrev_b32 v5, 4, v1
    v_lshlrev_b32 v5, 18, v5
    v_and_b32 v6, 15, v1
    v_lshlrev_b32 v6, 3, v6
    v_add3_u32 v8, v5, v6, s25
    s_mov_b32 s24, 0
    buffer_load_dwordx2 v[16:17], v8, s[8:11], s24 offen
    s_mov_b32 s24, 8192
    buffer_load_dwordx2 v[18:19], v8, s[8:11], s24 offen
    s_mov_b32 s24, 16384
    buffer_load_dwordx2 v[20:21], v8, s[8:11], s24 offen
    s_mov_b32 s24, 24576
    buffer_load_dwordx2 v[22:23], v8, s[8:11], s24 offen
    s_mov_b32 s24, 32768
    buffer_load_dwordx2 v[24:25], v8, s[8:11], s24 offen
    s_mov_b32 s24, 40960
    buffer_load_dwordx2 v[26:27], v8, s[8:11], s24 offen
    s_mov_b32 s24, 49152
    buffer_load_dwordx2 v[28:29], v8, s[8:11], s24 offen
    s_mov_b32 s24, 57344
    buffer_load_dwordx2 v[30:31], v8, s[8:11], s24 offen
    s_mov_b32 s24, 65536
    buffer_load_dwordx2 v[32:33], v8, s[8:11], s24 offen
    s_mov_b32 s24, 73728
    buffer_load_dwordx2 v[34:35], v8, s[8:11], s24 offen
    s_mov_b32 s24, 81920
    buffer_load_dwordx2 v[36:37], v8, s[8:11], s24 offen
    s_mov_b32 s24, 90112
    buffer_load_dwordx2 v[38:39], v8, s[8:11], s24 offen
    s_mov_b32 s24, 98304
    buffer_load_dwordx2 v[40:41], v8, s[8:11], s24 offen
    s_mov_b32 s24, 106496
    buffer_load_dwordx2 v[42:43], v8, s[8:11], s24 offen
    s_mov_b32 s24, 114688
    buffer_load_dwordx2 v[44:45], v8, s[8:11], s24 offen
    s_mov_b32 s24, 122880
    buffer_load_dwordx2 v[46:47], v8, s[8:11], s24 offen
    s_mov_b32 s24, 131072
    buffer_load_dwordx2 v[48:49], v8, s[8:11], s24 offen
    s_mov_b32 s24, 139264
    buffer_load_dwordx2 v[50:51], v8, s[8:11], s24 offen
    s_mov_b32 s24, 147456
    buffer_load_dwordx2 v[52:53], v8, s[8:11], s24 offen
    s_mov_b32 s24, 155648
    buffer_load_dwordx2 v[54:55], v8, s[8:11], s24 offen
    s_mov_b32 s24, 163840
    buffer_load_dwordx2 v[56:57], v8, s[8:11], s24 offen
    s_mov_b32 s24, 172032
    buffer_load_dwordx2 v[58:59], v8, s[8:11], s24 offen
    s_mov_b32 s24, 180224
    buffer_load_dwordx2 v[60:61], v8, s[8:11], s24 offen
    s_mov_b32 s24, 188416
    buffer_load_dwordx2 v[62:63], v8, s[8:11], s24 offen
    s_mov_b32 s24, 196608
    buffer_load_dwordx2 v[64:65], v8, s[8:11], s24 offen
    s_mov_b32 s24, 204800
    buffer_load_dwordx2 v[66:67], v8, s[8:11], s24 offen
    s_mov_b32 s24, 212992
    buffer_load_dwordx2 v[68:69], v8, s[8:11], s24 offen
    s_mov_b32 s24, 221184
    buffer_load_dwordx2 v[70:71], v8, s[8:11], s24 offen
    s_mov_b32 s24, 229376
    buffer_load_dwordx2 v[72:73], v8, s[8:11], s24 offen
    s_mov_b32 s24, 237568
    buffer_load_dwordx2 v[74:75], v8, s[8:11], s24 offen
    s_mov_b32 s24, 245760
    buffer_load_dwordx2 v[76:77], v8, s[8:11], s24 offen
    s_mov_b32 s24, 253952
    buffer_load_dwordx2 v[78:79], v8, s[8:11], s24 offen
    s_mov_b32 s24, 1048576
    buffer_load_dwordx2 v[80:81], v8, s[8:11], s24 offen
    s_mov_b32 s24, 1056768
    buffer_load_dwordx2 v[82:83], v8, s[8:11], s24 offen
    s_mov_b32 s24, 1064960
    buffer_load_dwordx2 v[84:85], v8, s[8:11], s24 offen
    s_mov_b32 s24, 1073152
    buffer_load_dwordx2 v[86:87], v8, s[8:11], s24 offen
    s_mov_b32 s24, 1081344
    buffer_load_dwordx2 v[88:89], v8, s[8:11], s24 offen
    s_mov_b32 s24, 1089536
    buffer_load_dwordx2 v[90:91], v8, s[8:11], s24 offen
    s_mov_b32 s24, 1097728
    buffer_load_dwordx2 v[92:93], v8, s[8:11], s24 offen
    s_mov_b32 s24, 1105920
    buffer_load_dwordx2 v[94:95], v8, s[8:11], s24 offen
    s_mov_b32 s24, 1114112
    buffer_load_dwordx2 v[96:97], v8, s[8:11], s24 offen
    s_mov_b32 s24, 1122304
    buffer_load_dwordx2 v[98:99], v8, s[8:11], s24 offen
    s_mov_b32 s24, 1130496
    buffer_load_dwordx2 v[100:101], v8, s[8:11], s24 offen
    s_mov_b32 s24, 1138688
    buffer_load_dwordx2 v[102:103], v8, s[8:11], s24 offen
    s_mov_b32 s24, 1146880
    buffer_load_dwordx2 v[104:105], v8, s[8:11], s24 offen
    s_mov_b32 s24, 1155072
    buffer_load_dwordx2 v[106:107], v8, s[8:11], s24 offen
    s_mov_b32 s24, 1163264
    buffer_load_dwordx2 v[108:109], v8, s[8:11], s24 offen
    s_mov_b32 s24, 1171456
    buffer_load_dwordx2 v[110:111], v8, s[8:11], s24 offen
    s_waitcnt vmcnt(40)
    v_perm_b32 v5, v18, v16, s31
    v_accvgpr_write_b32 a0, v5
    v_perm_b32 v6, v22, v20, s31
    v_accvgpr_write_b32 a1, v6
    v_perm_b32 v5, v26, v24, s31
    v_accvgpr_write_b32 a2, v5
    v_perm_b32 v6, v30, v28, s31
    v_accvgpr_write_b32 a3, v6
    v_perm_b32 v5, v18, v16, s32
    v_accvgpr_write_b32 a4, v5
    v_perm_b32 v6, v22, v20, s32
    v_accvgpr_write_b32 a5, v6
    v_perm_b32 v5, v26, v24, s32
    v_accvgpr_write_b32 a6, v5
    v_perm_b32 v6, v30, v28, s32
    v_accvgpr_write_b32 a7, v6
    v_perm_b32 v5, v19, v17, s31
    v_accvgpr_write_b32 a8, v5
    v_perm_b32 v6, v23, v21, s31
    v_accvgpr_write_b32 a9, v6
    v_perm_b32 v5, v27, v25, s31
    v_accvgpr_write_b32 a10, v5
    v_perm_b32 v6, v31, v29, s31
    v_accvgpr_write_b32 a11, v6
    v_perm_b32 v5, v19, v17, s32
    v_accvgpr_write_b32 a12, v5
    v_perm_b32 v6, v23, v21, s32
    v_accvgpr_write_b32 a13, v6
    v_perm_b32 v5, v27, v25, s32
    v_accvgpr_write_b32 a14, v5
    v_perm_b32 v6, v31, v29, s32
    v_accvgpr_write_b32 a15, v6
    s_mov_b32 s24, 1179648
    buffer_load_dwordx2 v[16:17], v8, s[8:11], s24 offen
    s_mov_b32 s24, 1187840
    buffer_load_dwordx2 v[18:19], v8, s[8:11], s24 offen
    s_mov_b32 s24, 1196032
    buffer_load_dwordx2 v[20:21], v8, s[8:11], s24 offen
    s_mov_b32 s24, 1204224
    buffer_load_dwordx2 v[22:23], v8, s[8:11], s24 offen
    s_mov_b32 s24, 1212416
    buffer_load_dwordx2 v[24:25], v8, s[8:11], s24 offen
    s_mov_b32 s24, 1220608
    buffer_load_dwordx2 v[26:27], v8, s[8:11], s24 offen
    s_mov_b32 s24, 1228800
    buffer_load_dwordx2 v[28:29], v8, s[8:11], s24 offen
    s_mov_b32 s24, 1236992
    buffer_load_dwordx2 v[30:31], v8, s[8:11], s24 offen
    s_waitcnt vmcnt(40)
    v_perm_b32 v5, v34, v32, s31
    v_accvgpr_write_b32 a16, v5
    v_perm_b32 v6, v38, v36, s31
    v_accvgpr_write_b32 a17, v6
    v_perm_b32 v5, v42, v40, s31
    v_accvgpr_write_b32 a18, v5
    v_perm_b32 v6, v46, v44, s31
    v_accvgpr_write_b32 a19, v6
    v_perm_b32 v5, v34, v32, s32
    v_accvgpr_write_b32 a20, v5
    v_perm_b32 v6, v38, v36, s32
    v_accvgpr_write_b32 a21, v6
    v_perm_b32 v5, v42, v40, s32
    v_accvgpr_write_b32 a22, v5
    v_perm_b32 v6, v46, v44, s32
    v_accvgpr_write_b32 a23, v6
    v_perm_b32 v5, v35, v33, s31
    v_accvgpr_write_b32 a24, v5
    v_perm_b32 v6, v39, v37, s31
    v_accvgpr_write_b32 a25, v6
    v_perm_b32 v5, v43, v41, s31
    v_accvgpr_write_b32 a26, v5
    v_perm_b32 v6, v47, v45, s31
    v_accvgpr_write_b32 a27, v6
    v_perm_b32 v5, v35, v33, s32
    v_accvgpr_write_b32 a28, v5
    v_perm_b32 v6, v39, v37, s32
    v_accvgpr_write_b32 a29, v6
    v_perm_b32 v5, v43, v41, s32
    v_accvgpr_write_b32 a30, v5
    v_perm_b32 v6, v47, v45, s32
    v_accvgpr_write_b32 a31, v6
    s_mov_b32 s24, 1245184
    buffer_load_dwordx2 v[32:33], v8, s[8:11], s24 offen
    s_mov_b32 s24, 1253376
    buffer_load_dwordx2 v[34:35], v8, s[8:11], s24 offen
    s_mov_b32 s24, 1261568
    buffer_load_dwordx2 v[36:37], v8, s[8:11], s24 offen
    s_mov_b32 s24, 1269760
    buffer_load_dwordx2 v[38:39], v8, s[8:11], s24 offen
    s_mov_b32 s24, 1277952
    buffer_load_dwordx2 v[40:41], v8, s[8:11], s24 offen
    s_mov_b32 s24, 1286144
    buffer_load_dwordx2 v[42:43], v8, s[8:11], s24 offen
    s_mov_b32 s24, 1294336
    buffer_load_dwordx2 v[44:45], v8, s[8:11], s24 offen
    s_mov_b32 s24, 1302528
    buffer_load_dwordx2 v[46:47], v8, s[8:11], s24 offen
    s_waitcnt vmcnt(40)
    v_perm_b32 v5, v50, v48, s31
    v_accvgpr_write_b32 a32, v5
    v_perm_b32 v6, v54, v52, s31
    v_accvgpr_write_b32 a33, v6
    v_perm_b32 v5, v58, v56, s31
    v_accvgpr_write_b32 a34, v5
    v_perm_b32 v6, v62, v60, s31
    v_accvgpr_write_b32 a35, v6
    v_perm_b32 v5, v50, v48, s32
    v_accvgpr_write_b32 a36, v5
    v_perm_b32 v6, v54, v52, s32
    v_accvgpr_write_b32 a37, v6
    v_perm_b32 v5, v58, v56, s32
    v_accvgpr_write_b32 a38, v5
    v_perm_b32 v6, v62, v60, s32
    v_accvgpr_write_b32 a39, v6
    v_perm_b32 v5, v51, v49, s31
    v_accvgpr_write_b32 a40, v5
    v_perm_b32 v6, v55, v53, s31
    v_accvgpr_write_b32 a41, v6
    v_perm_b32 v5, v59, v57, s31
    v_accvgpr_write_b32 a42, v5
    v_perm_b32 v6, v63, v61, s31
    v_accvgpr_write_b32 a43, v6
    v_perm_b32 v5, v51, v49, s32
    v_accvgpr_write_b32 a44, v5
    v_perm_b32 v6, v55, v53, s32
    v_accvgpr_write_b32 a45, v6
    v_perm_b32 v5, v59, v57, s32
    v_accvgpr_write_b32 a46, v5
    v_perm_b32 v6, v63, v61, s32
    v_accvgpr_write_b32 a47, v6
    s_mov_b32 s24, 2097152
    buffer_load_dwordx2 v[48:49], v8, s[8:11], s24 offen
    s_mov_b32 s24, 2105344
    buffer_load_dwordx2 v[50:51], v8, s[8:11], s24 offen
    s_mov_b32 s24, 2113536
    buffer_load_dwordx2 v[52:53], v8, s[8:11], s24 offen
    s_mov_b32 s24, 2121728
    buffer_load_dwordx2 v[54:55], v8, s[8:11], s24 offen
    s_mov_b32 s24, 2129920
    buffer_load_dwordx2 v[56:57], v8, s[8:11], s24 offen
    s_mov_b32 s24, 2138112
    buffer_load_dwordx2 v[58:59], v8, s[8:11], s24 offen
    s_mov_b32 s24, 2146304
    buffer_load_dwordx2 v[60:61], v8, s[8:11], s24 offen
    s_mov_b32 s24, 2154496
    buffer_load_dwordx2 v[62:63], v8, s[8:11], s24 offen
    s_waitcnt vmcnt(40)
    v_perm_b32 v5, v66, v64, s31
    v_accvgpr_write_b32 a48, v5
    v_perm_b32 v6, v70, v68, s31
    v_accvgpr_write_b32 a49, v6
    v_perm_b32 v5, v74, v72, s31
    v_accvgpr_write_b32 a50, v5
    v_perm_b32 v6, v78, v76, s31
    v_accvgpr_write_b32 a51, v6
    v_perm_b32 v5, v66, v64, s32
    v_accvgpr_write_b32 a52, v5
    v_perm_b32 v6, v70, v68, s32
    v_accvgpr_write_b32 a53, v6
    v_perm_b32 v5, v74, v72, s32
    v_accvgpr_write_b32 a54, v5
    v_perm_b32 v6, v78, v76, s32
    v_accvgpr_write_b32 a55, v6
    v_perm_b32 v5, v67, v65, s31
    v_accvgpr_write_b32 a56, v5
    v_perm_b32 v6, v71, v69, s31
    v_accvgpr_write_b32 a57, v6
    v_perm_b32 v5, v75, v73, s31
    v_accvgpr_write_b32 a58, v5
    v_perm_b32 v6, v79, v77, s31
    v_accvgpr_write_b32 a59, v6
    v_perm_b32 v5, v67, v65, s32
    v_accvgpr_write_b32 a60, v5
    v_perm_b32 v6, v71, v69, s32
    v_accvgpr_write_b32 a61, v6
    v_perm_b32 v5, v75, v73, s32
    v_accvgpr_write_b32 a62, v5
    v_perm_b32 v6, v79, v77, s32
    v_accvgpr_write_b32 a63, v6
    s_mov_b32 s24, 2162688
    buffer_load_dwordx2 v[64:65], v8, s[8:11], s24 offen
    s_mov_b32 s24, 2170880
    buffer_load_dwordx2 v[66:67], v8, s[8:11], s24 offen
    s_mov_b32 s24, 2179072
    buffer_load_dwordx2 v[68:69], v8, s[8:11], s24 offen
    s_mov_b32 s24, 2187264
    buffer_load_dwordx2 v[70:71], v8, s[8:11], s24 offen
    s_mov_b32 s24, 2195456
    buffer_load_dwordx2 v[72:73], v8, s[8:11], s24 offen
    s_mov_b32 s24, 2203648
    buffer_load_dwordx2 v[74:75], v8, s[8:11], s24 offen
    s_mov_b32 s24, 2211840
    buffer_load_dwordx2 v[76:77], v8, s[8:11], s24 offen
    s_mov_b32 s24, 2220032
    buffer_load_dwordx2 v[78:79], v8, s[8:11], s24 offen
    s_waitcnt vmcnt(40)
    v_perm_b32 v5, v82, v80, s31
    v_accvgpr_write_b32 a64, v5
    v_perm_b32 v6, v86, v84, s31
    v_accvgpr_write_b32 a65, v6
    v_perm_b32 v5, v90, v88, s31
    v_accvgpr_write_b32 a66, v5
    v_perm_b32 v6, v94, v92, s31
    v_accvgpr_write_b32 a67, v6
    v_perm_b32 v5, v82, v80, s32
    v_accvgpr_write_b32 a68, v5
    v_perm_b32 v6, v86, v84, s32
    v_accvgpr_write_b32 a69, v6
    v_perm_b32 v5, v90, v88, s32
    v_accvgpr_write_b32 a70, v5
    v_perm_b32 v6, v94, v92, s32
    v_accvgpr_write_b32 a71, v6
    v_perm_b32 v5, v83, v81, s31
    v_accvgpr_write_b32 a72, v5
    v_perm_b32 v6, v87, v85, s31
    v_accvgpr_write_b32 a73, v6
    v_perm_b32 v5, v91, v89, s31
    v_accvgpr_write_b32 a74, v5
    v_perm_b32 v6, v95, v93, s31
    v_accvgpr_write_b32 a75, v6
    v_perm_b32 v5, v83, v81, s32
    v_accvgpr_write_b32 a76, v5
    v_perm_b32 v6, v87, v85, s32
    v_accvgpr_write_b32 a77, v6
    v_perm_b32 v5, v91, v89, s32
    v_accvgpr_write_b32 a78, v5
    v_perm_b32 v6, v95, v93, s32
    v_accvgpr_write_b32 a79, v6
    s_mov_b32 s24, 2228224
    buffer_load_dwordx2 v[80:81], v8, s[8:11], s24 offen
    s_mov_b32 s24, 2236416
    buffer_load_dwordx2 v[82:83], v8, s[8:11], s24 offen
    s_mov_b32 s24, 2244608
    buffer_load_dwordx2 v[84:85], v8, s[8:11], s24 offen
    s_mov_b32 s24, 2252800
    buffer_load_dwordx2 v[86:87], v8, s[8:11], s24 offen
    s_mov_b32 s24, 2260992
    buffer_load_dwordx2 v[88:89], v8, s[8:11], s24 offen
    s_mov_b32 s24, 2269184
    buffer_load_dwordx2 v[90:91], v8, s[8:11], s24 offen
    s_mov_b32 s24, 2277376
    buffer_load_dwordx2 v[92:93], v8, s[8:11], s24 offen
    s_mov_b32 s24, 2285568
    buffer_load_dwordx2 v[94:95], v8, s[8:11], s24 offen
    s_waitcnt vmcnt(40)
    v_perm_b32 v5, v98, v96, s31
    v_accvgpr_write_b32 a80, v5
    v_perm_b32 v6, v102, v100, s31
    v_accvgpr_write_b32 a81, v6
    v_perm_b32 v5, v106, v104, s31
    v_accvgpr_write_b32 a82, v5
    v_perm_b32 v6, v110, v108, s31
    v_accvgpr_write_b32 a83, v6
    v_perm_b32 v5, v98, v96, s32
    v_accvgpr_write_b32 a84, v5
    v_perm_b32 v6, v102, v100, s32
    v_accvgpr_write_b32 a85, v6
    v_perm_b32 v5, v106, v104, s32
    v_accvgpr_write_b32 a86, v5
    v_perm_b32 v6, v110, v108, s32
    v_accvgpr_write_b32 a87, v6
    v_perm_b32 v5, v99, v97, s31
    v_accvgpr_write_b32 a88, v5
    v_perm_b32 v6, v103, v101, s31
    v_accvgpr_write_b32 a89, v6
    v_perm_b32 v5, v107, v105, s31
    v_accvgpr_write_b32 a90, v5
    v_perm_b32 v6, v111, v109, s31
    v_accvgpr_write_b32 a91, v6
    v_perm_b32 v5, v99, v97, s32
    v_accvgpr_write_b32 a92, v5
    v_perm_b32 v6, v103, v101, s32
    v_accvgpr_write_b32 a93, v6
    v_perm_b32 v5, v107, v105, s32
    v_accvgpr_write_b32 a94, v5
    v_perm_b32 v6, v111, v109, s32
    v_accvgpr_write_b32 a95, v6
    s_mov_b32 s24, 2293760
    buffer_load_dwordx2 v[96:97], v8, s[8:11], s24 offen
    s_mov_b32 s24, 2301952
    buffer_load_dwordx2 v[98:99], v8, s[8:11], s24 offen
    s_mov_b32 s24, 2310144
    buffer_load_dwordx2 v[100:101], v8, s[8:11], s24 offen
    s_mov_b32 s24, 2318336
    buffer_load_dwordx2 v[102:103], v8, s[8:11], s24 offen
    s_mov_b32 s24, 2326528
    buffer_load_dwordx2 v[104:105], v8, s[8:11], s24 offen
    s_mov_b32 s24, 2334720
    buffer_load_dwordx2 v[106:107], v8, s[8:11], s24 offen
    s_mov_b32 s24, 2342912
    buffer_load_dwordx2 v[108:109], v8, s[8:11], s24 offen
    s_mov_b32 s24, 2351104
    buffer_load_dwordx2 v[110:111], v8, s[8:11], s24 offen
    s_waitcnt vmcnt(40)
    v_perm_b32 v5, v18, v16, s31
    v_accvgpr_write_b32 a96, v5
    v_perm_b32 v6, v22, v20, s31
    v_accvgpr_write_b32 a97, v6
    v_perm_b32 v5, v26, v24, s31
    v_accvgpr_write_b32 a98, v5
    v_perm_b32 v6, v30, v28, s31
    v_accvgpr_write_b32 a99, v6
    v_perm_b32 v5, v18, v16, s32
    v_accvgpr_write_b32 a100, v5
    v_perm_b32 v6, v22, v20, s32
    v_accvgpr_write_b32 a101, v6
    v_perm_b32 v5, v26, v24, s32
    v_accvgpr_write_b32 a102, v5
    v_perm_b32 v6, v30, v28, s32
    v_accvgpr_write_b32 a103, v6
    v_perm_b32 v5, v19, v17, s31
    v_accvgpr_write_b32 a104, v5
    v_perm_b32 v6, v23, v21, s31
    v_accvgpr_write_b32 a105, v6
    v_perm_b32 v5, v27, v25, s31
    v_accvgpr_write_b32 a106, v5
    v_perm_b32 v6, v31, v29, s31
    v_accvgpr_write_b32 a107, v6
    v_perm_b32 v5, v19, v17, s32
    v_accvgpr_write_b32 a108, v5
    v_perm_b32 v6, v23, v21, s32
    v_accvgpr_write_b32 a109, v6
    v_perm_b32 v5, v27, v25, s32
    v_accvgpr_write_b32 a110, v5
    v_perm_b32 v6, v31, v29, s32
    v_accvgpr_write_b32 a111, v6
    s_mov_b32 s24, 3145728
    buffer_load_dwordx2 v[16:17], v8, s[8:11], s24 offen
    s_mov_b32 s24, 3153920
    buffer_load_dwordx2 v[18:19], v8, s[8:11], s24 offen
    s_mov_b32 s24, 3162112
    buffer_load_dwordx2 v[20:21], v8, s[8:11], s24 offen
    s_mov_b32 s24, 3170304
    buffer_load_dwordx2 v[22:23], v8, s[8:11], s24 offen
    s_mov_b32 s24, 3178496
    buffer_load_dwordx2 v[24:25], v8, s[8:11], s24 offen
    s_mov_b32 s24, 3186688
    buffer_load_dwordx2 v[26:27], v8, s[8:11], s24 offen
    s_mov_b32 s24, 3194880
    buffer_load_dwordx2 v[28:29], v8, s[8:11], s24 offen
    s_mov_b32 s24, 3203072
    buffer_load_dwordx2 v[30:31], v8, s[8:11], s24 offen
    s_waitcnt vmcnt(40)
    v_perm_b32 v5, v34, v32, s31
    v_accvgpr_write_b32 a112, v5
    v_perm_b32 v6, v38, v36, s31
    v_accvgpr_write_b32 a113, v6
    v_perm_b32 v5, v42, v40, s31
    v_accvgpr_write_b32 a114, v5
    v_perm_b32 v6, v46, v44, s31
    v_accvgpr_write_b32 a115, v6
    v_perm_b32 v5, v34, v32, s32
    v_accvgpr_write_b32 a116, v5
    v_perm_b32 v6, v38, v36, s32
    v_accvgpr_write_b32 a117, v6
    v_perm_b32 v5, v42, v40, s32
    v_accvgpr_write_b32 a118, v5
    v_perm_b32 v6, v46, v44, s32
    v_accvgpr_write_b32 a119, v6
    v_perm_b32 v5, v35, v33, s31
    v_accvgpr_write_b32 a120, v5
    v_perm_b32 v6, v39, v37, s31
    v_accvgpr_write_b32 a121, v6
    v_perm_b32 v5, v43, v41, s31
    v_accvgpr_write_b32 a122, v5
    v_perm_b32 v6, v47, v45, s31
    v_accvgpr_write_b32 a123, v6
    v_perm_b32 v5, v35, v33, s32
    v_accvgpr_write_b32 a124, v5
    v_perm_b32 v6, v39, v37, s32
    v_accvgpr_write_b32 a125, v6
    v_perm_b32 v5, v43, v41, s32
    v_accvgpr_write_b32 a126, v5
    v_perm_b32 v6, v47, v45, s32
    v_accvgpr_write_b32 a127, v6
    s_mov_b32 s24, 3211264
    buffer_load_dwordx2 v[32:33], v8, s[8:11], s24 offen
    s_mov_b32 s24, 3219456
    buffer_load_dwordx2 v[34:35], v8, s[8:11], s24 offen
    s_mov_b32 s24, 3227648
    buffer_load_dwordx2 v[36:37], v8, s[8:11], s24 offen
    s_mov_b32 s24, 3235840
    buffer_load_dwordx2 v[38:39], v8, s[8:11], s24 offen
    s_mov_b32 s24, 3244032
    buffer_load_dwordx2 v[40:41], v8, s[8:11], s24 offen
    s_mov_b32 s24, 3252224
    buffer_load_dwordx2 v[42:43], v8, s[8:11], s24 offen
    s_mov_b32 s24, 3260416
    buffer_load_dwordx2 v[44:45], v8, s[8:11], s24 offen
    s_mov_b32 s24, 3268608
    buffer_load_dwordx2 v[46:47], v8, s[8:11], s24 offen
    s_waitcnt vmcnt(40)
    v_perm_b32 v5, v50, v48, s31
    v_accvgpr_write_b32 a128, v5
    v_perm_b32 v6, v54, v52, s31
    v_accvgpr_write_b32 a129, v6
    v_perm_b32 v5, v58, v56, s31
    v_accvgpr_write_b32 a130, v5
    v_perm_b32 v6, v62, v60, s31
    v_accvgpr_write_b32 a131, v6
    v_perm_b32 v5, v50, v48, s32
    v_accvgpr_write_b32 a132, v5
    v_perm_b32 v6, v54, v52, s32
    v_accvgpr_write_b32 a133, v6
    v_perm_b32 v5, v58, v56, s32
    v_accvgpr_write_b32 a134, v5
    v_perm_b32 v6, v62, v60, s32
    v_accvgpr_write_b32 a135, v6
    v_perm_b32 v5, v51, v49, s31
    v_accvgpr_write_b32 a136, v5
    v_perm_b32 v6, v55, v53, s31
    v_accvgpr_write_b32 a137, v6
    v_perm_b32 v5, v59, v57, s31
    v_accvgpr_write_b32 a138, v5
    v_perm_b32 v6, v63, v61, s31
    v_accvgpr_write_b32 a139, v6
    v_perm_b32 v5, v51, v49, s32
    v_accvgpr_write_b32 a140, v5
    v_perm_b32 v6, v55, v53, s32
    v_accvgpr_write_b32 a141, v6
    v_perm_b32 v5, v59, v57, s32
    v_accvgpr_write_b32 a142, v5
    v_perm_b32 v6, v63, v61, s32
    v_accvgpr_write_b32 a143, v6
    s_mov_b32 s24, 3276800
    buffer_load_dwordx2 v[48:49], v8, s[8:11], s24 offen
    s_mov_b32 s24, 3284992
    buffer_load_dwordx2 v[50:51], v8, s[8:11], s24 offen
    s_mov_b32 s24, 3293184
    buffer_load_dwordx2 v[52:53], v8, s[8:11], s24 offen
    s_mov_b32 s24, 3301376
    buffer_load_dwordx2 v[54:55], v8, s[8:11], s24 offen
    s_mov_b32 s24, 3309568
    buffer_load_dwordx2 v[56:57], v8, s[8:11], s24 offen
    s_mov_b32 s24, 3317760
    buffer_load_dwordx2 v[58:59], v8, s[8:11], s24 offen
    s_mov_b32 s24, 3325952
    buffer_load_dwordx2 v[60:61], v8, s[8:11], s24 offen
    s_mov_b32 s24, 3334144
    buffer_load_dwordx2 v[62:63], v8, s[8:11], s24 offen
    s_waitcnt vmcnt(40)
    v_perm_b32 v5, v66, v64, s31
    v_accvgpr_write_b32 a144, v5
    v_perm_b32 v6, v70, v68, s31
    v_accvgpr_write_b32 a145, v6
    v_perm_b32 v5, v74, v72, s31
    v_accvgpr_write_b32 a146, v5
    v_perm_b32 v6, v78, v76, s31
    v_accvgpr_write_b32 a147, v6
    v_perm_b32 v5, v66, v64, s32
    v_accvgpr_write_b32 a148, v5
    v_perm_b32 v6, v70, v68, s32
    v_accvgpr_write_b32 a149, v6
    v_perm_b32 v5, v74, v72, s32
    v_accvgpr_write_b32 a150, v5
    v_perm_b32 v6, v78, v76, s32
    v_accvgpr_write_b32 a151, v6
    v_perm_b32 v5, v67, v65, s31
    v_accvgpr_write_b32 a152, v5
    v_perm_b32 v6, v71, v69, s31
    v_accvgpr_write_b32 a153, v6
    v_perm_b32 v5, v75, v73, s31
    v_accvgpr_write_b32 a154, v5
    v_perm_b32 v6, v79, v77, s31
    v_accvgpr_write_b32 a155, v6
    v_perm_b32 v5, v67, v65, s32
    v_accvgpr_write_b32 a156, v5
    v_perm_b32 v6, v71, v69, s32
    v_accvgpr_write_b32 a157, v6
    v_perm_b32 v5, v75, v73, s32
    v_accvgpr_write_b32 a158, v5
    v_perm_b32 v6, v79, v77, s32
    v_accvgpr_write_b32 a159, v6
    s_mov_b32 s24, 3342336
    buffer_load_dwordx2 v[64:65], v8, s[8:11], s24 offen
    s_mov_b32 s24, 3350528
    buffer_load_dwordx2 v[66:67], v8, s[8:11], s24 offen
    s_mov_b32 s24, 3358720
    buffer_load_dwordx2 v[68:69], v8, s[8:11], s24 offen
    s_mov_b32 s24, 3366912
    buffer_load_dwordx2 v[70:71], v8, s[8:11], s24 offen
    s_mov_b32 s24, 3375104
    buffer_load_dwordx2 v[72:73], v8, s[8:11], s24 offen
    s_mov_b32 s24, 3383296
    buffer_load_dwordx2 v[74:75], v8, s[8:11], s24 offen
    s_mov_b32 s24, 3391488
    buffer_load_dwordx2 v[76:77], v8, s[8:11], s24 offen
    s_mov_b32 s24, 3399680
    buffer_load_dwordx2 v[78:79], v8, s[8:11], s24 offen
    s_waitcnt vmcnt(40)
    v_perm_b32 v5, v82, v80, s31
    v_accvgpr_write_b32 a160, v5
    v_perm_b32 v6, v86, v84, s31
    v_accvgpr_write_b32 a161, v6
    v_perm_b32 v5, v90, v88, s31
    v_accvgpr_write_b32 a162, v5
    v_perm_b32 v6, v94, v92, s31
    v_accvgpr_write_b32 a163, v6
    v_perm_b32 v5, v82, v80, s32
    v_accvgpr_write_b32 a164, v5
    v_perm_b32 v6, v86, v84, s32
    v_accvgpr_write_b32 a165, v6
    v_perm_b32 v5, v90, v88, s32
    v_accvgpr_write_b32 a166, v5
    v_perm_b32 v6, v94, v92, s32
    v_accvgpr_write_b32 a167, v6
    v_perm_b32 v5, v83, v81, s31
    v_accvgpr_write_b32 a168, v5
    v_perm_b32 v6, v87, v85, s31
    v_accvgpr_write_b32 a169, v6
    v_perm_b32 v5, v91, v89, s31
    v_accvgpr_write_b32 a170, v5
    v_perm_b32 v6, v95, v93, s31
    v_accvgpr_write_b32 a171, v6
    v_perm_b32 v5, v83, v81, s32
    v_accvgpr_write_b32 a172, v5
    v_perm_b32 v6, v87, v85, s32
    v_accvgpr_write_b32 a173, v6
    v_perm_b32 v5, v91, v89, s32
    v_accvgpr_write_b32 a174, v5
    v_perm_b32 v6, v95, v93, s32
    v_accvgpr_write_b32 a175, v6
    s_waitcnt vmcnt(32)
    v_perm_b32 v5, v98, v96, s31
    v_accvgpr_write_b32 a176, v5
    v_perm_b32 v6, v102, v100, s31
    v_accvgpr_write_b32 a177, v6
    v_perm_b32 v5, v106, v104, s31
    v_accvgpr_write_b32 a178, v5
    v_perm_b32 v6, v110, v108, s31
    v_accvgpr_write_b32 a179, v6
    v_perm_b32 v5, v98, v96, s32
    v_accvgpr_write_b32 a180, v5
    v_perm_b32 v6, v102, v100, s32
    v_accvgpr_write_b32 a181, v6
    v_perm_b32 v5, v106, v104, s32
    v_accvgpr_write_b32 a182, v5
    v_perm_b32 v6, v110, v108, s32
    v_accvgpr_write_b32 a183, v6
    v_perm_b32 v5, v99, v97, s31
    v_accvgpr_write_b32 a184, v5
    v_perm_b32 v6, v103, v101, s31
    v_accvgpr_write_b32 a185, v6
    v_perm_b32 v5, v107, v105, s31
    v_accvgpr_write_b32 a186, v5
    v_perm_b32 v6, v111, v109, s31
    v_accvgpr_write_b32 a187, v6
    v_perm_b32 v5, v99, v97, s32
    v_accvgpr_write_b32 a188, v5
    v_perm_b32 v6, v103, v101, s32
    v_accvgpr_write_b32 a189, v6
    v_perm_b32 v5, v107, v105, s32
    v_accvgpr_write_b32 a190, v5
    v_perm_b32 v6, v111, v109, s32
    v_accvgpr_write_b32 a191, v6
    s_waitcnt vmcnt(24)
    v_perm_b32 v5, v18, v16, s31
    v_accvgpr_write_b32 a192, v5
    v_perm_b32 v6, v22, v20, s31
    v_accvgpr_write_b32 a193, v6
    v_perm_b32 v5, v26, v24, s31
    v_accvgpr_write_b32 a194, v5
    v_perm_b32 v6, v30, v28, s31
    v_accvgpr_write_b32 a195, v6
    v_perm_b32 v5, v18, v16, s32
    v_accvgpr_write_b32 a196, v5
    v_perm_b32 v6, v22, v20, s32
    v_accvgpr_write_b32 a197, v6
    v_perm_b32 v5, v26, v24, s32
    v_accvgpr_write_b32 a198, v5
    v_perm_b32 v6, v30, v28, s32
    v_accvgpr_write_b32 a199, v6
    v_perm_b32 v5, v19, v17, s31
    v_accvgpr_write_b32 a200, v5
    v_perm_b32 v6, v23, v21, s31
    v_accvgpr_write_b32 a201, v6
    v_perm_b32 v5, v27, v25, s31
    v_accvgpr_write_b32 a202, v5
    v_perm_b32 v6, v31, v29, s31
    v_accvgpr_write_b32 a203, v6
    v_perm_b32 v5, v19, v17, s32
    v_accvgpr_write_b32 a204, v5
    v_perm_b32 v6, v23, v21, s32
    v_accvgpr_write_b32 a205, v6
    v_perm_b32 v5, v27, v25, s32
    v_accvgpr_write_b32 a206, v5
    v_perm_b32 v6, v31, v29, s32
    v_accvgpr_write_b32 a207, v6
    s_waitcnt vmcnt(16)
    v_perm_b32 v5, v34, v32, s31
    v_accvgpr_write_b32 a208, v5
    v_perm_b32 v6, v38, v36, s31
    v_accvgpr_write_b32 a209, v6
    v_perm_b32 v5, v42, v40, s31
    v_accvgpr_write_b32 a210, v5
    v_perm_b32 v6, v46, v44, s31
    v_accvgpr_write_b32 a211, v6
    v_perm_b32 v5, v34, v32, s32
    v_accvgpr_write_b32 a212, v5
    v_perm_b32 v6, v38, v36, s32
    v_accvgpr_write_b32 a213, v6
    v_perm_b32 v5, v42, v40, s32
    v_accvgpr_write_b32 a214, v5
    v_perm_b32 v6, v46, v44, s32
    v_accvgpr_write_b32 a215, v6
    v_perm_b32 v5, v35, v33, s31
    v_accvgpr_write_b32 a216, v5
    v_perm_b32 v6, v39, v37, s31
    v_accvgpr_write_b32 a217, v6
    v_perm_b32 v5, v43, v41, s31
    v_accvgpr_write_b32 a218, v5
    v_perm_b32 v6, v47, v45, s31
    v_accvgpr_write_b32 a219, v6
    v_perm_b32 v5, v35, v33, s32
    v_accvgpr_write_b32 a220, v5
    v_perm_b32 v6, v39, v37, s32
    v_accvgpr_write_b32 a221, v6
    v_perm_b32 v5, v43, v41, s32
    v_accvgpr_write_b32 a222, v5
    v_perm_b32 v6, v47, v45, s32
    v_accvgpr_write_b32 a223, v6
    s_waitcnt vmcnt(8)
    v_perm_b32 v5, v50, v48, s31
    v_accvgpr_write_b32 a224, v5
    v_perm_b32 v6, v54, v52, s31
    v_accvgpr_write_b32 a225, v6
    v_perm_b32 v5, v58, v56, s31
    v_accvgpr_write_b32 a226, v5
    v_perm_b32 v6, v62, v60, s31
    v_accvgpr_write_b32 a227, v6
    v_perm_b32 v5, v50, v48, s32
    v_accvgpr_write_b32 a228, v5
    v_perm_b32 v6, v54, v52, s32
    v_accvgpr_write_b32 a229, v6
    v_perm_b32 v5, v58, v56, s32
    v_accvgpr_write_b32 a230, v5
    v_perm_b32 v6, v62, v60, s32
    v_accvgpr_write_b32 a231, v6
    v_perm_b32 v5, v51, v49, s31
    v_accvgpr_write_b32 a232, v5
    v_perm_b32 v6, v55, v53, s31
    v_accvgpr_write_b32 a233, v6
    v_perm_b32 v5, v59, v57, s31
    v_accvgpr_write_b32 a234, v5
    v_perm_b32 v6, v63, v61, s31
    v_accvgpr_write_b32 a235, v6
    v_perm_b32 v5, v51, v49, s32
    v_accvgpr_write_b32 a236, v5
    v_perm_b32 v6, v55, v53, s32
    v_accvgpr_write_b32 a237, v6
    v_perm_b32 v5, v59, v57, s32
    v_accvgpr_write_b32 a238, v5
    v_perm_b32 v6, v63, v61, s32
    v_accvgpr_write_b32 a239, v6
    s_waitcnt vmcnt(0)
    v_perm_b32 v5, v66, v64, s31
    v_accvgpr_write_b32 a240, v5
    v_perm_b32 v6, v70, v68, s31
    v_accvgpr_write_b32 a241, v6
    v_perm_b32 v5, v74, v72, s31
    v_accvgpr_write_b32 a242, v5
    v_perm_b32 v6, v78, v76, s31
    v_accvgpr_write_b32 a243, v6
    v_perm_b32 v5, v66, v64, s32
    v_accvgpr_write_b32 a244, v5
    v_perm_b32 v6, v70, v68, s32
    v_accvgpr_write_b32 a245, v6
    v_perm_b32 v5, v74, v72, s32
    v_accvgpr_write_b32 a246, v5
    v_perm_b32 v6, v78, v76, s32
    v_accvgpr_write_b32 a247, v6
    v_perm_b32 v5, v67, v65, s31
    v_accvgpr_write_b32 a248, v5
    v_perm_b32 v6, v71, v69, s31
    v_accvgpr_write_b32 a249, v6
    v_perm_b32 v5, v75, v73, s31
    v_accvgpr_write_b32 a250, v5
    v_perm_b32 v6, v79, v77, s31
    v_accvgpr_write_b32 a251, v6
    v_perm_b32 v5, v67, v65, s32
    v_accvgpr_write_b32 a252, v5
    v_perm_b32 v6, v71, v69, s32
    v_accvgpr_write_b32 a253, v6
    v_perm_b32 v5, v75, v73, s32
    v_accvgpr_write_b32 a254, v5
    v_perm_b32 v6, v79, v77, s32
    v_accvgpr_write_b32 a255, v6
    s_cmp_lg_u32 s95, 0
    s_cbranch_scc1 Lsc_130
    s_mov_b32 s18, 0
    s_mov_b32 s84, 34
    s_mov_b32 s85, 2
    s_mov_b32 s86, 1
    s_mov_b32 s87, 64
    s_mov_b32 s19, 64
    s_mov_b32 s88, 0
    s_mov_b32 s89, 1
    s_mov_b32 s90, 1
    s_mov_b32 s91, 64
    s_branch Lsc_129
Lsc_130:
    s_cmp_lg_u32 s95, 1
    s_cbranch_scc1 Lsc_131
    s_mov_b32 s18, 1
    s_mov_b32 s84, 0
    s_mov_b32 s85, 2
    s_mov_b32 s86, 2
    s_mov_b32 s87, 34
    s_mov_b32 s19, 0
    s_mov_b32 s88, 0
    s_mov_b32 s89, 1
    s_mov_b32 s90, 1
    s_mov_b32 s91, 64
    s_branch Lsc_129
Lsc_131:
Lsc_129:
    s_cmp_lg_u32 s16, 0
    s_cbranch_scc1 RV_DW
    v_and_b32 v4, 63, v0
    v_lshlrev_b32 v4, 2, v4
Ldw_132:
    buffer_load_dword v3, v4, s[12:15], 0 offen sc1
    s_waitcnt vmcnt(0)
    s_mov_b32 s24, 0
    v_readlane_b32 s25, v3, 8
    s_add_u32 s24, s24, s25
    v_readlane_b32 s25, v3, 24
    s_add_u32 s24, s24, s25
    v_readlane_b32 s25, v3, 40
    s_add_u32 s24, s24, s25
    v_readlane_b32 s25, v3, 56
    s_add_u32 s24, s24, s25
    s_cmp_ge_u32 s24, 96
    s_cbranch_scc1 Ldw_133
    s_sleep 4
    s_memrealtime s[36:37]
    s_waitcnt lgkmcnt(0)
    s_sub_u32 s36, s36, s28
    s_cmp_gt_u32 s36, 3000000
    s_cbranch_scc1 RV_DW
    s_branch Ldw_132
Ldw_133:
RV_DW:
    s_mov_b32 s22, -1
    s_mov_b32 s20, -1
    s_mov_b32 s30, 0
RV_B1:
    s_min_u32 s24, s18, s19
    s_cmp_ge_u32 s24, 64
    s_cbranch_scc1 E_QKV
    s_cmp_lg_u32 s16, 0
    s_cbranch_scc1 RV_B3
RV_B2:
    s_min_u32 s25, s18, 63
    s_lshl_b32 s24, s25, 8
    s_add_u32 s24, s24, 131072
    buffer_load_dword v3, v2, s[4:7], s24 offen sc1
    s_min_u32 s25, s19, 63
    s_lshl_b32 s24, s25, 8
    s_add_u32 s24, s24, 147456
    buffer_load_dword v4, v2, s[4:7], s24 offen sc1
    s_waitcnt vmcnt(0)
    v_readfirstlane_b32 s25, v3
    v_readfirstlane_b32 s26, v4
    s_mov_b32 s24, -1
    s_cmp_ge_u32 s18, 64
    s_cbranch_scc1 Lsk_134
    s_cmp_lg_u32 s25, 4
    s_cbranch_scc1 Lsk_134
    s_add_u32 s24, s18, 0
Lsk_134:
    s_cmp_ge_u32 s19, 64
    s_cbranch_scc1 Lsk_135
    s_cmp_lg_u32 s26, 4
    s_cbranch_scc1 Lsk_135
    s_add_u32 s24, s19, 64
Lsk_135:
    s_cmp_lg_u32 s24, -1
    s_cbranch_scc1 RV_B2x
    s_sleep 2
    s_memrealtime s[36:37]
    s_waitcnt lgkmcnt(0)
    s_sub_u32 s36, s36, s28
    s_cmp_gt_u32 s36, 3000000
    s_cbranch_scc1 RV_B2x
    s_branch RV_B2
RV_B2x:
    v_mov_b32 v5, s24
    v_mov_b32 v6, 163776
    ds_write_b32 v6, v5 offset:8
    s_waitcnt lgkmcnt(0)
RV_B3:
    s_barrier
    v_mov_b32 v6, 163776
    ds_read_b32 v5, v6 offset:8
    s_waitcnt lgkmcnt(0)
    v_readfirstlane_b32 s20, v5
    s_cmp_eq_u32 s20, -1
    s_cbranch_scc1 E_QKV
RV_GO:
    s_cmp_ge_u32 s20, 64
    s_cbranch_scc1 Lad_136
    s_cmp_ge_u32 s18, s84
    s_cselect_b32 s24, s86, s85
    s_add_u32 s18, s18, s24
    s_cmp_ge_u32 s18, s87
    s_cselect_b32 s18, 64, s18
    s_branch Lad_137
Lad_136:
    s_cmp_ge_u32 s19, s88
    s_cselect_b32 s24, s90, s89
    s_add_u32 s19, s19, s24
    s_cmp_ge_u32 s19, s91
    s_cselect_b32 s19, 64, s19
Lad_137:
    s_min_u32 s25, s18, 63
    s_lshl_b32 s24, s25, 8
    s_add_u32 s24, s24, 131072
    buffer_load_dword v3, v2, s[4:7], s24 offen sc1
    s_min_u32 s25, s19, 63
    s_lshl_b32 s24, s25, 8
    s_add_u32 s24, s24, 147456
    buffer_load_dword v4, v2, s[4:7], s24 offen sc1
    s_lshl_b32 s92, s20, 15
    s_lshl_b32 s93, s16, 13
    s_add_u32 s92, s92, s93
    s_add_u32 s92, s92, 6291456
    s_xor_b32 s94, s30, 1
    s_lshl_b32 s94, s94, 15
    s_add_u32 m0, s94, s93
    s_nop 0
    buffer_load_dwordx4 v9, s[4:7], s92 offen offset:0 sc1 lds
    buffer_load_dwordx4 v9, s[4:7], s92 offen offset:1024 sc1 lds
    buffer_load_dwordx4 v9, s[4:7], s92 offen offset:2048 sc1 lds
    buffer_load_dwordx4 v9, s[4:7], s92 offen offset:3072 sc1 lds
    s_add_u32 s92, s92, 4096
    s_add_u32 m0, m0, 4096
    s_nop 0
    buffer_load_dwordx4 v9, s[4:7], s92 offen offset:0 sc1 lds
    buffer_load_dwordx4 v9, s[4:7], s92 offen offset:1024 sc1 lds
    buffer_load_dwordx4 v9, s[4:7], s92 offen offset:2048 sc1 lds
    buffer_load_dwordx4 v9, s[4:7], s92 offen offset:3072 sc1 lds
    s_cmp_eq_u32 s22, -1
    s_cbranch_scc1 RV_G1
    s_waitcnt vmcnt(10)
    s_barrier
    s_cmp_lg_u32 s16, 0
    s_cbranch_scc1 Lsg_138
    s_lshl_b32 s24, s22, 4
    s_add_u32 s24, s24, s41
    s_lshl_b32 s24, s24, 6
    s_cmp_eq_u32 s40, 0
    s_cselect_b32 s25, 1, 0x100
    v_mov_b32 v5, s25
    s_mov_b64 s[38:39], exec
    s_mov_b64 exec, 1
    buffer_atomic_add v5, v2, s[4:7], s24 offen
    s_mov_b64 exec, s[38:39]
Lsg_138:
    s_mov_b32 s22, -1
RV_G1:
    s_waitcnt vmcnt(0)
RV_TOP:
    s_xor_b32 s30, s30, 1
    s_cmp_lg_u32 s16, 0
    s_cbranch_scc1 Lw0_139
    v_readfirstlane_b32 s25, v3
    v_readfirstlane_b32 s26, v4
    s_mov_b32 s24, -1
    s_cmp_ge_u32 s18, 64
    s_cbranch_scc1 Lsk_140
    s_cmp_lg_u32 s25, 4
    s_cbranch_scc1 Lsk_140
    s_add_u32 s24, s18, 0
Lsk_140:
    s_cmp_ge_u32 s19, 64
    s_cbranch_scc1 Lsk_141
    s_cmp_lg_u32 s26, 4
    s_cbranch_scc1 Lsk_141
    s_add_u32 s24, s19, 64
Lsk_141:
    v_mov_b32 v5, s24
    v_mov_b32 v6, 163776
    ds_write_b32 v6, v5 offset:0
Lw0_139:
    s_lshl_b32 s24, s30, 15
    v_add_u32 v8, s24, v9
RV_S1:
    s_waitcnt lgkmcnt(0)
    s_barrier
    v_mov_b32 v6, 163776
    ds_read_b32 v5, v6 offset:0
    s_waitcnt lgkmcnt(0)
    v_readfirstlane_b32 s21, v5
    s_cmp_eq_u32 s21, -1
    s_cbranch_scc1 RV_T1
    s_cmp_ge_u32 s21, 64
    s_cbranch_scc1 Lad_142
    s_cmp_ge_u32 s18, s84
    s_cselect_b32 s24, s86, s85
    s_add_u32 s18, s18, s24
    s_cmp_ge_u32 s18, s87
    s_cselect_b32 s18, 64, s18
    s_branch Lad_143
Lad_142:
    s_cmp_ge_u32 s19, s88
    s_cselect_b32 s24, s90, s89
    s_add_u32 s19, s19, s24
    s_cmp_ge_u32 s19, s91
    s_cselect_b32 s19, 64, s19
Lad_143:
    s_lshl_b32 s92, s21, 15
    s_lshl_b32 s93, s16, 13
    s_add_u32 s92, s92, s93
    s_add_u32 s92, s92, 6291456
    s_xor_b32 s94, s30, 1
    s_lshl_b32 s94, s94, 15
    s_add_u32 m0, s94, s93
    s_nop 0
    ds_read_b128 v[80:83], v8 offset:0
    ds_read_b128 v[84:87], v8 offset:16384
    ds_read_b128 v[88:91], v8 offset:1024
    ds_read_b128 v[92:95], v8 offset:17408
    ds_read_b128 v[96:99], v8 offset:2048
    ds_read_b128 v[100:103], v8 offset:18432
    s_waitcnt lgkmcnt(4)
    v_mfma_f32_16x16x32_bf16 v[48:51], v[80:83], a[0:3], 0
    v_mfma_f32_16x16x32_bf16 v[52:55], v[80:83], a[4:7], 0
    v_mfma_f32_16x16x32_bf16 v[56:59], v[80:83], a[8:11], 0
    v_mfma_f32_16x16x32_bf16 v[60:63], v[80:83], a[12:15], 0
    ds_read_b128 v[104:107], v8 offset:3072
    ds_read_b128 v[108:111], v8 offset:19456
    v_mfma_f32_16x16x32_bf16 v[64:67], v[84:87], a[0:3], 0
    v_mfma_f32_16x16x32_bf16 v[68:71], v[84:87], a[4:7], 0
    v_mfma_f32_16x16x32_bf16 v[72:75], v[84:87], a[8:11], 0
    v_mfma_f32_16x16x32_bf16 v[76:79], v[84:87], a[12:15], 0
    buffer_load_dwordx4 v9, s[4:7], s92 offen offset:0 sc1 lds
    s_waitcnt lgkmcnt(4)
    v_mfma_f32_16x16x32_bf16 v[48:51], v[88:91], a[16:19], v[48:51]
    v_mfma_f32_16x16x32_bf16 v[52:55], v[88:91], a[20:23], v[52:55]
    v_mfma_f32_16x16x32_bf16 v[56:59], v[88:91], a[24:27], v[56:59]
    v_mfma_f32_16x16x32_bf16 v[60:63], v[88:91], a[28:31], v[60:63]
    ds_read_b128 v[80:83], v8 offset:4096
    ds_read_b128 v[84:87], v8 offset:20480
    v_mfma_f32_16x16x32_bf16 v[64:67], v[92:95], a[16:19], v[64:67]
    v_mfma_f32_16x16x32_bf16 v[68:71], v[92:95], a[20:23], v[68:71]
    v_mfma_f32_16x16x32_bf16 v[72:75], v[92:95], a[24:27], v[72:75]
    v_mfma_f32_16x16x32_bf16 v[76:79], v[92:95], a[28:31], v[76:79]
    buffer_load_dwordx4 v9, s[4:7], s92 offen offset:1024 sc1 lds
    s_waitcnt lgkmcnt(4)
    v_mfma_f32_16x16x32_bf16 v[48:51], v[96:99], a[32:35], v[48:51]
    v_mfma_f32_16x16x32_bf16 v[52:55], v[96:99], a[36:39], v[52:55]
    v_mfma_f32_16x16x32_bf16 v[56:59], v[96:99], a[40:43], v[56:59]
    v_mfma_f32_16x16x32_bf16 v[60:63], v[96:99], a[44:47], v[60:63]
    v_mfma_f32_16x16x32_bf16 v[64:67], v[100:103], a[32:35], v[64:67]
    v_mfma_f32_16x16x32_bf16 v[68:71], v[100:103], a[36:39], v[68:71]
    v_mfma_f32_16x16x32_bf16 v[72:75], v[100:103], a[40:43], v[72:75]
    v_mfma_f32_16x16x32_bf16 v[76:79], v[100:103], a[44:47], v[76:79]
    buffer_load_dwordx4 v9, s[4:7], s92 offen offset:2048 sc1 lds
    s_waitcnt lgkmcnt(2)
    v_mfma_f32_16x16x32_bf16 v[48:51], v[104:107], a[48:51], v[48:51]
    v_mfma_f32_16x16x32_bf16 v[52:55], v[104:107], a[52:55], v[52:55]
    v_mfma_f32_16x16x32_bf16 v[56:59], v[104:107], a[56:59], v[56:59]
    v_mfma_f32_16x16x32_bf16 v[60:63], v[104:107], a[60:63], v[60:63]
    v_mfma_f32_16x16x32_bf16 v[64:67], v[108:111], a[48:51], v[64:67]
    v_mfma_f32_16x16x32_bf16 v[68:71], v[108:111], a[52:55], v[68:71]
    v_mfma_f32_16x16x32_bf16 v[72:75], v[108:111], a[56:59], v[72:75]
    v_mfma_f32_16x16x32_bf16 v[76:79], v[108:111], a[60:63], v[76:79]
    buffer_load_dwordx4 v9, s[4:7], s92 offen offset:3072 sc1 lds
    s_waitcnt lgkmcnt(0)
    v_mfma_f32_16x16x32_bf16 v[48:51], v[80:83], a[64:67], v[48:51]
    v_mfma_f32_16x16x32_bf16 v[52:55], v[80:83], a[68:71], v[52:55]
    v_mfma_f32_16x16x32_bf16 v[56:59], v[80:83], a[72:75], v[56:59]
    v_mfma_f32_16x16x32_bf16 v[60:63], v[80:83], a[76:79], v[60:63]
    v_mfma_f32_16x16x32_bf16 v[64:67], v[84:87], a[64:67], v[64:67]
    v_mfma_f32_16x16x32_bf16 v[68:71], v[84:87], a[68:71], v[68:71]
    v_mfma_f32_16x16x32_bf16 v[72:75], v[84:87], a[72:75], v[72:75]
    v_mfma_f32_16x16x32_bf16 v[76:79], v[84:87], a[76:79], v[76:79]
    s_add_u32 s92, s92, 4096
    s_add_u32 m0, m0, 4096
    s_nop 0
    buffer_load_dwordx4 v9, s[4:7], s92 offen offset:0 sc1 lds
    s_waitcnt vmcnt(5) lgkmcnt(0)
    s_barrier
    s_cmp_eq_u32 s22, -1
    s_cbranch_scc1 Lms_144
    s_cmp_lg_u32 s16, 0
    s_cbranch_scc1 Lsg_145
    s_lshl_b32 s24, s22, 4
    s_add_u32 s24, s24, s41
    s_lshl_b32 s24, s24, 6
    s_cmp_eq_u32 s40, 0
    s_cselect_b32 s25, 1, 0x100
    v_mov_b32 v5, s25
    s_mov_b64 s[38:39], exec
    s_mov_b64 exec, 1
    buffer_atomic_add v5, v2, s[4:7], s24 offen
    s_mov_b64 exec, s[38:39]
Lsg_145:
    s_mov_b32 s22, -1
Lms_144:
    s_min_u32 s25, s18, 63
    s_lshl_b32 s24, s25, 8
    s_add_u32 s24, s24, 131072
    buffer_load_dword v3, v2, s[4:7], s24 offen sc1
    s_min_u32 s25, s19, 63
    s_lshl_b32 s24, s25, 8
    s_add_u32 s24, s24, 147456
    buffer_load_dword v4, v2, s[4:7], s24 offen sc1
    ds_read_b128 v[88:91], v8 offset:5120
    ds_read_b128 v[92:95], v8 offset:21504
    ds_read_b128 v[96:99], v8 offset:6144
    ds_read_b128 v[100:103], v8 offset:22528
    ds_read_b128 v[104:107], v8 offset:7168
    ds_read_b128 v[108:111], v8 offset:23552
    s_waitcnt lgkmcnt(4)
    v_mfma_f32_16x16x32_bf16 v[48:51], v[88:91], a[80:83], v[48:51]
    v_mfma_f32_16x16x32_bf16 v[52:55], v[88:91], a[84:87], v[52:55]
    v_mfma_f32_16x16x32_bf16 v[56:59], v[88:91], a[88:91], v[56:59]
    v_mfma_f32_16x16x32_bf16 v[60:63], v[88:91], a[92:95], v[60:63]
    ds_read_b128 v[80:83], v8 offset:8192
    ds_read_b128 v[84:87], v8 offset:24576
    v_mfma_f32_16x16x32_bf16 v[64:67], v[92:95], a[80:83], v[64:67]
    v_mfma_f32_16x16x32_bf16 v[68:71], v[92:95], a[84:87], v[68:71]
    v_mfma_f32_16x16x32_bf16 v[72:75], v[92:95], a[88:91], v[72:75]
    v_mfma_f32_16x16x32_bf16 v[76:79], v[92:95], a[92:95], v[76:79]
    buffer_load_dwordx4 v9, s[4:7], s92 offen offset:1024 sc1 lds
    s_waitcnt lgkmcnt(4)
    v_mfma_f32_16x16x32_bf16 v[48:51], v[96:99], a[96:99], v[48:51]
    v_mfma_f32_16x16x32_bf16 v[52:55], v[96:99], a[100:103], v[52:55]
    v_mfma_f32_16x16x32_bf16 v[56:59], v[96:99], a[104:107], v[56:59]
    v_mfma_f32_16x16x32_bf16 v[60:63], v[96:99], a[108:111], v[60:63]
    ds_read_b128 v[88:91], v8 offset:9216
    ds_read_b128 v[92:95], v8 offset:25600
    v_mfma_f32_16x16x32_bf16 v[64:67], v[100:103], a[96:99], v[64:67]
    v_mfma_f32_16x16x32_bf16 v[68:71], v[100:103], a[100:103], v[68:71]
    v_mfma_f32_16x16x32_bf16 v[72:75], v[100:103], a[104:107], v[72:75]
    v_mfma_f32_16x16x32_bf16 v[76:79], v[100:103], a[108:111], v[76:79]
    buffer_load_dwordx4 v9, s[4:7], s92 offen offset:2048 sc1 lds
    s_waitcnt lgkmcnt(4)
    v_mfma_f32_16x16x32_bf16 v[48:51], v[104:107], a[112:115], v[48:51]
    v_mfma_f32_16x16x32_bf16 v[52:55], v[104:107], a[116:119], v[52:55]
    v_mfma_f32_16x16x32_bf16 v[56:59], v[104:107], a[120:123], v[56:59]
    v_mfma_f32_16x16x32_bf16 v[60:63], v[104:107], a[124:127], v[60:63]
    ds_read_b128 v[96:99], v8 offset:10240
    ds_read_b128 v[100:103], v8 offset:26624
    v_mfma_f32_16x16x32_bf16 v[64:67], v[108:111], a[112:115], v[64:67]
    v_mfma_f32_16x16x32_bf16 v[68:71], v[108:111], a[116:119], v[68:71]
    v_mfma_f32_16x16x32_bf16 v[72:75], v[108:111], a[120:123], v[72:75]
    v_mfma_f32_16x16x32_bf16 v[76:79], v[108:111], a[124:127], v[76:79]
    buffer_load_dwordx4 v9, s[4:7], s92 offen offset:3072 sc1 lds
    s_waitcnt lgkmcnt(4)
    v_mfma_f32_16x16x32_bf16 v[48:51], v[80:83], a[128:131], v[48:51]
    v_mfma_f32_16x16x32_bf16 v[52:55], v[80:83], a[132:135], v[52:55]
    v_mfma_f32_16x16x32_bf16 v[56:59], v[80:83], a[136:139], v[56:59]
    v_mfma_f32_16x16x32_bf16 v[60:63], v[80:83], a[140:143], v[60:63]
    ds_read_b128 v[104:107], v8 offset:11264
    ds_read_b128 v[108:111], v8 offset:27648
    v_mfma_f32_16x16x32_bf16 v[64:67], v[84:87], a[128:131], v[64:67]
    v_mfma_f32_16x16x32_bf16 v[68:71], v[84:87], a[132:135], v[68:71]
    v_mfma_f32_16x16x32_bf16 v[72:75], v[84:87], a[136:139], v[72:75]
    v_mfma_f32_16x16x32_bf16 v[76:79], v[84:87], a[140:143], v[76:79]
    s_waitcnt lgkmcnt(4)
    v_mfma_f32_16x16x32_bf16 v[48:51], v[88:91], a[144:147], v[48:51]
    v_mfma_f32_16x16x32_bf16 v[52:55], v[88:91], a[148:151], v[52:55]
    v_mfma_f32_16x16x32_bf16 v[56:59], v[88:91], a[152:155], v[56:59]
    v_mfma_f32_16x16x32_bf16 v[60:63], v[88:91], a[156:159], v[60:63]
    ds_read_b128 v[80:83], v8 offset:12288
    ds_read_b128 v[84:87], v8 offset:28672
    v_mfma_f32_16x16x32_bf16 v[64:67], v[92:95], a[144:147], v[64:67]
    v_mfma_f32_16x16x32_bf16 v[68:71], v[92:95], a[148:151], v[68:71]
    v_mfma_f32_16x16x32_bf16 v[72:75], v[92:95], a[152:155], v[72:75]
    v_mfma_f32_16x16x32_bf16 v[76:79], v[92:95], a[156:159], v[76:79]
    s_waitcnt lgkmcnt(4)
    v_mfma_f32_16x16x32_bf16 v[48:51], v[96:99], a[160:163], v[48:51]
    v_mfma_f32_16x16x32_bf16 v[52:55], v[96:99], a[164:167], v[52:55]
    v_mfma_f32_16x16x32_bf16 v[56:59], v[96:99], a[168:171], v[56:59]
    v_mfma_f32_16x16x32_bf16 v[60:63], v[96:99], a[172:175], v[60:63]
    ds_read_b128 v[88:91], v8 offset:13312
    ds_read_b128 v[92:95], v8 offset:29696
    v_mfma_f32_16x16x32_bf16 v[64:67], v[100:103], a[160:163], v[64:67]
    v_mfma_f32_16x16x32_bf16 v[68:71], v[100:103], a[164:167], v[68:71]
    v_mfma_f32_16x16x32_bf16 v[72:75], v[100:103], a[168:171], v[72:75]
    v_mfma_f32_16x16x32_bf16 v[76:79], v[100:103], a[172:175], v[76:79]
    s_waitcnt lgkmcnt(4)
    v_mfma_f32_16x16x32_bf16 v[48:51], v[104:107], a[176:179], v[48:51]
    v_mfma_f32_16x16x32_bf16 v[52:55], v[104:107], a[180:183], v[52:55]
    v_mfma_f32_16x16x32_bf16 v[56:59], v[104:107], a[184:187], v[56:59]
    v_mfma_f32_16x16x32_bf16 v[60:63], v[104:107], a[188:191], v[60:63]
    ds_read_b128 v[96:99], v8 offset:14336
    ds_read_b128 v[100:103], v8 offset:30720
    v_mfma_f32_16x16x32_bf16 v[64:67], v[108:111], a[176:179], v[64:67]
    v_mfma_f32_16x16x32_bf16 v[68:71], v[108:111], a[180:183], v[68:71]
    v_mfma_f32_16x16x32_bf16 v[72:75], v[108:111], a[184:187], v[72:75]
    v_mfma_f32_16x16x32_bf16 v[76:79], v[108:111], a[188:191], v[76:79]
    s_waitcnt lgkmcnt(4)
    v_mfma_f32_16x16x32_bf16 v[48:51], v[80:83], a[192:195], v[48:51]
    v_mfma_f32_16x16x32_bf16 v[52:55], v[80:83], a[196:199], v[52:55]
    v_mfma_f32_16x16x32_bf16 v[56:59], v[80:83], a[200:203], v[56:59]
    v_mfma_f32_16x16x32_bf16 v[60:63], v[80:83], a[204:207], v[60:63]
    ds_read_b128 v[104:107], v8 offset:15360
    ds_read_b128 v[108:111], v8 offset:31744
    v_mfma_f32_16x16x32_bf16 v[64:67], v[84:87], a[192:195], v[64:67]
    v_mfma_f32_16x16x32_bf16 v[68:71], v[84:87], a[196:199], v[68:71]
    v_mfma_f32_16x16x32_bf16 v[72:75], v[84:87], a[200:203], v[72:75]
    v_mfma_f32_16x16x32_bf16 v[76:79], v[84:87], a[204:207], v[76:79]
    s_waitcnt lgkmcnt(4)
    v_mfma_f32_16x16x32_bf16 v[48:51], v[88:91], a[208:211], v[48:51]
    v_mfma_f32_16x16x32_bf16 v[52:55], v[88:91], a[212:215], v[52:55]
    v_mfma_f32_16x16x32_bf16 v[56:59], v[88:91], a[216:219], v[56:59]
    v_mfma_f32_16x16x32_bf16 v[60:63], v[88:91], a[220:223], v[60:63]
    v_mfma_f32_16x16x32_bf16 v[64:67], v[92:95], a[208:211], v[64:67]
    v_mfma_f32_16x16x32_bf16 v[68:71], v[92:95], a[212:215], v[68:71]
    v_mfma_f32_16x16x32_bf16 v[72:75], v[92:95], a[216:219], v[72:75]
    v_mfma_f32_16x16x32_bf16 v[76:79], v[92:95], a[220:223], v[76:79]
    s_waitcnt lgkmcnt(2)
    v_mfma_f32_16x16x32_bf16 v[48:51], v[96:99], a[224:227], v[48:51]
    v_mfma_f32_16x16x32_bf16 v[52:55], v[96:99], a[228:231], v[52:55]
    v_mfma_f32_16x16x32_bf16 v[56:59], v[96:99], a[232:235], v[56:59]
    v_mfma_f32_16x16x32_bf16 v[60:63], v[96:99], a[236:239], v[60:63]
    v_mfma_f32_16x16x32_bf16 v[64:67], v[100:103], a[224:227], v[64:67]
    v_mfma_f32_16x16x32_bf16 v[68:71], v[100:103], a[228:231], v[68:71]
    v_mfma_f32_16x16x32_bf16 v[72:75], v[100:103], a[232:235], v[72:75]
    v_mfma_f32_16x16x32_bf16 v[76:79], v[100:103], a[236:239], v[76:79]
    s_waitcnt lgkmcnt(0)
    v_mfma_f32_16x16x32_bf16 v[48:51], v[104:107], a[240:243], v[48:51]
    v_mfma_f32_16x16x32_bf16 v[52:55], v[104:107], a[244:247], v[52:55]
    v_mfma_f32_16x16x32_bf16 v[56:59], v[104:107], a[248:251], v[56:59]
    v_mfma_f32_16x16x32_bf16 v[60:63], v[104:107], a[252:255], v[60:63]
    v_mfma_f32_16x16x32_bf16 v[64:67], v[108:111], a[240:243], v[64:67]
    v_mfma_f32_16x16x32_bf16 v[68:71], v[108:111], a[244:247], v[68:71]
    v_mfma_f32_16x16x32_bf16 v[72:75], v[108:111], a[248:251], v[72:75]
    v_mfma_f32_16x16x32_bf16 v[76:79], v[108:111], a[252:255], v[76:79]
    s_branch RV_T6
RV_T1:
    s_min_u32 s25, s18, 63
    s_lshl_b32 s24, s25, 8
    s_add_u32 s24, s24, 131072
    buffer_load_dword v3, v2, s[4:7], s24 offen sc1
    s_min_u32 s25, s19, 63
    s_lshl_b32 s24, s25, 8
    s_add_u32 s24, s24, 147456
    buffer_load_dword v4, v2, s[4:7], s24 offen sc1
    ds_read_b128 v[80:83], v8 offset:0
    ds_read_b128 v[84:87], v8 offset:16384
    ds_read_b128 v[88:91], v8 offset:1024
    ds_read_b128 v[92:95], v8 offset:17408
    ds_read_b128 v[96:99], v8 offset:2048
    ds_read_b128 v[100:103], v8 offset:18432
    s_waitcnt lgkmcnt(4)
    v_mfma_f32_16x16x32_bf16 v[48:51], v[80:83], a[0:3], 0
    v_mfma_f32_16x16x32_bf16 v[52:55], v[80:83], a[4:7], 0
    v_mfma_f32_16x16x32_bf16 v[56:59], v[80:83], a[8:11], 0
    v_mfma_f32_16x16x32_bf16 v[60:63], v[80:83], a[12:15], 0
    ds_read_b128 v[104:107], v8 offset:3072
    ds_read_b128 v[108:111], v8 offset:19456
    v_mfma_f32_16x16x32_bf16 v[64:67], v[84:87], a[0:3], 0
    v_mfma_f32_16x16x32_bf16 v[68:71], v[84:87], a[4:7], 0
    v_mfma_f32_16x16x32_bf16 v[72:75], v[84:87], a[8:11], 0
    v_mfma_f32_16x16x32_bf16 v[76:79], v[84:87], a[12:15], 0
    s_waitcnt lgkmcnt(4)
    v_mfma_f32_16x16x32_bf16 v[48:51], v[88:91], a[16:19], v[48:51]
    v_mfma_f32_16x16x32_bf16 v[52:55], v[88:91], a[20:23], v[52:55]
    v_mfma_f32_16x16x32_bf16 v[56:59], v[88:91], a[24:27], v[56:59]
    v_mfma_f32_16x16x32_bf16 v[60:63], v[88:91], a[28:31], v[60:63]
    ds_read_b128 v[80:83], v8 offset:4096
    ds_read_b128 v[84:87], v8 offset:20480
    v_mfma_f32_16x16x32_bf16 v[64:67], v[92:95], a[16:19], v[64:67]
    v_mfma_f32_16x16x32_bf16 v[68:71], v[92:95], a[20:23], v[68:71]
    v_mfma_f32_16x16x32_bf16 v[72:75], v[92:95], a[24:27], v[72:75]
    v_mfma_f32_16x16x32_bf16 v[76:79], v[92:95], a[28:31], v[76:79]
    s_waitcnt lgkmcnt(4)
    v_mfma_f32_16x16x32_bf16 v[48:51], v[96:99], a[32:35], v[48:51]
    v_mfma_f32_16x16x32_bf16 v[52:55], v[96:99], a[36:39], v[52:55]
    v_mfma_f32_16x16x32_bf16 v[56:59], v[96:99], a[40:43], v[56:59]
    v_mfma_f32_16x16x32_bf16 v[60:63], v[96:99], a[44:47], v[60:63]
    v_mfma_f32_16x16x32_bf16 v[64:67], v[100:103], a[32:35], v[64:67]
    v_mfma_f32_16x16x32_bf16 v[68:71], v[100:103], a[36:39], v[68:71]
    v_mfma_f32_16x16x32_bf16 v[72:75], v[100:103], a[40:43], v[72:75]
    v_mfma_f32_16x16x32_bf16 v[76:79], v[100:103], a[44:47], v[76:79]
    s_waitcnt lgkmcnt(2)
    v_mfma_f32_16x16x32_bf16 v[48:51], v[104:107], a[48:51], v[48:51]
    v_mfma_f32_16x16x32_bf16 v[52:55], v[104:107], a[52:55], v[52:55]
    v_mfma_f32_16x16x32_bf16 v[56:59], v[104:107], a[56:59], v[56:59]
    v_mfma_f32_16x16x32_bf16 v[60:63], v[104:107], a[60:63], v[60:63]
    v_mfma_f32_16x16x32_bf16 v[64:67], v[108:111], a[48:51], v[64:67]
    v_mfma_f32_16x16x32_bf16 v[68:71], v[108:111], a[52:55], v[68:71]
    v_mfma_f32_16x16x32_bf16 v[72:75], v[108:111], a[56:59], v[72:75]
    v_mfma_f32_16x16x32_bf16 v[76:79], v[108:111], a[60:63], v[76:79]
    s_waitcnt lgkmcnt(0)
    v_mfma_f32_16x16x32_bf16 v[48:51], v[80:83], a[64:67], v[48:51]
    v_mfma_f32_16x16x32_bf16 v[52:55], v[80:83], a[68:71], v[52:55]
    v_mfma_f32_16x16x32_bf16 v[56:59], v[80:83], a[72:75], v[56:59]
    v_mfma_f32_16x16x32_bf16 v[60:63], v[80:83], a[76:79], v[60:63]
    v_mfma_f32_16x16x32_bf16 v[64:67], v[84:87], a[64:67], v[64:67]
    v_mfma_f32_16x16x32_bf16 v[68:71], v[84:87], a[68:71], v[68:71]
    v_mfma_f32_16x16x32_bf16 v[72:75], v[84:87], a[72:75], v[72:75]
    v_mfma_f32_16x16x32_bf16 v[76:79], v[84:87], a[76:79], v[76:79]
    s_waitcnt vmcnt(0)
    s_cmp_lg_u32 s16, 0
    s_cbranch_scc1 Lw0_146
    v_readfirstlane_b32 s25, v3
    v_readfirstlane_b32 s26, v4
    s_mov_b32 s24, -1
    s_cmp_ge_u32 s18, 64
    s_cbranch_scc1 Lsk_147
    s_cmp_lg_u32 s25, 4
    s_cbranch_scc1 Lsk_147
    s_add_u32 s24, s18, 0
Lsk_147:
    s_cmp_ge_u32 s19, 64
    s_cbranch_scc1 Lsk_148
    s_cmp_lg_u32 s26, 4
    s_cbranch_scc1 Lsk_148
    s_add_u32 s24, s19, 64
Lsk_148:
    v_mov_b32 v5, s24
    v_mov_b32 v6, 163776
    ds_write_b32 v6, v5 offset:4
Lw0_146:
    s_waitcnt lgkmcnt(0)
    s_barrier
    v_mov_b32 v6, 163776
    ds_read_b32 v5, v6 offset:4
    s_waitcnt lgkmcnt(0)
    v_readfirstlane_b32 s21, v5
    s_cmp_eq_u32 s21, -1
    s_cbranch_scc1 RV_T4
    s_cmp_ge_u32 s21, 64
    s_cbranch_scc1 Lad_149
    s_cmp_ge_u32 s18, s84
    s_cselect_b32 s24, s86, s85
    s_add_u32 s18, s18, s24
    s_cmp_ge_u32 s18, s87
    s_cselect_b32 s18, 64, s18
    s_branch Lad_150
Lad_149:
    s_cmp_ge_u32 s19, s88
    s_cselect_b32 s24, s90, s89
    s_add_u32 s19, s19, s24
    s_cmp_ge_u32 s19, s91
    s_cselect_b32 s19, 64, s19
Lad_150:
    s_cmp_eq_u32 s22, -1
    s_cbranch_scc1 Lms_151
    s_cmp_lg_u32 s16, 0
    s_cbranch_scc1 Lsg_152
    s_lshl_b32 s24, s22, 4
    s_add_u32 s24, s24, s41
    s_lshl_b32 s24, s24, 6
    s_cmp_eq_u32 s40, 0
    s_cselect_b32 s25, 1, 0x100
    v_mov_b32 v5, s25
    s_mov_b64 s[38:39], exec
    s_mov_b64 exec, 1
    buffer_atomic_add v5, v2, s[4:7], s24 offen
    s_mov_b64 exec, s[38:39]
Lsg_152:
    s_mov_b32 s22, -1
Lms_151:
    s_min_u32 s25, s18, 63
    s_lshl_b32 s24, s25, 8
    s_add_u32 s24, s24, 131072
    buffer_load_dword v3, v2, s[4:7], s24 offen sc1
    s_min_u32 s25, s19, 63
    s_lshl_b32 s24, s25, 8
    s_add_u32 s24, s24, 147456
    buffer_load_dword v4, v2, s[4:7], s24 offen sc1
    s_lshl_b32 s92, s21, 15
    s_lshl_b32 s93, s16, 13
    s_add_u32 s92, s92, s93
    s_add_u32 s92, s92, 6291456
    s_xor_b32 s94, s30, 1
    s_lshl_b32 s94, s94, 15
    s_add_u32 m0, s94, s93
    s_nop 0
    ds_read_b128 v[88:91], v8 offset:5120
    ds_read_b128 v[92:95], v8 offset:21504
    ds_read_b128 v[96:99], v8 offset:6144
    ds_read_b128 v[100:103], v8 offset:22528
    ds_read_b128 v[104:107], v8 offset:7168
    ds_read_b128 v[108:111], v8 offset:23552
    s_waitcnt lgkmcnt(4)
    v_mfma_f32_16x16x32_bf16 v[48:51], v[88:91], a[80:83], v[48:51]
    v_mfma_f32_16x16x32_bf16 v[52:55], v[88:91], a[84:87], v[52:55]
    v_mfma_f32_16x16x32_bf16 v[56:59], v[88:91], a[88:91], v[56:59]
    v_mfma_f32_16x16x32_bf16 v[60:63], v[88:91], a[92:95], v[60:63]
    ds_read_b128 v[80:83], v8 offset:8192
    ds_read_b128 v[84:87], v8 offset:24576
    v_mfma_f32_16x16x32_bf16 v[64:67], v[92:95], a[80:83], v[64:67]
    v_mfma_f32_16x16x32_bf16 v[68:71], v[92:95], a[84:87], v[68:71]
    v_mfma_f32_16x16x32_bf16 v[72:75], v[92:95], a[88:91], v[72:75]
    v_mfma_f32_16x16x32_bf16 v[76:79], v[92:95], a[92:95], v[76:79]
    buffer_load_dwordx4 v9, s[4:7], s92 offen offset:0 sc1 lds
    s_waitcnt lgkmcnt(4)
    v_mfma_f32_16x16x32_bf16 v[48:51], v[96:99], a[96:99], v[48:51]
    v_mfma_f32_16x16x32_bf16 v[52:55], v[96:99], a[100:103], v[52:55]
    v_mfma_f32_16x16x32_bf16 v[56:59], v[96:99], a[104:107], v[56:59]
    v_mfma_f32_16x16x32_bf16 v[60:63], v[96:99], a[108:111], v[60:63]
    ds_read_b128 v[88:91], v8 offset:9216
    ds_read_b128 v[92:95], v8 offset:25600
    v_mfma_f32_16x16x32_bf16 v[64:67], v[100:103], a[96:99], v[64:67]
    v_mfma_f32_16x16x32_bf16 v[68:71], v[100:103], a[100:103], v[68:71]
    v_mfma_f32_16x16x32_bf16 v[72:75], v[100:103], a[104:107], v[72:75]
    v_mfma_f32_16x16x32_bf16 v[76:79], v[100:103], a[108:111], v[76:79]
    buffer_load_dwordx4 v9, s[4:7], s92 offen offset:1024 sc1 lds
    s_waitcnt lgkmcnt(4)
    v_mfma_f32_16x16x32_bf16 v[48:51], v[104:107], a[112:115], v[48:51]
    v_mfma_f32_16x16x32_bf16 v[52:55], v[104:107], a[116:119], v[52:55]
    v_mfma_f32_16x16x32_bf16 v[56:59], v[104:107], a[120:123], v[56:59]
    v_mfma_f32_16x16x32_bf16 v[60:63], v[104:107], a[124:127], v[60:63]
    ds_read_b128 v[96:99], v8 offset:10240
    ds_read_b128 v[100:103], v8 offset:26624
    v_mfma_f32_16x16x32_bf16 v[64:67], v[108:111], a[112:115], v[64:67]
    v_mfma_f32_16x16x32_bf16 v[68:71], v[108:111], a[116:119], v[68:71]
    v_mfma_f32_16x16x32_bf16 v[72:75], v[108:111], a[120:123], v[72:75]
    v_mfma_f32_16x16x32_bf16 v[76:79], v[108:111], a[124:127], v[76:79]
    buffer_load_dwordx4 v9, s[4:7], s92 offen offset:2048 sc1 lds
    s_waitcnt lgkmcnt(4)
    v_mfma_f32_16x16x32_bf16 v[48:51], v[80:83], a[128:131], v[48:51]
    v_mfma_f32_16x16x32_bf16 v[52:55], v[80:83], a[132:135], v[52:55]
    v_mfma_f32_16x16x32_bf16 v[56:59], v[80:83], a[136:139], v[56:59]
    v_mfma_f32_16x16x32_bf16 v[60:63], v[80:83], a[140:143], v[60:63]
    ds_read_b128 v[104:107], v8 offset:11264
    ds_read_b128 v[108:111], v8 offset:27648
    v_mfma_f32_16x16x32_bf16 v[64:67], v[84:87], a[128:131], v[64:67]
    v_mfma_f32_16x16x32_bf16 v[68:71], v[84:87], a[132:135], v[68:71]
    v_mfma_f32_16x16x32_bf16 v[72:75], v[84:87], a[136:139], v[72:75]
    v_mfma_f32_16x16x32_bf16 v[76:79], v[84:87], a[140:143], v[76:79]
    buffer_load_dwordx4 v9, s[4:7], s92 offen offset:3072 sc1 lds
    s_waitcnt lgkmcnt(4)
    v_mfma_f32_16x16x32_bf16 v[48:51], v[88:91], a[144:147], v[48:51]
    v_mfma_f32_16x16x32_bf16 v[52:55], v[88:91], a[148:151], v[52:55]
    v_mfma_f32_16x16x32_bf16 v[56:59], v[88:91], a[152:155], v[56:59]
    v_mfma_f32_16x16x32_bf16 v[60:63], v[88:91], a[156:159], v[60:63]
    ds_read_b128 v[80:83], v8 offset:12288
    ds_read_b128 v[84:87], v8 offset:28672
    v_mfma_f32_16x16x32_bf16 v[64:67], v[92:95], a[144:147], v[64:67]
    v_mfma_f32_16x16x32_bf16 v[68:71], v[92:95], a[148:151], v[68:71]
    v_mfma_f32_16x16x32_bf16 v[72:75], v[92:95], a[152:155], v[72:75]
    v_mfma_f32_16x16x32_bf16 v[76:79], v[92:95], a[156:159], v[76:79]
    s_add_u32 s92, s92, 4096
    s_add_u32 m0, m0, 4096
    s_nop 0
    buffer_load_dwordx4 v9, s[4:7], s92 offen offset:0 sc1 lds
    s_waitcnt lgkmcnt(4)
    v_mfma_f32_16x16x32_bf16 v[48:51], v[96:99], a[160:163], v[48:51]
    v_mfma_f32_16x16x32_bf16 v[52:55], v[96:99], a[164:167], v[52:55]
    v_mfma_f32_16x16x32_bf16 v[56:59], v[96:99], a[168:171], v[56:59]
    v_mfma_f32_16x16x32_bf16 v[60:63], v[96:99], a[172:175], v[60:63]
    ds_read_b128 v[88:91], v8 offset:13312
    ds_read_b128 v[92:95], v8 offset:29696
    v_mfma_f32_16x16x32_bf16 v[64:67], v[100:103], a[160:163], v[64:67]
    v_mfma_f32_16x16x32_bf16 v[68:71], v[100:103], a[164:167], v[68:71]
    v_mfma_f32_16x16x32_bf16 v[72:75], v[100:103], a[168:171], v[72:75]
    v_mfma_f32_16x16x32_bf16 v[76:79], v[100:103], a[172:175], v[76:79]
    buffer_load_dwordx4 v9, s[4:7], s92 offen offset:1024 sc1 lds
    s_waitcnt lgkmcnt(4)
    v_mfma_f32_16x16x32_bf16 v[48:51], v[104:107], a[176:179], v[48:51]
    v_mfma_f32_16x16x32_bf16 v[52:55], v[104:107], a[180:183], v[52:55]
    v_mfma_f32_16x16x32_bf16 v[56:59], v[104:107], a[184:187], v[56:59]
    v_mfma_f32_16x16x32_bf16 v[60:63], v[104:107], a[188:191], v[60:63]
    ds_read_b128 v[96:99], v8 offset:14336
    ds_read_b128 v[100:103], v8 offset:30720
    v_mfma_f32_16x16x32_bf16 v[64:67], v[108:111], a[176:179], v[64:67]
    v_mfma_f32_16x16x32_bf16 v[68:71], v[108:111], a[180:183], v[68:71]
    v_mfma_f32_16x16x32_bf16 v[72:75], v[108:111], a[184:187], v[72:75]
    v_mfma_f32_16x16x32_bf16 v[76:79], v[108:111], a[188:191], v[76:79]
    buffer_load_dwordx4 v9, s[4:7], s92 offen offset:2048 sc1 lds
    s_waitcnt lgkmcnt(4)
    v_mfma_f32_16x16x32_bf16 v[48:51], v[80:83], a[192:195], v[48:51]
    v_mfma_f32_16x16x32_bf16 v[52:55], v[80:83], a[196:199], v[52:55]
    v_mfma_f32_16x16x32_bf16 v[56:59], v[80:83], a[200:203], v[56:59]
    v_mfma_f32_16x16x32_bf16 v[60:63], v[80:83], a[204:207], v[60:63]
    ds_read_b128 v[104:107], v8 offset:15360
    ds_read_b128 v[108:111], v8 offset:31744
    v_mfma_f32_16x16x32_bf16 v[64:67], v[84:87], a[192:195], v[64:67]
    v_mfma_f32_16x16x32_bf16 v[68:71], v[84:87], a[196:199], v[68:71]
    v_mfma_f32_16x16x32_bf16 v[72:75], v[84:87], a[200:203], v[72:75]
    v_mfma_f32_16x16x32_bf16 v[76:79], v[84:87], a[204:207], v[76:79]
    buffer_load_dwordx4 v9, s[4:7], s92 offen offset:3072 sc1 lds
    s_waitcnt lgkmcnt(4)
    v_mfma_f32_16x16x32_bf16 v[48:51], v[88:91], a[208:211], v[48:51]
    v_mfma_f32_16x16x32_bf16 v[52:55], v[88:91], a[212:215], v[52:55]
    v_mfma_f32_16x16x32_bf16 v[56:59], v[88:91], a[216:219], v[56:59]
    v_mfma_f32_16x16x32_bf16 v[60:63], v[88:91], a[220:223], v[60:63]
    v_mfma_f32_16x16x32_bf16 v[64:67], v[92:95], a[208:211], v[64:67]
    v_mfma_f32_16x16x32_bf16 v[68:71], v[92:95], a[212:215], v[68:71]
    v_mfma_f32_16x16x32_bf16 v[72:75], v[92:95], a[216:219], v[72:75]
    v_mfma_f32_16x16x32_bf16 v[76:79], v[92:95], a[220:223], v[76:79]
    s_waitcnt lgkmcnt(2)
    v_mfma_f32_16x16x32_bf16 v[48:51], v[96:99], a[224:227], v[48:51]
    v_mfma_f32_16x16x32_bf16 v[52:55], v[96:99], a[228:231], v[52:55]
    v_mfma_f32_16x16x32_bf16 v[56:59], v[96:99], a[232:235], v[56:59]
    v_mfma_f32_16x16x32_bf16 v[60:63], v[96:99], a[236:239], v[60:63]
    v_mfma_f32_16x16x32_bf16 v[64:67], v[100:103], a[224:227], v[64:67]
    v_mfma_f32_16x16x32_bf16 v[68:71], v[100:103], a[228:231], v[68:71]
    v_mfma_f32_16x16x32_bf16 v[72:75], v[100:103], a[232:235], v[72:75]
    v_mfma_f32_16x16x32_bf16 v[76:79], v[100:103], a[236:239], v[76:79]
    s_waitcnt lgkmcnt(0)
    v_mfma_f32_16x16x32_bf16 v[48:51], v[104:107], a[240:243], v[48:51]
    v_mfma_f32_16x16x32_bf16 v[52:55], v[104:107], a[244:247], v[52:55]
    v_mfma_f32_16x16x32_bf16 v[56:59], v[104:107], a[248:251], v[56:59]
    v_mfma_f32_16x16x32_bf16 v[60:63], v[104:107], a[252:255], v[60:63]
    v_mfma_f32_16x16x32_bf16 v[64:67], v[108:111], a[240:243], v[64:67]
    v_mfma_f32_16x16x32_bf16 v[68:71], v[108:111], a[244:247], v[68:71]
    v_mfma_f32_16x16x32_bf16 v[72:75], v[108:111], a[248:251], v[72:75]
    v_mfma_f32_16x16x32_bf16 v[76:79], v[108:111], a[252:255], v[76:79]
    s_branch RV_T6
RV_T4:
    s_cmp_eq_u32 s22, -1
    s_cbranch_scc1 Lms_153
    s_cmp_lg_u32 s16, 0
    s_cbranch_scc1 Lsg_154
    s_lshl_b32 s24, s22, 4
    s_add_u32 s24, s24, s41
    s_lshl_b32 s24, s24, 6
    s_cmp_eq_u32 s40, 0
    s_cselect_b32 s25, 1, 0x100
    v_mov_b32 v5, s25
    s_mov_b64 s[38:39], exec
    s_mov_b64 exec, 1
    buffer_atomic_add v5, v2, s[4:7], s24 offen
    s_mov_b64 exec, s[38:39]
Lsg_154:
    s_mov_b32 s22, -1
Lms_153:
    s_min_u32 s25, s18, 63
    s_lshl_b32 s24, s25, 8
    s_add_u32 s24, s24, 131072
    buffer_load_dword v3, v2, s[4:7], s24 offen sc1
    s_min_u32 s25, s19, 63
    s_lshl_b32 s24, s25, 8
    s_add_u32 s24, s24, 147456
    buffer_load_dword v4, v2, s[4:7], s24 offen sc1
    ds_read_b128 v[88:91], v8 offset:5120
    ds_read_b128 v[92:95], v8 offset:21504
    ds_read_b128 v[96:99], v8 offset:6144
    ds_read_b128 v[100:103], v8 offset:22528
    ds_read_b128 v[104:107], v8 offset:7168
    ds_read_b128 v[108:111], v8 offset:23552
    s_waitcnt lgkmcnt(4)
    v_mfma_f32_16x16x32_bf16 v[48:51], v[88:91], a[80:83], v[48:51]
    v_mfma_f32_16x16x32_bf16 v[52:55], v[88:91], a[84:87], v[52:55]
    v_mfma_f32_16x16x32_bf16 v[56:59], v[88:91], a[88:91], v[56:59]
    v_mfma_f32_16x16x32_bf16 v[60:63], v[88:91], a[92:95], v[60:63]
    ds_read_b128 v[80:83], v8 offset:8192
    ds_read_b128 v[84:87], v8 offset:24576
    v_mfma_f32_16x16x32_bf16 v[64:67], v[92:95], a[80:83], v[64:67]
    v_mfma_f32_16x16x32_bf16 v[68:71], v[92:95], a[84:87], v[68:71]
    v_mfma_f32_16x16x32_bf16 v[72:75], v[92:95], a[88:91], v[72:75]
    v_mfma_f32_16x16x32_bf16 v[76:79], v[92:95], a[92:95], v[76:79]
    s_waitcnt lgkmcnt(4)
    v_mfma_f32_16x16x32_bf16 v[48:51], v[96:99], a[96:99], v[48:51]
    v_mfma_f32_16x16x32_bf16 v[52:55], v[96:99], a[100:103], v[52:55]
    v_mfma_f32_16x16x32_bf16 v[56:59], v[96:99], a[104:107], v[56:59]
    v_mfma_f32_16x16x32_bf16 v[60:63], v[96:99], a[108:111], v[60:63]
    ds_read_b128 v[88:91], v8 offset:9216
    ds_read_b128 v[92:95], v8 offset:25600
    v_mfma_f32_16x16x32_bf16 v[64:67], v[100:103], a[96:99], v[64:67]
    v_mfma_f32_16x16x32_bf16 v[68:71], v[100:103], a[100:103], v[68:71]
    v_mfma_f32_16x16x32_bf16 v[72:75], v[100:103], a[104:107], v[72:75]
    v_mfma_f32_16x16x32_bf16 v[76:79], v[100:103], a[108:111], v[76:79]
    s_waitcnt lgkmcnt(4)
    v_mfma_f32_16x16x32_bf16 v[48:51], v[104:107], a[112:115], v[48:51]
    v_mfma_f32_16x16x32_bf16 v[52:55], v[104:107], a[116:119], v[52:55]
    v_mfma_f32_16x16x32_bf16 v[56:59], v[104:107], a[120:123], v[56:59]
    v_mfma_f32_16x16x32_bf16 v[60:63], v[104:107], a[124:127], v[60:63]
    ds_read_b128 v[96:99], v8 offset:10240
    ds_read_b128 v[100:103], v8 offset:26624
    v_mfma_f32_16x16x32_bf16 v[64:67], v[108:111], a[112:115], v[64:67]
    v_mfma_f32_16x16x32_bf16 v[68:71], v[108:111], a[116:119], v[68:71]
    v_mfma_f32_16x16x32_bf16 v[72:75], v[108:111], a[120:123], v[72:75]
    v_mfma_f32_16x16x32_bf16 v[76:79], v[108:111], a[124:127], v[76:79]
    s_waitcnt lgkmcnt(4)
    v_mfma_f32_16x16x32_bf16 v[48:51], v[80:83], a[128:131], v[48:51]
    v_mfma_f32_16x16x32_bf16 v[52:55], v[80:83], a[132:135], v[52:55]
    v_mfma_f32_16x16x32_bf16 v[56:59], v[80:83], a[136:139], v[56:59]
    v_mfma_f32_16x16x32_bf16 v[60:63], v[80:83], a[140:143], v[60:63]
    ds_read_b128 v[104:107], v8 offset:11264
    ds_read_b128 v[108:111], v8 offset:27648
    v_mfma_f32_16x16x32_bf16 v[64:67], v[84:87], a[128:131], v[64:67]
    v_mfma_f32_16x16x32_bf16 v[68:71], v[84:87], a[132:135], v[68:71]
    v_mfma_f32_16x16x32_bf16 v[72:75], v[84:87], a[136:139], v[72:75]
    v_mfma_f32_16x16x32_bf16 v[76:79], v[84:87], a[140:143], v[76:79]
    s_waitcnt lgkmcnt(4)
    v_mfma_f32_16x16x32_bf16 v[48:51], v[88:91], a[144:147], v[48:51]
    v_mfma_f32_16x16x32_bf16 v[52:55], v[88:91], a[148:151], v[52:55]
    v_mfma_f32_16x16x32_bf16 v[56:59], v[88:91], a[152:155], v[56:59]
    v_mfma_f32_16x16x32_bf16 v[60:63], v[88:91], a[156:159], v[60:63]
    ds_read_b128 v[80:83], v8 offset:12288
    ds_read_b128 v[84:87], v8 offset:28672
    v_mfma_f32_16x16x32_bf16 v[64:67], v[92:95], a[144:147], v[64:67]
    v_mfma_f32_16x16x32_bf16 v[68:71], v[92:95], a[148:151], v[68:71]
    v_mfma_f32_16x16x32_bf16 v[72:75], v[92:95], a[152:155], v[72:75]
    v_mfma_f32_16x16x32_bf16 v[76:79], v[92:95], a[156:159], v[76:79]
    s_waitcnt lgkmcnt(4)
    v_mfma_f32_16x16x32_bf16 v[48:51], v[96:99], a[160:163], v[48:51]
    v_mfma_f32_16x16x32_bf16 v[52:55], v[96:99], a[164:167], v[52:55]
    v_mfma_f32_16x16x32_bf16 v[56:59], v[96:99], a[168:171], v[56:59]
    v_mfma_f32_16x16x32_bf16 v[60:63], v[96:99], a[172:175], v[60:63]
    ds_read_b128 v[88:91], v8 offset:13312
    ds_read_b128 v[92:95], v8 offset:29696
    v_mfma_f32_16x16x32_bf16 v[64:67], v[100:103], a[160:163], v[64:67]
    v_mfma_f32_16x16x32_bf16 v[68:71], v[100:103], a[164:167], v[68:71]
    v_mfma_f32_16x16x32_bf16 v[72:75], v[100:103], a[168:171], v[72:75]
    v_mfma_f32_16x16x32_bf16 v[76:79], v[100:103], a[172:175], v[76:79]
    s_waitcnt lgkmcnt(4)
    v_mfma_f32_16x16x32_bf16 v[48:51], v[104:107], a[176:179], v[48:51]
    v_mfma_f32_16x16x32_bf16 v[52:55], v[104:107], a[180:183], v[52:55]
    v_mfma_f32_16x16x32_bf16 v[56:59], v[104:107], a[184:187], v[56:59]
    v_mfma_f32_16x16x32_bf16 v[60:63], v[104:107], a[188:191], v[60:63]
    ds_read_b128 v[96:99], v8 offset:14336
    ds_read_b128 v[100:103], v8 offset:30720
    v_mfma_f32_16x16x32_bf16 v[64:67], v[108:111], a[176:179], v[64:67]
    v_mfma_f32_16x16x32_bf16 v[68:71], v[108:111], a[180:183], v[68:71]
    v_mfma_f32_16x16x32_bf16 v[72:75], v[108:111], a[184:187], v[72:75]
    v_mfma_f32_16x16x32_bf16 v[76:79], v[108:111], a[188:191], v[76:79]
    s_waitcnt lgkmcnt(4)
    v_mfma_f32_16x16x32_bf16 v[48:51], v[80:83], a[192:195], v[48:51]
    v_mfma_f32_16x16x32_bf16 v[52:55], v[80:83], a[196:199], v[52:55]
    v_mfma_f32_16x16x32_bf16 v[56:59], v[80:83], a[200:203], v[56:59]
    v_mfma_f32_16x16x32_bf16 v[60:63], v[80:83], a[204:207], v[60:63]
    ds_read_b128 v[104:107], v8 offset:15360
    ds_read_b128 v[108:111], v8 offset:31744
    v_mfma_f32_16x16x32_bf16 v[64:67], v[84:87], a[192:195], v[64:67]
    v_mfma_f32_16x16x32_bf16 v[68:71], v[84:87], a[196:199], v[68:71]
    v_mfma_f32_16x16x32_bf16 v[72:75], v[84:87], a[200:203], v[72:75]
    v_mfma_f32_16x16x32_bf16 v[76:79], v[84:87], a[204:207], v[76:79]
    s_waitcnt lgkmcnt(4)
    v_mfma_f32_16x16x32_bf16 v[48:51], v[88:91], a[208:211], v[48:51]
    v_mfma_f32_16x16x32_bf16 v[52:55], v[88:91], a[212:215], v[52:55]
    v_mfma_f32_16x16x32_bf16 v[56:59], v[88:91], a[216:219], v[56:59]
    v_mfma_f32_16x16x32_bf16 v[60:63], v[88:91], a[220:223], v[60:63]
    v_mfma_f32_16x16x32_bf16 v[64:67], v[92:95], a[208:211], v[64:67]
    v_mfma_f32_16x16x32_bf16 v[68:71], v[92:95], a[212:215], v[68:71]
    v_mfma_f32_16x16x32_bf16 v[72:75], v[92:95], a[216:219], v[72:75]
    v_mfma_f32_16x16x32_bf16 v[76:79], v[92:95], a[220:223], v[76:79]
    s_waitcnt lgkmcnt(2)
    v_mfma_f32_16x16x32_bf16 v[48:51], v[96:99], a[224:227], v[48:51]
    v_mfma_f32_16x16x32_bf16 v[52:55], v[96:99], a[228:231], v[52:55]
    v_mfma_f32_16x16x32_bf16 v[56:59], v[96:99], a[232:235], v[56:59]
    v_mfma_f32_16x16x32_bf16 v[60:63], v[96:99], a[236:239], v[60:63]
    v_mfma_f32_16x16x32_bf16 v[64:67], v[100:103], a[224:227], v[64:67]
    v_mfma_f32_16x16x32_bf16 v[68:71], v[100:103], a[228:231], v[68:71]
    v_mfma_f32_16x16x32_bf16 v[72:75], v[100:103], a[232:235], v[72:75]
    v_mfma_f32_16x16x32_bf16 v[76:79], v[100:103], a[236:239], v[76:79]
    s_waitcnt lgkmcnt(0)
    v_mfma_f32_16x16x32_bf16 v[48:51], v[104:107], a[240:243], v[48:51]
    v_mfma_f32_16x16x32_bf16 v[52:55], v[104:107], a[244:247], v[52:55]
    v_mfma_f32_16x16x32_bf16 v[56:59], v[104:107], a[248:251], v[56:59]
    v_mfma_f32_16x16x32_bf16 v[60:63], v[104:107], a[252:255], v[60:63]
    v_mfma_f32_16x16x32_bf16 v[64:67], v[108:111], a[240:243], v[64:67]
    v_mfma_f32_16x16x32_bf16 v[68:71], v[108:111], a[244:247], v[68:71]
    v_mfma_f32_16x16x32_bf16 v[72:75], v[108:111], a[248:251], v[72:75]
    v_mfma_f32_16x16x32_bf16 v[76:79], v[108:111], a[252:255], v[76:79]
RV_T6:
    s_mul_i32 s24, s20, 786432
    s_add_u32 s24, s24, s33
    s_add_u32 s25, s24, 4096
    v_cvt_pk_bf16_f32 v112, v48, v49
    v_cvt_pk_bf16_f32 v113, v50, v51
    v_cvt_pk_bf16_f32 v114, v64, v65
    v_cvt_pk_bf16_f32 v115, v66, v67
    buffer_store_dwordx4 v[112:115], v9, s[4:7], s24 offen offset:0 sc1
    v_cvt_pk_bf16_f32 v116, v52, v53
    v_cvt_pk_bf16_f32 v117, v54, v55
    v_cvt_pk_bf16_f32 v118, v68, v69
    v_cvt_pk_bf16_f32 v119, v70, v71
    buffer_store_dwordx4 v[116:119], v9, s[4:7], s24 offen offset:1024 sc1
    v_cvt_pk_bf16_f32 v120, v56, v57
    v_cvt_pk_bf16_f32 v121, v58, v59
    v_cvt_pk_bf16_f32 v122, v72, v73
    v_cvt_pk_bf16_f32 v123, v74, v75
    buffer_store_dwordx4 v[120:123], v9, s[4:7], s24 offen offset:2048 sc1
    v_cvt_pk_bf16_f32 v124, v60, v61
    v_cvt_pk_bf16_f32 v125, v62, v63
    v_cvt_pk_bf16_f32 v126, v76, v77
    v_cvt_pk_bf16_f32 v127, v78, v79
    buffer_store_dwordx4 v[124:127], v9, s[4:7], s24 offen offset:3072 sc1
    s_mov_b32 s22, s20
    s_mov_b32 s20, s21
    s_waitcnt vmcnt(4)
    s_cmp_lg_u32 s21, -1
    s_nop 5
    s_cbranch_scc1 RV_TOP
    s_cmp_lg_u32 s16, 0
    s_cbranch_scc1 Lw0_155
    v_readfirstlane_b32 s25, v3
    v_readfirstlane_b32 s26, v4
    s_mov_b32 s24, -1
    s_cmp_ge_u32 s18, 64
    s_cbranch_scc1 Lsk_156
    s_cmp_lg_u32 s25, 4
    s_cbranch_scc1 Lsk_156
    s_add_u32 s24, s18, 0
Lsk_156:
    s_cmp_ge_u32 s19, 64
    s_cbranch_scc1 Lsk_157
    s_cmp_lg_u32 s26, 4
    s_cbranch_scc1 Lsk_157
    s_add_u32 s24, s19, 64
Lsk_157:
    v_mov_b32 v5, s24
    v_mov_b32 v6, 163776
    ds_write_b32 v6, v5 offset:8
Lw0_155:
    s_waitcnt lgkmcnt(0)
    s_barrier
    v_mov_b32 v6, 163776
    ds_read_b32 v5, v6 offset:8
    s_waitcnt lgkmcnt(0)
    v_readfirstlane_b32 s20, v5
    s_cmp_lg_u32 s20, -1
    s_cbranch_scc1 RV_GO
    s_waitcnt vmcnt(0)
    s_barrier
    s_cmp_lg_u32 s16, 0
    s_cbranch_scc1 Lsg_158
    s_lshl_b32 s24, s22, 4
    s_add_u32 s24, s24, s41
    s_lshl_b32 s24, s24, 6
    s_cmp_eq_u32 s40, 0
    s_cselect_b32 s25, 1, 0x100
    v_mov_b32 v5, s25
    s_mov_b64 s[38:39], exec
    s_mov_b64 exec, 1
    buffer_atomic_add v5, v2, s[4:7], s24 offen
    s_mov_b64 exec, s[38:39]
Lsg_158:
    s_mov_b32 s22, -1
    s_branch RV_B1
E_QKV:
    s_mov_b32 s96, 1
    s_mov_b32 s97, 14
    s_cmp_eq_u32 s95, 0
    s_cbranch_scc1 D_LATE
    s_endpgm
J_FF:
    s_cmp_ge_u32 s44, 11
    s_cselect_b32 s95, 1, 0
    s_cselect_b32 s24, 11, 0
    s_lshl1_add_u32 s95, s96, s95
    s_sub_u32 s41, s44, s24
    v_lshlrev_b32 v9, 4, v1
    s_lshl_b32 s33, s41, 15
    s_lshl_b32 s24, s16, 12
    s_add_u32 s33, s33, s24
    s_add_u32 s33, s33, 203423744
    s_lshl_b32 s25, s41, 8
    s_lshl_b32 s24, s16, 6
    s_add_u32 s25, s25, s24
    s_cmp_ge_u32 s25, 2752
    s_cselect_b32 s25, 0x10000000, s25
    v_lshrrev_b32 v5, 4, v1
    v_mul_u32_u24 v5, 88064, v5
    v_and_b32 v6, 15, v1
    v_lshlrev_b32 v6, 2, v6
    v_add3_u32 v8, v5, v6, s25
    s_lshl_b32 s24, s16, 10
    v_add_u32 v11, s24, v9
    v_add_u32 v11, 65536, v11
    v_add_u32 v10, 65536, v9
    s_load_dwordx2 s[8:9], s[0:1], 64
    s_mov_b32 s10, 1409024
    s_mov_b32 s11, 0x00020000
    s_waitcnt lgkmcnt(0)
    s_mov_b32 s24, 0
    buffer_load_dword v16, v8, s[8:11], s24 offen
    s_mov_b32 s24, 2752
    buffer_load_dword v17, v8, s[8:11], s24 offen
    s_mov_b32 s24, 5504
    buffer_load_dword v18, v8, s[8:11], s24 offen
    s_mov_b32 s24, 8256
    buffer_load_dword v19, v8, s[8:11], s24 offen
    s_mov_b32 s24, 11008
    buffer_load_dword v20, v8, s[8:11], s24 offen
    s_mov_b32 s24, 13760
    buffer_load_dword v21, v8, s[8:11], s24 offen
    s_mov_b32 s24, 16512
    buffer_load_dword v22, v8, s[8:11], s24 offen
    s_mov_b32 s24, 19264
    buffer_load_dword v23, v8, s[8:11], s24 offen
    s_mov_b32 s24, 22016
    buffer_load_dword v24, v8, s[8:11], s24 offen
    s_mov_b32 s24, 24768
    buffer_load_dword v25, v8, s[8:11], s24 offen
    s_mov_b32 s24, 27520
    buffer_load_dword v26, v8, s[8:11], s24 offen
    s_mov_b32 s24, 30272
    buffer_load_dword v27, v8, s[8:11], s24 offen
    s_mov_b32 s24, 33024
    buffer_load_dword v28, v8, s[8:11], s24 offen
    s_mov_b32 s24, 35776
    buffer_load_dword v29, v8, s[8:11], s24 offen
    s_mov_b32 s24, 38528
    buffer_load_dword v30, v8, s[8:11], s24 offen
    s_mov_b32 s24, 41280
    buffer_load_dword v31, v8, s[8:11], s24 offen
    s_mov_b32 s24, 44032
    buffer_load_dword v32, v8, s[8:11], s24 offen
    s_mov_b32 s24, 46784
    buffer_load_dword v33, v8, s[8:11], s24 offen
    s_mov_b32 s24, 49536
    buffer_load_dword v34, v8, s[8:11], s24 offen
    s_mov_b32 s24, 52288
    buffer_load_dword v35, v8, s[8:11], s24 offen
    s_mov_b32 s24, 55040
    buffer_load_dword v36, v8, s[8:11], s24 offen
    s_mov_b32 s24, 57792
    buffer_load_dword v37, v8, s[8:11], s24 offen
    s_mov_b32 s24, 60544
    buffer_load_dword v38, v8, s[8:11], s24 offen
    s_mov_b32 s24, 63296
    buffer_load_dword v39, v8, s[8:11], s24 offen
    s_mov_b32 s24, 66048
    buffer_load_dword v40, v8, s[8:11], s24 offen
    s_mov_b32 s24, 68800
    buffer_load_dword v41, v8, s[8:11], s24 offen
    s_mov_b32 s24, 71552
    buffer_load_dword v42, v8, s[8:11], s24 offen
    s_mov_b32 s24, 74304
    buffer_load_dword v43, v8, s[8:11], s24 offen
    s_mov_b32 s24, 77056
    buffer_load_dword v44, v8, s[8:11], s24 offen
    s_mov_b32 s24, 79808
    buffer_load_dword v45, v8, s[8:11], s24 offen
    s_mov_b32 s24, 82560
    buffer_load_dword v46, v8, s[8:11], s24 offen
    s_mov_b32 s24, 85312
    buffer_load_dword v47, v8, s[8:11], s24 offen
    s_mov_b32 s24, 352256
    buffer_load_dword v48, v8, s[8:11], s24 offen
    s_mov_b32 s24, 355008
    buffer_load_dword v49, v8, s[8:11], s24 offen
    s_mov_b32 s24, 357760
    buffer_load_dword v50, v8, s[8:11], s24 offen
    s_mov_b32 s24, 360512
    buffer_load_dword v51, v8, s[8:11], s24 offen
    s_mov_b32 s24, 363264
    buffer_load_dword v52, v8, s[8:11], s24 offen
    s_mov_b32 s24, 366016
    buffer_load_dword v53, v8, s[8:11], s24 offen
    s_mov_b32 s24, 368768
    buffer_load_dword v54, v8, s[8:11], s24 offen
    s_mov_b32 s24, 371520
    buffer_load_dword v55, v8, s[8:11], s24 offen
    s_mov_b32 s24, 374272
    buffer_load_dword v56, v8, s[8:11], s24 offen
    s_mov_b32 s24, 377024
    buffer_load_dword v57, v8, s[8:11], s24 offen
    s_mov_b32 s24, 379776
    buffer_load_dword v58, v8, s[8:11], s24 offen
    s_mov_b32 s24, 382528
    buffer_load_dword v59, v8, s[8:11], s24 offen
    s_mov_b32 s24, 385280
    buffer_load_dword v60, v8, s[8:11], s24 offen
    s_mov_b32 s24, 388032
    buffer_load_dword v61, v8, s[8:11], s24 offen
    s_mov_b32 s24, 390784
    buffer_load_dword v62, v8, s[8:11], s24 offen
    s_mov_b32 s24, 393536
    buffer_load_dword v63, v8, s[8:11], s24 offen
    s_mov_b32 s24, 396288
    buffer_load_dword v64, v8, s[8:11], s24 offen
    s_mov_b32 s24, 399040
    buffer_load_dword v65, v8, s[8:11], s24 offen
    s_mov_b32 s24, 401792
    buffer_load_dword v66, v8, s[8:11], s24 offen
    s_mov_b32 s24, 404544
    buffer_load_dword v67, v8, s[8:11], s24 offen
    s_mov_b32 s24, 407296
    buffer_load_dword v68, v8, s[8:11], s24 offen
    s_mov_b32 s24, 410048
    buffer_load_dword v69, v8, s[8:11], s24 offen
    s_mov_b32 s24, 412800
    buffer_load_dword v70, v8, s[8:11], s24 offen
    s_mov_b32 s24, 415552
    buffer_load_dword v71, v8, s[8:11], s24 offen
    s_waitcnt vmcnt(48)
    v_perm_b32 v5, v17, v16, s31
    v_accvgpr_write_b32 a0, v5
    v_perm_b32 v6, v19, v18, s31
    v_accvgpr_write_b32 a1, v6
    v_perm_b32 v5, v21, v20, s31
    v_accvgpr_write_b32 a2, v5
    v_perm_b32 v6, v23, v22, s31
    v_accvgpr_write_b32 a3, v6
    v_perm_b32 v5, v17, v16, s32
    v_accvgpr_write_b32 a4, v5
    v_perm_b32 v6, v19, v18, s32
    v_accvgpr_write_b32 a5, v6
    v_perm_b32 v5, v21, v20, s32
    v_accvgpr_write_b32 a6, v5
    v_perm_b32 v6, v23, v22, s32
    v_accvgpr_write_b32 a7, v6
    s_mov_b32 s24, 418304
    buffer_load_dword v16, v8, s[8:11], s24 offen
    s_mov_b32 s24, 421056
    buffer_load_dword v17, v8, s[8:11], s24 offen
    s_mov_b32 s24, 423808
    buffer_load_dword v18, v8, s[8:11], s24 offen
    s_mov_b32 s24, 426560
    buffer_load_dword v19, v8, s[8:11], s24 offen
    s_mov_b32 s24, 429312
    buffer_load_dword v20, v8, s[8:11], s24 offen
    s_mov_b32 s24, 432064
    buffer_load_dword v21, v8, s[8:11], s24 offen
    s_mov_b32 s24, 434816
    buffer_load_dword v22, v8, s[8:11], s24 offen
    s_mov_b32 s24, 437568
    buffer_load_dword v23, v8, s[8:11], s24 offen
    s_waitcnt vmcnt(48)
    v_perm_b32 v5, v25, v24, s31
    v_accvgpr_write_b32 a8, v5
    v_perm_b32 v6, v27, v26, s31
    v_accvgpr_write_b32 a9, v6
    v_perm_b32 v5, v29, v28, s31
    v_accvgpr_write_b32 a10, v5
    v_perm_b32 v6, v31, v30, s31
    v_accvgpr_write_b32 a11, v6
    v_perm_b32 v5, v25, v24, s32
    v_accvgpr_write_b32 a12, v5
    v_perm_b32 v6, v27, v26, s32
    v_accvgpr_write_b32 a13, v6
    v_perm_b32 v5, v29, v28, s32
    v_accvgpr_write_b32 a14, v5
    v_perm_b32 v6, v31, v30, s32
    v_accvgpr_write_b32 a15, v6
    s_mov_b32 s24, 704512
    buffer_load_dword v24, v8, s[8:11], s24 offen
    s_mov_b32 s24, 707264
    buffer_load_dword v25, v8, s[8:11], s24 offen
    s_mov_b32 s24, 710016
    buffer_load_dword v26, v8, s[8:11], s24 offen
    s_mov_b32 s24, 712768
    buffer_load_dword v27, v8, s[8:11], s24 offen
    s_mov_b32 s24, 715520
    buffer_load_dword v28, v8, s[8:11], s24 offen
    s_mov_b32 s24, 718272
    buffer_load_dword v29, v8, s[8:11], s24 offen
    s_mov_b32 s24, 721024
    buffer_load_dword v30, v8, s[8:11], s24 offen
    s_mov_b32 s24, 723776
    buffer_load_dword v31, v8, s[8:11], s24 offen
    s_waitcnt vmcnt(48)
    v_perm_b32 v5, v33, v32, s31
    v_accvgpr_write_b32 a16, v5
    v_perm_b32 v6, v35, v34, s31
    v_accvgpr_write_b32 a17, v6
    v_perm_b32 v5, v37, v36, s31
    v_accvgpr_write_b32 a18, v5
    v_perm_b32 v6, v39, v38, s31
    v_accvgpr_write_b32 a19, v6
    v_perm_b32 v5, v33, v32, s32
    v_accvgpr_write_b32 a20, v5
    v_perm_b32 v6, v35, v34, s32
    v_accvgpr_write_b32 a21, v6
    v_perm_b32 v5, v37, v36, s32
    v_accvgpr_write_b32 a22, v5
    v_perm_b32 v6, v39, v38, s32
    v_accvgpr_write_b32 a23, v6
    s_mov_b32 s24, 726528
    buffer_load_dword v32, v8, s[8:11], s24 offen
    s_mov_b32 s24, 729280
    buffer_load_dword v33, v8, s[8:11], s24 offen
    s_mov_b32 s24, 732032
    buffer_load_dword v34, v8, s[8:11], s24 offen
    s_mov_b32 s24, 734784
    buffer_load_dword v35, v8, s[8:11], s24 offen
    s_mov_b32 s24, 737536
    buffer_load_dword v36, v8, s[8:11], s24 offen
    s_mov_b32 s24, 740288
    buffer_load_dword v37, v8, s[8:11], s24 offen
    s_mov_b32 s24, 743040
    buffer_load_dword v38, v8, s[8:11], s24 offen
    s_mov_b32 s24, 745792
    buffer_load_dword v39, v8, s[8:11], s24 offen
    s_waitcnt vmcnt(48)
    v_perm_b32 v5, v41, v40, s31
    v_accvgpr_write_b32 a24, v5
    v_perm_b32 v6, v43, v42, s31
    v_accvgpr_write_b32 a25, v6
    v_perm_b32 v5, v45, v44, s31
    v_accvgpr_write_b32 a26, v5
    v_perm_b32 v6, v47, v46, s31
    v_accvgpr_write_b32 a27, v6
    v_perm_b32 v5, v41, v40, s32
    v_accvgpr_write_b32 a28, v5
    v_perm_b32 v6, v43, v42, s32
    v_accvgpr_write_b32 a29, v6
    v_perm_b32 v5, v45, v44, s32
    v_accvgpr_write_b32 a30, v5
    v_perm_b32 v6, v47, v46, s32
    v_accvgpr_write_b32 a31, v6
    s_mov_b32 s24, 748544
    buffer_load_dword v40, v8, s[8:11], s24 offen
    s_mov_b32 s24, 751296
    buffer_load_dword v41, v8, s[8:11], s24 offen
    s_mov_b32 s24, 754048
    buffer_load_dword v42, v8, s[8:11], s24 offen
    s_mov_b32 s24, 756800
    buffer_load_dword v43, v8, s[8:11], s24 offen
    s_mov_b32 s24, 759552
    buffer_load_dword v44, v8, s[8:11], s24 offen
    s_mov_b32 s24, 762304
    buffer_load_dword v45, v8, s[8:11], s24 offen
    s_mov_b32 s24, 765056
    buffer_load_dword v46, v8, s[8:11], s24 offen
    s_mov_b32 s24, 767808
    buffer_load_dword v47, v8, s[8:11], s24 offen
    s_waitcnt vmcnt(48)
    v_perm_b32 v5, v49, v48, s31
    v_accvgpr_write_b32 a32, v5
    v_perm_b32 v6, v51, v50, s31
    v_accvgpr_write_b32 a33, v6
    v_perm_b32 v5, v53, v52, s31
    v_accvgpr_write_b32 a34, v5
    v_perm_b32 v6, v55, v54, s31
    v_accvgpr_write_b32 a35, v6
    v_perm_b32 v5, v49, v48, s32
    v_accvgpr_write_b32 a36, v5
    v_perm_b32 v6, v51, v50, s32
    v_accvgpr_write_b32 a37, v6
    v_perm_b32 v5, v53, v52, s32
    v_accvgpr_write_b32 a38, v5
    v_perm_b32 v6, v55, v54, s32
    v_accvgpr_write_b32 a39, v6
    s_mov_b32 s24, 770560
    buffer_load_dword v48, v8, s[8:11], s24 offen
    s_mov_b32 s24, 773312
    buffer_load_dword v49, v8, s[8:11], s24 offen
    s_mov_b32 s24, 776064
    buffer_load_dword v50, v8, s[8:11], s24 offen
    s_mov_b32 s24, 778816
    buffer_load_dword v51, v8, s[8:11], s24 offen
    s_mov_b32 s24, 781568
    buffer_load_dword v52, v8, s[8:11], s24 offen
    s_mov_b32 s24, 784320
    buffer_load_dword v53, v8, s[8:11], s24 offen
    s_mov_b32 s24, 787072
    buffer_load_dword v54, v8, s[8:11], s24 offen
    s_mov_b32 s24, 789824
    buffer_load_dword v55, v8, s[8:11], s24 offen
    s_waitcnt vmcnt(48)
    v_perm_b32 v5, v57, v56, s31
    v_accvgpr_write_b32 a40, v5
    v_perm_b32 v6, v59, v58, s31
    v_accvgpr_write_b32 a41, v6
    v_perm_b32 v5, v61, v60, s31
    v_accvgpr_write_b32 a42, v5
    v_perm_b32 v6, v63, v62, s31
    v_accvgpr_write_b32 a43, v6
    v_perm_b32 v5, v57, v56, s32
    v_accvgpr_write_b32 a44, v5
    v_perm_b32 v6, v59, v58, s32
    v_accvgpr_write_b32 a45, v6
    v_perm_b32 v5, v61, v60, s32
    v_accvgpr_write_b32 a46, v5
    v_perm_b32 v6, v63, v62, s32
    v_accvgpr_write_b32 a47, v6
    s_mov_b32 s24, 1056768
    buffer_load_dword v56, v8, s[8:11], s24 offen
    s_mov_b32 s24, 1059520
    buffer_load_dword v57, v8, s[8:11], s24 offen
    s_mov_b32 s24, 1062272
    buffer_load_dword v58, v8, s[8:11], s24 offen
    s_mov_b32 s24, 1065024
    buffer_load_dword v59, v8, s[8:11], s24 offen
    s_mov_b32 s24, 1067776
    buffer_load_dword v60, v8, s[8:11], s24 offen
    s_mov_b32 s24, 1070528
    buffer_load_dword v61, v8, s[8:11], s24 offen
    s_mov_b32 s24, 1073280
    buffer_load_dword v62, v8, s[8:11], s24 offen
    s_mov_b32 s24, 1076032
    buffer_load_dword v63, v8, s[8:11], s24 offen
    s_waitcnt vmcnt(48)
    v_perm_b32 v5, v65, v64, s31
    v_accvgpr_write_b32 a48, v5
    v_perm_b32 v6, v67, v66, s31
    v_accvgpr_write_b32 a49, v6
    v_perm_b32 v5, v69, v68, s31
    v_accvgpr_write_b32 a50, v5
    v_perm_b32 v6, v71, v70, s31
    v_accvgpr_write_b32 a51, v6
    v_perm_b32 v5, v65, v64, s32
    v_accvgpr_write_b32 a52, v5
    v_perm_b32 v6, v67, v66, s32
    v_accvgpr_write_b32 a53, v6
    v_perm_b32 v5, v69, v68, s32
    v_accvgpr_write_b32 a54, v5
    v_perm_b32 v6, v71, v70, s32
    v_accvgpr_write_b32 a55, v6
    s_mov_b32 s24, 1078784
    buffer_load_dword v64, v8, s[8:11], s24 offen
    s_mov_b32 s24, 1081536
    buffer_load_dword v65, v8, s[8:11], s24 offen
    s_mov_b32 s24, 1084288
    buffer_load_dword v66, v8, s[8:11], s24 offen
    s_mov_b32 s24, 1087040
    buffer_load_dword v67, v8, s[8:11], s24 offen
    s_mov_b32 s24, 1089792
    buffer_load_dword v68, v8, s[8:11], s24 offen
    s_mov_b32 s24, 1092544
    buffer_load_dword v69, v8, s[8:11], s24 offen
    s_mov_b32 s24, 1095296
    buffer_load_dword v70, v8, s[8:11], s24 offen
    s_mov_b32 s24, 1098048
    buffer_load_dword v71, v8, s[8:11], s24 offen
    s_waitcnt vmcnt(48)
    v_perm_b32 v5, v17, v16, s31
    v_accvgpr_write_b32 a56, v5
    v_perm_b32 v6, v19, v18, s31
    v_accvgpr_write_b32 a57, v6
    v_perm_b32 v5, v21, v20, s31
    v_accvgpr_write_b32 a58, v5
    v_perm_b32 v6, v23, v22, s31
    v_accvgpr_write_b32 a59, v6
    v_perm_b32 v5, v17, v16, s32
    v_accvgpr_write_b32 a60, v5
    v_perm_b32 v6, v19, v18, s32
    v_accvgpr_write_b32 a61, v6
    v_perm_b32 v5, v21, v20, s32
    v_accvgpr_write_b32 a62, v5
    v_perm_b32 v6, v23, v22, s32
    v_accvgpr_write_b32 a63, v6
    s_mov_b32 s24, 1100800
    buffer_load_dword v16, v8, s[8:11], s24 offen
    s_mov_b32 s24, 1103552
    buffer_load_dword v17, v8, s[8:11], s24 offen
    s_mov_b32 s24, 1106304
    buffer_load_dword v18, v8, s[8:11], s24 offen
    s_mov_b32 s24, 1109056
    buffer_load_dword v19, v8, s[8:11], s24 offen
    s_mov_b32 s24, 1111808
    buffer_load_dword v20, v8, s[8:11], s24 offen
    s_mov_b32 s24, 1114560
    buffer_load_dword v21, v8, s[8:11], s24 offen
    s_mov_b32 s24, 1117312
    buffer_load_dword v22, v8, s[8:11], s24 offen
    s_mov_b32 s24, 1120064
    buffer_load_dword v23, v8, s[8:11], s24 offen
    s_waitcnt vmcnt(48)
    v_perm_b32 v5, v25, v24, s31
    v_accvgpr_write_b32 a64, v5
    v_perm_b32 v6, v27, v26, s31
    v_accvgpr_write_b32 a65, v6
    v_perm_b32 v5, v29, v28, s31
    v_accvgpr_write_b32 a66, v5
    v_perm_b32 v6, v31, v30, s31
    v_accvgpr_write_b32 a67, v6
    v_perm_b32 v5, v25, v24, s32
    v_accvgpr_write_b32 a68, v5
    v_perm_b32 v6, v27, v26, s32
    v_accvgpr_write_b32 a69, v6
    v_perm_b32 v5, v29, v28, s32
    v_accvgpr_write_b32 a70, v5
    v_perm_b32 v6, v31, v30, s32
    v_accvgpr_write_b32 a71, v6
    s_mov_b32 s24, 1122816
    buffer_load_dword v24, v8, s[8:11], s24 offen
    s_mov_b32 s24, 1125568
    buffer_load_dword v25, v8, s[8:11], s24 offen
    s_mov_b32 s24, 1128320
    buffer_load_dword v26, v8, s[8:11], s24 offen
    s_mov_b32 s24, 1131072
    buffer_load_dword v27, v8, s[8:11], s24 offen
    s_mov_b32 s24, 1133824
    buffer_load_dword v28, v8, s[8:11], s24 offen
    s_mov_b32 s24, 1136576
    buffer_load_dword v29, v8, s[8:11], s24 offen
    s_mov_b32 s24, 1139328
    buffer_load_dword v30, v8, s[8:11], s24 offen
    s_mov_b32 s24, 1142080
    buffer_load_dword v31, v8, s[8:11], s24 offen
    s_waitcnt vmcnt(48)
    v_perm_b32 v5, v33, v32, s31
    v_accvgpr_write_b32 a72, v5
    v_perm_b32 v6, v35, v34, s31
    v_accvgpr_write_b32 a73, v6
    v_perm_b32 v5, v37, v36, s31
    v_accvgpr_write_b32 a74, v5
    v_perm_b32 v6, v39, v38, s31
    v_accvgpr_write_b32 a75, v6
    v_perm_b32 v5, v33, v32, s32
    v_accvgpr_write_b32 a76, v5
    v_perm_b32 v6, v35, v34, s32
    v_accvgpr_write_b32 a77, v6
    v_perm_b32 v5, v37, v36, s32
    v_accvgpr_write_b32 a78, v5
    v_perm_b32 v6, v39, v38, s32
    v_accvgpr_write_b32 a79, v6
    s_waitcnt vmcnt(40)
    v_perm_b32 v5, v41, v40, s31
    v_accvgpr_write_b32 a80, v5
    v_perm_b32 v6, v43, v42, s31
    v_accvgpr_write_b32 a81, v6
    v_perm_b32 v5, v45, v44, s31
    v_accvgpr_write_b32 a82, v5
    v_perm_b32 v6, v47, v46, s31
    v_accvgpr_write_b32 a83, v6
    v_perm_b32 v5, v41, v40, s32
    v_accvgpr_write_b32 a84, v5
    v_perm_b32 v6, v43, v42, s32
    v_accvgpr_write_b32 a85, v6
    v_perm_b32 v5, v45, v44, s32
    v_accvgpr_write_b32 a86, v5
    v_perm_b32 v6, v47, v46, s32
    v_accvgpr_write_b32 a87, v6
    s_waitcnt vmcnt(32)
    v_perm_b32 v5, v49, v48, s31
    v_accvgpr_write_b32 a88, v5
    v_perm_b32 v6, v51, v50, s31
    v_accvgpr_write_b32 a89, v6
    v_perm_b32 v5, v53, v52, s31
    v_accvgpr_write_b32 a90, v5
    v_perm_b32 v6, v55, v54, s31
    v_accvgpr_write_b32 a91, v6
    v_perm_b32 v5, v49, v48, s32
    v_accvgpr_write_b32 a92, v5
    v_perm_b32 v6, v51, v50, s32
    v_accvgpr_write_b32 a93, v6
    v_perm_b32 v5, v53, v52, s32
    v_accvgpr_write_b32 a94, v5
    v_perm_b32 v6, v55, v54, s32
    v_accvgpr_write_b32 a95, v6
    s_waitcnt vmcnt(24)
    v_perm_b32 v5, v57, v56, s31
    v_accvgpr_write_b32 a96, v5
    v_perm_b32 v6, v59, v58, s31
    v_accvgpr_write_b32 a97, v6
    v_perm_b32 v5, v61, v60, s31
    v_accvgpr_write_b32 a98, v5
    v_perm_b32 v6, v63, v62, s31
    v_accvgpr_write_b32 a99, v6
    v_perm_b32 v5, v57, v56, s32
    v_accvgpr_write_b32 a100, v5
    v_perm_b32 v6, v59, v58, s32
    v_accvgpr_write_b32 a101, v6
    v_perm_b32 v5, v61, v60, s32
    v_accvgpr_write_b32 a102, v5
    v_perm_b32 v6, v63, v62, s32
    v_accvgpr_write_b32 a103, v6
    s_waitcnt vmcnt(16)
    v_perm_b32 v5, v65, v64, s31
    v_accvgpr_write_b32 a104, v5
    v_perm_b32 v6, v67, v66, s31
    v_accvgpr_write_b32 a105, v6
    v_perm_b32 v5, v69, v68, s31
    v_accvgpr_write_b32 a106, v5
    v_perm_b32 v6, v71, v70, s31
    v_accvgpr_write_b32 a107, v6
    v_perm_b32 v5, v65, v64, s32
    v_accvgpr_write_b32 a108, v5
    v_perm_b32 v6, v67, v66, s32
    v_accvgpr_write_b32 a109, v6
    v_perm_b32 v5, v69, v68, s32
    v_accvgpr_write_b32 a110, v5
    v_perm_b32 v6, v71, v70, s32
    v_accvgpr_write_b32 a111, v6
    s_waitcnt vmcnt(8)
    v_perm_b32 v5, v17, v16, s31
    v_accvgpr_write_b32 a112, v5
    v_perm_b32 v6, v19, v18, s31
    v_accvgpr_write_b32 a113, v6
    v_perm_b32 v5, v21, v20, s31
    v_accvgpr_write_b32 a114, v5
    v_perm_b32 v6, v23, v22, s31
    v_accvgpr_write_b32 a115, v6
    v_perm_b32 v5, v17, v16, s32
    v_accvgpr_write_b32 a116, v5
    v_perm_b32 v6, v19, v18, s32
    v_accvgpr_write_b32 a117, v6
    v_perm_b32 v5, v21, v20, s32
    v_accvgpr_write_b32 a118, v5
    v_perm_b32 v6, v23, v22, s32
    v_accvgpr_write_b32 a119, v6
    s_waitcnt vmcnt(0)
    v_perm_b32 v5, v25, v24, s31
    v_accvgpr_write_b32 a120, v5
    v_perm_b32 v6, v27, v26, s31
    v_accvgpr_write_b32 a121, v6
    v_perm_b32 v5, v29, v28, s31
    v_accvgpr_write_b32 a122, v5
    v_perm_b32 v6, v31, v30, s31
    v_accvgpr_write_b32 a123, v6
    v_perm_b32 v5, v25, v24, s32
    v_accvgpr_write_b32 a124, v5
    v_perm_b32 v6, v27, v26, s32
    v_accvgpr_write_b32 a125, v6
    v_perm_b32 v5, v29, v28, s32
    v_accvgpr_write_b32 a126, v5
    v_perm_b32 v6, v31, v30, s32
    v_accvgpr_write_b32 a127, v6
    s_load_dwordx2 s[8:9], s[0:1], 72
    s_mov_b32 s10, 1409024
    s_mov_b32 s11, 0x00020000
    s_waitcnt lgkmcnt(0)
    s_lshl_b32 s34, s41, 17
    v_lshrrev_b32 v5, 4, v1
    v_mul_u32_u24 v5, 8192, v5
    v_and_b32 v6, 15, v1
    v_lshlrev_b32 v6, 4, v6
    s_lshl_b32 s25, s16, 8
    v_add3_u32 v8, v5, v6, s25
    s_add_u32 s24, s34, 0
    buffer_load_dwordx4 v[16:19], v8, s[8:11], s24 offen
    s_add_u32 s24, s34, 1024
    buffer_load_dwordx4 v[20:23], v8, s[8:11], s24 offen
    s_add_u32 s24, s34, 2048
    buffer_load_dwordx4 v[24:27], v8, s[8:11], s24 offen
    s_add_u32 s24, s34, 3072
    buffer_load_dwordx4 v[28:31], v8, s[8:11], s24 offen
    s_add_u32 s24, s34, 4096
    buffer_load_dwordx4 v[32:35], v8, s[8:11], s24 offen
    s_add_u32 s24, s34, 5120
    buffer_load_dwordx4 v[36:39], v8, s[8:11], s24 offen
    s_add_u32 s24, s34, 6144
    buffer_load_dwordx4 v[40:43], v8, s[8:11], s24 offen
    s_add_u32 s24, s34, 7168
    buffer_load_dwordx4 v[44:47], v8, s[8:11], s24 offen
    s_add_u32 s24, s34, 32768
    buffer_load_dwordx4 v[48:51], v8, s[8:11], s24 offen
    s_add_u32 s24, s34, 33792
    buffer_load_dwordx4 v[52:55], v8, s[8:11], s24 offen
    s_add_u32 s24, s34, 34816
    buffer_load_dwordx4 v[56:59], v8, s[8:11], s24 offen
    s_add_u32 s24, s34, 35840
    buffer_load_dwordx4 v[60:63], v8, s[8:11], s24 offen
    s_add_u32 s24, s34, 36864
    buffer_load_dwordx4 v[64:67], v8, s[8:11], s24 offen
    s_add_u32 s24, s34, 37888
    buffer_load_dwordx4 v[68:71], v8, s[8:11], s24 offen
    s_add_u32 s24, s34, 38912
    buffer_load_dwordx4 v[72:75], v8, s[8:11], s24 offen
    s_add_u32 s24, s34, 39936
    buffer_load_dwordx4 v[76:79], v8, s[8:11], s24 offen
    s_add_u32 s24, s34, 65536
    buffer_load_dwordx4 v[80:83], v8, s[8:11], s24 offen
    s_add_u32 s24, s34, 66560
    buffer_load_dwordx4 v[84:87], v8, s[8:11], s24 offen
    s_add_u32 s24, s34, 67584
    buffer_load_dwordx4 v[88:91], v8, s[8:11], s24 offen
    s_add_u32 s24, s34, 68608
    buffer_load_dwordx4 v[92:95], v8, s[8:11], s24 offen
    s_add_u32 s24, s34, 69632
    buffer_load_dwordx4 v[96:99], v8, s[8:11], s24 offen
    s_add_u32 s24, s34, 70656
    buffer_load_dwordx4 v[100:103], v8, s[8:11], s24 offen
    s_add_u32 s24, s34, 71680
    buffer_load_dwordx4 v[104:107], v8, s[8:11], s24 offen
    s_add_u32 s24, s34, 72704
    buffer_load_dwordx4 v[108:111], v8, s[8:11], s24 offen
    s_add_u32 s24, s34, 98304
    buffer_load_dwordx4 v[112:115], v8, s[8:11], s24 offen
    s_add_u32 s24, s34, 99328
    buffer_load_dwordx4 v[116:119], v8, s[8:11], s24 offen
    s_add_u32 s24, s34, 100352
    buffer_load_dwordx4 v[120:123], v8, s[8:11], s24 offen
    s_add_u32 s24, s34, 101376
    buffer_load_dwordx4 v[124:127], v8, s[8:11], s24 offen
    s_add_u32 s24, s34, 102400
    buffer_load_dwordx4 v[128:131], v8, s[8:11], s24 offen
    s_add_u32 s24, s34, 103424
    buffer_load_dwordx4 v[132:135], v8, s[8:11], s24 offen
    s_add_u32 s24, s34, 104448
    buffer_load_dwordx4 v[136:139], v8, s[8:11], s24 offen
    s_add_u32 s24, s34, 105472
    buffer_load_dwordx4 v[140:143], v8, s[8:11], s24 offen
    s_waitcnt vmcnt(24)
    v_perm_b32 v5, v20, v16, s31
    v_accvgpr_write_b32 a128, v5
    v_perm_b32 v6, v28, v24, s31
    v_accvgpr_write_b32 a129, v6
    v_perm_b32 v5, v36, v32, s31
    v_accvgpr_write_b32 a130, v5
    v_perm_b32 v6, v44, v40, s31
    v_accvgpr_write_b32 a131, v6
    v_perm_b32 v5, v20, v16, s32
    v_accvgpr_write_b32 a132, v5
    v_perm_b32 v6, v28, v24, s32
    v_accvgpr_write_b32 a133, v6
    v_perm_b32 v5, v36, v32, s32
    v_accvgpr_write_b32 a134, v5
    v_perm_b32 v6, v44, v40, s32
    v_accvgpr_write_b32 a135, v6
    v_perm_b32 v5, v21, v17, s31
    v_accvgpr_write_b32 a136, v5
    v_perm_b32 v6, v29, v25, s31
    v_accvgpr_write_b32 a137, v6
    v_perm_b32 v5, v37, v33, s31
    v_accvgpr_write_b32 a138, v5
    v_perm_b32 v6, v45, v41, s31
    v_accvgpr_write_b32 a139, v6
    v_perm_b32 v5, v21, v17, s32
    v_accvgpr_write_b32 a140, v5
    v_perm_b32 v6, v29, v25, s32
    v_accvgpr_write_b32 a141, v6
    v_perm_b32 v5, v37, v33, s32
    v_accvgpr_write_b32 a142, v5
    v_perm_b32 v6, v45, v41, s32
    v_accvgpr_write_b32 a143, v6
    v_perm_b32 v5, v22, v18, s31
    v_accvgpr_write_b32 a144, v5
    v_perm_b32 v6, v30, v26, s31
    v_accvgpr_write_b32 a145, v6
    v_perm_b32 v5, v38, v34, s31
    v_accvgpr_write_b32 a146, v5
    v_perm_b32 v6, v46, v42, s31
    v_accvgpr_write_b32 a147, v6
    v_perm_b32 v5, v22, v18, s32
    v_accvgpr_write_b32 a148, v5
    v_perm_b32 v6, v30, v26, s32
    v_accvgpr_write_b32 a149, v6
    v_perm_b32 v5, v38, v34, s32
    v_accvgpr_write_b32 a150, v5
    v_perm_b32 v6, v46, v42, s32
    v_accvgpr_write_b32 a151, v6
    v_perm_b32 v5, v23, v19, s31
    v_accvgpr_write_b32 a152, v5
    v_perm_b32 v6, v31, v27, s31
    v_accvgpr_write_b32 a153, v6
    v_perm_b32 v5, v39, v35, s31
    v_accvgpr_write_b32 a154, v5
    v_perm_b32 v6, v47, v43, s31
    v_accvgpr_write_b32 a155, v6
    v_perm_b32 v5, v23, v19, s32
    v_accvgpr_write_b32 a156, v5
    v_perm_b32 v6, v31, v27, s32
    v_accvgpr_write_b32 a157, v6
    v_perm_b32 v5, v39, v35, s32
    v_accvgpr_write_b32 a158, v5
    v_perm_b32 v6, v47, v43, s32
    v_accvgpr_write_b32 a159, v6
    s_waitcnt vmcnt(16)
    v_perm_b32 v5, v52, v48, s31
    v_accvgpr_write_b32 a160, v5
    v_perm_b32 v6, v60, v56, s31
    v_accvgpr_write_b32 a161, v6
    v_perm_b32 v5, v68, v64, s31
    v_accvgpr_write_b32 a162, v5
    v_perm_b32 v6, v76, v72, s31
    v_accvgpr_write_b32 a163, v6
    v_perm_b32 v5, v52, v48, s32
    v_accvgpr_write_b32 a164, v5
    v_perm_b32 v6, v60, v56, s32
    v_accvgpr_write_b32 a165, v6
    v_perm_b32 v5, v68, v64, s32
    v_accvgpr_write_b32 a166, v5
    v_perm_b32 v6, v76, v72, s32
    v_accvgpr_write_b32 a167, v6
    v_perm_b32 v5, v53, v49, s31
    v_accvgpr_write_b32 a168, v5
    v_perm_b32 v6, v61, v57, s31
    v_accvgpr_write_b32 a169, v6
    v_perm_b32 v5, v69, v65, s31
    v_accvgpr_write_b32 a170, v5
    v_perm_b32 v6, v77, v73, s31
    v_accvgpr_write_b32 a171, v6
    v_perm_b32 v5, v53, v49, s32
    v_accvgpr_write_b32 a172, v5
    v_perm_b32 v6, v61, v57, s32
    v_accvgpr_write_b32 a173, v6
    v_perm_b32 v5, v69, v65, s32
    v_accvgpr_write_b32 a174, v5
    v_perm_b32 v6, v77, v73, s32
    v_accvgpr_write_b32 a175, v6
    v_perm_b32 v5, v54, v50, s31
    v_accvgpr_write_b32 a176, v5
    v_perm_b32 v6, v62, v58, s31
    v_accvgpr_write_b32 a177, v6
    v_perm_b32 v5, v70, v66, s31
    v_accvgpr_write_b32 a178, v5
    v_perm_b32 v6, v78, v74, s31
    v_accvgpr_write_b32 a179, v6
    v_perm_b32 v5, v54, v50, s32
    v_accvgpr_write_b32 a180, v5
    v_perm_b32 v6, v62, v58, s32
    v_accvgpr_write_b32 a181, v6
    v_perm_b32 v5, v70, v66, s32
    v_accvgpr_write_b32 a182, v5
    v_perm_b32 v6, v78, v74, s32
    v_accvgpr_write_b32 a183, v6
    v_perm_b32 v5, v55, v51, s31
    v_accvgpr_write_b32 a184, v5
    v_perm_b32 v6, v63, v59, s31
    v_accvgpr_write_b32 a185, v6
    v_perm_b32 v5, v71, v67, s31
    v_accvgpr_write_b32 a186, v5
    v_perm_b32 v6, v79, v75, s31
    v_accvgpr_write_b32 a187, v6
    v_perm_b32 v5, v55, v51, s32
    v_accvgpr_write_b32 a188, v5
    v_perm_b32 v6, v63, v59, s32
    v_accvgpr_write_b32 a189, v6
    v_perm_b32 v5, v71, v67, s32
    v_accvgpr_write_b32 a190, v5
    v_perm_b32 v6, v79, v75, s32
    v_accvgpr_write_b32 a191, v6
    s_waitcnt vmcnt(8)
    v_perm_b32 v5, v84, v80, s31
    v_accvgpr_write_b32 a192, v5
    v_perm_b32 v6, v92, v88, s31
    v_accvgpr_write_b32 a193, v6
    v_perm_b32 v5, v100, v96, s31
    v_accvgpr_write_b32 a194, v5
    v_perm_b32 v6, v108, v104, s31
    v_accvgpr_write_b32 a195, v6
    v_perm_b32 v5, v84, v80, s32
    v_accvgpr_write_b32 a196, v5
    v_perm_b32 v6, v92, v88, s32
    v_accvgpr_write_b32 a197, v6
    v_perm_b32 v5, v100, v96, s32
    v_accvgpr_write_b32 a198, v5
    v_perm_b32 v6, v108, v104, s32
    v_accvgpr_write_b32 a199, v6
    v_perm_b32 v5, v85, v81, s31
    v_accvgpr_write_b32 a200, v5
    v_perm_b32 v6, v93, v89, s31
    v_accvgpr_write_b32 a201, v6
    v_perm_b32 v5, v101, v97, s31
    v_accvgpr_write_b32 a202, v5
    v_perm_b32 v6, v109, v105, s31
    v_accvgpr_write_b32 a203, v6
    v_perm_b32 v5, v85, v81, s32
    v_accvgpr_write_b32 a204, v5
    v_perm_b32 v6, v93, v89, s32
    v_accvgpr_write_b32 a205, v6
    v_perm_b32 v5, v101, v97, s32
    v_accvgpr_write_b32 a206, v5
    v_perm_b32 v6, v109, v105, s32
    v_accvgpr_write_b32 a207, v6
    v_perm_b32 v5, v86, v82, s31
    v_accvgpr_write_b32 a208, v5
    v_perm_b32 v6, v94, v90, s31
    v_accvgpr_write_b32 a209, v6
    v_perm_b32 v5, v102, v98, s31
    v_accvgpr_write_b32 a210, v5
    v_perm_b32 v6, v110, v106, s31
    v_accvgpr_write_b32 a211, v6
    v_perm_b32 v5, v86, v82, s32
    v_accvgpr_write_b32 a212, v5
    v_perm_b32 v6, v94, v90, s32
    v_accvgpr_write_b32 a213, v6
    v_perm_b32 v5, v102, v98, s32
    v_accvgpr_write_b32 a214, v5
    v_perm_b32 v6, v110, v106, s32
    v_accvgpr_write_b32 a215, v6
    v_perm_b32 v5, v87, v83, s31
    v_accvgpr_write_b32 a216, v5
    v_perm_b32 v6, v95, v91, s31
    v_accvgpr_write_b32 a217, v6
    v_perm_b32 v5, v103, v99, s31
    v_accvgpr_write_b32 a218, v5
    v_perm_b32 v6, v111, v107, s31
    v_accvgpr_write_b32 a219, v6
    v_perm_b32 v5, v87, v83, s32
    v_accvgpr_write_b32 a220, v5
    v_perm_b32 v6, v95, v91, s32
    v_accvgpr_write_b32 a221, v6
    v_perm_b32 v5, v103, v99, s32
    v_accvgpr_write_b32 a222, v5
    v_perm_b32 v6, v111, v107, s32
    v_accvgpr_write_b32 a223, v6
    s_waitcnt vmcnt(0)
    v_perm_b32 v5, v116, v112, s31
    v_accvgpr_write_b32 a224, v5
    v_perm_b32 v6, v124, v120, s31
    v_accvgpr_write_b32 a225, v6
    v_perm_b32 v5, v132, v128, s31
    v_accvgpr_write_b32 a226, v5
    v_perm_b32 v6, v140, v136, s31
    v_accvgpr_write_b32 a227, v6
    v_perm_b32 v5, v116, v112, s32
    v_accvgpr_write_b32 a228, v5
    v_perm_b32 v6, v124, v120, s32
    v_accvgpr_write_b32 a229, v6
    v_perm_b32 v5, v132, v128, s32
    v_accvgpr_write_b32 a230, v5
    v_perm_b32 v6, v140, v136, s32
    v_accvgpr_write_b32 a231, v6
    v_perm_b32 v5, v117, v113, s31
    v_accvgpr_write_b32 a232, v5
    v_perm_b32 v6, v125, v121, s31
    v_accvgpr_write_b32 a233, v6
    v_perm_b32 v5, v133, v129, s31
    v_accvgpr_write_b32 a234, v5
    v_perm_b32 v6, v141, v137, s31
    v_accvgpr_write_b32 a235, v6
    v_perm_b32 v5, v117, v113, s32
    v_accvgpr_write_b32 a236, v5
    v_perm_b32 v6, v125, v121, s32
    v_accvgpr_write_b32 a237, v6
    v_perm_b32 v5, v133, v129, s32
    v_accvgpr_write_b32 a238, v5
    v_perm_b32 v6, v141, v137, s32
    v_accvgpr_write_b32 a239, v6
    v_perm_b32 v5, v118, v114, s31
    v_accvgpr_write_b32 a240, v5
    v_perm_b32 v6, v126, v122, s31
    v_accvgpr_write_b32 a241, v6
    v_perm_b32 v5, v134, v130, s31
    v_accvgpr_write_b32 a242, v5
    v_perm_b32 v6, v142, v138, s31
    v_accvgpr_write_b32 a243, v6
    v_perm_b32 v5, v118, v114, s32
    v_accvgpr_write_b32 a244, v5
    v_perm_b32 v6, v126, v122, s32
    v_accvgpr_write_b32 a245, v6
    v_perm_b32 v5, v134, v130, s32
    v_accvgpr_write_b32 a246, v5
    v_perm_b32 v6, v142, v138, s32
    v_accvgpr_write_b32 a247, v6
    v_perm_b32 v5, v119, v115, s31
    v_accvgpr_write_b32 a248, v5
    v_perm_b32 v6, v127, v123, s31
    v_accvgpr_write_b32 a249, v6
    v_perm_b32 v5, v135, v131, s31
    v_accvgpr_write_b32 a250, v5
    v_perm_b32 v6, v143, v139, s31
    v_accvgpr_write_b32 a251, v6
    v_perm_b32 v5, v119, v115, s32
    v_accvgpr_write_b32 a252, v5
    v_perm_b32 v6, v127, v123, s32
    v_accvgpr_write_b32 a253, v6
    v_perm_b32 v5, v135, v131, s32
    v_accvgpr_write_b32 a254, v5
    v_perm_b32 v6, v143, v139, s32
    v_accvgpr_write_b32 a255, v6
    s_cmp_lg_u32 s95, 0
    s_cbranch_scc1 Lsc_160
    s_mov_b32 s18, 0
    s_mov_b32 s84, 0
    s_mov_b32 s85, 2
    s_mov_b32 s86, 2
    s_mov_b32 s87, 64
    s_mov_b32 s19, 66
    s_mov_b32 s88, 0
    s_mov_b32 s89, 4
    s_mov_b32 s90, 4
    s_mov_b32 s91, 64
    s_branch Lsc_159
Lsc_160:
    s_cmp_lg_u32 s95, 1
    s_cbranch_scc1 Lsc_161
    s_mov_b32 s18, 1
    s_mov_b32 s84, 0
    s_mov_b32 s85, 2
    s_mov_b32 s86, 2
    s_mov_b32 s87, 64
    s_mov_b32 s19, 67
    s_mov_b32 s88, 0
    s_mov_b32 s89, 4
    s_mov_b32 s90, 4
    s_mov_b32 s91, 64
    s_branch Lsc_159
Lsc_161:
    s_cmp_lg_u32 s95, 2
    s_cbranch_scc1 Lsc_162
    s_mov_b32 s18, 64
    s_mov_b32 s84, 0
    s_mov_b32 s85, 1
    s_mov_b32 s86, 1
    s_mov_b32 s87, 64
    s_mov_b32 s19, 0
    s_mov_b32 s88, 64
    s_mov_b32 s89, 2
    s_mov_b32 s90, 4
    s_mov_b32 s91, 64
    s_branch Lsc_159
Lsc_162:
    s_cmp_lg_u32 s95, 3
    s_cbranch_scc1 Lsc_163
    s_mov_b32 s18, 64
    s_mov_b32 s84, 0
    s_mov_b32 s85, 1
    s_mov_b32 s86, 1
    s_mov_b32 s87, 64
    s_mov_b32 s19, 1
    s_mov_b32 s88, 64
    s_mov_b32 s89, 2
    s_mov_b32 s90, 4
    s_mov_b32 s91, 64
    s_branch Lsc_159
Lsc_163:
Lsc_159:
    s_cmp_lg_u32 s16, 0
    s_cbranch_scc1 RFF_DW
    v_and_b32 v4, 63, v0
    v_lshlrev_b32 v4, 2, v4
Ldw_164:
    buffer_load_dword v3, v4, s[12:15], 0 offen sc1
    s_waitcnt vmcnt(0)
    s_mov_b32 s24, 0
    v_readlane_b32 s25, v3, 8
    s_add_u32 s24, s24, s25
    v_readlane_b32 s25, v3, 24
    s_add_u32 s24, s24, s25
    v_readlane_b32 s25, v3, 40
    s_add_u32 s24, s24, s25
    v_readlane_b32 s25, v3, 56
    s_add_u32 s24, s24, s25
    s_cmp_ge_u32 s24, 96
    s_cbranch_scc1 Ldw_165
    s_sleep 4
    s_memrealtime s[36:37]
    s_waitcnt lgkmcnt(0)
    s_sub_u32 s36, s36, s28
    s_cmp_gt_u32 s36, 3000000
    s_cbranch_scc1 RFF_DW
    s_branch Ldw_164
Ldw_165:
RFF_DW:
    s_mov_b32 s22, -1
    s_mov_b32 s20, -1
    s_mov_b32 s30, 0
RFF_B1:
    s_min_u32 s24, s18, s19
    s_cmp_ge_u32 s24, 64
    s_cbranch_scc1 E_FF
    s_cmp_lg_u32 s16, 0
    s_cbranch_scc1 RFF_B3
RFF_B2:
    s_min_u32 s25, s18, 63
    s_lshl_b32 s24, s25, 8
    s_add_u32 s24, s24, 131200
    buffer_load_dword v3, v2, s[4:7], s24 offen sc1
    s_min_u32 s25, s19, 63
    s_lshl_b32 s24, s25, 8
    s_add_u32 s24, s24, 147584
    buffer_load_dword v4, v2, s[4:7], s24 offen sc1
    s_waitcnt vmcnt(0)
    v_readfirstlane_b32 s25, v3
    v_readfirstlane_b32 s26, v4
    s_mov_b32 s24, -1
    s_cmp_ge_u32 s19, 64
    s_cbranch_scc1 Lsk_166
    s_cmp_lg_u32 s26, 4
    s_cbranch_scc1 Lsk_166
    s_add_u32 s24, s19, 64
Lsk_166:
    s_cmp_ge_u32 s18, 64
    s_cbranch_scc1 Lsk_167
    s_cmp_lg_u32 s25, 4
    s_cbranch_scc1 Lsk_167
    s_add_u32 s24, s18, 0
Lsk_167:
    s_cmp_lg_u32 s24, -1
    s_cbranch_scc1 RFF_B2x
    s_sleep 2
    s_memrealtime s[36:37]
    s_waitcnt lgkmcnt(0)
    s_sub_u32 s36, s36, s28
    s_cmp_gt_u32 s36, 3000000
    s_cbranch_scc1 RFF_B2x
    s_branch RFF_B2
RFF_B2x:
    v_mov_b32 v5, s24
    v_mov_b32 v6, 163776
    ds_write_b32 v6, v5 offset:8
    s_waitcnt lgkmcnt(0)
RFF_B3:
    s_barrier
    v_mov_b32 v6, 163776
    ds_read_b32 v5, v6 offset:8
    s_waitcnt lgkmcnt(0)
    v_readfirstlane_b32 s20, v5
    s_cmp_eq_u32 s20, -1
    s_cbranch_scc1 E_FF
RFF_GO:
    s_cmp_ge_u32 s20, 64
    s_cbranch_scc1 Lad_168
    s_cmp_ge_u32 s18, s84
    s_cselect_b32 s24, s86, s85
    s_add_u32 s18, s18, s24
    s_cmp_ge_u32 s18, s87
    s_cselect_b32 s18, 64, s18
    s_branch Lad_169
Lad_168:
    s_cmp_ge_u32 s19, s88
    s_cselect_b32 s24, s90, s89
    s_add_u32 s19, s19, s24
    s_cmp_ge_u32 s19, s91
    s_cselect_b32 s19, 64, s19
Lad_169:
    s_min_u32 s25, s18, 63
    s_lshl_b32 s24, s25, 8
    s_add_u32 s24, s24, 131200
    buffer_load_dword v3, v2, s[4:7], s24 offen sc1
    s_min_u32 s25, s19, 63
    s_lshl_b32 s24, s25, 8
    s_add_u32 s24, s24, 147584
    buffer_load_dword v4, v2, s[4:7], s24 offen sc1
    s_lshl_b32 s92, s20, 15
    s_lshl_b32 s93, s16, 13
    s_add_u32 s92, s92, s93
    s_add_u32 s92, s92, 14680064
    s_xor_b32 s94, s30, 1
    s_lshl_b32 s94, s94, 15
    s_add_u32 m0, s94, s93
    s_nop 0
    buffer_load_dwordx4 v9, s[4:7], s92 offen offset:0 sc1 lds
    buffer_load_dwordx4 v9, s[4:7], s92 offen offset:1024 sc1 lds
    buffer_load_dwordx4 v9, s[4:7], s92 offen offset:2048 sc1 lds
    buffer_load_dwordx4 v9, s[4:7], s92 offen offset:3072 sc1 lds
    s_add_u32 s92, s92, 4096
    s_add_u32 m0, m0, 4096
    s_nop 0
    buffer_load_dwordx4 v9, s[4:7], s92 offen offset:0 sc1 lds
    buffer_load_dwordx4 v9, s[4:7], s92 offen offset:1024 sc1 lds
    buffer_load_dwordx4 v9, s[4:7], s92 offen offset:2048 sc1 lds
    buffer_load_dwordx4 v9, s[4:7], s92 offen offset:3072 sc1 lds
    s_cmp_eq_u32 s22, -1
    s_cbranch_scc1 RFF_G1
    s_waitcnt vmcnt(10)
    s_barrier
    s_cmp_lg_u32 s16, 0
    s_cbranch_scc1 Lsg_170
    s_lshl_b32 s24, s22, 8
    s_add_u32 s24, s24, 131264
    v_mov_b32 v5, 1
    s_mov_b64 s[38:39], exec
    s_mov_b64 exec, 1
    buffer_atomic_add v5, v2, s[4:7], s24 offen
    s_mov_b64 exec, s[38:39]
Lsg_170:
    s_mov_b32 s22, -1
RFF_G1:
    s_waitcnt vmcnt(0)
RFF_TOP:
    s_xor_b32 s30, s30, 1
    s_cmp_lg_u32 s16, 0
    s_cbranch_scc1 Lw0_171
    v_readfirstlane_b32 s25, v3
    v_readfirstlane_b32 s26, v4
    s_mov_b32 s24, -1
    s_cmp_ge_u32 s19, 64
    s_cbranch_scc1 Lsk_172
    s_cmp_lg_u32 s26, 4
    s_cbranch_scc1 Lsk_172
    s_add_u32 s24, s19, 64
Lsk_172:
    s_cmp_ge_u32 s18, 64
    s_cbranch_scc1 Lsk_173
    s_cmp_lg_u32 s25, 4
    s_cbranch_scc1 Lsk_173
    s_add_u32 s24, s18, 0
Lsk_173:
    v_mov_b32 v5, s24
    v_mov_b32 v6, 163776
    ds_write_b32 v6, v5 offset:0
Lw0_171:
    s_lshl_b32 s24, s30, 15
    v_add_u32 v8, s24, v9
RFF_S1:
    s_waitcnt lgkmcnt(0)
    s_barrier
    v_mov_b32 v6, 163776
    ds_read_b32 v5, v6 offset:0
    s_waitcnt lgkmcnt(0)
    v_readfirstlane_b32 s21, v5
    s_cmp_eq_u32 s21, -1
    s_cbranch_scc1 RFF_T1
    s_cmp_ge_u32 s21, 64
    s_cbranch_scc1 Lad_174
    s_cmp_ge_u32 s18, s84
    s_cselect_b32 s24, s86, s85
    s_add_u32 s18, s18, s24
    s_cmp_ge_u32 s18, s87
    s_cselect_b32 s18, 64, s18
    s_branch Lad_175
Lad_174:
    s_cmp_ge_u32 s19, s88
    s_cselect_b32 s24, s90, s89
    s_add_u32 s19, s19, s24
    s_cmp_ge_u32 s19, s91
    s_cselect_b32 s19, 64, s19
Lad_175:
    s_lshl_b32 s92, s21, 15
    s_lshl_b32 s93, s16, 13
    s_add_u32 s92, s92, s93
    s_add_u32 s92, s92, 14680064
    s_xor_b32 s94, s30, 1
    s_lshl_b32 s94, s94, 15
    s_add_u32 m0, s94, s93
    s_nop 0
    ds_read_b128 v[80:83], v8 offset:0
    ds_read_b128 v[84:87], v8 offset:1024
    ds_read_b128 v[88:91], v8 offset:2048
    ds_read_b128 v[92:95], v8 offset:3072
    ds_read_b128 v[96:99], v8 offset:4096
    ds_read_b128 v[100:103], v8 offset:5120
    s_waitcnt lgkmcnt(5)
    v_mfma_f32_16x16x32_bf16 v[48:51], a[0:3], v[80:83], 0
    ds_read_b128 v[104:107], v8 offset:6144
    v_mfma_f32_16x16x32_bf16 v[52:55], a[4:7], v[80:83], 0
    buffer_load_dwordx4 v9, s[4:7], s92 offen offset:0 sc1 lds
    s_waitcnt lgkmcnt(5)
    v_mfma_f32_16x16x32_bf16 v[48:51], a[8:11], v[84:87], v[48:51]
    ds_read_b128 v[108:111], v8 offset:7168
    v_mfma_f32_16x16x32_bf16 v[52:55], a[12:15], v[84:87], v[52:55]
    s_waitcnt lgkmcnt(5)
    v_mfma_f32_16x16x32_bf16 v[48:51], a[16:19], v[88:91], v[48:51]
    ds_read_b128 v[80:83], v8 offset:8192
    v_mfma_f32_16x16x32_bf16 v[52:55], a[20:23], v[88:91], v[52:55]
    buffer_load_dwordx4 v9, s[4:7], s92 offen offset:1024 sc1 lds
    s_waitcnt lgkmcnt(5)
    v_mfma_f32_16x16x32_bf16 v[48:51], a[24:27], v[92:95], v[48:51]
    ds_read_b128 v[84:87], v8 offset:9216
    v_mfma_f32_16x16x32_bf16 v[52:55], a[28:31], v[92:95], v[52:55]
    s_waitcnt lgkmcnt(5)
    v_mfma_f32_16x16x32_bf16 v[48:51], a[32:35], v[96:99], v[48:51]
    ds_read_b128 v[88:91], v8 offset:10240
    v_mfma_f32_16x16x32_bf16 v[52:55], a[36:39], v[96:99], v[52:55]
    buffer_load_dwordx4 v9, s[4:7], s92 offen offset:2048 sc1 lds
    s_waitcnt lgkmcnt(5)
    v_mfma_f32_16x16x32_bf16 v[48:51], a[40:43], v[100:103], v[48:51]
    ds_read_b128 v[92:95], v8 offset:11264
    v_mfma_f32_16x16x32_bf16 v[52:55], a[44:47], v[100:103], v[52:55]
    s_waitcnt lgkmcnt(5)
    v_mfma_f32_16x16x32_bf16 v[48:51], a[48:51], v[104:107], v[48:51]
    ds_read_b128 v[96:99], v8 offset:12288
    v_mfma_f32_16x16x32_bf16 v[52:55], a[52:55], v[104:107], v[52:55]
    buffer_load_dwordx4 v9, s[4:7], s92 offen offset:3072 sc1 lds
    s_waitcnt lgkmcnt(5)
    v_mfma_f32_16x16x32_bf16 v[48:51], a[56:59], v[108:111], v[48:51]
    ds_read_b128 v[100:103], v8 offset:13312
    v_mfma_f32_16x16x32_bf16 v[52:55], a[60:63], v[108:111], v[52:55]
    s_waitcnt lgkmcnt(5)
    v_mfma_f32_16x16x32_bf16 v[48:51], a[64:67], v[80:83], v[48:51]
    ds_read_b128 v[104:107], v8 offset:14336
    v_mfma_f32_16x16x32_bf16 v[52:55], a[68:71], v[80:83], v[52:55]
    s_add_u32 s92, s92, 4096
    s_add_u32 m0, m0, 4096
    s_nop 0
    buffer_load_dwordx4 v9, s[4:7], s92 offen offset:0 sc1 lds
    s_waitcnt lgkmcnt(5)
    v_mfma_f32_16x16x32_bf16 v[48:51], a[72:75], v[84:87], v[48:51]
    ds_read_b128 v[108:111], v8 offset:15360
    v_mfma_f32_16x16x32_bf16 v[52:55], a[76:79], v[84:87], v[52:55]
    s_waitcnt lgkmcnt(5)
    v_mfma_f32_16x16x32_bf16 v[48:51], a[80:83], v[88:91], v[48:51]
    ds_read_b128 v[80:83], v8 offset:16384
    v_mfma_f32_16x16x32_bf16 v[52:55], a[84:87], v[88:91], v[52:55]
    buffer_load_dwordx4 v9, s[4:7], s92 offen offset:1024 sc1 lds
    s_waitcnt lgkmcnt(5)
    v_mfma_f32_16x16x32_bf16 v[48:51], a[88:91], v[92:95], v[48:51]
    ds_read_b128 v[84:87], v8 offset:17408
    v_mfma_f32_16x16x32_bf16 v[52:55], a[92:95], v[92:95], v[52:55]
    s_waitcnt lgkmcnt(5)
    v_mfma_f32_16x16x32_bf16 v[48:51], a[96:99], v[96:99], v[48:51]
    ds_read_b128 v[88:91], v8 offset:18432
    v_mfma_f32_16x16x32_bf16 v[52:55], a[100:103], v[96:99], v[52:55]
    buffer_load_dwordx4 v9, s[4:7], s92 offen offset:2048 sc1 lds
    s_waitcnt lgkmcnt(5)
    v_mfma_f32_16x16x32_bf16 v[48:51], a[104:107], v[100:103], v[48:51]
    ds_read_b128 v[92:95], v8 offset:19456
    v_mfma_f32_16x16x32_bf16 v[52:55], a[108:111], v[100:103], v[52:55]
    s_waitcnt lgkmcnt(5)
    v_mfma_f32_16x16x32_bf16 v[48:51], a[112:115], v[104:107], v[48:51]
    ds_read_b128 v[96:99], v8 offset:20480
    v_mfma_f32_16x16x32_bf16 v[52:55], a[116:119], v[104:107], v[52:55]
    buffer_load_dwordx4 v9, s[4:7], s92 offen offset:3072 sc1 lds
    s_waitcnt lgkmcnt(5)
    v_mfma_f32_16x16x32_bf16 v[48:51], a[120:123], v[108:111], v[48:51]
    ds_read_b128 v[100:103], v8 offset:21504
    v_mfma_f32_16x16x32_bf16 v[52:55], a[124:127], v[108:111], v[52:55]
    s_waitcnt lgkmcnt(5)
    v_mfma_f32_16x16x32_bf16 v[56:59], a[0:3], v[80:83], 0
    ds_read_b128 v[104:107], v8 offset:22528
    v_mfma_f32_16x16x32_bf16 v[60:63], a[4:7], v[80:83], 0
    s_waitcnt lgkmcnt(5)
    v_mfma_f32_16x16x32_bf16 v[56:59], a[8:11], v[84:87], v[56:59]
    ds_read_b128 v[108:111], v8 offset:23552
    v_mfma_f32_16x16x32_bf16 v[60:63], a[12:15], v[84:87], v[60:63]
    s_waitcnt lgkmcnt(5)
    v_mfma_f32_16x16x32_bf16 v[56:59], a[16:19], v[88:91], v[56:59]
    ds_read_b128 v[80:83], v8 offset:24576
    v_mul_f32 v64, 0xbfb8aa3b, v48
    v_mfma_f32_16x16x32_bf16 v[60:63], a[20:23], v[88:91], v[60:63]
    v_mul_f32 v65, 0xbfb8aa3b, v49
    v_mul_f32 v66, 0xbfb8aa3b, v50
    s_waitcnt lgkmcnt(5)
    v_mfma_f32_16x16x32_bf16 v[56:59], a[24:27], v[92:95], v[56:59]
    ds_read_b128 v[84:87], v8 offset:25600
    v_mul_f32 v67, 0xbfb8aa3b, v51
    v_mfma_f32_16x16x32_bf16 v[60:63], a[28:31], v[92:95], v[60:63]
    v_mul_f32 v68, 0xbfb8aa3b, v52
    v_mul_f32 v69, 0xbfb8aa3b, v53
    s_waitcnt lgkmcnt(5)
    v_mfma_f32_16x16x32_bf16 v[56:59], a[32:35], v[96:99], v[56:59]
    ds_read_b128 v[88:91], v8 offset:26624
    v_mul_f32 v70, 0xbfb8aa3b, v54
    v_mfma_f32_16x16x32_bf16 v[60:63], a[36:39], v[96:99], v[60:63]
    v_mul_f32 v71, 0xbfb8aa3b, v55
    v_exp_f32 v64, v64
    s_waitcnt lgkmcnt(5)
    v_mfma_f32_16x16x32_bf16 v[56:59], a[40:43], v[100:103], v[56:59]
    ds_read_b128 v[92:95], v8 offset:27648
    v_exp_f32 v65, v65
    v_mfma_f32_16x16x32_bf16 v[60:63], a[44:47], v[100:103], v[60:63]
    v_exp_f32 v66, v66
    v_exp_f32 v67, v67
    s_waitcnt lgkmcnt(5)
    v_mfma_f32_16x16x32_bf16 v[56:59], a[48:51], v[104:107], v[56:59]
    ds_read_b128 v[96:99], v8 offset:28672
    v_exp_f32 v68, v68
    v_mfma_f32_16x16x32_bf16 v[60:63], a[52:55], v[104:107], v[60:63]
    v_exp_f32 v69, v69
    v_exp_f32 v70, v70
    s_waitcnt lgkmcnt(5)
    v_mfma_f32_16x16x32_bf16 v[56:59], a[56:59], v[108:111], v[56:59]
    ds_read_b128 v[100:103], v8 offset:29696
    v_exp_f32 v71, v71
    v_mfma_f32_16x16x32_bf16 v[60:63], a[60:63], v[108:111], v[60:63]
    v_pk_add_f32 v[64:65], v[64:65], 1.0 op_sel_hi:[1,0]
    v_pk_add_f32 v[66:67], v[66:67], 1.0 op_sel_hi:[1,0]
    s_waitcnt lgkmcnt(5)
    v_mfma_f32_16x16x32_bf16 v[56:59], a[64:67], v[80:83], v[56:59]
    ds_read_b128 v[104:107], v8 offset:30720
    v_pk_add_f32 v[68:69], v[68:69], 1.0 op_sel_hi:[1,0]
    v_mfma_f32_16x16x32_bf16 v[60:63], a[68:71], v[80:83], v[60:63]
    v_pk_add_f32 v[70:71], v[70:71], 1.0 op_sel_hi:[1,0]
    v_rcp_f32 v64, v64
    s_waitcnt lgkmcnt(5)
    v_mfma_f32_16x16x32_bf16 v[56:59], a[72:75], v[84:87], v[56:59]
    ds_read_b128 v[108:111], v8 offset:31744
    v_rcp_f32 v65, v65
    v_mfma_f32_16x16x32_bf16 v[60:63], a[76:79], v[84:87], v[60:63]
    v_rcp_f32 v66, v66
    v_rcp_f32 v67, v67
    s_waitcnt lgkmcnt(5)
    v_mfma_f32_16x16x32_bf16 v[56:59], a[80:83], v[88:91], v[56:59]
    v_rcp_f32 v68, v68
    v_mfma_f32_16x16x32_bf16 v[60:63], a[84:87], v[88:91], v[60:63]
    v_rcp_f32 v69, v69
    v_rcp_f32 v70, v70
    s_waitcnt lgkmcnt(4)
    v_mfma_f32_16x16x32_bf16 v[56:59], a[88:91], v[92:95], v[56:59]
    v_rcp_f32 v71, v71
    v_mfma_f32_16x16x32_bf16 v[60:63], a[92:95], v[92:95], v[60:63]
    v_pk_mul_f32 v[48:49], v[48:49], v[64:65]
    v_pk_mul_f32 v[50:51], v[50:51], v[66:67]
    s_waitcnt lgkmcnt(3)
    v_mfma_f32_16x16x32_bf16 v[56:59], a[96:99], v[96:99], v[56:59]
    v_pk_mul_f32 v[52:53], v[52:53], v[68:69]
    v_mfma_f32_16x16x32_bf16 v[60:63], a[100:103], v[96:99], v[60:63]
    v_pk_mul_f32 v[54:55], v[54:55], v[70:71]
    v_cvt_pk_bf16_f32 v64, v48, v52
    s_waitcnt lgkmcnt(2)
    v_mfma_f32_16x16x32_bf16 v[56:59], a[104:107], v[100:103], v[56:59]
    v_cvt_pk_bf16_f32 v65, v49, v53
    v_mfma_f32_16x16x32_bf16 v[60:63], a[108:111], v[100:103], v[60:63]
    v_cvt_pk_bf16_f32 v66, v50, v54
    v_cvt_pk_bf16_f32 v67, v51, v55
    s_waitcnt lgkmcnt(1)
    v_mfma_f32_16x16x32_bf16 v[56:59], a[112:115], v[104:107], v[56:59]
    v_mfma_f32_16x16x32_bf16 v[60:63], a[116:119], v[104:107], v[60:63]
    s_waitcnt lgkmcnt(0)
    v_mfma_f32_16x16x32_bf16 v[56:59], a[120:123], v[108:111], v[56:59]
    v_mfma_f32_16x16x32_bf16 v[60:63], a[124:127], v[108:111], v[60:63]
    ds_write_b128 v11, v[64:67]
    s_nop 5
    v_mul_f32 v72, 0xbfb8aa3b, v56
    v_mul_f32 v73, 0xbfb8aa3b, v57
    v_mul_f32 v74, 0xbfb8aa3b, v58
    v_mul_f32 v75, 0xbfb8aa3b, v59
    v_mul_f32 v76, 0xbfb8aa3b, v60
    v_mul_f32 v77, 0xbfb8aa3b, v61
    v_mul_f32 v78, 0xbfb8aa3b, v62
    v_mul_f32 v79, 0xbfb8aa3b, v63
    v_exp_f32 v72, v72
    v_exp_f32 v73, v73
    v_exp_f32 v74, v74
    v_exp_f32 v75, v75
    v_exp_f32 v76, v76
    v_exp_f32 v77, v77
    v_exp_f32 v78, v78
    v_exp_f32 v79, v79
    v_pk_add_f32 v[72:73], v[72:73], 1.0 op_sel_hi:[1,0]
    v_pk_add_f32 v[74:75], v[74:75], 1.0 op_sel_hi:[1,0]
    v_pk_add_f32 v[76:77], v[76:77], 1.0 op_sel_hi:[1,0]
    v_pk_add_f32 v[78:79], v[78:79], 1.0 op_sel_hi:[1,0]
    v_rcp_f32 v72, v72
    v_rcp_f32 v73, v73
    v_rcp_f32 v74, v74
    v_rcp_f32 v75, v75
    v_rcp_f32 v76, v76
    v_rcp_f32 v77, v77
    v_rcp_f32 v78, v78
    v_rcp_f32 v79, v79
    v_pk_mul_f32 v[56:57], v[56:57], v[72:73]
    v_pk_mul_f32 v[58:59], v[58:59], v[74:75]
    v_pk_mul_f32 v[60:61], v[60:61], v[76:77]
    v_pk_mul_f32 v[62:63], v[62:63], v[78:79]
    v_cvt_pk_bf16_f32 v72, v56, v60
    v_cvt_pk_bf16_f32 v73, v57, v61
    v_cvt_pk_bf16_f32 v74, v58, v62
    v_cvt_pk_bf16_f32 v75, v59, v63
    ds_write_b128 v11, v[72:75] offset:4096
    s_waitcnt vmcnt(8) lgkmcnt(0)
    s_barrier
    s_branch RFF_T4
RFF_T1:
    s_min_u32 s25, s18, 63
    s_lshl_b32 s24, s25, 8
    s_add_u32 s24, s24, 131200
    buffer_load_dword v3, v2, s[4:7], s24 offen sc1
    s_min_u32 s25, s19, 63
    s_lshl_b32 s24, s25, 8
    s_add_u32 s24, s24, 147584
    buffer_load_dword v4, v2, s[4:7], s24 offen sc1
    ds_read_b128 v[80:83], v8 offset:0
    ds_read_b128 v[84:87], v8 offset:1024
    ds_read_b128 v[88:91], v8 offset:2048
    ds_read_b128 v[92:95], v8 offset:3072
    ds_read_b128 v[96:99], v8 offset:4096
    ds_read_b128 v[100:103], v8 offset:5120
    s_waitcnt lgkmcnt(5)
    v_mfma_f32_16x16x32_bf16 v[48:51], a[0:3], v[80:83], 0
    ds_read_b128 v[104:107], v8 offset:6144
    v_mfma_f32_16x16x32_bf16 v[52:55], a[4:7], v[80:83], 0
    s_waitcnt lgkmcnt(5)
    v_mfma_f32_16x16x32_bf16 v[48:51], a[8:11], v[84:87], v[48:51]
    ds_read_b128 v[108:111], v8 offset:7168
    v_mfma_f32_16x16x32_bf16 v[52:55], a[12:15], v[84:87], v[52:55]
    s_waitcnt lgkmcnt(5)
    v_mfma_f32_16x16x32_bf16 v[48:51], a[16:19], v[88:91], v[48:51]
    ds_read_b128 v[80:83], v8 offset:8192
    v_mfma_f32_16x16x32_bf16 v[52:55], a[20:23], v[88:91], v[52:55]
    s_waitcnt lgkmcnt(5)
    v_mfma_f32_16x16x32_bf16 v[48:51], a[24:27], v[92:95], v[48:51]
    ds_read_b128 v[84:87], v8 offset:9216
    v_mfma_f32_16x16x32_bf16 v[52:55], a[28:31], v[92:95], v[52:55]
    s_waitcnt lgkmcnt(5)
    v_mfma_f32_16x16x32_bf16 v[48:51], a[32:35], v[96:99], v[48:51]
    ds_read_b128 v[88:91], v8 offset:10240
    v_mfma_f32_16x16x32_bf16 v[52:55], a[36:39], v[96:99], v[52:55]
    s_waitcnt lgkmcnt(5)
    v_mfma_f32_16x16x32_bf16 v[48:51], a[40:43], v[100:103], v[48:51]
    ds_read_b128 v[92:95], v8 offset:11264
    v_mfma_f32_16x16x32_bf16 v[52:55], a[44:47], v[100:103], v[52:55]
    s_waitcnt lgkmcnt(5)
    v_mfma_f32_16x16x32_bf16 v[48:51], a[48:51], v[104:107], v[48:51]
    ds_read_b128 v[96:99], v8 offset:12288
    v_mfma_f32_16x16x32_bf16 v[52:55], a[52:55], v[104:107], v[52:55]
    s_waitcnt lgkmcnt(5)
    v_mfma_f32_16x16x32_bf16 v[48:51], a[56:59], v[108:111], v[48:51]
    ds_read_b128 v[100:103], v8 offset:13312
    v_mfma_f32_16x16x32_bf16 v[52:55], a[60:63], v[108:111], v[52:55]
    s_waitcnt lgkmcnt(5)
    v_mfma_f32_16x16x32_bf16 v[48:51], a[64:67], v[80:83], v[48:51]
    ds_read_b128 v[104:107], v8 offset:14336
    v_mfma_f32_16x16x32_bf16 v[52:55], a[68:71], v[80:83], v[52:55]
    s_waitcnt lgkmcnt(5)
    v_mfma_f32_16x16x32_bf16 v[48:51], a[72:75], v[84:87], v[48:51]
    ds_read_b128 v[108:111], v8 offset:15360
    v_mfma_f32_16x16x32_bf16 v[52:55], a[76:79], v[84:87], v[52:55]
    s_waitcnt lgkmcnt(5)
    v_mfma_f32_16x16x32_bf16 v[48:51], a[80:83], v[88:91], v[48:51]
    ds_read_b128 v[80:83], v8 offset:16384
    v_mfma_f32_16x16x32_bf16 v[52:55], a[84:87], v[88:91], v[52:55]
    s_waitcnt lgkmcnt(5)
    v_mfma_f32_16x16x32_bf16 v[48:51], a[88:91], v[92:95], v[48:51]
    ds_read_b128 v[84:87], v8 offset:17408
    v_mfma_f32_16x16x32_bf16 v[52:55], a[92:95], v[92:95], v[52:55]
    s_waitcnt lgkmcnt(5)
    v_mfma_f32_16x16x32_bf16 v[48:51], a[96:99], v[96:99], v[48:51]
    ds_read_b128 v[88:91], v8 offset:18432
    v_mfma_f32_16x16x32_bf16 v[52:55], a[100:103], v[96:99], v[52:55]
    s_waitcnt lgkmcnt(5)
    v_mfma_f32_16x16x32_bf16 v[48:51], a[104:107], v[100:103], v[48:51]
    ds_read_b128 v[92:95], v8 offset:19456
    v_mfma_f32_16x16x32_bf16 v[52:55], a[108:111], v[100:103], v[52:55]
    s_waitcnt lgkmcnt(5)
    v_mfma_f32_16x16x32_bf16 v[48:51], a[112:115], v[104:107], v[48:51]
    ds_read_b128 v[96:99], v8 offset:20480
    v_mfma_f32_16x16x32_bf16 v[52:55], a[116:119], v[104:107], v[52:55]
    s_waitcnt lgkmcnt(5)
    v_mfma_f32_16x16x32_bf16 v[48:51], a[120:123], v[108:111], v[48:51]
    ds_read_b128 v[100:103], v8 offset:21504
    v_mfma_f32_16x16x32_bf16 v[52:55], a[124:127], v[108:111], v[52:55]
    s_waitcnt lgkmcnt(5)
    v_mfma_f32_16x16x32_bf16 v[56:59], a[0:3], v[80:83], 0
    ds_read_b128 v[104:107], v8 offset:22528
    v_mfma_f32_16x16x32_bf16 v[60:63], a[4:7], v[80:83], 0
    s_waitcnt lgkmcnt(5)
    v_mfma_f32_16x16x32_bf16 v[56:59], a[8:11], v[84:87], v[56:59]
    ds_read_b128 v[108:111], v8 offset:23552
    v_mfma_f32_16x16x32_bf16 v[60:63], a[12:15], v[84:87], v[60:63]
    s_waitcnt lgkmcnt(5)
    v_mfma_f32_16x16x32_bf16 v[56:59], a[16:19], v[88:91], v[56:59]
    ds_read_b128 v[80:83], v8 offset:24576
    v_mul_f32 v64, 0xbfb8aa3b, v48
    v_mfma_f32_16x16x32_bf16 v[60:63], a[20:23], v[88:91], v[60:63]
    v_mul_f32 v65, 0xbfb8aa3b, v49
    v_mul_f32 v66, 0xbfb8aa3b, v50
    s_waitcnt lgkmcnt(5)
    v_mfma_f32_16x16x32_bf16 v[56:59], a[24:27], v[92:95], v[56:59]
    ds_read_b128 v[84:87], v8 offset:25600
    v_mul_f32 v67, 0xbfb8aa3b, v51
    v_mfma_f32_16x16x32_bf16 v[60:63], a[28:31], v[92:95], v[60:63]
    v_mul_f32 v68, 0xbfb8aa3b, v52
    v_mul_f32 v69, 0xbfb8aa3b, v53
    s_waitcnt lgkmcnt(5)
    v_mfma_f32_16x16x32_bf16 v[56:59], a[32:35], v[96:99], v[56:59]
    ds_read_b128 v[88:91], v8 offset:26624
    v_mul_f32 v70, 0xbfb8aa3b, v54
    v_mfma_f32_16x16x32_bf16 v[60:63], a[36:39], v[96:99], v[60:63]
    v_mul_f32 v71, 0xbfb8aa3b, v55
    v_exp_f32 v64, v64
    s_waitcnt lgkmcnt(5)
    v_mfma_f32_16x16x32_bf16 v[56:59], a[40:43], v[100:103], v[56:59]
    ds_read_b128 v[92:95], v8 offset:27648
    v_exp_f32 v65, v65
    v_mfma_f32_16x16x32_bf16 v[60:63], a[44:47], v[100:103], v[60:63]
    v_exp_f32 v66, v66
    v_exp_f32 v67, v67
    s_waitcnt lgkmcnt(5)
    v_mfma_f32_16x16x32_bf16 v[56:59], a[48:51], v[104:107], v[56:59]
    ds_read_b128 v[96:99], v8 offset:28672
    v_exp_f32 v68, v68
    v_mfma_f32_16x16x32_bf16 v[60:63], a[52:55], v[104:107], v[60:63]
    v_exp_f32 v69, v69
    v_exp_f32 v70, v70
    s_waitcnt lgkmcnt(5)
    v_mfma_f32_16x16x32_bf16 v[56:59], a[56:59], v[108:111], v[56:59]
    ds_read_b128 v[100:103], v8 offset:29696
    v_exp_f32 v71, v71
    v_mfma_f32_16x16x32_bf16 v[60:63], a[60:63], v[108:111], v[60:63]
    v_pk_add_f32 v[64:65], v[64:65], 1.0 op_sel_hi:[1,0]
    v_pk_add_f32 v[66:67], v[66:67], 1.0 op_sel_hi:[1,0]
    s_waitcnt lgkmcnt(5)
    v_mfma_f32_16x16x32_bf16 v[56:59], a[64:67], v[80:83], v[56:59]
    ds_read_b128 v[104:107], v8 offset:30720
    v_pk_add_f32 v[68:69], v[68:69], 1.0 op_sel_hi:[1,0]
    v_mfma_f32_16x16x32_bf16 v[60:63], a[68:71], v[80:83], v[60:63]
    v_pk_add_f32 v[70:71], v[70:71], 1.0 op_sel_hi:[1,0]
    v_rcp_f32 v64, v64
    s_waitcnt lgkmcnt(5)
    v_mfma_f32_16x16x32_bf16 v[56:59], a[72:75], v[84:87], v[56:59]
    ds_read_b128 v[108:111], v8 offset:31744
    v_rcp_f32 v65, v65
    v_mfma_f32_16x16x32_bf16 v[60:63], a[76:79], v[84:87], v[60:63]
    v_rcp_f32 v66, v66
    v_rcp_f32 v67, v67
    s_waitcnt lgkmcnt(5)
    v_mfma_f32_16x16x32_bf16 v[56:59], a[80:83], v[88:91], v[56:59]
    v_rcp_f32 v68, v68
    v_mfma_f32_16x16x32_bf16 v[60:63], a[84:87], v[88:91], v[60:63]
    v_rcp_f32 v69, v69
    v_rcp_f32 v70, v70
    s_waitcnt lgkmcnt(4)
    v_mfma_f32_16x16x32_bf16 v[56:59], a[88:91], v[92:95], v[56:59]
    v_rcp_f32 v71, v71
    v_mfma_f32_16x16x32_bf16 v[60:63], a[92:95], v[92:95], v[60:63]
    v_pk_mul_f32 v[48:49], v[48:49], v[64:65]
    v_pk_mul_f32 v[50:51], v[50:51], v[66:67]
    s_waitcnt lgkmcnt(3)
    v_mfma_f32_16x16x32_bf16 v[56:59], a[96:99], v[96:99], v[56:59]
    v_pk_mul_f32 v[52:53], v[52:53], v[68:69]
    v_mfma_f32_16x16x32_bf16 v[60:63], a[100:103], v[96:99], v[60:63]
    v_pk_mul_f32 v[54:55], v[54:55], v[70:71]
    v_cvt_pk_bf16_f32 v64, v48, v52
    s_waitcnt lgkmcnt(2)
    v_mfma_f32_16x16x32_bf16 v[56:59], a[104:107], v[100:103], v[56:59]
    v_cvt_pk_bf16_f32 v65, v49, v53
    v_mfma_f32_16x16x32_bf16 v[60:63], a[108:111], v[100:103], v[60:63]
    v_cvt_pk_bf16_f32 v66, v50, v54
    v_cvt_pk_bf16_f32 v67, v51, v55
    s_waitcnt lgkmcnt(1)
    v_mfma_f32_16x16x32_bf16 v[56:59], a[112:115], v[104:107], v[56:59]
    v_mfma_f32_16x16x32_bf16 v[60:63], a[116:119], v[104:107], v[60:63]
    s_waitcnt lgkmcnt(0)
    v_mfma_f32_16x16x32_bf16 v[56:59], a[120:123], v[108:111], v[56:59]
    v_mfma_f32_16x16x32_bf16 v[60:63], a[124:127], v[108:111], v[60:63]
    ds_write_b128 v11, v[64:67]
    s_nop 5
    v_mul_f32 v72, 0xbfb8aa3b, v56
    v_mul_f32 v73, 0xbfb8aa3b, v57
    v_mul_f32 v74, 0xbfb8aa3b, v58
    v_mul_f32 v75, 0xbfb8aa3b, v59
    v_mul_f32 v76, 0xbfb8aa3b, v60
    v_mul_f32 v77, 0xbfb8aa3b, v61
    v_mul_f32 v78, 0xbfb8aa3b, v62
    v_mul_f32 v79, 0xbfb8aa3b, v63
    v_exp_f32 v72, v72
    v_exp_f32 v73, v73
    v_exp_f32 v74, v74
    v_exp_f32 v75, v75
    v_exp_f32 v76, v76
    v_exp_f32 v77, v77
    v_exp_f32 v78, v78
    v_exp_f32 v79, v79
    v_pk_add_f32 v[72:73], v[72:73], 1.0 op_sel_hi:[1,0]
    v_pk_add_f32 v[74:75], v[74:75], 1.0 op_sel_hi:[1,0]
    v_pk_add_f32 v[76:77], v[76:77], 1.0 op_sel_hi:[1,0]
    v_pk_add_f32 v[78:79], v[78:79], 1.0 op_sel_hi:[1,0]
    v_rcp_f32 v72, v72
    v_rcp_f32 v73, v73
    v_rcp_f32 v74, v74
    v_rcp_f32 v75, v75
    v_rcp_f32 v76, v76
    v_rcp_f32 v77, v77
    v_rcp_f32 v78, v78
    v_rcp_f32 v79, v79
    v_pk_mul_f32 v[56:57], v[56:57], v[72:73]
    v_pk_mul_f32 v[58:59], v[58:59], v[74:75]
    v_pk_mul_f32 v[60:61], v[60:61], v[76:77]
    v_pk_mul_f32 v[62:63], v[62:63], v[78:79]
    v_cvt_pk_bf16_f32 v72, v56, v60
    v_cvt_pk_bf16_f32 v73, v57, v61
    v_cvt_pk_bf16_f32 v74, v58, v62
    v_cvt_pk_bf16_f32 v75, v59, v63
    ds_write_b128 v11, v[72:75] offset:4096
    s_waitcnt vmcnt(0)
    s_cmp_lg_u32 s16, 0
    s_cbranch_scc1 Lw0_176
    v_readfirstlane_b32 s25, v3
    v_readfirstlane_b32 s26, v4
    s_mov_b32 s24, -1
    s_cmp_ge_u32 s19, 64
    s_cbranch_scc1 Lsk_177
    s_cmp_lg_u32 s26, 4
    s_cbranch_scc1 Lsk_177
    s_add_u32 s24, s19, 64
Lsk_177:
    s_cmp_ge_u32 s18, 64
    s_cbranch_scc1 Lsk_178
    s_cmp_lg_u32 s25, 4
    s_cbranch_scc1 Lsk_178
    s_add_u32 s24, s18, 0
Lsk_178:
    v_mov_b32 v5, s24
    v_mov_b32 v6, 163776
    ds_write_b32 v6, v5 offset:4
Lw0_176:
    s_waitcnt lgkmcnt(0)
    s_barrier
    v_mov_b32 v6, 163776
    ds_read_b32 v5, v6 offset:4
    s_waitcnt lgkmcnt(0)
    v_readfirstlane_b32 s21, v5
    s_cmp_eq_u32 s21, -1
    s_cbranch_scc1 RFF_T4
    s_cmp_ge_u32 s21, 64
    s_cbranch_scc1 Lad_179
    s_cmp_ge_u32 s18, s84
    s_cselect_b32 s24, s86, s85
    s_add_u32 s18, s18, s24
    s_cmp_ge_u32 s18, s87
    s_cselect_b32 s18, 64, s18
    s_branch Lad_180
Lad_179:
    s_cmp_ge_u32 s19, s88
    s_cselect_b32 s24, s90, s89
    s_add_u32 s19, s19, s24
    s_cmp_ge_u32 s19, s91
    s_cselect_b32 s19, 64, s19
Lad_180:
    s_cmp_eq_u32 s22, -1
    s_cbranch_scc1 Lms_181
    s_cmp_lg_u32 s16, 0
    s_cbranch_scc1 Lsg_182
    s_lshl_b32 s24, s22, 8
    s_add_u32 s24, s24, 131264
    v_mov_b32 v5, 1
    s_mov_b64 s[38:39], exec
    s_mov_b64 exec, 1
    buffer_atomic_add v5, v2, s[4:7], s24 offen
    s_mov_b64 exec, s[38:39]
Lsg_182:
    s_mov_b32 s22, -1
Lms_181:
    s_min_u32 s25, s18, 63
    s_lshl_b32 s24, s25, 8
    s_add_u32 s24, s24, 131200
    buffer_load_dword v3, v2, s[4:7], s24 offen sc1
    s_min_u32 s25, s19, 63
    s_lshl_b32 s24, s25, 8
    s_add_u32 s24, s24, 147584
    buffer_load_dword v4, v2, s[4:7], s24 offen sc1
    s_lshl_b32 s92, s21, 15
    s_lshl_b32 s93, s16, 13
    s_add_u32 s92, s92, s93
    s_add_u32 s92, s92, 14680064
    s_xor_b32 s94, s30, 1
    s_lshl_b32 s94, s94, 15
    s_add_u32 m0, s94, s93
    s_nop 0
    s_mul_i32 s26, s20, 360448
    s_add_u32 s26, s26, s33
    s_add_u32 s27, s26, 16384
    ds_read_b128 v[80:83], v10 offset:0
    ds_read_b128 v[84:87], v10 offset:1024
    ds_read_b128 v[88:91], v10 offset:2048
    s_waitcnt lgkmcnt(2)
    v_mfma_f32_16x16x32_bf16 v[128:131], a[128:131], v[80:83], 0
    v_mfma_f32_16x16x32_bf16 v[132:135], a[132:135], v[80:83], 0
    ds_read_b128 v[92:95], v10 offset:3072
    v_mfma_f32_16x16x32_bf16 v[136:139], a[136:139], v[80:83], 0
    buffer_load_dwordx4 v9, s[4:7], s92 offen offset:0 sc1 lds
    v_mfma_f32_16x16x32_bf16 v[140:143], a[140:143], v[80:83], 0
    v_mfma_f32_16x16x32_bf16 v[144:147], a[144:147], v[80:83], 0
    v_mfma_f32_16x16x32_bf16 v[148:151], a[148:151], v[80:83], 0
    buffer_load_dwordx4 v9, s[4:7], s92 offen offset:1024 sc1 lds
    v_mfma_f32_16x16x32_bf16 v[152:155], a[152:155], v[80:83], 0
    v_mfma_f32_16x16x32_bf16 v[156:159], a[156:159], v[80:83], 0
    s_waitcnt lgkmcnt(2)
    v_mfma_f32_16x16x32_bf16 v[128:131], a[160:163], v[84:87], v[128:131]
    v_mfma_f32_16x16x32_bf16 v[132:135], a[164:167], v[84:87], v[132:135]
    ds_read_b128 v[80:83], v10 offset:4096
    buffer_load_dwordx4 v9, s[4:7], s92 offen offset:2048 sc1 lds
    v_mfma_f32_16x16x32_bf16 v[136:139], a[168:171], v[84:87], v[136:139]
    v_mfma_f32_16x16x32_bf16 v[140:143], a[172:175], v[84:87], v[140:143]
    v_mfma_f32_16x16x32_bf16 v[144:147], a[176:179], v[84:87], v[144:147]
    v_mfma_f32_16x16x32_bf16 v[148:151], a[180:183], v[84:87], v[148:151]
    buffer_load_dwordx4 v9, s[4:7], s92 offen offset:3072 sc1 lds
    v_mfma_f32_16x16x32_bf16 v[152:155], a[184:187], v[84:87], v[152:155]
    v_mfma_f32_16x16x32_bf16 v[156:159], a[188:191], v[84:87], v[156:159]
    s_waitcnt lgkmcnt(2)
    v_mfma_f32_16x16x32_bf16 v[128:131], a[192:195], v[88:91], v[128:131]
    v_mfma_f32_16x16x32_bf16 v[132:135], a[196:199], v[88:91], v[132:135]
    ds_read_b128 v[84:87], v10 offset:5120
    s_add_u32 s92, s92, 4096
    s_add_u32 m0, m0, 4096
    s_nop 0
    buffer_load_dwordx4 v9, s[4:7], s92 offen offset:0 sc1 lds
    v_mfma_f32_16x16x32_bf16 v[136:139], a[200:203], v[88:91], v[136:139]
    v_mfma_f32_16x16x32_bf16 v[140:143], a[204:207], v[88:91], v[140:143]
    v_mfma_f32_16x16x32_bf16 v[144:147], a[208:211], v[88:91], v[144:147]
    buffer_load_dwordx4 v9, s[4:7], s92 offen offset:1024 sc1 lds
    v_mfma_f32_16x16x32_bf16 v[148:151], a[212:215], v[88:91], v[148:151]
    v_mfma_f32_16x16x32_bf16 v[152:155], a[216:219], v[88:91], v[152:155]
    v_mfma_f32_16x16x32_bf16 v[156:159], a[220:223], v[88:91], v[156:159]
    s_waitcnt lgkmcnt(2)
    v_mfma_f32_16x16x32_bf16 v[128:131], a[224:227], v[92:95], v[128:131]
    buffer_load_dwordx4 v9, s[4:7], s92 offen offset:2048 sc1 lds
    v_mfma_f32_16x16x32_bf16 v[132:135], a[228:231], v[92:95], v[132:135]
    ds_read_b128 v[88:91], v10 offset:6144
    v_mfma_f32_16x16x32_bf16 v[136:139], a[232:235], v[92:95], v[136:139]
    v_mfma_f32_16x16x32_bf16 v[140:143], a[236:239], v[92:95], v[140:143]
    v_mfma_f32_16x16x32_bf16 v[144:147], a[240:243], v[92:95], v[144:147]
    buffer_load_dwordx4 v9, s[4:7], s92 offen offset:3072 sc1 lds
    v_mfma_f32_16x16x32_bf16 v[148:151], a[244:247], v[92:95], v[148:151]
    v_mfma_f32_16x16x32_bf16 v[152:155], a[248:251], v[92:95], v[152:155]
    v_mfma_f32_16x16x32_bf16 v[156:159], a[252:255], v[92:95], v[156:159]
    s_waitcnt lgkmcnt(2)
    v_mfma_f32_16x16x32_bf16 v[160:163], a[128:131], v[80:83], 0
    v_mfma_f32_16x16x32_bf16 v[164:167], a[132:135], v[80:83], 0
    ds_read_b128 v[92:95], v10 offset:7168
    v_mfma_f32_16x16x32_bf16 v[168:171], a[136:139], v[80:83], 0
    v_cvt_pk_bf16_f32 v192, v128, v132
    v_mfma_f32_16x16x32_bf16 v[172:175], a[140:143], v[80:83], 0
    v_cvt_pk_bf16_f32 v193, v136, v140
    v_mfma_f32_16x16x32_bf16 v[176:179], a[144:147], v[80:83], 0
    v_mfma_f32_16x16x32_bf16 v[180:183], a[148:151], v[80:83], 0
    v_cvt_pk_bf16_f32 v194, v144, v148
    v_mfma_f32_16x16x32_bf16 v[184:187], a[152:155], v[80:83], 0
    v_cvt_pk_bf16_f32 v195, v152, v156
    v_mfma_f32_16x16x32_bf16 v[188:191], a[156:159], v[80:83], 0
    s_waitcnt lgkmcnt(2)
    v_mfma_f32_16x16x32_bf16 v[160:163], a[160:163], v[84:87], v[160:163]
    buffer_store_dwordx4 v[192:195], v9, s[4:7], s26 offen offset:0 sc1
    v_mfma_f32_16x16x32_bf16 v[164:167], a[164:167], v[84:87], v[164:167]
    v_cvt_pk_bf16_f32 v196, v129, v133
    v_mfma_f32_16x16x32_bf16 v[168:171], a[168:171], v[84:87], v[168:171]
    v_mfma_f32_16x16x32_bf16 v[172:175], a[172:175], v[84:87], v[172:175]
    v_cvt_pk_bf16_f32 v197, v137, v141
    v_mfma_f32_16x16x32_bf16 v[176:179], a[176:179], v[84:87], v[176:179]
    v_cvt_pk_bf16_f32 v198, v145, v149
    v_mfma_f32_16x16x32_bf16 v[180:183], a[180:183], v[84:87], v[180:183]
    v_mfma_f32_16x16x32_bf16 v[184:187], a[184:187], v[84:87], v[184:187]
    v_cvt_pk_bf16_f32 v199, v153, v157
    v_mfma_f32_16x16x32_bf16 v[188:191], a[188:191], v[84:87], v[188:191]
    buffer_store_dwordx4 v[196:199], v9, s[4:7], s26 offen offset:1024 sc1
    s_waitcnt lgkmcnt(1)
    v_mfma_f32_16x16x32_bf16 v[160:163], a[192:195], v[88:91], v[160:163]
    v_mfma_f32_16x16x32_bf16 v[164:167], a[196:199], v[88:91], v[164:167]
    v_cvt_pk_bf16_f32 v200, v130, v134
    v_mfma_f32_16x16x32_bf16 v[168:171], a[200:203], v[88:91], v[168:171]
    v_cvt_pk_bf16_f32 v201, v138, v142
    v_mfma_f32_16x16x32_bf16 v[172:175], a[204:207], v[88:91], v[172:175]
    v_mfma_f32_16x16x32_bf16 v[176:179], a[208:211], v[88:91], v[176:179]
    v_cvt_pk_bf16_f32 v202, v146, v150
    v_mfma_f32_16x16x32_bf16 v[180:183], a[212:215], v[88:91], v[180:183]
    v_cvt_pk_bf16_f32 v203, v154, v158
    v_mfma_f32_16x16x32_bf16 v[184:187], a[216:219], v[88:91], v[184:187]
    v_mfma_f32_16x16x32_bf16 v[188:191], a[220:223], v[88:91], v[188:191]
    buffer_store_dwordx4 v[200:203], v9, s[4:7], s26 offen offset:2048 sc1
    s_waitcnt lgkmcnt(0)
    v_mfma_f32_16x16x32_bf16 v[160:163], a[224:227], v[92:95], v[160:163]
    v_cvt_pk_bf16_f32 v204, v131, v135
    v_mfma_f32_16x16x32_bf16 v[164:167], a[228:231], v[92:95], v[164:167]
    v_mfma_f32_16x16x32_bf16 v[168:171], a[232:235], v[92:95], v[168:171]
    v_cvt_pk_bf16_f32 v205, v139, v143
    v_mfma_f32_16x16x32_bf16 v[172:175], a[236:239], v[92:95], v[172:175]
    v_cvt_pk_bf16_f32 v206, v147, v151
    v_mfma_f32_16x16x32_bf16 v[176:179], a[240:243], v[92:95], v[176:179]
    v_mfma_f32_16x16x32_bf16 v[180:183], a[244:247], v[92:95], v[180:183]
    v_cvt_pk_bf16_f32 v207, v155, v159
    v_mfma_f32_16x16x32_bf16 v[184:187], a[248:251], v[92:95], v[184:187]
    buffer_store_dwordx4 v[204:207], v9, s[4:7], s26 offen offset:3072 sc1
    v_mfma_f32_16x16x32_bf16 v[188:191], a[252:255], v[92:95], v[188:191]
    s_branch RFF_T6
RFF_T4:
    s_cmp_eq_u32 s22, -1
    s_cbranch_scc1 Lms_183
    s_cmp_lg_u32 s16, 0
    s_cbranch_scc1 Lsg_184
    s_lshl_b32 s24, s22, 8
    s_add_u32 s24, s24, 131264
    v_mov_b32 v5, 1
    s_mov_b64 s[38:39], exec
    s_mov_b64 exec, 1
    buffer_atomic_add v5, v2, s[4:7], s24 offen
    s_mov_b64 exec, s[38:39]
Lsg_184:
    s_mov_b32 s22, -1
Lms_183:
    s_min_u32 s25, s18, 63
    s_lshl_b32 s24, s25, 8
    s_add_u32 s24, s24, 131200
    buffer_load_dword v3, v2, s[4:7], s24 offen sc1
    s_min_u32 s25, s19, 63
    s_lshl_b32 s24, s25, 8
    s_add_u32 s24, s24, 147584
    buffer_load_dword v4, v2, s[4:7], s24 offen sc1
    s_mul_i32 s26, s20, 360448
    s_add_u32 s26, s26, s33
    s_add_u32 s27, s26, 16384
    ds_read_b128 v[80:83], v10 offset:0
    ds_read_b128 v[84:87], v10 offset:1024
    ds_read_b128 v[88:91], v10 offset:2048
    s_waitcnt lgkmcnt(2)
    v_mfma_f32_16x16x32_bf16 v[128:131], a[128:131], v[80:83], 0
    v_mfma_f32_16x16x32_bf16 v[132:135], a[132:135], v[80:83], 0
    ds_read_b128 v[92:95], v10 offset:3072
    v_mfma_f32_16x16x32_bf16 v[136:139], a[136:139], v[80:83], 0
    v_mfma_f32_16x16x32_bf16 v[140:143], a[140:143], v[80:83], 0
    v_mfma_f32_16x16x32_bf16 v[144:147], a[144:147], v[80:83], 0
    v_mfma_f32_16x16x32_bf16 v[148:151], a[148:151], v[80:83], 0
    v_mfma_f32_16x16x32_bf16 v[152:155], a[152:155], v[80:83], 0
    v_mfma_f32_16x16x32_bf16 v[156:159], a[156:159], v[80:83], 0
    s_waitcnt lgkmcnt(2)
    v_mfma_f32_16x16x32_bf16 v[128:131], a[160:163], v[84:87], v[128:131]
    v_mfma_f32_16x16x32_bf16 v[132:135], a[164:167], v[84:87], v[132:135]
    ds_read_b128 v[80:83], v10 offset:4096
    v_mfma_f32_16x16x32_bf16 v[136:139], a[168:171], v[84:87], v[136:139]
    v_mfma_f32_16x16x32_bf16 v[140:143], a[172:175], v[84:87], v[140:143]
    v_mfma_f32_16x16x32_bf16 v[144:147], a[176:179], v[84:87], v[144:147]
    v_mfma_f32_16x16x32_bf16 v[148:151], a[180:183], v[84:87], v[148:151]
    v_mfma_f32_16x16x32_bf16 v[152:155], a[184:187], v[84:87], v[152:155]
    v_mfma_f32_16x16x32_bf16 v[156:159], a[188:191], v[84:87], v[156:159]
    s_waitcnt lgkmcnt(2)
    v_mfma_f32_16x16x32_bf16 v[128:131], a[192:195], v[88:91], v[128:131]
    v_mfma_f32_16x16x32_bf16 v[132:135], a[196:199], v[88:91], v[132:135]
    ds_read_b128 v[84:87], v10 offset:5120
    v_mfma_f32_16x16x32_bf16 v[136:139], a[200:203], v[88:91], v[136:139]
    v_mfma_f32_16x16x32_bf16 v[140:143], a[204:207], v[88:91], v[140:143]
    v_mfma_f32_16x16x32_bf16 v[144:147], a[208:211], v[88:91], v[144:147]
    v_mfma_f32_16x16x32_bf16 v[148:151], a[212:215], v[88:91], v[148:151]
    v_mfma_f32_16x16x32_bf16 v[152:155], a[216:219], v[88:91], v[152:155]
    v_mfma_f32_16x16x32_bf16 v[156:159], a[220:223], v[88:91], v[156:159]
    s_waitcnt lgkmcnt(2)
    v_mfma_f32_16x16x32_bf16 v[128:131], a[224:227], v[92:95], v[128:131]
    v_mfma_f32_16x16x32_bf16 v[132:135], a[228:231], v[92:95], v[132:135]
    ds_read_b128 v[88:91], v10 offset:6144
    v_mfma_f32_16x16x32_bf16 v[136:139], a[232:235], v[92:95], v[136:139]
    v_mfma_f32_16x16x32_bf16 v[140:143], a[236:239], v[92:95], v[140:143]
    v_mfma_f32_16x16x32_bf16 v[144:147], a[240:243], v[92:95], v[144:147]
    v_mfma_f32_16x16x32_bf16 v[148:151], a[244:247], v[92:95], v[148:151]
    v_mfma_f32_16x16x32_bf16 v[152:155], a[248:251], v[92:95], v[152:155]
    v_mfma_f32_16x16x32_bf16 v[156:159], a[252:255], v[92:95], v[156:159]
    s_waitcnt lgkmcnt(2)
    v_mfma_f32_16x16x32_bf16 v[160:163], a[128:131], v[80:83], 0
    v_mfma_f32_16x16x32_bf16 v[164:167], a[132:135], v[80:83], 0
    ds_read_b128 v[92:95], v10 offset:7168
    v_mfma_f32_16x16x32_bf16 v[168:171], a[136:139], v[80:83], 0
    v_cvt_pk_bf16_f32 v192, v128, v132
    v_mfma_f32_16x16x32_bf16 v[172:175], a[140:143], v[80:83], 0
    v_cvt_pk_bf16_f32 v193, v136, v140
    v_mfma_f32_16x16x32_bf16 v[176:179], a[144:147], v[80:83], 0
    v_mfma_f32_16x16x32_bf16 v[180:183], a[148:151], v[80:83], 0
    v_cvt_pk_bf16_f32 v194, v144, v148
    v_mfma_f32_16x16x32_bf16 v[184:187], a[152:155], v[80:83], 0
    v_cvt_pk_bf16_f32 v195, v152, v156
    v_mfma_f32_16x16x32_bf16 v[188:191], a[156:159], v[80:83], 0
    s_waitcnt lgkmcnt(2)
    v_mfma_f32_16x16x32_bf16 v[160:163], a[160:163], v[84:87], v[160:163]
    buffer_store_dwordx4 v[192:195], v9, s[4:7], s26 offen offset:0 sc1
    v_mfma_f32_16x16x32_bf16 v[164:167], a[164:167], v[84:87], v[164:167]
    v_cvt_pk_bf16_f32 v196, v129, v133
    v_mfma_f32_16x16x32_bf16 v[168:171], a[168:171], v[84:87], v[168:171]
    v_mfma_f32_16x16x32_bf16 v[172:175], a[172:175], v[84:87], v[172:175]
    v_cvt_pk_bf16_f32 v197, v137, v141
    v_mfma_f32_16x16x32_bf16 v[176:179], a[176:179], v[84:87], v[176:179]
    v_cvt_pk_bf16_f32 v198, v145, v149
    v_mfma_f32_16x16x32_bf16 v[180:183], a[180:183], v[84:87], v[180:183]
    v_mfma_f32_16x16x32_bf16 v[184:187], a[184:187], v[84:87], v[184:187]
    v_cvt_pk_bf16_f32 v199, v153, v157
    v_mfma_f32_16x16x32_bf16 v[188:191], a[188:191], v[84:87], v[188:191]
    buffer_store_dwordx4 v[196:199], v9, s[4:7], s26 offen offset:1024 sc1
    s_waitcnt lgkmcnt(1)
    v_mfma_f32_16x16x32_bf16 v[160:163], a[192:195], v[88:91], v[160:163]
    v_mfma_f32_16x16x32_bf16 v[164:167], a[196:199], v[88:91], v[164:167]
    v_cvt_pk_bf16_f32 v200, v130, v134
    v_mfma_f32_16x16x32_bf16 v[168:171], a[200:203], v[88:91], v[168:171]
    v_cvt_pk_bf16_f32 v201, v138, v142
    v_mfma_f32_16x16x32_bf16 v[172:175], a[204:207], v[88:91], v[172:175]
    v_mfma_f32_16x16x32_bf16 v[176:179], a[208:211], v[88:91], v[176:179]
    v_cvt_pk_bf16_f32 v202, v146, v150
    v_mfma_f32_16x16x32_bf16 v[180:183], a[212:215], v[88:91], v[180:183]
    v_cvt_pk_bf16_f32 v203, v154, v158
    v_mfma_f32_16x16x32_bf16 v[184:187], a[216:219], v[88:91], v[184:187]
    v_mfma_f32_16x16x32_bf16 v[188:191], a[220:223], v[88:91], v[188:191]
    buffer_store_dwordx4 v[200:203], v9, s[4:7], s26 offen offset:2048 sc1
    s_waitcnt lgkmcnt(0)
    v_mfma_f32_16x16x32_bf16 v[160:163], a[224:227], v[92:95], v[160:163]
    v_cvt_pk_bf16_f32 v204, v131, v135
    v_mfma_f32_16x16x32_bf16 v[164:167], a[228:231], v[92:95], v[164:167]
    v_mfma_f32_16x16x32_bf16 v[168:171], a[232:235], v[92:95], v[168:171]
    v_cvt_pk_bf16_f32 v205, v139, v143
    v_mfma_f32_16x16x32_bf16 v[172:175], a[236:239], v[92:95], v[172:175]
    v_cvt_pk_bf16_f32 v206, v147, v151
    v_mfma_f32_16x16x32_bf16 v[176:179], a[240:243], v[92:95], v[176:179]
    v_mfma_f32_16x16x32_bf16 v[180:183], a[244:247], v[92:95], v[180:183]
    v_cvt_pk_bf16_f32 v207, v155, v159
    v_mfma_f32_16x16x32_bf16 v[184:187], a[248:251], v[92:95], v[184:187]
    buffer_store_dwordx4 v[204:207], v9, s[4:7], s26 offen offset:3072 sc1
    v_mfma_f32_16x16x32_bf16 v[188:191], a[252:255], v[92:95], v[188:191]
RFF_T6:
    v_cvt_pk_bf16_f32 v208, v160, v164
    v_cvt_pk_bf16_f32 v209, v168, v172
    s_nop 1
    v_cvt_pk_bf16_f32 v210, v176, v180
    s_nop 2
    v_cvt_pk_bf16_f32 v211, v184, v188
    buffer_store_dwordx4 v[208:211], v9, s[4:7], s27 offen offset:0 sc1
    v_cvt_pk_bf16_f32 v212, v161, v165
    v_cvt_pk_bf16_f32 v213, v169, v173
    v_cvt_pk_bf16_f32 v214, v177, v181
    v_cvt_pk_bf16_f32 v215, v185, v189
    buffer_store_dwordx4 v[212:215], v9, s[4:7], s27 offen offset:1024 sc1
    v_cvt_pk_bf16_f32 v216, v162, v166
    v_cvt_pk_bf16_f32 v217, v170, v174
    v_cvt_pk_bf16_f32 v218, v178, v182
    v_cvt_pk_bf16_f32 v219, v186, v190
    buffer_store_dwordx4 v[216:219], v9, s[4:7], s27 offen offset:2048 sc1
    v_cvt_pk_bf16_f32 v220, v163, v167
    v_cvt_pk_bf16_f32 v221, v171, v175
    v_cvt_pk_bf16_f32 v222, v179, v183
    v_cvt_pk_bf16_f32 v223, v187, v191
    buffer_store_dwordx4 v[220:223], v9, s[4:7], s27 offen offset:3072 sc1
    s_mov_b32 s22, s20
    s_mov_b32 s20, s21
    s_waitcnt vmcnt(8)
    s_cmp_lg_u32 s21, -1
    s_nop 5
    s_cbranch_scc1 RFF_TOP
    s_cmp_lg_u32 s16, 0
    s_cbranch_scc1 Lw0_185
    v_readfirstlane_b32 s25, v3
    v_readfirstlane_b32 s26, v4
    s_mov_b32 s24, -1
    s_cmp_ge_u32 s19, 64
    s_cbranch_scc1 Lsk_186
    s_cmp_lg_u32 s26, 4
    s_cbranch_scc1 Lsk_186
    s_add_u32 s24, s19, 64
Lsk_186:
    s_cmp_ge_u32 s18, 64
    s_cbranch_scc1 Lsk_187
    s_cmp_lg_u32 s25, 4
    s_cbranch_scc1 Lsk_187
    s_add_u32 s24, s18, 0
Lsk_187:
    v_mov_b32 v5, s24
    v_mov_b32 v6, 163776
    ds_write_b32 v6, v5 offset:8
Lw0_185:
    s_waitcnt lgkmcnt(0)
    s_barrier
    v_mov_b32 v6, 163776
    ds_read_b32 v5, v6 offset:8
    s_waitcnt lgkmcnt(0)
    v_readfirstlane_b32 s20, v5
    s_cmp_lg_u32 s20, -1
    s_cbranch_scc1 RFF_GO
    s_waitcnt vmcnt(0)
    s_barrier
    s_cmp_lg_u32 s16, 0
    s_cbranch_scc1 Lsg_188
    s_lshl_b32 s24, s22, 8
    s_add_u32 s24, s24, 131264
    v_mov_b32 v5, 1
    s_mov_b64 s[38:39], exec
    s_mov_b64 exec, 1
    buffer_atomic_add v5, v2, s[4:7], s24 offen
    s_mov_b64 exec, s[38:39]
Lsg_188:
    s_mov_b32 s22, -1
    s_branch RFF_B1
E_FF:
    s_endpgm
J_AW:
    s_lshr_b32 s95, s44, 4
    s_and_b32 s41, s44, 15
    s_mov_b32 s45, 0x3e0293ee
    v_lshlrev_b32 v9, 4, v1
    s_lshl_b32 s33, s41, 15
    s_lshl_b32 s24, s16, 12
    s_add_u32 s33, s33, s24
    s_add_u32 s33, s33, 136314880
    s_lshr_b32 s46, s16, 1
    s_and_b32 s47, s16, 1
    s_lshl_b32 s48, s41, 1
    s_add_u32 s48, s48, s46
    v_lshrrev_b32 v5, 4, v1
    v_and_b32 v6, 15, v1
    v_lshrrev_b32 v10, 2, v6
    v_lshlrev_b32 v10, 5, v10
    v_and_b32 v11, 1, v1
    v_lshl_add_u32 v10, v11, 4, v10
    v_lshl_add_u32 v10, v5, 7, v10
    v_lshlrev_b32 v11, 3, v1
    s_lshl_b32 s24, s47, 4
    v_add_u32 v6, s24, v6
    v_lshlrev_b32 v5, 2, v5
    v_mov_b32 v13, 0xd028965f
    s_lshl_b32 s24, s47, 13
    s_lshl_b32 s25, s46, 12
    s_add_u32 s24, s24, s25
    v_add_u32 v14, s24, v9
    v_add_u32 v7, 0, v5
    v_cmp_le_u32 s[52:53], v7, v6
    v_add_u32 v7, 1, v5
    v_cmp_le_u32 s[54:55], v7, v6
    v_add_u32 v7, 2, v5
    v_cmp_le_u32 s[56:57], v7, v6
    v_add_u32 v7, 3, v5
    v_cmp_le_u32 s[58:59], v7, v6
    v_add_u32 v7, 16, v5
    v_cmp_le_u32 s[60:61], v7, v6
    v_add_u32 v7, 17, v5
    v_cmp_le_u32 s[62:63], v7, v6
    v_add_u32 v7, 18, v5
    v_cmp_le_u32 s[64:65], v7, v6
    v_add_u32 v7, 19, v5
    v_cmp_le_u32 s[66:67], v7, v6
    s_load_dwordx2 s[8:9], s[0:1], 40
    s_mov_b32 s10, 4194304
    s_mov_b32 s11, 0x00020000
    s_waitcnt lgkmcnt(0)
    s_lshl_b32 s34, s41, 18
    v_lshrrev_b32 v5, 4, v1
    v_mul_u32_u24 v5, 16384, v5
    v_and_b32 v6, 15, v1
    v_lshlrev_b32 v6, 4, v6
    s_lshl_b32 s25, s16, 8
    v_add3_u32 v8, v5, v6, s25
    s_add_u32 s24, s34, 0
    buffer_load_dwordx4 v[16:19], v8, s[8:11], s24 offen
    s_add_u32 s24, s34, 1024
    buffer_load_dwordx4 v[20:23], v8, s[8:11], s24 offen
    s_add_u32 s24, s34, 2048
    buffer_load_dwordx4 v[24:27], v8, s[8:11], s24 offen
    s_add_u32 s24, s34, 3072
    buffer_load_dwordx4 v[28:31], v8, s[8:11], s24 offen
    s_add_u32 s24, s34, 4096
    buffer_load_dwordx4 v[32:35], v8, s[8:11], s24 offen
    s_add_u32 s24, s34, 5120
    buffer_load_dwordx4 v[36:39], v8, s[8:11], s24 offen
    s_add_u32 s24, s34, 6144
    buffer_load_dwordx4 v[40:43], v8, s[8:11], s24 offen
    s_add_u32 s24, s34, 7168
    buffer_load_dwordx4 v[44:47], v8, s[8:11], s24 offen
    s_add_u32 s24, s34, 8192
    buffer_load_dwordx4 v[48:51], v8, s[8:11], s24 offen
    s_add_u32 s24, s34, 9216
    buffer_load_dwordx4 v[52:55], v8, s[8:11], s24 offen
    s_add_u32 s24, s34, 10240
    buffer_load_dwordx4 v[56:59], v8, s[8:11], s24 offen
    s_add_u32 s24, s34, 11264
    buffer_load_dwordx4 v[60:63], v8, s[8:11], s24 offen
    s_add_u32 s24, s34, 12288
    buffer_load_dwordx4 v[64:67], v8, s[8:11], s24 offen
    s_add_u32 s24, s34, 13312
    buffer_load_dwordx4 v[68:71], v8, s[8:11], s24 offen
    s_add_u32 s24, s34, 14336
    buffer_load_dwordx4 v[72:75], v8, s[8:11], s24 offen
    s_add_u32 s24, s34, 15360
    buffer_load_dwordx4 v[76:79], v8, s[8:11], s24 offen
    s_add_u32 s24, s34, 65536
    buffer_load_dwordx4 v[80:83], v8, s[8:11], s24 offen
    s_add_u32 s24, s34, 66560
    buffer_load_dwordx4 v[84:87], v8, s[8:11], s24 offen
    s_add_u32 s24, s34, 67584
    buffer_load_dwordx4 v[88:91], v8, s[8:11], s24 offen
    s_add_u32 s24, s34, 68608
    buffer_load_dwordx4 v[92:95], v8, s[8:11], s24 offen
    s_add_u32 s24, s34, 69632
    buffer_load_dwordx4 v[96:99], v8, s[8:11], s24 offen
    s_add_u32 s24, s34, 70656
    buffer_load_dwordx4 v[100:103], v8, s[8:11], s24 offen
    s_add_u32 s24, s34, 71680
    buffer_load_dwordx4 v[104:107], v8, s[8:11], s24 offen
    s_add_u32 s24, s34, 72704
    buffer_load_dwordx4 v[108:111], v8, s[8:11], s24 offen
    s_add_u32 s24, s34, 73728
    buffer_load_dwordx4 v[112:115], v8, s[8:11], s24 offen
    s_add_u32 s24, s34, 74752
    buffer_load_dwordx4 v[116:119], v8, s[8:11], s24 offen
    s_add_u32 s24, s34, 75776
    buffer_load_dwordx4 v[120:123], v8, s[8:11], s24 offen
    s_add_u32 s24, s34, 76800
    buffer_load_dwordx4 v[124:127], v8, s[8:11], s24 offen
    s_add_u32 s24, s34, 77824
    buffer_load_dwordx4 v[128:131], v8, s[8:11], s24 offen
    s_add_u32 s24, s34, 78848
    buffer_load_dwordx4 v[132:135], v8, s[8:11], s24 offen
    s_add_u32 s24, s34, 79872
    buffer_load_dwordx4 v[136:139], v8, s[8:11], s24 offen
    s_add_u32 s24, s34, 80896
    buffer_load_dwordx4 v[140:143], v8, s[8:11], s24 offen
    s_waitcnt vmcnt(24)
    v_perm_b32 v5, v20, v16, s31
    v_accvgpr_write_b32 a0, v5
    v_perm_b32 v6, v28, v24, s31
    v_accvgpr_write_b32 a1, v6
    v_perm_b32 v5, v36, v32, s31
    v_accvgpr_write_b32 a2, v5
    v_perm_b32 v6, v44, v40, s31
    v_accvgpr_write_b32 a3, v6
    v_perm_b32 v5, v20, v16, s32
    v_accvgpr_write_b32 a4, v5
    v_perm_b32 v6, v28, v24, s32
    v_accvgpr_write_b32 a5, v6
    v_perm_b32 v5, v36, v32, s32
    v_accvgpr_write_b32 a6, v5
    v_perm_b32 v6, v44, v40, s32
    v_accvgpr_write_b32 a7, v6
    v_perm_b32 v5, v21, v17, s31
    v_accvgpr_write_b32 a8, v5
    v_perm_b32 v6, v29, v25, s31
    v_accvgpr_write_b32 a9, v6
    v_perm_b32 v5, v37, v33, s31
    v_accvgpr_write_b32 a10, v5
    v_perm_b32 v6, v45, v41, s31
    v_accvgpr_write_b32 a11, v6
    v_perm_b32 v5, v21, v17, s32
    v_accvgpr_write_b32 a12, v5
    v_perm_b32 v6, v29, v25, s32
    v_accvgpr_write_b32 a13, v6
    v_perm_b32 v5, v37, v33, s32
    v_accvgpr_write_b32 a14, v5
    v_perm_b32 v6, v45, v41, s32
    v_accvgpr_write_b32 a15, v6
    v_perm_b32 v5, v22, v18, s31
    v_accvgpr_write_b32 a16, v5
    v_perm_b32 v6, v30, v26, s31
    v_accvgpr_write_b32 a17, v6
    v_perm_b32 v5, v38, v34, s31
    v_accvgpr_write_b32 a18, v5
    v_perm_b32 v6, v46, v42, s31
    v_accvgpr_write_b32 a19, v6
    v_perm_b32 v5, v22, v18, s32
    v_accvgpr_write_b32 a20, v5
    v_perm_b32 v6, v30, v26, s32
    v_accvgpr_write_b32 a21, v6
    v_perm_b32 v5, v38, v34, s32
    v_accvgpr_write_b32 a22, v5
    v_perm_b32 v6, v46, v42, s32
    v_accvgpr_write_b32 a23, v6
    v_perm_b32 v5, v23, v19, s31
    v_accvgpr_write_b32 a24, v5
    v_perm_b32 v6, v31, v27, s31
    v_accvgpr_write_b32 a25, v6
    v_perm_b32 v5, v39, v35, s31
    v_accvgpr_write_b32 a26, v5
    v_perm_b32 v6, v47, v43, s31
    v_accvgpr_write_b32 a27, v6
    v_perm_b32 v5, v23, v19, s32
    v_accvgpr_write_b32 a28, v5
    v_perm_b32 v6, v31, v27, s32
    v_accvgpr_write_b32 a29, v6
    v_perm_b32 v5, v39, v35, s32
    v_accvgpr_write_b32 a30, v5
    v_perm_b32 v6, v47, v43, s32
    v_accvgpr_write_b32 a31, v6
    s_add_u32 s24, s34, 131072
    buffer_load_dwordx4 v[16:19], v8, s[8:11], s24 offen
    s_add_u32 s24, s34, 132096
    buffer_load_dwordx4 v[20:23], v8, s[8:11], s24 offen
    s_add_u32 s24, s34, 133120
    buffer_load_dwordx4 v[24:27], v8, s[8:11], s24 offen
    s_add_u32 s24, s34, 134144
    buffer_load_dwordx4 v[28:31], v8, s[8:11], s24 offen
    s_add_u32 s24, s34, 135168
    buffer_load_dwordx4 v[32:35], v8, s[8:11], s24 offen
    s_add_u32 s24, s34, 136192
    buffer_load_dwordx4 v[36:39], v8, s[8:11], s24 offen
    s_add_u32 s24, s34, 137216
    buffer_load_dwordx4 v[40:43], v8, s[8:11], s24 offen
    s_add_u32 s24, s34, 138240
    buffer_load_dwordx4 v[44:47], v8, s[8:11], s24 offen
    s_waitcnt vmcnt(24)
    v_perm_b32 v5, v52, v48, s31
    v_accvgpr_write_b32 a32, v5
    v_perm_b32 v6, v60, v56, s31
    v_accvgpr_write_b32 a33, v6
    v_perm_b32 v5, v68, v64, s31
    v_accvgpr_write_b32 a34, v5
    v_perm_b32 v6, v76, v72, s31
    v_accvgpr_write_b32 a35, v6
    v_perm_b32 v5, v52, v48, s32
    v_accvgpr_write_b32 a36, v5
    v_perm_b32 v6, v60, v56, s32
    v_accvgpr_write_b32 a37, v6
    v_perm_b32 v5, v68, v64, s32
    v_accvgpr_write_b32 a38, v5
    v_perm_b32 v6, v76, v72, s32
    v_accvgpr_write_b32 a39, v6
    v_perm_b32 v5, v53, v49, s31
    v_accvgpr_write_b32 a40, v5
    v_perm_b32 v6, v61, v57, s31
    v_accvgpr_write_b32 a41, v6
    v_perm_b32 v5, v69, v65, s31
    v_accvgpr_write_b32 a42, v5
    v_perm_b32 v6, v77, v73, s31
    v_accvgpr_write_b32 a43, v6
    v_perm_b32 v5, v53, v49, s32
    v_accvgpr_write_b32 a44, v5
    v_perm_b32 v6, v61, v57, s32
    v_accvgpr_write_b32 a45, v6
    v_perm_b32 v5, v69, v65, s32
    v_accvgpr_write_b32 a46, v5
    v_perm_b32 v6, v77, v73, s32
    v_accvgpr_write_b32 a47, v6
    v_perm_b32 v5, v54, v50, s31
    v_accvgpr_write_b32 a48, v5
    v_perm_b32 v6, v62, v58, s31
    v_accvgpr_write_b32 a49, v6
    v_perm_b32 v5, v70, v66, s31
    v_accvgpr_write_b32 a50, v5
    v_perm_b32 v6, v78, v74, s31
    v_accvgpr_write_b32 a51, v6
    v_perm_b32 v5, v54, v50, s32
    v_accvgpr_write_b32 a52, v5
    v_perm_b32 v6, v62, v58, s32
    v_accvgpr_write_b32 a53, v6
    v_perm_b32 v5, v70, v66, s32
    v_accvgpr_write_b32 a54, v5
    v_perm_b32 v6, v78, v74, s32
    v_accvgpr_write_b32 a55, v6
    v_perm_b32 v5, v55, v51, s31
    v_accvgpr_write_b32 a56, v5
    v_perm_b32 v6, v63, v59, s31
    v_accvgpr_write_b32 a57, v6
    v_perm_b32 v5, v71, v67, s31
    v_accvgpr_write_b32 a58, v5
    v_perm_b32 v6, v79, v75, s31
    v_accvgpr_write_b32 a59, v6
    v_perm_b32 v5, v55, v51, s32
    v_accvgpr_write_b32 a60, v5
    v_perm_b32 v6, v63, v59, s32
    v_accvgpr_write_b32 a61, v6
    v_perm_b32 v5, v71, v67, s32
    v_accvgpr_write_b32 a62, v5
    v_perm_b32 v6, v79, v75, s32
    v_accvgpr_write_b32 a63, v6
    s_add_u32 s24, s34, 139264
    buffer_load_dwordx4 v[48:51], v8, s[8:11], s24 offen
    s_add_u32 s24, s34, 140288
    buffer_load_dwordx4 v[52:55], v8, s[8:11], s24 offen
    s_add_u32 s24, s34, 141312
    buffer_load_dwordx4 v[56:59], v8, s[8:11], s24 offen
    s_add_u32 s24, s34, 142336
    buffer_load_dwordx4 v[60:63], v8, s[8:11], s24 offen
    s_add_u32 s24, s34, 143360
    buffer_load_dwordx4 v[64:67], v8, s[8:11], s24 offen
    s_add_u32 s24, s34, 144384
    buffer_load_dwordx4 v[68:71], v8, s[8:11], s24 offen
    s_add_u32 s24, s34, 145408
    buffer_load_dwordx4 v[72:75], v8, s[8:11], s24 offen
    s_add_u32 s24, s34, 146432
    buffer_load_dwordx4 v[76:79], v8, s[8:11], s24 offen
    s_waitcnt vmcnt(24)
    v_perm_b32 v5, v84, v80, s31
    v_accvgpr_write_b32 a64, v5
    v_perm_b32 v6, v92, v88, s31
    v_accvgpr_write_b32 a65, v6
    v_perm_b32 v5, v100, v96, s31
    v_accvgpr_write_b32 a66, v5
    v_perm_b32 v6, v108, v104, s31
    v_accvgpr_write_b32 a67, v6
    v_perm_b32 v5, v84, v80, s32
    v_accvgpr_write_b32 a68, v5
    v_perm_b32 v6, v92, v88, s32
    v_accvgpr_write_b32 a69, v6
    v_perm_b32 v5, v100, v96, s32
    v_accvgpr_write_b32 a70, v5
    v_perm_b32 v6, v108, v104, s32
    v_accvgpr_write_b32 a71, v6
    v_perm_b32 v5, v85, v81, s31
    v_accvgpr_write_b32 a72, v5
    v_perm_b32 v6, v93, v89, s31
    v_accvgpr_write_b32 a73, v6
    v_perm_b32 v5, v101, v97, s31
    v_accvgpr_write_b32 a74, v5
    v_perm_b32 v6, v109, v105, s31
    v_accvgpr_write_b32 a75, v6
    v_perm_b32 v5, v85, v81, s32
    v_accvgpr_write_b32 a76, v5
    v_perm_b32 v6, v93, v89, s32
    v_accvgpr_write_b32 a77, v6
    v_perm_b32 v5, v101, v97, s32
    v_accvgpr_write_b32 a78, v5
    v_perm_b32 v6, v109, v105, s32
    v_accvgpr_write_b32 a79, v6
    v_perm_b32 v5, v86, v82, s31
    v_accvgpr_write_b32 a80, v5
    v_perm_b32 v6, v94, v90, s31
    v_accvgpr_write_b32 a81, v6
    v_perm_b32 v5, v102, v98, s31
    v_accvgpr_write_b32 a82, v5
    v_perm_b32 v6, v110, v106, s31
    v_accvgpr_write_b32 a83, v6
    v_perm_b32 v5, v86, v82, s32
    v_accvgpr_write_b32 a84, v5
    v_perm_b32 v6, v94, v90, s32
    v_accvgpr_write_b32 a85, v6
    v_perm_b32 v5, v102, v98, s32
    v_accvgpr_write_b32 a86, v5
    v_perm_b32 v6, v110, v106, s32
    v_accvgpr_write_b32 a87, v6
    v_perm_b32 v5, v87, v83, s31
    v_accvgpr_write_b32 a88, v5
    v_perm_b32 v6, v95, v91, s31
    v_accvgpr_write_b32 a89, v6
    v_perm_b32 v5, v103, v99, s31
    v_accvgpr_write_b32 a90, v5
    v_perm_b32 v6, v111, v107, s31
    v_accvgpr_write_b32 a91, v6
    v_perm_b32 v5, v87, v83, s32
    v_accvgpr_write_b32 a92, v5
    v_perm_b32 v6, v95, v91, s32
    v_accvgpr_write_b32 a93, v6
    v_perm_b32 v5, v103, v99, s32
    v_accvgpr_write_b32 a94, v5
    v_perm_b32 v6, v111, v107, s32
    v_accvgpr_write_b32 a95, v6
    s_add_u32 s24, s34, 196608
    buffer_load_dwordx4 v[80:83], v8, s[8:11], s24 offen
    s_add_u32 s24, s34, 197632
    buffer_load_dwordx4 v[84:87], v8, s[8:11], s24 offen
    s_add_u32 s24, s34, 198656
    buffer_load_dwordx4 v[88:91], v8, s[8:11], s24 offen
    s_add_u32 s24, s34, 199680
    buffer_load_dwordx4 v[92:95], v8, s[8:11], s24 offen
    s_add_u32 s24, s34, 200704
    buffer_load_dwordx4 v[96:99], v8, s[8:11], s24 offen
    s_add_u32 s24, s34, 201728
    buffer_load_dwordx4 v[100:103], v8, s[8:11], s24 offen
    s_add_u32 s24, s34, 202752
    buffer_load_dwordx4 v[104:107], v8, s[8:11], s24 offen
    s_add_u32 s24, s34, 203776
    buffer_load_dwordx4 v[108:111], v8, s[8:11], s24 offen
    s_waitcnt vmcnt(24)
    v_perm_b32 v5, v116, v112, s31
    v_accvgpr_write_b32 a96, v5
    v_perm_b32 v6, v124, v120, s31
    v_accvgpr_write_b32 a97, v6
    v_perm_b32 v5, v132, v128, s31
    v_accvgpr_write_b32 a98, v5
    v_perm_b32 v6, v140, v136, s31
    v_accvgpr_write_b32 a99, v6
    v_perm_b32 v5, v116, v112, s32
    v_accvgpr_write_b32 a100, v5
    v_perm_b32 v6, v124, v120, s32
    v_accvgpr_write_b32 a101, v6
    v_perm_b32 v5, v132, v128, s32
    v_accvgpr_write_b32 a102, v5
    v_perm_b32 v6, v140, v136, s32
    v_accvgpr_write_b32 a103, v6
    v_perm_b32 v5, v117, v113, s31
    v_accvgpr_write_b32 a104, v5
    v_perm_b32 v6, v125, v121, s31
    v_accvgpr_write_b32 a105, v6
    v_perm_b32 v5, v133, v129, s31
    v_accvgpr_write_b32 a106, v5
    v_perm_b32 v6, v141, v137, s31
    v_accvgpr_write_b32 a107, v6
    v_perm_b32 v5, v117, v113, s32
    v_accvgpr_write_b32 a108, v5
    v_perm_b32 v6, v125, v121, s32
    v_accvgpr_write_b32 a109, v6
    v_perm_b32 v5, v133, v129, s32
    v_accvgpr_write_b32 a110, v5
    v_perm_b32 v6, v141, v137, s32
    v_accvgpr_write_b32 a111, v6
    v_perm_b32 v5, v118, v114, s31
    v_accvgpr_write_b32 a112, v5
    v_perm_b32 v6, v126, v122, s31
    v_accvgpr_write_b32 a113, v6
    v_perm_b32 v5, v134, v130, s31
    v_accvgpr_write_b32 a114, v5
    v_perm_b32 v6, v142, v138, s31
    v_accvgpr_write_b32 a115, v6
    v_perm_b32 v5, v118, v114, s32
    v_accvgpr_write_b32 a116, v5
    v_perm_b32 v6, v126, v122, s32
    v_accvgpr_write_b32 a117, v6
    v_perm_b32 v5, v134, v130, s32
    v_accvgpr_write_b32 a118, v5
    v_perm_b32 v6, v142, v138, s32
    v_accvgpr_write_b32 a119, v6
    v_perm_b32 v5, v119, v115, s31
    v_accvgpr_write_b32 a120, v5
    v_perm_b32 v6, v127, v123, s31
    v_accvgpr_write_b32 a121, v6
    v_perm_b32 v5, v135, v131, s31
    v_accvgpr_write_b32 a122, v5
    v_perm_b32 v6, v143, v139, s31
    v_accvgpr_write_b32 a123, v6
    v_perm_b32 v5, v119, v115, s32
    v_accvgpr_write_b32 a124, v5
    v_perm_b32 v6, v127, v123, s32
    v_accvgpr_write_b32 a125, v6
    v_perm_b32 v5, v135, v131, s32
    v_accvgpr_write_b32 a126, v5
    v_perm_b32 v6, v143, v139, s32
    v_accvgpr_write_b32 a127, v6
    s_add_u32 s24, s34, 204800
    buffer_load_dwordx4 v[112:115], v8, s[8:11], s24 offen
    s_add_u32 s24, s34, 205824
    buffer_load_dwordx4 v[116:119], v8, s[8:11], s24 offen
    s_add_u32 s24, s34, 206848
    buffer_load_dwordx4 v[120:123], v8, s[8:11], s24 offen
    s_add_u32 s24, s34, 207872
    buffer_load_dwordx4 v[124:127], v8, s[8:11], s24 offen
    s_add_u32 s24, s34, 208896
    buffer_load_dwordx4 v[128:131], v8, s[8:11], s24 offen
    s_add_u32 s24, s34, 209920
    buffer_load_dwordx4 v[132:135], v8, s[8:11], s24 offen
    s_add_u32 s24, s34, 210944
    buffer_load_dwordx4 v[136:139], v8, s[8:11], s24 offen
    s_add_u32 s24, s34, 211968
    buffer_load_dwordx4 v[140:143], v8, s[8:11], s24 offen
    s_waitcnt vmcnt(24)
    v_perm_b32 v5, v20, v16, s31
    v_accvgpr_write_b32 a128, v5
    v_perm_b32 v6, v28, v24, s31
    v_accvgpr_write_b32 a129, v6
    v_perm_b32 v5, v36, v32, s31
    v_accvgpr_write_b32 a130, v5
    v_perm_b32 v6, v44, v40, s31
    v_accvgpr_write_b32 a131, v6
    v_perm_b32 v5, v20, v16, s32
    v_accvgpr_write_b32 a132, v5
    v_perm_b32 v6, v28, v24, s32
    v_accvgpr_write_b32 a133, v6
    v_perm_b32 v5, v36, v32, s32
    v_accvgpr_write_b32 a134, v5
    v_perm_b32 v6, v44, v40, s32
    v_accvgpr_write_b32 a135, v6
    v_perm_b32 v5, v21, v17, s31
    v_accvgpr_write_b32 a136, v5
    v_perm_b32 v6, v29, v25, s31
    v_accvgpr_write_b32 a137, v6
    v_perm_b32 v5, v37, v33, s31
    v_accvgpr_write_b32 a138, v5
    v_perm_b32 v6, v45, v41, s31
    v_accvgpr_write_b32 a139, v6
    v_perm_b32 v5, v21, v17, s32
    v_accvgpr_write_b32 a140, v5
    v_perm_b32 v6, v29, v25, s32
    v_accvgpr_write_b32 a141, v6
    v_perm_b32 v5, v37, v33, s32
    v_accvgpr_write_b32 a142, v5
    v_perm_b32 v6, v45, v41, s32
    v_accvgpr_write_b32 a143, v6
    v_perm_b32 v5, v22, v18, s31
    v_accvgpr_write_b32 a144, v5
    v_perm_b32 v6, v30, v26, s31
    v_accvgpr_write_b32 a145, v6
    v_perm_b32 v5, v38, v34, s31
    v_accvgpr_write_b32 a146, v5
    v_perm_b32 v6, v46, v42, s31
    v_accvgpr_write_b32 a147, v6
    v_perm_b32 v5, v22, v18, s32
    v_accvgpr_write_b32 a148, v5
    v_perm_b32 v6, v30, v26, s32
    v_accvgpr_write_b32 a149, v6
    v_perm_b32 v5, v38, v34, s32
    v_accvgpr_write_b32 a150, v5
    v_perm_b32 v6, v46, v42, s32
    v_accvgpr_write_b32 a151, v6
    v_perm_b32 v5, v23, v19, s31
    v_accvgpr_write_b32 a152, v5
    v_perm_b32 v6, v31, v27, s31
    v_accvgpr_write_b32 a153, v6
    v_perm_b32 v5, v39, v35, s31
    v_accvgpr_write_b32 a154, v5
    v_perm_b32 v6, v47, v43, s31
    v_accvgpr_write_b32 a155, v6
    v_perm_b32 v5, v23, v19, s32
    v_accvgpr_write_b32 a156, v5
    v_perm_b32 v6, v31, v27, s32
    v_accvgpr_write_b32 a157, v6
    v_perm_b32 v5, v39, v35, s32
    v_accvgpr_write_b32 a158, v5
    v_perm_b32 v6, v47, v43, s32
    v_accvgpr_write_b32 a159, v6
    s_waitcnt vmcnt(16)
    v_perm_b32 v5, v52, v48, s31
    v_accvgpr_write_b32 a160, v5
    v_perm_b32 v6, v60, v56, s31
    v_accvgpr_write_b32 a161, v6
    v_perm_b32 v5, v68, v64, s31
    v_accvgpr_write_b32 a162, v5
    v_perm_b32 v6, v76, v72, s31
    v_accvgpr_write_b32 a163, v6
    v_perm_b32 v5, v52, v48, s32
    v_accvgpr_write_b32 a164, v5
    v_perm_b32 v6, v60, v56, s32
    v_accvgpr_write_b32 a165, v6
    v_perm_b32 v5, v68, v64, s32
    v_accvgpr_write_b32 a166, v5
    v_perm_b32 v6, v76, v72, s32
    v_accvgpr_write_b32 a167, v6
    v_perm_b32 v5, v53, v49, s31
    v_accvgpr_write_b32 a168, v5
    v_perm_b32 v6, v61, v57, s31
    v_accvgpr_write_b32 a169, v6
    v_perm_b32 v5, v69, v65, s31
    v_accvgpr_write_b32 a170, v5
    v_perm_b32 v6, v77, v73, s31
    v_accvgpr_write_b32 a171, v6
    v_perm_b32 v5, v53, v49, s32
    v_accvgpr_write_b32 a172, v5
    v_perm_b32 v6, v61, v57, s32
    v_accvgpr_write_b32 a173, v6
    v_perm_b32 v5, v69, v65, s32
    v_accvgpr_write_b32 a174, v5
    v_perm_b32 v6, v77, v73, s32
    v_accvgpr_write_b32 a175, v6
    v_perm_b32 v5, v54, v50, s31
    v_accvgpr_write_b32 a176, v5
    v_perm_b32 v6, v62, v58, s31
    v_accvgpr_write_b32 a177, v6
    v_perm_b32 v5, v70, v66, s31
    v_accvgpr_write_b32 a178, v5
    v_perm_b32 v6, v78, v74, s31
    v_accvgpr_write_b32 a179, v6
    v_perm_b32 v5, v54, v50, s32
    v_accvgpr_write_b32 a180, v5
    v_perm_b32 v6, v62, v58, s32
    v_accvgpr_write_b32 a181, v6
    v_perm_b32 v5, v70, v66, s32
    v_accvgpr_write_b32 a182, v5
    v_perm_b32 v6, v78, v74, s32
    v_accvgpr_write_b32 a183, v6
    v_perm_b32 v5, v55, v51, s31
    v_accvgpr_write_b32 a184, v5
    v_perm_b32 v6, v63, v59, s31
    v_accvgpr_write_b32 a185, v6
    v_perm_b32 v5, v71, v67, s31
    v_accvgpr_write_b32 a186, v5
    v_perm_b32 v6, v79, v75, s31
    v_accvgpr_write_b32 a187, v6
    v_perm_b32 v5, v55, v51, s32
    v_accvgpr_write_b32 a188, v5
    v_perm_b32 v6, v63, v59, s32
    v_accvgpr_write_b32 a189, v6
    v_perm_b32 v5, v71, v67, s32
    v_accvgpr_write_b32 a190, v5
    v_perm_b32 v6, v79, v75, s32
    v_accvgpr_write_b32 a191, v6
    s_waitcnt vmcnt(8)
    v_perm_b32 v5, v84, v80, s31
    v_accvgpr_write_b32 a192, v5
    v_perm_b32 v6, v92, v88, s31
    v_accvgpr_write_b32 a193, v6
    v_perm_b32 v5, v100, v96, s31
    v_accvgpr_write_b32 a194, v5
    v_perm_b32 v6, v108, v104, s31
    v_accvgpr_write_b32 a195, v6
    v_perm_b32 v5, v84, v80, s32
    v_accvgpr_write_b32 a196, v5
    v_perm_b32 v6, v92, v88, s32
    v_accvgpr_write_b32 a197, v6
    v_perm_b32 v5, v100, v96, s32
    v_accvgpr_write_b32 a198, v5
    v_perm_b32 v6, v108, v104, s32
    v_accvgpr_write_b32 a199, v6
    v_perm_b32 v5, v85, v81, s31
    v_accvgpr_write_b32 a200, v5
    v_perm_b32 v6, v93, v89, s31
    v_accvgpr_write_b32 a201, v6
    v_perm_b32 v5, v101, v97, s31
    v_accvgpr_write_b32 a202, v5
    v_perm_b32 v6, v109, v105, s31
    v_accvgpr_write_b32 a203, v6
    v_perm_b32 v5, v85, v81, s32
    v_accvgpr_write_b32 a204, v5
    v_perm_b32 v6, v93, v89, s32
    v_accvgpr_write_b32 a205, v6
    v_perm_b32 v5, v101, v97, s32
    v_accvgpr_write_b32 a206, v5
    v_perm_b32 v6, v109, v105, s32
    v_accvgpr_write_b32 a207, v6
    v_perm_b32 v5, v86, v82, s31
    v_accvgpr_write_b32 a208, v5
    v_perm_b32 v6, v94, v90, s31
    v_accvgpr_write_b32 a209, v6
    v_perm_b32 v5, v102, v98, s31
    v_accvgpr_write_b32 a210, v5
    v_perm_b32 v6, v110, v106, s31
    v_accvgpr_write_b32 a211, v6
    v_perm_b32 v5, v86, v82, s32
    v_accvgpr_write_b32 a212, v5
    v_perm_b32 v6, v94, v90, s32
    v_accvgpr_write_b32 a213, v6
    v_perm_b32 v5, v102, v98, s32
    v_accvgpr_write_b32 a214, v5
    v_perm_b32 v6, v110, v106, s32
    v_accvgpr_write_b32 a215, v6
    v_perm_b32 v5, v87, v83, s31
    v_accvgpr_write_b32 a216, v5
    v_perm_b32 v6, v95, v91, s31
    v_accvgpr_write_b32 a217, v6
    v_perm_b32 v5, v103, v99, s31
    v_accvgpr_write_b32 a218, v5
    v_perm_b32 v6, v111, v107, s31
    v_accvgpr_write_b32 a219, v6
    v_perm_b32 v5, v87, v83, s32
    v_accvgpr_write_b32 a220, v5
    v_perm_b32 v6, v95, v91, s32
    v_accvgpr_write_b32 a221, v6
    v_perm_b32 v5, v103, v99, s32
    v_accvgpr_write_b32 a222, v5
    v_perm_b32 v6, v111, v107, s32
    v_accvgpr_write_b32 a223, v6
    s_waitcnt vmcnt(0)
    v_perm_b32 v5, v116, v112, s31
    v_accvgpr_write_b32 a224, v5
    v_perm_b32 v6, v124, v120, s31
    v_accvgpr_write_b32 a225, v6
    v_perm_b32 v5, v132, v128, s31
    v_accvgpr_write_b32 a226, v5
    v_perm_b32 v6, v140, v136, s31
    v_accvgpr_write_b32 a227, v6
    v_perm_b32 v5, v116, v112, s32
    v_accvgpr_write_b32 a228, v5
    v_perm_b32 v6, v124, v120, s32
    v_accvgpr_write_b32 a229, v6
    v_perm_b32 v5, v132, v128, s32
    v_accvgpr_write_b32 a230, v5
    v_perm_b32 v6, v140, v136, s32
    v_accvgpr_write_b32 a231, v6
    v_perm_b32 v5, v117, v113, s31
    v_accvgpr_write_b32 a232, v5
    v_perm_b32 v6, v125, v121, s31
    v_accvgpr_write_b32 a233, v6
    v_perm_b32 v5, v133, v129, s31
    v_accvgpr_write_b32 a234, v5
    v_perm_b32 v6, v141, v137, s31
    v_accvgpr_write_b32 a235, v6
    v_perm_b32 v5, v117, v113, s32
    v_accvgpr_write_b32 a236, v5
    v_perm_b32 v6, v125, v121, s32
    v_accvgpr_write_b32 a237, v6
    v_perm_b32 v5, v133, v129, s32
    v_accvgpr_write_b32 a238, v5
    v_perm_b32 v6, v141, v137, s32
    v_accvgpr_write_b32 a239, v6
    v_perm_b32 v5, v118, v114, s31
    v_accvgpr_write_b32 a240, v5
    v_perm_b32 v6, v126, v122, s31
    v_accvgpr_write_b32 a241, v6
    v_perm_b32 v5, v134, v130, s31
    v_accvgpr_write_b32 a242, v5
    v_perm_b32 v6, v142, v138, s31
    v_accvgpr_write_b32 a243, v6
    v_perm_b32 v5, v118, v114, s32
    v_accvgpr_write_b32 a244, v5
    v_perm_b32 v6, v126, v122, s32
    v_accvgpr_write_b32 a245, v6
    v_perm_b32 v5, v134, v130, s32
    v_accvgpr_write_b32 a246, v5
    v_perm_b32 v6, v142, v138, s32
    v_accvgpr_write_b32 a247, v6
    v_perm_b32 v5, v119, v115, s31
    v_accvgpr_write_b32 a248, v5
    v_perm_b32 v6, v127, v123, s31
    v_accvgpr_write_b32 a249, v6
    v_perm_b32 v5, v135, v131, s31
    v_accvgpr_write_b32 a250, v5
    v_perm_b32 v6, v143, v139, s31
    v_accvgpr_write_b32 a251, v6
    v_perm_b32 v5, v119, v115, s32
    v_accvgpr_write_b32 a252, v5
    v_perm_b32 v6, v127, v123, s32
    v_accvgpr_write_b32 a253, v6
    v_perm_b32 v5, v135, v131, s32
    v_accvgpr_write_b32 a254, v5
    v_perm_b32 v6, v143, v139, s32
    v_accvgpr_write_b32 a255, v6
    s_cmp_lg_u32 s95, 0
    s_cbranch_scc1 Lsc_190
    s_mov_b32 s18, 0
    s_mov_b32 s84, 0x55555555
    s_mov_b32 s85, 0x55555555
    s_mov_b32 s19, 5
    s_mov_b32 s88, 0x20
    s_mov_b32 s89, 0x49249000
    s_branch Lsc_189
Lsc_190:
    s_cmp_lg_u32 s95, 1
    s_cbranch_scc1 Lsc_191
    s_mov_b32 s18, 1
    s_mov_b32 s84, 0xaaaaaaaa
    s_mov_b32 s85, 0xaaaaaaaa
    s_mov_b32 s19, 11
    s_mov_b32 s88, 0x800
    s_mov_b32 s89, 0x92492000
    s_branch Lsc_189
Lsc_191:
    s_cmp_lg_u32 s95, 2
    s_cbranch_scc1 Lsc_192
    s_mov_b32 s18, 64
    s_mov_b32 s84, 0x0
    s_mov_b32 s85, 0x0
    s_mov_b32 s19, 0
    s_mov_b32 s88, 0xfffff7df
    s_mov_b32 s89, 0x24924fff
    s_branch Lsc_189
Lsc_192:
Lsc_189:
    s_cmp_lg_u32 s16, 0
    s_cbranch_scc1 RAW_DW
    v_and_b32 v4, 63, v0
    v_lshlrev_b32 v4, 2, v4
Ldw_193:
    buffer_load_dword v3, v4, s[12:15], 0 offen sc1
    s_waitcnt vmcnt(0)
    s_mov_b32 s24, 0
    v_readlane_b32 s25, v3, 8
    s_add_u32 s24, s24, s25
    v_readlane_b32 s25, v3, 24
    s_add_u32 s24, s24, s25
    v_readlane_b32 s25, v3, 40
    s_add_u32 s24, s24, s25
    v_readlane_b32 s25, v3, 56
    s_add_u32 s24, s24, s25
    s_cmp_ge_u32 s24, 96
    s_cbranch_scc1 Ldw_194
    s_sleep 4
    s_memrealtime s[36:37]
    s_waitcnt lgkmcnt(0)
    s_sub_u32 s36, s36, s28
    s_cmp_gt_u32 s36, 3000000
    s_cbranch_scc1 RAW_DW
    s_branch Ldw_193
Ldw_194:
RAW_DW:
    s_mov_b32 s22, -1
    s_mov_b32 s20, -1
    s_mov_b32 s30, 0
RAW_B1:
    s_min_u32 s24, s18, s19
    s_cmp_ge_u32 s24, 64
    s_cbranch_scc1 E_AW
    s_cmp_lg_u32 s16, 0
    s_cbranch_scc1 RAW_B3
RAW_B2:
    s_min_u32 s25, s18, 63
    s_lshl_b32 s24, s25, 4
    s_add_u32 s24, s24, s41
    s_lshl_b32 s24, s24, 6
    s_add_u32 s24, s24, 0
    buffer_load_dword v3, v2, s[4:7], s24 offen sc1
    s_min_u32 s25, s19, 63
    s_lshl_b32 s24, s25, 4
    s_add_u32 s24, s24, s41
    s_lshl_b32 s24, s24, 6
    s_add_u32 s24, s24, 65536
    buffer_load_dword v4, v2, s[4:7], s24 offen sc1
    s_waitcnt vmcnt(0)
    v_readfirstlane_b32 s25, v3
    v_readfirstlane_b32 s26, v4
    s_mov_b32 s24, -1
    s_min_u32 s27, s18, s20
    s_cmp_lt_u32 s20, 30
    s_cselect_b32 s27, 64, s27
    s_cmp_lt_u32 s27, 64
    s_cbranch_scc1 Lsk_195
    s_cmp_ge_u32 s19, 64
    s_cbranch_scc1 Lsk_195
    s_cmp_lg_u32 s26, 515
    s_cbranch_scc1 Lsk_195
    s_add_u32 s24, s19, 64
Lsk_195:
    s_cmp_ge_u32 s18, 64
    s_cbranch_scc1 Lsk_196
    s_cmp_lg_u32 s25, 515
    s_cbranch_scc1 Lsk_196
    s_add_u32 s24, s18, 0
Lsk_196:
    s_cmp_lg_u32 s24, -1
    s_cbranch_scc1 RAW_B2x
    s_sleep 2
    s_memrealtime s[36:37]
    s_waitcnt lgkmcnt(0)
    s_sub_u32 s36, s36, s28
    s_cmp_gt_u32 s36, 3000000
    s_cbranch_scc1 RAW_B2x
    s_branch RAW_B2
RAW_B2x:
    v_mov_b32 v5, s24
    v_mov_b32 v6, 163776
    ds_write_b32 v6, v5 offset:8
    s_waitcnt lgkmcnt(0)
RAW_B3:
    s_barrier
    v_mov_b32 v6, 163776
    ds_read_b32 v5, v6 offset:8
    s_waitcnt lgkmcnt(0)
    v_readfirstlane_b32 s20, v5
    s_cmp_eq_u32 s20, -1
    s_cbranch_scc1 E_AW
RAW_GO:
    s_cmp_ge_u32 s20, 64
    s_cbranch_scc1 Lad_197
    s_bitset0_b64 s[84:85], s18
    s_ff1_i32_b64 s18, s[84:85]
    s_min_u32 s18, s18, 64
    s_branch Lad_198
Lad_197:
    s_bitset0_b64 s[88:89], s19
    s_ff1_i32_b64 s19, s[88:89]
    s_min_u32 s19, s19, 64
Lad_198:
    s_min_u32 s25, s18, 63
    s_lshl_b32 s24, s25, 4
    s_add_u32 s24, s24, s41
    s_lshl_b32 s24, s24, 6
    s_add_u32 s24, s24, 0
    buffer_load_dword v3, v2, s[4:7], s24 offen sc1
    s_min_u32 s25, s19, 63
    s_lshl_b32 s24, s25, 4
    s_add_u32 s24, s24, s41
    s_lshl_b32 s24, s24, 6
    s_add_u32 s24, s24, 65536
    buffer_load_dword v4, v2, s[4:7], s24 offen sc1
    s_mul_i32 s92, s20, 786432
    s_lshl_b32 s93, s48, 13
    s_add_u32 s92, s92, s93
    s_add_u32 s92, s92, 35651584
    s_lshl_b32 s93, s47, 12
    s_add_u32 s93, s93, s92
    s_lshl_b32 s94, s20, 5
    s_add_u32 s94, s94, s48
    s_lshl_b32 s94, s94, 12
    s_add_u32 s94, s94, 18874368
    buffer_load_dwordx4 v[16:19], v9, s[4:7], s93 offen offset:0 sc1
    buffer_load_dwordx4 v[20:23], v9, s[4:7], s93 offen offset:1024 sc1
    buffer_load_dwordx4 v[24:27], v9, s[4:7], s93 offen offset:2048 sc1
    buffer_load_dwordx4 v[28:31], v9, s[4:7], s93 offen offset:3072 sc1
    s_add_u32 s92, s92, 262144
    buffer_load_dwordx4 v[32:35], v9, s[4:7], s92 offen offset:0 sc1
    buffer_load_dwordx4 v[36:39], v9, s[4:7], s92 offen offset:1024 sc1
    buffer_load_dwordx4 v[40:43], v9, s[4:7], s92 offen offset:2048 sc1
    buffer_load_dwordx4 v[44:47], v9, s[4:7], s92 offen offset:3072 sc1
    s_cmp_eq_u32 s22, -1
    s_cbranch_scc1 RAW_G1
    s_waitcnt vmcnt(10)
    s_barrier
    s_cmp_lg_u32 s16, 0
    s_cbranch_scc1 Lsg_199
    s_lshl_b32 s24, s22, 8
    s_add_u32 s24, s24, 131136
    v_mov_b32 v5, 1
    s_mov_b64 s[38:39], exec
    s_mov_b64 exec, 1
    buffer_atomic_add v5, v2, s[4:7], s24 offen
    s_mov_b64 exec, s[38:39]
Lsg_199:
    s_mov_b32 s22, -1
RAW_G1:
    s_add_u32 s92, s92, 4096
    buffer_load_dwordx4 v[48:51], v9, s[4:7], s92 offen offset:0 sc1
    buffer_load_dwordx4 v[52:55], v9, s[4:7], s92 offen offset:1024 sc1
    buffer_load_dwordx4 v[56:59], v9, s[4:7], s92 offen offset:2048 sc1
    buffer_load_dwordx4 v[60:63], v9, s[4:7], s92 offen offset:3072 sc1
    buffer_load_dwordx4 v[96:99], v10, s[4:7], s94 offen offset:0 sc1
    buffer_load_dwordx4 v[100:103], v10, s[4:7], s94 offen offset:512 sc1
    buffer_load_dwordx4 v[104:107], v10, s[4:7], s94 offen offset:1024 sc1
    buffer_load_dwordx4 v[108:111], v10, s[4:7], s94 offen offset:1536 sc1
    s_add_u32 s92, s92, 258048
    buffer_load_dwordx4 v[64:67], v9, s[4:7], s92 offen offset:0 sc1
    buffer_load_dwordx4 v[68:71], v9, s[4:7], s92 offen offset:1024 sc1
    buffer_load_dwordx4 v[72:75], v9, s[4:7], s92 offen offset:2048 sc1
    buffer_load_dwordx4 v[76:79], v9, s[4:7], s92 offen offset:3072 sc1
    s_add_u32 s92, s92, 4096
    buffer_load_dwordx4 v[80:83], v9, s[4:7], s92 offen offset:0 sc1
    buffer_load_dwordx4 v[84:87], v9, s[4:7], s92 offen offset:1024 sc1
    buffer_load_dwordx4 v[88:91], v9, s[4:7], s92 offen offset:2048 sc1
    buffer_load_dwordx4 v[92:95], v9, s[4:7], s92 offen offset:3072 sc1
    buffer_load_dwordx2 v[112:113], v11, s[4:7], s94 offen offset:2048 sc1
    buffer_load_dwordx2 v[114:115], v11, s[4:7], s94 offen offset:2560 sc1
    buffer_load_dwordx2 v[116:117], v11, s[4:7], s94 offen offset:3072 sc1
    buffer_load_dwordx2 v[118:119], v11, s[4:7], s94 offen offset:3584 sc1
    s_waitcnt vmcnt(28)
    s_xor_b32 s30, s30, 1
    s_cmp_lg_u32 s16, 0
    s_cbranch_scc1 Lw0_200
    v_readfirstlane_b32 s25, v3
    v_readfirstlane_b32 s26, v4
    s_mov_b32 s24, -1
    s_min_u32 s27, s18, s20
    s_cmp_lt_u32 s20, 30
    s_cselect_b32 s27, 64, s27
    s_cmp_lt_u32 s27, 64
    s_cbranch_scc1 Lsk_201
    s_cmp_ge_u32 s19, 64
    s_cbranch_scc1 Lsk_201
    s_cmp_lg_u32 s26, 515
    s_cbranch_scc1 Lsk_201
    s_add_u32 s24, s19, 64
Lsk_201:
    s_cmp_ge_u32 s18, 64
    s_cbranch_scc1 Lsk_202
    s_cmp_lg_u32 s25, 515
    s_cbranch_scc1 Lsk_202
    s_add_u32 s24, s18, 0
Lsk_202:
    v_mov_b32 v5, s24
    v_mov_b32 v6, 163776
    ds_write_b32 v6, v5 offset:0
Lw0_200:
    s_waitcnt vmcnt(12)
    v_mfma_f32_16x16x32_bf16 v[192:195], v[32:35], v[16:19], 0
    v_mfma_f32_16x16x32_bf16 v[196:199], v[48:51], v[16:19], 0
    v_mfma_f32_16x16x32_bf16 v[200:203], v[96:99], v[16:19], 0
    v_mfma_f32_16x16x32_bf16 v[192:195], v[36:39], v[20:23], v[192:195]
    v_mfma_f32_16x16x32_bf16 v[196:199], v[52:55], v[20:23], v[196:199]
    v_mfma_f32_16x16x32_bf16 v[200:203], v[100:103], v[20:23], v[200:203]
    v_mfma_f32_16x16x32_bf16 v[192:195], v[40:43], v[24:27], v[192:195]
    v_mfma_f32_16x16x32_bf16 v[196:199], v[56:59], v[24:27], v[196:199]
    v_mfma_f32_16x16x32_bf16 v[200:203], v[104:107], v[24:27], v[200:203]
    v_mfma_f32_16x16x32_bf16 v[192:195], v[44:47], v[28:31], v[192:195]
    v_mfma_f32_16x16x32_bf16 v[196:199], v[60:63], v[28:31], v[196:199]
    v_mfma_f32_16x16x32_bf16 v[200:203], v[108:111], v[28:31], v[200:203]
    s_nop 5
    v_cndmask_b32 v192, v13, v192, s[52:53]
    v_cndmask_b32 v193, v13, v193, s[54:55]
    v_cndmask_b32 v194, v13, v194, s[56:57]
    v_cndmask_b32 v195, v13, v195, s[58:59]
    v_cndmask_b32 v196, v13, v196, s[60:61]
    v_cndmask_b32 v197, v13, v197, s[62:63]
    v_cndmask_b32 v198, v13, v198, s[64:65]
    v_cndmask_b32 v199, v13, v199, s[66:67]
    v_max3_f32 v204, v192, v193, v194
    v_max3_f32 v204, v204, v195, v196
    v_max3_f32 v204, v204, v197, v198
    v_max3_f32 v204, v204, v199, v200
    v_max_f32 v204, v204, v201
    v_mov_b32 v205, v204
    s_nop 1
    v_permlane16_swap_b32 v204, v205
    v_max_f32 v204, v204, v205
    v_mov_b32 v205, v204
    s_nop 1
    v_permlane32_swap_b32 v204, v205
    v_max_f32 v204, v204, v205
    v_mul_f32 v204, s45, v204
    v_fma_f32 v192, v192, s45, -v204
    v_fma_f32 v193, v193, s45, -v204
    v_fma_f32 v194, v194, s45, -v204
    v_fma_f32 v195, v195, s45, -v204
    v_fma_f32 v196, v196, s45, -v204
    v_fma_f32 v197, v197, s45, -v204
    v_fma_f32 v198, v198, s45, -v204
    v_fma_f32 v199, v199, s45, -v204
    v_fma_f32 v200, v200, s45, -v204
    v_fma_f32 v201, v201, s45, -v204
    v_exp_f32 v192, v192
    v_exp_f32 v193, v193
    v_exp_f32 v194, v194
    v_exp_f32 v195, v195
    v_exp_f32 v196, v196
    v_exp_f32 v197, v197
    v_exp_f32 v198, v198
    v_exp_f32 v199, v199
    v_exp_f32 v200, v200
    v_exp_f32 v201, v201
    v_add_f32 v204, v192, v193
    v_add_f32 v205, v194, v195
    v_add_f32 v204, v204, v196
    v_add_f32 v205, v205, v197
    v_add_f32 v204, v204, v198
    v_add_f32 v205, v205, v199
    v_add_f32 v204, v204, v200
    v_add_f32 v205, v205, v201
    v_add_f32 v204, v204, v205
    v_mov_b32 v205, v204
    s_nop 1
    v_permlane16_swap_b32 v204, v205
    v_add_f32 v204, v204, v205
    v_mov_b32 v205, v204
    s_nop 1
    v_permlane32_swap_b32 v204, v205
    v_add_f32 v204, v204, v205
    v_rcp_f32 v204, v204
    v_mov_b32 v213, 0
    v_mov_b32 v214, 0
    v_mul_f32 v192, v192, v204
    v_mul_f32 v193, v193, v204
    v_mul_f32 v194, v194, v204
    v_mul_f32 v195, v195, v204
    v_mul_f32 v196, v196, v204
    v_mul_f32 v197, v197, v204
    v_mul_f32 v198, v198, v204
    v_mul_f32 v199, v199, v204
    v_mul_f32 v200, v200, v204
    v_mul_f32 v201, v201, v204
    v_cvt_pk_bf16_f32 v208, v192, v193
    v_cvt_pk_bf16_f32 v209, v194, v195
    v_cvt_pk_bf16_f32 v210, v196, v197
    v_cvt_pk_bf16_f32 v211, v198, v199
    v_cvt_pk_bf16_f32 v212, v200, v201
    v_cvt_pk_bf16_f32 v215, v200, v201
    s_waitcnt vmcnt(0)
    v_mfma_f32_16x16x32_bf16 v[216:219], v[64:67], v[208:211], 0
    v_mfma_f32_16x16x32_bf16 v[220:223], v[68:71], v[208:211], 0
    v_mfma_f32_16x16x32_bf16 v[224:227], v[72:75], v[208:211], 0
    v_mfma_f32_16x16x32_bf16 v[228:231], v[76:79], v[208:211], 0
    v_mfma_f32_16x16x32_bf16 v[232:235], v[80:83], v[208:211], 0
    v_mfma_f32_16x16x32_bf16 v[236:239], v[84:87], v[208:211], 0
    v_mfma_f32_16x16x32_bf16 v[240:243], v[88:91], v[208:211], 0
    v_mfma_f32_16x16x32_bf16 v[244:247], v[92:95], v[208:211], 0
    v_mfma_f32_16x16x16_bf16 v[216:219], v[112:113], v[212:213], v[216:219]
    v_mfma_f32_16x16x16_bf16 v[220:223], v[112:113], v[214:215], v[220:223]
    v_mfma_f32_16x16x16_bf16 v[224:227], v[114:115], v[212:213], v[224:227]
    v_mfma_f32_16x16x16_bf16 v[228:231], v[114:115], v[214:215], v[228:231]
    v_mfma_f32_16x16x16_bf16 v[232:235], v[116:117], v[212:213], v[232:235]
    v_mfma_f32_16x16x16_bf16 v[236:239], v[116:117], v[214:215], v[236:239]
    v_mfma_f32_16x16x16_bf16 v[240:243], v[118:119], v[212:213], v[240:243]
    v_mfma_f32_16x16x16_bf16 v[244:247], v[118:119], v[214:215], v[244:247]
    s_lshl_b32 s24, s30, 14
    v_add_u32 v5, s24, v14
    v_add_u32 v8, s24, v9
    v_cvt_pk_bf16_f32 v192, v216, v220
    v_cvt_pk_bf16_f32 v193, v224, v228
    v_cvt_pk_bf16_f32 v194, v217, v221
    v_cvt_pk_bf16_f32 v195, v225, v229
    ds_write_b128 v5, v[192:195] offset:0
    v_cvt_pk_bf16_f32 v196, v218, v222
    v_cvt_pk_bf16_f32 v197, v226, v230
    v_cvt_pk_bf16_f32 v198, v219, v223
    v_cvt_pk_bf16_f32 v199, v227, v231
    ds_write_b128 v5, v[196:199] offset:1024
    v_cvt_pk_bf16_f32 v200, v232, v236
    v_cvt_pk_bf16_f32 v201, v240, v244
    v_cvt_pk_bf16_f32 v202, v233, v237
    v_cvt_pk_bf16_f32 v203, v241, v245
    ds_write_b128 v5, v[200:203] offset:2048
    v_cvt_pk_bf16_f32 v204, v234, v238
    v_cvt_pk_bf16_f32 v205, v242, v246
    v_cvt_pk_bf16_f32 v206, v235, v239
    v_cvt_pk_bf16_f32 v207, v243, v247
    ds_write_b128 v5, v[204:207] offset:3072
    s_branch RAW_S1
RAW_TOP:
    s_xor_b32 s30, s30, 1
    s_cmp_lg_u32 s16, 0
    s_cbranch_scc1 Lw0_203
    v_readfirstlane_b32 s25, v3
    v_readfirstlane_b32 s26, v4
    s_mov_b32 s24, -1
    s_min_u32 s27, s18, s20
    s_cmp_lt_u32 s20, 30
    s_cselect_b32 s27, 64, s27
    s_cmp_lt_u32 s27, 64
    s_cbranch_scc1 Lsk_204
    s_cmp_ge_u32 s19, 64
    s_cbranch_scc1 Lsk_204
    s_cmp_lg_u32 s26, 515
    s_cbranch_scc1 Lsk_204
    s_add_u32 s24, s19, 64
Lsk_204:
    s_cmp_ge_u32 s18, 64
    s_cbranch_scc1 Lsk_205
    s_cmp_lg_u32 s25, 515
    s_cbranch_scc1 Lsk_205
    s_add_u32 s24, s18, 0
Lsk_205:
    v_mov_b32 v5, s24
    v_mov_b32 v6, 163776
    ds_write_b32 v6, v5 offset:0
Lw0_203:
    v_mfma_f32_16x16x32_bf16 v[192:195], v[32:35], v[16:19], 0
    v_mfma_f32_16x16x32_bf16 v[196:199], v[48:51], v[16:19], 0
    v_mfma_f32_16x16x32_bf16 v[200:203], v[96:99], v[16:19], 0
    v_mfma_f32_16x16x32_bf16 v[192:195], v[36:39], v[20:23], v[192:195]
    v_mfma_f32_16x16x32_bf16 v[196:199], v[52:55], v[20:23], v[196:199]
    v_mfma_f32_16x16x32_bf16 v[200:203], v[100:103], v[20:23], v[200:203]
    v_mfma_f32_16x16x32_bf16 v[192:195], v[40:43], v[24:27], v[192:195]
    v_mfma_f32_16x16x32_bf16 v[196:199], v[56:59], v[24:27], v[196:199]
    v_mfma_f32_16x16x32_bf16 v[200:203], v[104:107], v[24:27], v[200:203]
    v_mfma_f32_16x16x32_bf16 v[192:195], v[44:47], v[28:31], v[192:195]
    v_mfma_f32_16x16x32_bf16 v[196:199], v[60:63], v[28:31], v[196:199]
    v_mfma_f32_16x16x32_bf16 v[200:203], v[108:111], v[28:31], v[200:203]
    s_nop 5
    v_cndmask_b32 v192, v13, v192, s[52:53]
    v_cndmask_b32 v193, v13, v193, s[54:55]
    v_cndmask_b32 v194, v13, v194, s[56:57]
    v_cndmask_b32 v195, v13, v195, s[58:59]
    v_cndmask_b32 v196, v13, v196, s[60:61]
    v_cndmask_b32 v197, v13, v197, s[62:63]
    v_cndmask_b32 v198, v13, v198, s[64:65]
    v_cndmask_b32 v199, v13, v199, s[66:67]
    v_max3_f32 v204, v192, v193, v194
    v_max3_f32 v204, v204, v195, v196
    v_max3_f32 v204, v204, v197, v198
    v_max3_f32 v204, v204, v199, v200
    v_max_f32 v204, v204, v201
    v_mov_b32 v205, v204
    s_nop 1
    v_permlane16_swap_b32 v204, v205
    v_max_f32 v204, v204, v205
    v_mov_b32 v205, v204
    s_nop 1
    v_permlane32_swap_b32 v204, v205
    v_max_f32 v204, v204, v205
    v_mul_f32 v204, s45, v204
    v_fma_f32 v192, v192, s45, -v204
    v_fma_f32 v193, v193, s45, -v204
    v_fma_f32 v194, v194, s45, -v204
    v_fma_f32 v195, v195, s45, -v204
    v_fma_f32 v196, v196, s45, -v204
    v_fma_f32 v197, v197, s45, -v204
    v_fma_f32 v198, v198, s45, -v204
    v_fma_f32 v199, v199, s45, -v204
    v_fma_f32 v200, v200, s45, -v204
    v_fma_f32 v201, v201, s45, -v204
    v_exp_f32 v192, v192
    v_exp_f32 v193, v193
    v_exp_f32 v194, v194
    v_exp_f32 v195, v195
    v_exp_f32 v196, v196
    v_exp_f32 v197, v197
    v_exp_f32 v198, v198
    v_exp_f32 v199, v199
    v_exp_f32 v200, v200
    v_exp_f32 v201, v201
    v_add_f32 v204, v192, v193
    v_add_f32 v205, v194, v195
    v_add_f32 v204, v204, v196
    v_add_f32 v205, v205, v197
    v_add_f32 v204, v204, v198
    v_add_f32 v205, v205, v199
    v_add_f32 v204, v204, v200
    v_add_f32 v205, v205, v201
    v_add_f32 v204, v204, v205
    v_mov_b32 v205, v204
    s_nop 1
    v_permlane16_swap_b32 v204, v205
    v_add_f32 v204, v204, v205
    v_mov_b32 v205, v204
    s_nop 1
    v_permlane32_swap_b32 v204, v205
    v_add_f32 v204, v204, v205
    v_rcp_f32 v204, v204
    v_mov_b32 v213, 0
    v_mov_b32 v214, 0
    v_mul_f32 v192, v192, v204
    v_mul_f32 v193, v193, v204
    v_mul_f32 v194, v194, v204
    v_mul_f32 v195, v195, v204
    v_mul_f32 v196, v196, v204
    v_mul_f32 v197, v197, v204
    v_mul_f32 v198, v198, v204
    v_mul_f32 v199, v199, v204
    v_mul_f32 v200, v200, v204
    v_mul_f32 v201, v201, v204
    v_cvt_pk_bf16_f32 v208, v192, v193
    v_cvt_pk_bf16_f32 v209, v194, v195
    v_cvt_pk_bf16_f32 v210, v196, v197
    v_cvt_pk_bf16_f32 v211, v198, v199
    v_cvt_pk_bf16_f32 v212, v200, v201
    v_cvt_pk_bf16_f32 v215, v200, v201
    v_mfma_f32_16x16x32_bf16 v[216:219], v[64:67], v[208:211], 0
    v_mfma_f32_16x16x32_bf16 v[220:223], v[68:71], v[208:211], 0
    v_mfma_f32_16x16x32_bf16 v[224:227], v[72:75], v[208:211], 0
    v_mfma_f32_16x16x32_bf16 v[228:231], v[76:79], v[208:211], 0
    v_mfma_f32_16x16x32_bf16 v[232:235], v[80:83], v[208:211], 0
    v_mfma_f32_16x16x32_bf16 v[236:239], v[84:87], v[208:211], 0
    v_mfma_f32_16x16x32_bf16 v[240:243], v[88:91], v[208:211], 0
    v_mfma_f32_16x16x32_bf16 v[244:247], v[92:95], v[208:211], 0
    v_mfma_f32_16x16x16_bf16 v[216:219], v[112:113], v[212:213], v[216:219]
    v_mfma_f32_16x16x16_bf16 v[220:223], v[112:113], v[214:215], v[220:223]
    v_mfma_f32_16x16x16_bf16 v[224:227], v[114:115], v[212:213], v[224:227]
    v_mfma_f32_16x16x16_bf16 v[228:231], v[114:115], v[214:215], v[228:231]
    v_mfma_f32_16x16x16_bf16 v[232:235], v[116:117], v[212:213], v[232:235]
    v_mfma_f32_16x16x16_bf16 v[236:239], v[116:117], v[214:215], v[236:239]
    v_mfma_f32_16x16x16_bf16 v[240:243], v[118:119], v[212:213], v[240:243]
    v_mfma_f32_16x16x16_bf16 v[244:247], v[118:119], v[214:215], v[244:247]
    s_lshl_b32 s24, s30, 14
    v_add_u32 v5, s24, v14
    v_add_u32 v8, s24, v9
    v_cvt_pk_bf16_f32 v192, v216, v220
    v_cvt_pk_bf16_f32 v193, v224, v228
    v_cvt_pk_bf16_f32 v194, v217, v221
    v_cvt_pk_bf16_f32 v195, v225, v229
    ds_write_b128 v5, v[192:195] offset:0
    v_cvt_pk_bf16_f32 v196, v218, v222
    v_cvt_pk_bf16_f32 v197, v226, v230
    v_cvt_pk_bf16_f32 v198, v219, v223
    v_cvt_pk_bf16_f32 v199, v227, v231
    ds_write_b128 v5, v[196:199] offset:1024
    v_cvt_pk_bf16_f32 v200, v232, v236
    v_cvt_pk_bf16_f32 v201, v240, v244
    v_cvt_pk_bf16_f32 v202, v233, v237
    v_cvt_pk_bf16_f32 v203, v241, v245
    ds_write_b128 v5, v[200:203] offset:2048
    v_cvt_pk_bf16_f32 v204, v234, v238
    v_cvt_pk_bf16_f32 v205, v242, v246
    v_cvt_pk_bf16_f32 v206, v235, v239
    v_cvt_pk_bf16_f32 v207, v243, v247
    ds_write_b128 v5, v[204:207] offset:3072
RAW_S1:
    s_waitcnt lgkmcnt(0)
    s_barrier
    v_mov_b32 v6, 163776
    ds_read_b32 v5, v6 offset:0
    s_waitcnt lgkmcnt(0)
    v_readfirstlane_b32 s21, v5
    s_cmp_eq_u32 s21, -1
    s_cbranch_scc1 RAW_T1
    s_cmp_ge_u32 s21, 64
    s_cbranch_scc1 Lad_206
    s_bitset0_b64 s[84:85], s18
    s_ff1_i32_b64 s18, s[84:85]
    s_min_u32 s18, s18, 64
    s_branch Lad_207
Lad_206:
    s_bitset0_b64 s[88:89], s19
    s_ff1_i32_b64 s19, s[88:89]
    s_min_u32 s19, s19, 64
Lad_207:
    s_mul_i32 s92, s21, 786432
    s_lshl_b32 s93, s48, 13
    s_add_u32 s92, s92, s93
    s_add_u32 s92, s92, 35651584
    s_lshl_b32 s93, s47, 12
    s_add_u32 s93, s93, s92
    s_lshl_b32 s94, s21, 5
    s_add_u32 s94, s94, s48
    s_lshl_b32 s94, s94, 12
    s_add_u32 s94, s94, 18874368
    ds_read_b128 v[192:195], v8 offset:0
    ds_read_b128 v[196:199], v8 offset:1024
    ds_read_b128 v[200:203], v8 offset:2048
    s_waitcnt lgkmcnt(2)
    v_mfma_f32_16x16x32_bf16 v[128:131], a[0:3], v[192:195], 0
    v_mfma_f32_16x16x32_bf16 v[132:135], a[4:7], v[192:195], 0
    ds_read_b128 v[204:207], v8 offset:3072
    v_mfma_f32_16x16x32_bf16 v[136:139], a[8:11], v[192:195], 0
    buffer_load_dwordx4 v[16:19], v9, s[4:7], s93 offen offset:0 sc1
    v_mfma_f32_16x16x32_bf16 v[140:143], a[12:15], v[192:195], 0
    v_mfma_f32_16x16x32_bf16 v[144:147], a[16:19], v[192:195], 0
    v_mfma_f32_16x16x32_bf16 v[148:151], a[20:23], v[192:195], 0
    buffer_load_dwordx4 v[20:23], v9, s[4:7], s93 offen offset:1024 sc1
    v_mfma_f32_16x16x32_bf16 v[152:155], a[24:27], v[192:195], 0
    v_mfma_f32_16x16x32_bf16 v[156:159], a[28:31], v[192:195], 0
    s_waitcnt lgkmcnt(2)
    v_mfma_f32_16x16x32_bf16 v[128:131], a[32:35], v[196:199], v[128:131]
    v_mfma_f32_16x16x32_bf16 v[132:135], a[36:39], v[196:199], v[132:135]
    ds_read_b128 v[192:195], v8 offset:4096
    buffer_load_dwordx4 v[24:27], v9, s[4:7], s93 offen offset:2048 sc1
    v_mfma_f32_16x16x32_bf16 v[136:139], a[40:43], v[196:199], v[136:139]
    v_mfma_f32_16x16x32_bf16 v[140:143], a[44:47], v[196:199], v[140:143]
    v_mfma_f32_16x16x32_bf16 v[144:147], a[48:51], v[196:199], v[144:147]
    v_mfma_f32_16x16x32_bf16 v[148:151], a[52:55], v[196:199], v[148:151]
    buffer_load_dwordx4 v[28:31], v9, s[4:7], s93 offen offset:3072 sc1
    v_mfma_f32_16x16x32_bf16 v[152:155], a[56:59], v[196:199], v[152:155]
    v_mfma_f32_16x16x32_bf16 v[156:159], a[60:63], v[196:199], v[156:159]
    s_waitcnt lgkmcnt(2)
    v_mfma_f32_16x16x32_bf16 v[128:131], a[64:67], v[200:203], v[128:131]
    v_mfma_f32_16x16x32_bf16 v[132:135], a[68:71], v[200:203], v[132:135]
    ds_read_b128 v[196:199], v8 offset:5120
    s_add_u32 s92, s92, 262144
    buffer_load_dwordx4 v[32:35], v9, s[4:7], s92 offen offset:0 sc1
    v_mfma_f32_16x16x32_bf16 v[136:139], a[72:75], v[200:203], v[136:139]
    v_mfma_f32_16x16x32_bf16 v[140:143], a[76:79], v[200:203], v[140:143]
    v_mfma_f32_16x16x32_bf16 v[144:147], a[80:83], v[200:203], v[144:147]
    v_mfma_f32_16x16x32_bf16 v[148:151], a[84:87], v[200:203], v[148:151]
    buffer_load_dwordx4 v[36:39], v9, s[4:7], s92 offen offset:1024 sc1
    v_mfma_f32_16x16x32_bf16 v[152:155], a[88:91], v[200:203], v[152:155]
    v_mfma_f32_16x16x32_bf16 v[156:159], a[92:95], v[200:203], v[156:159]
    s_waitcnt lgkmcnt(2)
    v_mfma_f32_16x16x32_bf16 v[128:131], a[96:99], v[204:207], v[128:131]
    v_mfma_f32_16x16x32_bf16 v[132:135], a[100:103], v[204:207], v[132:135]
    ds_read_b128 v[200:203], v8 offset:6144
    buffer_load_dwordx4 v[40:43], v9, s[4:7], s92 offen offset:2048 sc1
    v_mfma_f32_16x16x32_bf16 v[136:139], a[104:107], v[204:207], v[136:139]
    v_mfma_f32_16x16x32_bf16 v[140:143], a[108:111], v[204:207], v[140:143]
    v_mfma_f32_16x16x32_bf16 v[144:147], a[112:115], v[204:207], v[144:147]
    v_mfma_f32_16x16x32_bf16 v[148:151], a[116:119], v[204:207], v[148:151]
    buffer_load_dwordx4 v[44:47], v9, s[4:7], s92 offen offset:3072 sc1
    v_mfma_f32_16x16x32_bf16 v[152:155], a[120:123], v[204:207], v[152:155]
    v_mfma_f32_16x16x32_bf16 v[156:159], a[124:127], v[204:207], v[156:159]
    s_waitcnt lgkmcnt(2)
    v_mfma_f32_16x16x32_bf16 v[128:131], a[128:131], v[192:195], v[128:131]
    v_mfma_f32_16x16x32_bf16 v[132:135], a[132:135], v[192:195], v[132:135]
    ds_read_b128 v[204:207], v8 offset:7168
    s_add_u32 s92, s92, 4096
    buffer_load_dwordx4 v[48:51], v9, s[4:7], s92 offen offset:0 sc1
    v_mfma_f32_16x16x32_bf16 v[136:139], a[136:139], v[192:195], v[136:139]
    v_mfma_f32_16x16x32_bf16 v[140:143], a[140:143], v[192:195], v[140:143]
    v_mfma_f32_16x16x32_bf16 v[144:147], a[144:147], v[192:195], v[144:147]
    buffer_load_dwordx4 v[52:55], v9, s[4:7], s92 offen offset:1024 sc1
    v_mfma_f32_16x16x32_bf16 v[148:151], a[148:151], v[192:195], v[148:151]
    v_mfma_f32_16x16x32_bf16 v[152:155], a[152:155], v[192:195], v[152:155]
    v_mfma_f32_16x16x32_bf16 v[156:159], a[156:159], v[192:195], v[156:159]
    s_waitcnt lgkmcnt(2)
    v_mfma_f32_16x16x32_bf16 v[128:131], a[160:163], v[196:199], v[128:131]
    buffer_load_dwordx4 v[56:59], v9, s[4:7], s92 offen offset:2048 sc1
    v_mfma_f32_16x16x32_bf16 v[132:135], a[164:167], v[196:199], v[132:135]
    v_mfma_f32_16x16x32_bf16 v[136:139], a[168:171], v[196:199], v[136:139]
    v_mfma_f32_16x16x32_bf16 v[140:143], a[172:175], v[196:199], v[140:143]
    v_mfma_f32_16x16x32_bf16 v[144:147], a[176:179], v[196:199], v[144:147]
    buffer_load_dwordx4 v[60:63], v9, s[4:7], s92 offen offset:3072 sc1
    v_mfma_f32_16x16x32_bf16 v[148:151], a[180:183], v[196:199], v[148:151]
    v_mfma_f32_16x16x32_bf16 v[152:155], a[184:187], v[196:199], v[152:155]
    v_mfma_f32_16x16x32_bf16 v[156:159], a[188:191], v[196:199], v[156:159]
    s_waitcnt lgkmcnt(1)
    v_mfma_f32_16x16x32_bf16 v[128:131], a[192:195], v[200:203], v[128:131]
    buffer_load_dwordx4 v[96:99], v10, s[4:7], s94 offen offset:0 sc1
    v_mfma_f32_16x16x32_bf16 v[132:135], a[196:199], v[200:203], v[132:135]
    v_mfma_f32_16x16x32_bf16 v[136:139], a[200:203], v[200:203], v[136:139]
    v_mfma_f32_16x16x32_bf16 v[140:143], a[204:207], v[200:203], v[140:143]
    v_mfma_f32_16x16x32_bf16 v[144:147], a[208:211], v[200:203], v[144:147]
    buffer_load_dwordx4 v[100:103], v10, s[4:7], s94 offen offset:512 sc1
    v_mfma_f32_16x16x32_bf16 v[148:151], a[212:215], v[200:203], v[148:151]
    v_mfma_f32_16x16x32_bf16 v[152:155], a[216:219], v[200:203], v[152:155]
    v_mfma_f32_16x16x32_bf16 v[156:159], a[220:223], v[200:203], v[156:159]
    s_waitcnt lgkmcnt(0)
    v_mfma_f32_16x16x32_bf16 v[128:131], a[224:227], v[204:207], v[128:131]
    buffer_load_dwordx4 v[104:107], v10, s[4:7], s94 offen offset:1024 sc1
    v_mfma_f32_16x16x32_bf16 v[132:135], a[228:231], v[204:207], v[132:135]
    v_mfma_f32_16x16x32_bf16 v[136:139], a[232:235], v[204:207], v[136:139]
    v_mfma_f32_16x16x32_bf16 v[140:143], a[236:239], v[204:207], v[140:143]
    v_mfma_f32_16x16x32_bf16 v[144:147], a[240:243], v[204:207], v[144:147]
    buffer_load_dwordx4 v[108:111], v10, s[4:7], s94 offen offset:1536 sc1
    v_mfma_f32_16x16x32_bf16 v[148:151], a[244:247], v[204:207], v[148:151]
    v_mfma_f32_16x16x32_bf16 v[152:155], a[248:251], v[204:207], v[152:155]
    v_mfma_f32_16x16x32_bf16 v[156:159], a[252:255], v[204:207], v[156:159]
    s_waitcnt vmcnt(16) lgkmcnt(0)
    s_barrier
    s_cmp_eq_u32 s22, -1
    s_cbranch_scc1 Lms_208
    s_cmp_lg_u32 s16, 0
    s_cbranch_scc1 Lsg_209
    s_lshl_b32 s24, s22, 8
    s_add_u32 s24, s24, 131136
    v_mov_b32 v5, 1
    s_mov_b64 s[38:39], exec
    s_mov_b64 exec, 1
    buffer_atomic_add v5, v2, s[4:7], s24 offen
    s_mov_b64 exec, s[38:39]
Lsg_209:
    s_mov_b32 s22, -1
Lms_208:
    s_min_u32 s25, s18, 63
    s_lshl_b32 s24, s25, 4
    s_add_u32 s24, s24, s41
    s_lshl_b32 s24, s24, 6
    s_add_u32 s24, s24, 0
    buffer_load_dword v3, v2, s[4:7], s24 offen sc1
    s_min_u32 s25, s19, 63
    s_lshl_b32 s24, s25, 4
    s_add_u32 s24, s24, s41
    s_lshl_b32 s24, s24, 6
    s_add_u32 s24, s24, 65536
    buffer_load_dword v4, v2, s[4:7], s24 offen sc1
    s_mul_i32 s26, s20, 524288
    s_add_u32 s26, s26, s33
    s_add_u32 s27, s26, 16384
    ds_read_b128 v[192:195], v8 offset:8192
    ds_read_b128 v[196:199], v8 offset:9216
    ds_read_b128 v[200:203], v8 offset:10240
    s_waitcnt lgkmcnt(2)
    v_mfma_f32_16x16x32_bf16 v[160:163], a[0:3], v[192:195], 0
    v_mfma_f32_16x16x32_bf16 v[164:167], a[4:7], v[192:195], 0
    ds_read_b128 v[204:207], v8 offset:11264
    v_mfma_f32_16x16x32_bf16 v[168:171], a[8:11], v[192:195], 0
    s_add_u32 s92, s92, 258048
    buffer_load_dwordx4 v[64:67], v9, s[4:7], s92 offen offset:0 sc1
    v_mfma_f32_16x16x32_bf16 v[172:175], a[12:15], v[192:195], 0
    buffer_load_dwordx4 v[68:71], v9, s[4:7], s92 offen offset:1024 sc1
    v_mfma_f32_16x16x32_bf16 v[176:179], a[16:19], v[192:195], 0
    v_mfma_f32_16x16x32_bf16 v[180:183], a[20:23], v[192:195], 0
    buffer_load_dwordx4 v[72:75], v9, s[4:7], s92 offen offset:2048 sc1
    v_mfma_f32_16x16x32_bf16 v[184:187], a[24:27], v[192:195], 0
    v_mfma_f32_16x16x32_bf16 v[188:191], a[28:31], v[192:195], 0
    buffer_load_dwordx4 v[76:79], v9, s[4:7], s92 offen offset:3072 sc1
    s_waitcnt lgkmcnt(2)
    v_mfma_f32_16x16x32_bf16 v[160:163], a[32:35], v[196:199], v[160:163]
    v_mfma_f32_16x16x32_bf16 v[164:167], a[36:39], v[196:199], v[164:167]
    ds_read_b128 v[192:195], v8 offset:12288
    s_add_u32 s92, s92, 4096
    buffer_load_dwordx4 v[80:83], v9, s[4:7], s92 offen offset:0 sc1
    v_mfma_f32_16x16x32_bf16 v[168:171], a[40:43], v[196:199], v[168:171]
    v_mfma_f32_16x16x32_bf16 v[172:175], a[44:47], v[196:199], v[172:175]
    buffer_load_dwordx4 v[84:87], v9, s[4:7], s92 offen offset:1024 sc1
    v_mfma_f32_16x16x32_bf16 v[176:179], a[48:51], v[196:199], v[176:179]
    v_mfma_f32_16x16x32_bf16 v[180:183], a[52:55], v[196:199], v[180:183]
    buffer_load_dwordx4 v[88:91], v9, s[4:7], s92 offen offset:2048 sc1
    v_mfma_f32_16x16x32_bf16 v[184:187], a[56:59], v[196:199], v[184:187]
    v_mfma_f32_16x16x32_bf16 v[188:191], a[60:63], v[196:199], v[188:191]
    buffer_load_dwordx4 v[92:95], v9, s[4:7], s92 offen offset:3072 sc1
    s_waitcnt lgkmcnt(2)
    v_mfma_f32_16x16x32_bf16 v[160:163], a[64:67], v[200:203], v[160:163]
    v_mfma_f32_16x16x32_bf16 v[164:167], a[68:71], v[200:203], v[164:167]
    ds_read_b128 v[196:199], v8 offset:13312
    buffer_load_dwordx2 v[112:113], v11, s[4:7], s94 offen offset:2048 sc1
    v_mfma_f32_16x16x32_bf16 v[168:171], a[72:75], v[200:203], v[168:171]
    v_mfma_f32_16x16x32_bf16 v[172:175], a[76:79], v[200:203], v[172:175]
    buffer_load_dwordx2 v[114:115], v11, s[4:7], s94 offen offset:2560 sc1
    v_mfma_f32_16x16x32_bf16 v[176:179], a[80:83], v[200:203], v[176:179]
    v_mfma_f32_16x16x32_bf16 v[180:183], a[84:87], v[200:203], v[180:183]
    buffer_load_dwordx2 v[116:117], v11, s[4:7], s94 offen offset:3072 sc1
    v_mfma_f32_16x16x32_bf16 v[184:187], a[88:91], v[200:203], v[184:187]
    v_mfma_f32_16x16x32_bf16 v[188:191], a[92:95], v[200:203], v[188:191]
    buffer_load_dwordx2 v[118:119], v11, s[4:7], s94 offen offset:3584 sc1
    s_waitcnt lgkmcnt(2)
    v_mfma_f32_16x16x32_bf16 v[160:163], a[96:99], v[204:207], v[160:163]
    v_mfma_f32_16x16x32_bf16 v[164:167], a[100:103], v[204:207], v[164:167]
    ds_read_b128 v[200:203], v8 offset:14336
    v_cvt_pk_bf16_f32 v216, v128, v132
    v_mfma_f32_16x16x32_bf16 v[168:171], a[104:107], v[204:207], v[168:171]
    v_mfma_f32_16x16x32_bf16 v[172:175], a[108:111], v[204:207], v[172:175]
    v_cvt_pk_bf16_f32 v217, v136, v140
    v_mfma_f32_16x16x32_bf16 v[176:179], a[112:115], v[204:207], v[176:179]
    v_mfma_f32_16x16x32_bf16 v[180:183], a[116:119], v[204:207], v[180:183]
    v_cvt_pk_bf16_f32 v218, v144, v148
    v_mfma_f32_16x16x32_bf16 v[184:187], a[120:123], v[204:207], v[184:187]
    v_mfma_f32_16x16x32_bf16 v[188:191], a[124:127], v[204:207], v[188:191]
    v_cvt_pk_bf16_f32 v219, v152, v156
    s_waitcnt lgkmcnt(2)
    v_mfma_f32_16x16x32_bf16 v[160:163], a[128:131], v[192:195], v[160:163]
    v_mfma_f32_16x16x32_bf16 v[164:167], a[132:135], v[192:195], v[164:167]
    ds_read_b128 v[204:207], v8 offset:15360
    buffer_store_dwordx4 v[216:219], v9, s[4:7], s26 offen offset:0 sc1
    v_mfma_f32_16x16x32_bf16 v[168:171], a[136:139], v[192:195], v[168:171]
    v_cvt_pk_bf16_f32 v220, v129, v133
    v_mfma_f32_16x16x32_bf16 v[172:175], a[140:143], v[192:195], v[172:175]
    v_mfma_f32_16x16x32_bf16 v[176:179], a[144:147], v[192:195], v[176:179]
    v_cvt_pk_bf16_f32 v221, v137, v141
    v_mfma_f32_16x16x32_bf16 v[180:183], a[148:151], v[192:195], v[180:183]
    v_mfma_f32_16x16x32_bf16 v[184:187], a[152:155], v[192:195], v[184:187]
    v_cvt_pk_bf16_f32 v222, v145, v149
    v_mfma_f32_16x16x32_bf16 v[188:191], a[156:159], v[192:195], v[188:191]
    s_waitcnt lgkmcnt(2)
    v_mfma_f32_16x16x32_bf16 v[160:163], a[160:163], v[196:199], v[160:163]
    v_cvt_pk_bf16_f32 v223, v153, v157
    v_mfma_f32_16x16x32_bf16 v[164:167], a[164:167], v[196:199], v[164:167]
    v_mfma_f32_16x16x32_bf16 v[168:171], a[168:171], v[196:199], v[168:171]
    buffer_store_dwordx4 v[220:223], v9, s[4:7], s26 offen offset:1024 sc1
    v_mfma_f32_16x16x32_bf16 v[172:175], a[172:175], v[196:199], v[172:175]
    v_mfma_f32_16x16x32_bf16 v[176:179], a[176:179], v[196:199], v[176:179]
    v_cvt_pk_bf16_f32 v224, v130, v134
    v_mfma_f32_16x16x32_bf16 v[180:183], a[180:183], v[196:199], v[180:183]
    v_mfma_f32_16x16x32_bf16 v[184:187], a[184:187], v[196:199], v[184:187]
    v_cvt_pk_bf16_f32 v225, v138, v142
    v_mfma_f32_16x16x32_bf16 v[188:191], a[188:191], v[196:199], v[188:191]
    s_waitcnt lgkmcnt(1)
    v_mfma_f32_16x16x32_bf16 v[160:163], a[192:195], v[200:203], v[160:163]
    v_cvt_pk_bf16_f32 v226, v146, v150
    v_mfma_f32_16x16x32_bf16 v[164:167], a[196:199], v[200:203], v[164:167]
    v_mfma_f32_16x16x32_bf16 v[168:171], a[200:203], v[200:203], v[168:171]
    v_cvt_pk_bf16_f32 v227, v154, v158
    v_mfma_f32_16x16x32_bf16 v[172:175], a[204:207], v[200:203], v[172:175]
    v_mfma_f32_16x16x32_bf16 v[176:179], a[208:211], v[200:203], v[176:179]
    buffer_store_dwordx4 v[224:227], v9, s[4:7], s26 offen offset:2048 sc1
    v_mfma_f32_16x16x32_bf16 v[180:183], a[212:215], v[200:203], v[180:183]
    v_mfma_f32_16x16x32_bf16 v[184:187], a[216:219], v[200:203], v[184:187]
    v_cvt_pk_bf16_f32 v228, v131, v135
    v_mfma_f32_16x16x32_bf16 v[188:191], a[220:223], v[200:203], v[188:191]
    s_waitcnt lgkmcnt(0)
    v_mfma_f32_16x16x32_bf16 v[160:163], a[224:227], v[204:207], v[160:163]
    v_cvt_pk_bf16_f32 v229, v139, v143
    v_mfma_f32_16x16x32_bf16 v[164:167], a[228:231], v[204:207], v[164:167]
    v_mfma_f32_16x16x32_bf16 v[168:171], a[232:235], v[204:207], v[168:171]
    v_cvt_pk_bf16_f32 v230, v147, v151
    v_mfma_f32_16x16x32_bf16 v[172:175], a[236:239], v[204:207], v[172:175]
    v_mfma_f32_16x16x32_bf16 v[176:179], a[240:243], v[204:207], v[176:179]
    v_cvt_pk_bf16_f32 v231, v155, v159
    v_mfma_f32_16x16x32_bf16 v[180:183], a[244:247], v[204:207], v[180:183]
    v_mfma_f32_16x16x32_bf16 v[184:187], a[248:251], v[204:207], v[184:187]
    buffer_store_dwordx4 v[228:231], v9, s[4:7], s26 offen offset:3072 sc1
    v_mfma_f32_16x16x32_bf16 v[188:191], a[252:255], v[204:207], v[188:191]
    s_branch RAW_T6
RAW_T1:
    s_min_u32 s25, s18, 63
    s_lshl_b32 s24, s25, 4
    s_add_u32 s24, s24, s41
    s_lshl_b32 s24, s24, 6
    s_add_u32 s24, s24, 0
    buffer_load_dword v3, v2, s[4:7], s24 offen sc1
    s_min_u32 s25, s19, 63
    s_lshl_b32 s24, s25, 4
    s_add_u32 s24, s24, s41
    s_lshl_b32 s24, s24, 6
    s_add_u32 s24, s24, 65536
    buffer_load_dword v4, v2, s[4:7], s24 offen sc1
    ds_read_b128 v[192:195], v8 offset:0
    ds_read_b128 v[196:199], v8 offset:1024
    ds_read_b128 v[200:203], v8 offset:2048
    s_waitcnt lgkmcnt(2)
    v_mfma_f32_16x16x32_bf16 v[128:131], a[0:3], v[192:195], 0
    v_mfma_f32_16x16x32_bf16 v[132:135], a[4:7], v[192:195], 0
    ds_read_b128 v[204:207], v8 offset:3072
    v_mfma_f32_16x16x32_bf16 v[136:139], a[8:11], v[192:195], 0
    v_mfma_f32_16x16x32_bf16 v[140:143], a[12:15], v[192:195], 0
    v_mfma_f32_16x16x32_bf16 v[144:147], a[16:19], v[192:195], 0
    v_mfma_f32_16x16x32_bf16 v[148:151], a[20:23], v[192:195], 0
    v_mfma_f32_16x16x32_bf16 v[152:155], a[24:27], v[192:195], 0
    v_mfma_f32_16x16x32_bf16 v[156:159], a[28:31], v[192:195], 0
    s_waitcnt lgkmcnt(2)
    v_mfma_f32_16x16x32_bf16 v[128:131], a[32:35], v[196:199], v[128:131]
    v_mfma_f32_16x16x32_bf16 v[132:135], a[36:39], v[196:199], v[132:135]
    ds_read_b128 v[192:195], v8 offset:4096
    v_mfma_f32_16x16x32_bf16 v[136:139], a[40:43], v[196:199], v[136:139]
    v_mfma_f32_16x16x32_bf16 v[140:143], a[44:47], v[196:199], v[140:143]
    v_mfma_f32_16x16x32_bf16 v[144:147], a[48:51], v[196:199], v[144:147]
    v_mfma_f32_16x16x32_bf16 v[148:151], a[52:55], v[196:199], v[148:151]
    v_mfma_f32_16x16x32_bf16 v[152:155], a[56:59], v[196:199], v[152:155]
    v_mfma_f32_16x16x32_bf16 v[156:159], a[60:63], v[196:199], v[156:159]
    s_waitcnt lgkmcnt(2)
    v_mfma_f32_16x16x32_bf16 v[128:131], a[64:67], v[200:203], v[128:131]
    v_mfma_f32_16x16x32_bf16 v[132:135], a[68:71], v[200:203], v[132:135]
    ds_read_b128 v[196:199], v8 offset:5120
    v_mfma_f32_16x16x32_bf16 v[136:139], a[72:75], v[200:203], v[136:139]
    v_mfma_f32_16x16x32_bf16 v[140:143], a[76:79], v[200:203], v[140:143]
    v_mfma_f32_16x16x32_bf16 v[144:147], a[80:83], v[200:203], v[144:147]
    v_mfma_f32_16x16x32_bf16 v[148:151], a[84:87], v[200:203], v[148:151]
    v_mfma_f32_16x16x32_bf16 v[152:155], a[88:91], v[200:203], v[152:155]
    v_mfma_f32_16x16x32_bf16 v[156:159], a[92:95], v[200:203], v[156:159]
    s_waitcnt lgkmcnt(2)
    v_mfma_f32_16x16x32_bf16 v[128:131], a[96:99], v[204:207], v[128:131]
    v_mfma_f32_16x16x32_bf16 v[132:135], a[100:103], v[204:207], v[132:135]
    ds_read_b128 v[200:203], v8 offset:6144
    v_mfma_f32_16x16x32_bf16 v[136:139], a[104:107], v[204:207], v[136:139]
    v_mfma_f32_16x16x32_bf16 v[140:143], a[108:111], v[204:207], v[140:143]
    v_mfma_f32_16x16x32_bf16 v[144:147], a[112:115], v[204:207], v[144:147]
    v_mfma_f32_16x16x32_bf16 v[148:151], a[116:119], v[204:207], v[148:151]
    v_mfma_f32_16x16x32_bf16 v[152:155], a[120:123], v[204:207], v[152:155]
    v_mfma_f32_16x16x32_bf16 v[156:159], a[124:127], v[204:207], v[156:159]
    s_waitcnt lgkmcnt(2)
    v_mfma_f32_16x16x32_bf16 v[128:131], a[128:131], v[192:195], v[128:131]
    v_mfma_f32_16x16x32_bf16 v[132:135], a[132:135], v[192:195], v[132:135]
    ds_read_b128 v[204:207], v8 offset:7168
    v_mfma_f32_16x16x32_bf16 v[136:139], a[136:139], v[192:195], v[136:139]
    v_mfma_f32_16x16x32_bf16 v[140:143], a[140:143], v[192:195], v[140:143]
    v_mfma_f32_16x16x32_bf16 v[144:147], a[144:147], v[192:195], v[144:147]
    v_mfma_f32_16x16x32_bf16 v[148:151], a[148:151], v[192:195], v[148:151]
    v_mfma_f32_16x16x32_bf16 v[152:155], a[152:155], v[192:195], v[152:155]
    v_mfma_f32_16x16x32_bf16 v[156:159], a[156:159], v[192:195], v[156:159]
    s_waitcnt lgkmcnt(2)
    v_mfma_f32_16x16x32_bf16 v[128:131], a[160:163], v[196:199], v[128:131]
    v_mfma_f32_16x16x32_bf16 v[132:135], a[164:167], v[196:199], v[132:135]
    v_mfma_f32_16x16x32_bf16 v[136:139], a[168:171], v[196:199], v[136:139]
    v_mfma_f32_16x16x32_bf16 v[140:143], a[172:175], v[196:199], v[140:143]
    v_mfma_f32_16x16x32_bf16 v[144:147], a[176:179], v[196:199], v[144:147]
    v_mfma_f32_16x16x32_bf16 v[148:151], a[180:183], v[196:199], v[148:151]
    v_mfma_f32_16x16x32_bf16 v[152:155], a[184:187], v[196:199], v[152:155]
    v_mfma_f32_16x16x32_bf16 v[156:159], a[188:191], v[196:199], v[156:159]
    s_waitcnt lgkmcnt(1)
    v_mfma_f32_16x16x32_bf16 v[128:131], a[192:195], v[200:203], v[128:131]
    v_mfma_f32_16x16x32_bf16 v[132:135], a[196:199], v[200:203], v[132:135]
    v_mfma_f32_16x16x32_bf16 v[136:139], a[200:203], v[200:203], v[136:139]
    v_mfma_f32_16x16x32_bf16 v[140:143], a[204:207], v[200:203], v[140:143]
    v_mfma_f32_16x16x32_bf16 v[144:147], a[208:211], v[200:203], v[144:147]
    v_mfma_f32_16x16x32_bf16 v[148:151], a[212:215], v[200:203], v[148:151]
    v_mfma_f32_16x16x32_bf16 v[152:155], a[216:219], v[200:203], v[152:155]
    v_mfma_f32_16x16x32_bf16 v[156:159], a[220:223], v[200:203], v[156:159]
    s_waitcnt lgkmcnt(0)
    v_mfma_f32_16x16x32_bf16 v[128:131], a[224:227], v[204:207], v[128:131]
    v_mfma_f32_16x16x32_bf16 v[132:135], a[228:231], v[204:207], v[132:135]
    v_mfma_f32_16x16x32_bf16 v[136:139], a[232:235], v[204:207], v[136:139]
    v_mfma_f32_16x16x32_bf16 v[140:143], a[236:239], v[204:207], v[140:143]
    v_mfma_f32_16x16x32_bf16 v[144:147], a[240:243], v[204:207], v[144:147]
    v_mfma_f32_16x16x32_bf16 v[148:151], a[244:247], v[204:207], v[148:151]
    v_mfma_f32_16x16x32_bf16 v[152:155], a[248:251], v[204:207], v[152:155]
    v_mfma_f32_16x16x32_bf16 v[156:159], a[252:255], v[204:207], v[156:159]
    s_waitcnt vmcnt(0)
    s_cmp_lg_u32 s16, 0
    s_cbranch_scc1 Lw0_210
    v_readfirstlane_b32 s25, v3
    v_readfirstlane_b32 s26, v4
    s_mov_b32 s24, -1
    s_min_u32 s27, s18, s20
    s_cmp_lt_u32 s20, 30
    s_cselect_b32 s27, 64, s27
    s_cmp_lt_u32 s27, 64
    s_cbranch_scc1 Lsk_211
    s_cmp_ge_u32 s19, 64
    s_cbranch_scc1 Lsk_211
    s_cmp_lg_u32 s26, 515
    s_cbranch_scc1 Lsk_211
    s_add_u32 s24, s19, 64
Lsk_211:
    s_cmp_ge_u32 s18, 64
    s_cbranch_scc1 Lsk_212
    s_cmp_lg_u32 s25, 515
    s_cbranch_scc1 Lsk_212
    s_add_u32 s24, s18, 0
Lsk_212:
    v_mov_b32 v5, s24
    v_mov_b32 v6, 163776
    ds_write_b32 v6, v5 offset:4
Lw0_210:
    s_waitcnt lgkmcnt(0)
    s_barrier
    v_mov_b32 v6, 163776
    ds_read_b32 v5, v6 offset:4
    s_waitcnt lgkmcnt(0)
    v_readfirstlane_b32 s21, v5
    s_cmp_eq_u32 s21, -1
    s_cbranch_scc1 RAW_T4
    s_cmp_ge_u32 s21, 64
    s_cbranch_scc1 Lad_213
    s_bitset0_b64 s[84:85], s18
    s_ff1_i32_b64 s18, s[84:85]
    s_min_u32 s18, s18, 64
    s_branch Lad_214
Lad_213:
    s_bitset0_b64 s[88:89], s19
    s_ff1_i32_b64 s19, s[88:89]
    s_min_u32 s19, s19, 64
Lad_214:
    s_cmp_eq_u32 s22, -1
    s_cbranch_scc1 Lms_215
    s_cmp_lg_u32 s16, 0
    s_cbranch_scc1 Lsg_216
    s_lshl_b32 s24, s22, 8
    s_add_u32 s24, s24, 131136
    v_mov_b32 v5, 1
    s_mov_b64 s[38:39], exec
    s_mov_b64 exec, 1
    buffer_atomic_add v5, v2, s[4:7], s24 offen
    s_mov_b64 exec, s[38:39]
Lsg_216:
    s_mov_b32 s22, -1
Lms_215:
    s_min_u32 s25, s18, 63
    s_lshl_b32 s24, s25, 4
    s_add_u32 s24, s24, s41
    s_lshl_b32 s24, s24, 6
    s_add_u32 s24, s24, 0
    buffer_load_dword v3, v2, s[4:7], s24 offen sc1
    s_min_u32 s25, s19, 63
    s_lshl_b32 s24, s25, 4
    s_add_u32 s24, s24, s41
    s_lshl_b32 s24, s24, 6
    s_add_u32 s24, s24, 65536
    buffer_load_dword v4, v2, s[4:7], s24 offen sc1
    s_mul_i32 s92, s21, 786432
    s_lshl_b32 s93, s48, 13
    s_add_u32 s92, s92, s93
    s_add_u32 s92, s92, 35651584
    s_lshl_b32 s93, s47, 12
    s_add_u32 s93, s93, s92
    s_lshl_b32 s94, s21, 5
    s_add_u32 s94, s94, s48
    s_lshl_b32 s94, s94, 12
    s_add_u32 s94, s94, 18874368
    s_mul_i32 s26, s20, 524288
    s_add_u32 s26, s26, s33
    s_add_u32 s27, s26, 16384
    ds_read_b128 v[192:195], v8 offset:8192
    ds_read_b128 v[196:199], v8 offset:9216
    ds_read_b128 v[200:203], v8 offset:10240
    s_waitcnt lgkmcnt(2)
    v_mfma_f32_16x16x32_bf16 v[160:163], a[0:3], v[192:195], 0
    v_mfma_f32_16x16x32_bf16 v[164:167], a[4:7], v[192:195], 0
    ds_read_b128 v[204:207], v8 offset:11264
    v_mfma_f32_16x16x32_bf16 v[168:171], a[8:11], v[192:195], 0
    buffer_load_dwordx4 v[16:19], v9, s[4:7], s93 offen offset:0 sc1
    v_mfma_f32_16x16x32_bf16 v[172:175], a[12:15], v[192:195], 0
    buffer_load_dwordx4 v[20:23], v9, s[4:7], s93 offen offset:1024 sc1
    v_mfma_f32_16x16x32_bf16 v[176:179], a[16:19], v[192:195], 0
    buffer_load_dwordx4 v[24:27], v9, s[4:7], s93 offen offset:2048 sc1
    v_mfma_f32_16x16x32_bf16 v[180:183], a[20:23], v[192:195], 0
    buffer_load_dwordx4 v[28:31], v9, s[4:7], s93 offen offset:3072 sc1
    v_mfma_f32_16x16x32_bf16 v[184:187], a[24:27], v[192:195], 0
    v_mfma_f32_16x16x32_bf16 v[188:191], a[28:31], v[192:195], 0
    s_add_u32 s92, s92, 262144
    buffer_load_dwordx4 v[32:35], v9, s[4:7], s92 offen offset:0 sc1
    s_waitcnt lgkmcnt(2)
    v_mfma_f32_16x16x32_bf16 v[160:163], a[32:35], v[196:199], v[160:163]
    buffer_load_dwordx4 v[36:39], v9, s[4:7], s92 offen offset:1024 sc1
    v_mfma_f32_16x16x32_bf16 v[164:167], a[36:39], v[196:199], v[164:167]
    ds_read_b128 v[192:195], v8 offset:12288
    buffer_load_dwordx4 v[40:43], v9, s[4:7], s92 offen offset:2048 sc1
    v_mfma_f32_16x16x32_bf16 v[168:171], a[40:43], v[196:199], v[168:171]
    v_mfma_f32_16x16x32_bf16 v[172:175], a[44:47], v[196:199], v[172:175]
    buffer_load_dwordx4 v[44:47], v9, s[4:7], s92 offen offset:3072 sc1
    v_mfma_f32_16x16x32_bf16 v[176:179], a[48:51], v[196:199], v[176:179]
    s_add_u32 s92, s92, 4096
    buffer_load_dwordx4 v[48:51], v9, s[4:7], s92 offen offset:0 sc1
    v_mfma_f32_16x16x32_bf16 v[180:183], a[52:55], v[196:199], v[180:183]
    buffer_load_dwordx4 v[52:55], v9, s[4:7], s92 offen offset:1024 sc1
    v_mfma_f32_16x16x32_bf16 v[184:187], a[56:59], v[196:199], v[184:187]
    buffer_load_dwordx4 v[56:59], v9, s[4:7], s92 offen offset:2048 sc1
    v_mfma_f32_16x16x32_bf16 v[188:191], a[60:63], v[196:199], v[188:191]
    s_waitcnt lgkmcnt(2)
    v_mfma_f32_16x16x32_bf16 v[160:163], a[64:67], v[200:203], v[160:163]
    buffer_load_dwordx4 v[60:63], v9, s[4:7], s92 offen offset:3072 sc1
    v_mfma_f32_16x16x32_bf16 v[164:167], a[68:71], v[200:203], v[164:167]
    ds_read_b128 v[196:199], v8 offset:13312
    buffer_load_dwordx4 v[96:99], v10, s[4:7], s94 offen offset:0 sc1
    v_mfma_f32_16x16x32_bf16 v[168:171], a[72:75], v[200:203], v[168:171]
    buffer_load_dwordx4 v[100:103], v10, s[4:7], s94 offen offset:512 sc1
    v_mfma_f32_16x16x32_bf16 v[172:175], a[76:79], v[200:203], v[172:175]
    v_mfma_f32_16x16x32_bf16 v[176:179], a[80:83], v[200:203], v[176:179]
    buffer_load_dwordx4 v[104:107], v10, s[4:7], s94 offen offset:1024 sc1
    v_mfma_f32_16x16x32_bf16 v[180:183], a[84:87], v[200:203], v[180:183]
    buffer_load_dwordx4 v[108:111], v10, s[4:7], s94 offen offset:1536 sc1
    v_mfma_f32_16x16x32_bf16 v[184:187], a[88:91], v[200:203], v[184:187]
    s_add_u32 s92, s92, 258048
    buffer_load_dwordx4 v[64:67], v9, s[4:7], s92 offen offset:0 sc1
    v_mfma_f32_16x16x32_bf16 v[188:191], a[92:95], v[200:203], v[188:191]
    buffer_load_dwordx4 v[68:71], v9, s[4:7], s92 offen offset:1024 sc1
    s_waitcnt lgkmcnt(2)
    v_mfma_f32_16x16x32_bf16 v[160:163], a[96:99], v[204:207], v[160:163]
    v_mfma_f32_16x16x32_bf16 v[164:167], a[100:103], v[204:207], v[164:167]
    ds_read_b128 v[200:203], v8 offset:14336
    buffer_load_dwordx4 v[72:75], v9, s[4:7], s92 offen offset:2048 sc1
    v_mfma_f32_16x16x32_bf16 v[168:171], a[104:107], v[204:207], v[168:171]
    buffer_load_dwordx4 v[76:79], v9, s[4:7], s92 offen offset:3072 sc1
    v_mfma_f32_16x16x32_bf16 v[172:175], a[108:111], v[204:207], v[172:175]
    s_add_u32 s92, s92, 4096
    buffer_load_dwordx4 v[80:83], v9, s[4:7], s92 offen offset:0 sc1
    v_mfma_f32_16x16x32_bf16 v[176:179], a[112:115], v[204:207], v[176:179]
    v_mfma_f32_16x16x32_bf16 v[180:183], a[116:119], v[204:207], v[180:183]
    buffer_load_dwordx4 v[84:87], v9, s[4:7], s92 offen offset:1024 sc1
    v_mfma_f32_16x16x32_bf16 v[184:187], a[120:123], v[204:207], v[184:187]
    buffer_load_dwordx4 v[88:91], v9, s[4:7], s92 offen offset:2048 sc1
    v_mfma_f32_16x16x32_bf16 v[188:191], a[124:127], v[204:207], v[188:191]
    buffer_load_dwordx4 v[92:95], v9, s[4:7], s92 offen offset:3072 sc1
    s_waitcnt lgkmcnt(2)
    v_mfma_f32_16x16x32_bf16 v[160:163], a[128:131], v[192:195], v[160:163]
    v_mfma_f32_16x16x32_bf16 v[164:167], a[132:135], v[192:195], v[164:167]
    ds_read_b128 v[204:207], v8 offset:15360
    buffer_load_dwordx2 v[112:113], v11, s[4:7], s94 offen offset:2048 sc1
    v_mfma_f32_16x16x32_bf16 v[168:171], a[136:139], v[192:195], v[168:171]
    buffer_load_dwordx2 v[114:115], v11, s[4:7], s94 offen offset:2560 sc1
    v_mfma_f32_16x16x32_bf16 v[172:175], a[140:143], v[192:195], v[172:175]
    buffer_load_dwordx2 v[116:117], v11, s[4:7], s94 offen offset:3072 sc1
    v_mfma_f32_16x16x32_bf16 v[176:179], a[144:147], v[192:195], v[176:179]
    buffer_load_dwordx2 v[118:119], v11, s[4:7], s94 offen offset:3584 sc1
    v_mfma_f32_16x16x32_bf16 v[180:183], a[148:151], v[192:195], v[180:183]
    v_mfma_f32_16x16x32_bf16 v[184:187], a[152:155], v[192:195], v[184:187]
    v_cvt_pk_bf16_f32 v216, v128, v132
    v_mfma_f32_16x16x32_bf16 v[188:191], a[156:159], v[192:195], v[188:191]
    v_cvt_pk_bf16_f32 v217, v136, v140
    s_waitcnt lgkmcnt(2)
    v_mfma_f32_16x16x32_bf16 v[160:163], a[160:163], v[196:199], v[160:163]
    v_cvt_pk_bf16_f32 v218, v144, v148
    v_mfma_f32_16x16x32_bf16 v[164:167], a[164:167], v[196:199], v[164:167]
    v_mfma_f32_16x16x32_bf16 v[168:171], a[168:171], v[196:199], v[168:171]
    v_cvt_pk_bf16_f32 v219, v152, v156
    v_mfma_f32_16x16x32_bf16 v[172:175], a[172:175], v[196:199], v[172:175]
    buffer_store_dwordx4 v[216:219], v9, s[4:7], s26 offen offset:0 sc1
    v_mfma_f32_16x16x32_bf16 v[176:179], a[176:179], v[196:199], v[176:179]
    v_cvt_pk_bf16_f32 v220, v129, v133
    v_mfma_f32_16x16x32_bf16 v[180:183], a[180:183], v[196:199], v[180:183]
    v_cvt_pk_bf16_f32 v221, v137, v141
    v_mfma_f32_16x16x32_bf16 v[184:187], a[184:187], v[196:199], v[184:187]
    v_mfma_f32_16x16x32_bf16 v[188:191], a[188:191], v[196:199], v[188:191]
    v_cvt_pk_bf16_f32 v222, v145, v149
    s_waitcnt lgkmcnt(1)
    v_mfma_f32_16x16x32_bf16 v[160:163], a[192:195], v[200:203], v[160:163]
    v_cvt_pk_bf16_f32 v223, v153, v157
    v_mfma_f32_16x16x32_bf16 v[164:167], a[196:199], v[200:203], v[164:167]
    buffer_store_dwordx4 v[220:223], v9, s[4:7], s26 offen offset:1024 sc1
    v_mfma_f32_16x16x32_bf16 v[168:171], a[200:203], v[200:203], v[168:171]
    v_mfma_f32_16x16x32_bf16 v[172:175], a[204:207], v[200:203], v[172:175]
    v_cvt_pk_bf16_f32 v224, v130, v134
    v_mfma_f32_16x16x32_bf16 v[176:179], a[208:211], v[200:203], v[176:179]
    v_cvt_pk_bf16_f32 v225, v138, v142
    v_mfma_f32_16x16x32_bf16 v[180:183], a[212:215], v[200:203], v[180:183]
    v_cvt_pk_bf16_f32 v226, v146, v150
    v_mfma_f32_16x16x32_bf16 v[184:187], a[216:219], v[200:203], v[184:187]
    v_cvt_pk_bf16_f32 v227, v154, v158
    v_mfma_f32_16x16x32_bf16 v[188:191], a[220:223], v[200:203], v[188:191]
    s_waitcnt lgkmcnt(0)
    v_mfma_f32_16x16x32_bf16 v[160:163], a[224:227], v[204:207], v[160:163]
    buffer_store_dwordx4 v[224:227], v9, s[4:7], s26 offen offset:2048 sc1
    v_mfma_f32_16x16x32_bf16 v[164:167], a[228:231], v[204:207], v[164:167]
    v_cvt_pk_bf16_f32 v228, v131, v135
    v_mfma_f32_16x16x32_bf16 v[168:171], a[232:235], v[204:207], v[168:171]
    v_cvt_pk_bf16_f32 v229, v139, v143
    v_mfma_f32_16x16x32_bf16 v[172:175], a[236:239], v[204:207], v[172:175]
    v_mfma_f32_16x16x32_bf16 v[176:179], a[240:243], v[204:207], v[176:179]
    v_cvt_pk_bf16_f32 v230, v147, v151
    v_mfma_f32_16x16x32_bf16 v[180:183], a[244:247], v[204:207], v[180:183]
    v_cvt_pk_bf16_f32 v231, v155, v159
    v_mfma_f32_16x16x32_bf16 v[184:187], a[248:251], v[204:207], v[184:187]
    buffer_store_dwordx4 v[228:231], v9, s[4:7], s26 offen offset:3072 sc1
    v_mfma_f32_16x16x32_bf16 v[188:191], a[252:255], v[204:207], v[188:191]
    s_branch RAW_T6
RAW_T4:
    s_cmp_eq_u32 s22, -1
    s_cbranch_scc1 Lms_217
    s_cmp_lg_u32 s16, 0
    s_cbranch_scc1 Lsg_218
    s_lshl_b32 s24, s22, 8
    s_add_u32 s24, s24, 131136
    v_mov_b32 v5, 1
    s_mov_b64 s[38:39], exec
    s_mov_b64 exec, 1
    buffer_atomic_add v5, v2, s[4:7], s24 offen
    s_mov_b64 exec, s[38:39]
Lsg_218:
    s_mov_b32 s22, -1
Lms_217:
    s_min_u32 s25, s18, 63
    s_lshl_b32 s24, s25, 4
    s_add_u32 s24, s24, s41
    s_lshl_b32 s24, s24, 6
    s_add_u32 s24, s24, 0
    buffer_load_dword v3, v2, s[4:7], s24 offen sc1
    s_min_u32 s25, s19, 63
    s_lshl_b32 s24, s25, 4
    s_add_u32 s24, s24, s41
    s_lshl_b32 s24, s24, 6
    s_add_u32 s24, s24, 65536
    buffer_load_dword v4, v2, s[4:7], s24 offen sc1
    s_mul_i32 s26, s20, 524288
    s_add_u32 s26, s26, s33
    s_add_u32 s27, s26, 16384
    ds_read_b128 v[192:195], v8 offset:8192
    ds_read_b128 v[196:199], v8 offset:9216
    ds_read_b128 v[200:203], v8 offset:10240
    s_waitcnt lgkmcnt(2)
    v_mfma_f32_16x16x32_bf16 v[160:163], a[0:3], v[192:195], 0
    v_mfma_f32_16x16x32_bf16 v[164:167], a[4:7], v[192:195], 0
    ds_read_b128 v[204:207], v8 offset:11264
    v_mfma_f32_16x16x32_bf16 v[168:171], a[8:11], v[192:195], 0
    v_cvt_pk_bf16_f32 v216, v128, v132
    v_mfma_f32_16x16x32_bf16 v[172:175], a[12:15], v[192:195], 0
    v_mfma_f32_16x16x32_bf16 v[176:179], a[16:19], v[192:195], 0
    v_mfma_f32_16x16x32_bf16 v[180:183], a[20:23], v[192:195], 0
    v_cvt_pk_bf16_f32 v217, v136, v140
    v_mfma_f32_16x16x32_bf16 v[184:187], a[24:27], v[192:195], 0
    v_mfma_f32_16x16x32_bf16 v[188:191], a[28:31], v[192:195], 0
    s_waitcnt lgkmcnt(2)
    v_mfma_f32_16x16x32_bf16 v[160:163], a[32:35], v[196:199], v[160:163]
    v_cvt_pk_bf16_f32 v218, v144, v148
    v_mfma_f32_16x16x32_bf16 v[164:167], a[36:39], v[196:199], v[164:167]
    ds_read_b128 v[192:195], v8 offset:12288
    v_mfma_f32_16x16x32_bf16 v[168:171], a[40:43], v[196:199], v[168:171]
    v_mfma_f32_16x16x32_bf16 v[172:175], a[44:47], v[196:199], v[172:175]
    v_cvt_pk_bf16_f32 v219, v152, v156
    v_mfma_f32_16x16x32_bf16 v[176:179], a[48:51], v[196:199], v[176:179]
    v_mfma_f32_16x16x32_bf16 v[180:183], a[52:55], v[196:199], v[180:183]
    v_mfma_f32_16x16x32_bf16 v[184:187], a[56:59], v[196:199], v[184:187]
    buffer_store_dwordx4 v[216:219], v9, s[4:7], s26 offen offset:0 sc1
    v_mfma_f32_16x16x32_bf16 v[188:191], a[60:63], v[196:199], v[188:191]
    s_waitcnt lgkmcnt(2)
    v_mfma_f32_16x16x32_bf16 v[160:163], a[64:67], v[200:203], v[160:163]
    v_mfma_f32_16x16x32_bf16 v[164:167], a[68:71], v[200:203], v[164:167]
    ds_read_b128 v[196:199], v8 offset:13312
    v_cvt_pk_bf16_f32 v220, v129, v133
    v_mfma_f32_16x16x32_bf16 v[168:171], a[72:75], v[200:203], v[168:171]
    v_mfma_f32_16x16x32_bf16 v[172:175], a[76:79], v[200:203], v[172:175]
    v_mfma_f32_16x16x32_bf16 v[176:179], a[80:83], v[200:203], v[176:179]
    v_cvt_pk_bf16_f32 v221, v137, v141
    v_mfma_f32_16x16x32_bf16 v[180:183], a[84:87], v[200:203], v[180:183]
    v_mfma_f32_16x16x32_bf16 v[184:187], a[88:91], v[200:203], v[184:187]
    v_mfma_f32_16x16x32_bf16 v[188:191], a[92:95], v[200:203], v[188:191]
    v_cvt_pk_bf16_f32 v222, v145, v149
    s_waitcnt lgkmcnt(2)
    v_mfma_f32_16x16x32_bf16 v[160:163], a[96:99], v[204:207], v[160:163]
    v_mfma_f32_16x16x32_bf16 v[164:167], a[100:103], v[204:207], v[164:167]
    ds_read_b128 v[200:203], v8 offset:14336
    v_mfma_f32_16x16x32_bf16 v[168:171], a[104:107], v[204:207], v[168:171]
    v_cvt_pk_bf16_f32 v223, v153, v157
    v_mfma_f32_16x16x32_bf16 v[172:175], a[108:111], v[204:207], v[172:175]
    v_mfma_f32_16x16x32_bf16 v[176:179], a[112:115], v[204:207], v[176:179]
    v_mfma_f32_16x16x32_bf16 v[180:183], a[116:119], v[204:207], v[180:183]
    buffer_store_dwordx4 v[220:223], v9, s[4:7], s26 offen offset:1024 sc1
    v_mfma_f32_16x16x32_bf16 v[184:187], a[120:123], v[204:207], v[184:187]
    v_mfma_f32_16x16x32_bf16 v[188:191], a[124:127], v[204:207], v[188:191]
    s_waitcnt lgkmcnt(2)
    v_mfma_f32_16x16x32_bf16 v[160:163], a[128:131], v[192:195], v[160:163]
    v_mfma_f32_16x16x32_bf16 v[164:167], a[132:135], v[192:195], v[164:167]
    ds_read_b128 v[204:207], v8 offset:15360
    v_cvt_pk_bf16_f32 v224, v130, v134
    v_mfma_f32_16x16x32_bf16 v[168:171], a[136:139], v[192:195], v[168:171]
    v_mfma_f32_16x16x32_bf16 v[172:175], a[140:143], v[192:195], v[172:175]
    v_mfma_f32_16x16x32_bf16 v[176:179], a[144:147], v[192:195], v[176:179]
    v_cvt_pk_bf16_f32 v225, v138, v142
    v_mfma_f32_16x16x32_bf16 v[180:183], a[148:151], v[192:195], v[180:183]
    v_mfma_f32_16x16x32_bf16 v[184:187], a[152:155], v[192:195], v[184:187]
    v_mfma_f32_16x16x32_bf16 v[188:191], a[156:159], v[192:195], v[188:191]
    v_cvt_pk_bf16_f32 v226, v146, v150
    s_waitcnt lgkmcnt(2)
    v_mfma_f32_16x16x32_bf16 v[160:163], a[160:163], v[196:199], v[160:163]
    v_mfma_f32_16x16x32_bf16 v[164:167], a[164:167], v[196:199], v[164:167]
    v_mfma_f32_16x16x32_bf16 v[168:171], a[168:171], v[196:199], v[168:171]
    v_cvt_pk_bf16_f32 v227, v154, v158
    v_mfma_f32_16x16x32_bf16 v[172:175], a[172:175], v[196:199], v[172:175]
    v_mfma_f32_16x16x32_bf16 v[176:179], a[176:179], v[196:199], v[176:179]
    v_mfma_f32_16x16x32_bf16 v[180:183], a[180:183], v[196:199], v[180:183]
    buffer_store_dwordx4 v[224:227], v9, s[4:7], s26 offen offset:2048 sc1
    v_mfma_f32_16x16x32_bf16 v[184:187], a[184:187], v[196:199], v[184:187]
    v_mfma_f32_16x16x32_bf16 v[188:191], a[188:191], v[196:199], v[188:191]
    s_waitcnt lgkmcnt(1)
    v_mfma_f32_16x16x32_bf16 v[160:163], a[192:195], v[200:203], v[160:163]
    v_cvt_pk_bf16_f32 v228, v131, v135
    v_mfma_f32_16x16x32_bf16 v[164:167], a[196:199], v[200:203], v[164:167]
    v_mfma_f32_16x16x32_bf16 v[168:171], a[200:203], v[200:203], v[168:171]
    v_mfma_f32_16x16x32_bf16 v[172:175], a[204:207], v[200:203], v[172:175]
    v_cvt_pk_bf16_f32 v229, v139, v143
    v_mfma_f32_16x16x32_bf16 v[176:179], a[208:211], v[200:203], v[176:179]
    v_mfma_f32_16x16x32_bf16 v[180:183], a[212:215], v[200:203], v[180:183]
    v_mfma_f32_16x16x32_bf16 v[184:187], a[216:219], v[200:203], v[184:187]
    v_cvt_pk_bf16_f32 v230, v147, v151
    v_mfma_f32_16x16x32_bf16 v[188:191], a[220:223], v[200:203], v[188:191]
    s_waitcnt lgkmcnt(0)
    v_mfma_f32_16x16x32_bf16 v[160:163], a[224:227], v[204:207], v[160:163]
    v_mfma_f32_16x16x32_bf16 v[164:167], a[228:231], v[204:207], v[164:167]
    v_cvt_pk_bf16_f32 v231, v155, v159
    v_mfma_f32_16x16x32_bf16 v[168:171], a[232:235], v[204:207], v[168:171]
    v_mfma_f32_16x16x32_bf16 v[172:175], a[236:239], v[204:207], v[172:175]
    v_mfma_f32_16x16x32_bf16 v[176:179], a[240:243], v[204:207], v[176:179]
    buffer_store_dwordx4 v[228:231], v9, s[4:7], s26 offen offset:3072 sc1
    v_mfma_f32_16x16x32_bf16 v[180:183], a[244:247], v[204:207], v[180:183]
    v_mfma_f32_16x16x32_bf16 v[184:187], a[248:251], v[204:207], v[184:187]
    v_mfma_f32_16x16x32_bf16 v[188:191], a[252:255], v[204:207], v[188:191]
RAW_T6:
    v_cvt_pk_bf16_f32 v232, v160, v164
    s_nop 1
    v_cvt_pk_bf16_f32 v233, v168, v172
    s_nop 1
    v_cvt_pk_bf16_f32 v234, v176, v180
    s_nop 0
    v_cvt_pk_bf16_f32 v235, v184, v188
    buffer_store_dwordx4 v[232:235], v9, s[4:7], s27 offen offset:0 sc1
    v_cvt_pk_bf16_f32 v236, v161, v165
    v_cvt_pk_bf16_f32 v237, v169, v173
    v_cvt_pk_bf16_f32 v238, v177, v181
    v_cvt_pk_bf16_f32 v239, v185, v189
    buffer_store_dwordx4 v[236:239], v9, s[4:7], s27 offen offset:1024 sc1
    v_cvt_pk_bf16_f32 v240, v162, v166
    v_cvt_pk_bf16_f32 v241, v170, v174
    v_cvt_pk_bf16_f32 v242, v178, v182
    v_cvt_pk_bf16_f32 v243, v186, v190
    buffer_store_dwordx4 v[240:243], v9, s[4:7], s27 offen offset:2048 sc1
    v_cvt_pk_bf16_f32 v244, v163, v167
    v_cvt_pk_bf16_f32 v245, v171, v175
    v_cvt_pk_bf16_f32 v246, v179, v183
    v_cvt_pk_bf16_f32 v247, v187, v191
    buffer_store_dwordx4 v[244:247], v9, s[4:7], s27 offen offset:3072 sc1
    s_mov_b32 s22, s20
    s_mov_b32 s20, s21
    s_waitcnt vmcnt(8)
    s_cmp_lg_u32 s21, -1
    s_nop 5
    s_cbranch_scc1 RAW_TOP
    s_cmp_lg_u32 s16, 0
    s_cbranch_scc1 Lw0_219
    v_readfirstlane_b32 s25, v3
    v_readfirstlane_b32 s26, v4
    s_mov_b32 s24, -1
    s_min_u32 s27, s18, s20
    s_cmp_lt_u32 s20, 30
    s_cselect_b32 s27, 64, s27
    s_cmp_lt_u32 s27, 64
    s_cbranch_scc1 Lsk_220
    s_cmp_ge_u32 s19, 64
    s_cbranch_scc1 Lsk_220
    s_cmp_lg_u32 s26, 515
    s_cbranch_scc1 Lsk_220
    s_add_u32 s24, s19, 64
Lsk_220:
    s_cmp_ge_u32 s18, 64
    s_cbranch_scc1 Lsk_221
    s_cmp_lg_u32 s25, 515
    s_cbranch_scc1 Lsk_221
    s_add_u32 s24, s18, 0
Lsk_221:
    v_mov_b32 v5, s24
    v_mov_b32 v6, 163776
    ds_write_b32 v6, v5 offset:8
Lw0_219:
    s_waitcnt lgkmcnt(0)
    s_barrier
    v_mov_b32 v6, 163776
    ds_read_b32 v5, v6 offset:8
    s_waitcnt lgkmcnt(0)
    v_readfirstlane_b32 s20, v5
    s_cmp_lg_u32 s20, -1
    s_cbranch_scc1 RAW_GO
    s_waitcnt vmcnt(0)
    s_barrier
    s_cmp_lg_u32 s16, 0
    s_cbranch_scc1 Lsg_222
    s_lshl_b32 s24, s22, 8
    s_add_u32 s24, s24, 131136
    v_mov_b32 v5, 1
    s_mov_b64 s[38:39], exec
    s_mov_b64 exec, 1
    buffer_atomic_add v5, v2, s[4:7], s24 offen
    s_mov_b64 exec, s[38:39]
Lsg_222:
    s_mov_b32 s22, -1
    s_branch RAW_B1
E_AW:
    s_endpgm
J_ENG:
    s_lshr_b32 s40, s44, 5
    s_and_b32 s41, s44, 31
    s_mov_b32 s45, 0x3e0293ee
    s_mov_b32 s44, s45
    s_cmp_eq_u32 s40, 0
    s_cbranch_scc1 EN_NOG
    v_and_b32 v6, 63, v0
    v_lshlrev_b32 v6, 2, v6
Ldw_223:
    buffer_load_dword v5, v6, s[12:15], 0 offen sc1
    s_waitcnt vmcnt(0)
    s_mov_b32 s24, 0
    v_readlane_b32 s25, v5, 8
    s_add_u32 s24, s24, s25
    v_readlane_b32 s25, v5, 24
    s_add_u32 s24, s24, s25
    v_readlane_b32 s25, v5, 40
    s_add_u32 s24, s24, s25
    v_readlane_b32 s25, v5, 56
    s_add_u32 s24, s24, s25
    s_cmp_ge_u32 s24, 96
    s_cbranch_scc1 Ldw_224
    s_sleep 4
    s_memrealtime s[36:37]
    s_waitcnt lgkmcnt(0)
    s_sub_u32 s36, s36, s28
    s_cmp_gt_u32 s36, 3000000
    s_cbranch_scc1 E_ENG
    s_branch Ldw_223
Ldw_224:
    s_and_b32 s24, s41, 15
    s_lshl_b32 s24, s24, 6
    v_mov_b32 v6, s24
Lgt_225:
    buffer_load_dword v5, v6, s[4:7], 0 offen offset:0 sc1
    s_waitcnt vmcnt(0)
    v_readfirstlane_b32 s24, v5
    s_cmp_ge_u32 s24, 256
    s_cbranch_scc1 Lgt_226
    s_sleep 24
    s_memrealtime s[36:37]
    s_waitcnt lgkmcnt(0)
    s_sub_u32 s36, s36, s28
    s_cmp_gt_u32 s36, 3000000
    s_cbranch_scc1 E_ENG
    s_branch Lgt_225
Lgt_226:
EN_NOG:
    v_lshrrev_b32 v5, 4, v1
    v_and_b32 v6, 15, v1
    v_lshrrev_b32 v7, 1, v5
    v_and_b32 v9, 1, v5
    v_lshlrev_b32 v10, 4, v7
    v_lshl_add_u32 v11, v9, 2, v10
    v_lshl_add_u32 v12, v9, 1, v10
    v_lshlrev_b32 v11, 13, v11
    v_lshlrev_b32 v12, 10, v12
    s_lshl_b32 s25, s41, 8
    s_and_b32 s26, s16, 1
    v_lshlrev_b32 v13, 3, v6
    s_lshr_b32 s27, s16, 1
    s_lshl_b32 s27, s27, 7
    s_lshl_b32 s26, s26, 2
    s_add_u32 s27, s27, s26
    s_add_u32 s27, s27, s25
    v_add3_u32 v14, v11, v13, s27
    s_lshl_b32 s27, s16, 8
    v_lshlrev_b32 v13, 4, v6
    v_add3_u32 v15, v12, v13, s27
    s_lshl_b32 s27, s16, 15
    v_lshlrev_b32 v6, 4, v1
    v_add_u32 v6, s27, v6
    s_mov_b32 s68, 0x3f803f80
    s_mov_b32 s69, 0x3f803f80
    s_lshl_b32 s24, s16, 18
    s_add_u32 s24, s24, s25
    v_add3_u32 v14, v11, v13, s24
    v_bfe_u32 v8, v1, 3, 1
    v_lshlrev_b32 v8, 16, v8
    v_lshl_add_u32 v8, v5, 8, v8
    v_and_b32 v9, 7, v1
    v_lshl_add_u32 v8, v9, 5, v8
    s_lshr_b32 s24, s16, 1
    s_lshl_b32 s24, s24, 12
    s_and_b32 s26, s16, 1
    s_lshl_b32 s26, s26, 10
    s_add_u32 s24, s24, s26
    v_add_u32 v8, s24, v8
    s_load_dwordx2 s[76:77], s[0:1], 24
    s_mov_b32 s78, 4194304
    s_mov_b32 s79, 0x00020000
    s_waitcnt lgkmcnt(0)
    s_load_dwordx2 s[80:81], s[0:1], 32
    s_mov_b32 s82, 4194304
    s_mov_b32 s83, 0x00020000
    s_waitcnt lgkmcnt(0)
    s_load_dwordx2 s[84:85], s[0:1], 16
    s_mov_b32 s86, 4194304
    s_mov_b32 s87, 0x00020000
    s_waitcnt lgkmcnt(0)
    s_load_dwordx2 s[8:9], s[0:1], 40
    s_mov_b32 s10, 4194304
    s_mov_b32 s11, 0x00020000
    s_waitcnt lgkmcnt(0)
    s_lshl_b32 s34, s41, 17
    s_mov_b32 s24, 0
    buffer_load_dwordx4 v[16:19], v14, s[76:79], s24 offen
    s_mov_b32 s24, 8192
    buffer_load_dwordx4 v[20:23], v14, s[76:79], s24 offen
    s_mov_b32 s24, 65536
    buffer_load_dwordx4 v[24:27], v14, s[76:79], s24 offen
    s_mov_b32 s24, 73728
    buffer_load_dwordx4 v[28:31], v14, s[76:79], s24 offen
    s_mov_b32 s24, 16384
    buffer_load_dwordx4 v[32:35], v14, s[76:79], s24 offen
    s_mov_b32 s24, 24576
    buffer_load_dwordx4 v[36:39], v14, s[76:79], s24 offen
    s_mov_b32 s24, 81920
    buffer_load_dwordx4 v[40:43], v14, s[76:79], s24 offen
    s_mov_b32 s24, 90112
    buffer_load_dwordx4 v[44:47], v14, s[76:79], s24 offen
    s_mov_b32 s24, 1048576
    buffer_load_dwordx4 v[48:51], v14, s[76:79], s24 offen
    s_mov_b32 s24, 1056768
    buffer_load_dwordx4 v[52:55], v14, s[76:79], s24 offen
    s_mov_b32 s24, 1114112
    buffer_load_dwordx4 v[56:59], v14, s[76:79], s24 offen
    s_mov_b32 s24, 1122304
    buffer_load_dwordx4 v[60:63], v14, s[76:79], s24 offen
    s_mov_b32 s24, 1064960
    buffer_load_dwordx4 v[64:67], v14, s[76:79], s24 offen
    s_mov_b32 s24, 1073152
    buffer_load_dwordx4 v[68:71], v14, s[76:79], s24 offen
    s_mov_b32 s24, 1130496
    buffer_load_dwordx4 v[72:75], v14, s[76:79], s24 offen
    s_mov_b32 s24, 1138688
    buffer_load_dwordx4 v[76:79], v14, s[76:79], s24 offen
    s_mov_b32 s24, 2097152
    buffer_load_dwordx4 v[80:83], v14, s[76:79], s24 offen
    s_mov_b32 s24, 2105344
    buffer_load_dwordx4 v[84:87], v14, s[76:79], s24 offen
    s_mov_b32 s24, 2162688
    buffer_load_dwordx4 v[88:91], v14, s[76:79], s24 offen
    s_mov_b32 s24, 2170880
    buffer_load_dwordx4 v[92:95], v14, s[76:79], s24 offen
    s_mov_b32 s24, 2113536
    buffer_load_dwordx4 v[96:99], v14, s[76:79], s24 offen
    s_mov_b32 s24, 2121728
    buffer_load_dwordx4 v[100:103], v14, s[76:79], s24 offen
    s_mov_b32 s24, 2179072
    buffer_load_dwordx4 v[104:107], v14, s[76:79], s24 offen
    s_mov_b32 s24, 2187264
    buffer_load_dwordx4 v[108:111], v14, s[76:79], s24 offen
    s_mov_b32 s24, 3145728
    buffer_load_dwordx4 v[112:115], v14, s[76:79], s24 offen
    s_mov_b32 s24, 3153920
    buffer_load_dwordx4 v[116:119], v14, s[76:79], s24 offen
    s_mov_b32 s24, 3211264
    buffer_load_dwordx4 v[120:123], v14, s[76:79], s24 offen
    s_mov_b32 s24, 3219456
    buffer_load_dwordx4 v[124:127], v14, s[76:79], s24 offen
    s_mov_b32 s24, 3162112
    buffer_load_dwordx4 v[128:131], v14, s[76:79], s24 offen
    s_mov_b32 s24, 3170304
    buffer_load_dwordx4 v[132:135], v14, s[76:79], s24 offen
    s_mov_b32 s24, 3227648
    buffer_load_dwordx4 v[136:139], v14, s[76:79], s24 offen
    s_mov_b32 s24, 3235840
    buffer_load_dwordx4 v[140:143], v14, s[76:79], s24 offen
    s_mov_b32 s24, 0
    buffer_load_dwordx4 v[144:147], v14, s[80:83], s24 offen
    s_mov_b32 s24, 8192
    buffer_load_dwordx4 v[148:151], v14, s[80:83], s24 offen
    s_mov_b32 s24, 65536
    buffer_load_dwordx4 v[152:155], v14, s[80:83], s24 offen
    s_mov_b32 s24, 73728
    buffer_load_dwordx4 v[156:159], v14, s[80:83], s24 offen
    s_mov_b32 s24, 16384
    buffer_load_dwordx4 v[160:163], v14, s[80:83], s24 offen
    s_mov_b32 s24, 24576
    buffer_load_dwordx4 v[164:167], v14, s[80:83], s24 offen
    s_mov_b32 s24, 81920
    buffer_load_dwordx4 v[168:171], v14, s[80:83], s24 offen
    s_mov_b32 s24, 90112
    buffer_load_dwordx4 v[172:175], v14, s[80:83], s24 offen
    s_mov_b32 s24, 1048576
    buffer_load_dwordx4 v[176:179], v14, s[80:83], s24 offen
    s_mov_b32 s24, 1056768
    buffer_load_dwordx4 v[180:183], v14, s[80:83], s24 offen
    s_mov_b32 s24, 1114112
    buffer_load_dwordx4 v[184:187], v14, s[80:83], s24 offen
    s_mov_b32 s24, 1122304
    buffer_load_dwordx4 v[188:191], v14, s[80:83], s24 offen
    s_mov_b32 s24, 1064960
    buffer_load_dwordx4 v[192:195], v14, s[80:83], s24 offen
    s_mov_b32 s24, 1073152
    buffer_load_dwordx4 v[196:199], v14, s[80:83], s24 offen
    s_mov_b32 s24, 1130496
    buffer_load_dwordx4 v[200:203], v14, s[80:83], s24 offen
    s_mov_b32 s24, 1138688
    buffer_load_dwordx4 v[204:207], v14, s[80:83], s24 offen
    s_mov_b32 s24, 2097152
    buffer_load_dwordx4 v[208:211], v14, s[80:83], s24 offen
    s_mov_b32 s24, 2105344
    buffer_load_dwordx4 v[212:215], v14, s[80:83], s24 offen
    s_mov_b32 s24, 2162688
    buffer_load_dwordx4 v[216:219], v14, s[80:83], s24 offen
    s_mov_b32 s24, 2170880
    buffer_load_dwordx4 v[220:223], v14, s[80:83], s24 offen
    s_mov_b32 s24, 2113536
    buffer_load_dwordx4 v[224:227], v14, s[80:83], s24 offen
    s_mov_b32 s24, 2121728
    buffer_load_dwordx4 v[228:231], v14, s[80:83], s24 offen
    s_mov_b32 s24, 2179072
    buffer_load_dwordx4 v[232:235], v14, s[80:83], s24 offen
    s_mov_b32 s24, 2187264
    buffer_load_dwordx4 v[236:239], v14, s[80:83], s24 offen
    s_waitcnt vmcnt(48)
    v_perm_b32 v240, v20, v16, s31
    v_perm_b32 v241, v28, v24, s31
    v_perm_b32 v242, v36, v32, s31
    v_perm_b32 v243, v44, v40, s31
    ds_write_b128 v8, v[240:243] offset:0
    v_perm_b32 v244, v20, v16, s32
    v_perm_b32 v245, v28, v24, s32
    v_perm_b32 v246, v36, v32, s32
    v_perm_b32 v247, v44, v40, s32
    ds_write_b128 v8, v[244:247] offset:2048
    v_perm_b32 v248, v21, v17, s31
    v_perm_b32 v249, v29, v25, s31
    v_perm_b32 v250, v37, v33, s31
    v_perm_b32 v251, v45, v41, s31
    ds_write_b128 v8, v[248:251] offset:32768
    v_perm_b32 v252, v21, v17, s32
    v_perm_b32 v253, v29, v25, s32
    v_perm_b32 v254, v37, v33, s32
    v_perm_b32 v255, v45, v41, s32
    ds_write_b128 v8, v[252:255] offset:34816
    v_perm_b32 v240, v22, v18, s31
    v_perm_b32 v241, v30, v26, s31
    v_perm_b32 v242, v38, v34, s31
    v_perm_b32 v243, v46, v42, s31
    ds_write_b128 v8, v[240:243] offset:16
    v_perm_b32 v244, v22, v18, s32
    v_perm_b32 v245, v30, v26, s32
    v_perm_b32 v246, v38, v34, s32
    v_perm_b32 v247, v46, v42, s32
    ds_write_b128 v8, v[244:247] offset:2064
    v_perm_b32 v248, v23, v19, s31
    v_perm_b32 v249, v31, v27, s31
    v_perm_b32 v250, v39, v35, s31
    v_perm_b32 v251, v47, v43, s31
    ds_write_b128 v8, v[248:251] offset:32784
    v_perm_b32 v252, v23, v19, s32
    v_perm_b32 v253, v31, v27, s32
    v_perm_b32 v254, v39, v35, s32
    v_perm_b32 v255, v47, v43, s32
    ds_write_b128 v8, v[252:255] offset:34832
    s_mov_b32 s24, 3145728
    buffer_load_dwordx4 v[16:19], v14, s[80:83], s24 offen
    s_mov_b32 s24, 3153920
    buffer_load_dwordx4 v[20:23], v14, s[80:83], s24 offen
    s_mov_b32 s24, 3211264
    buffer_load_dwordx4 v[24:27], v14, s[80:83], s24 offen
    s_mov_b32 s24, 3219456
    buffer_load_dwordx4 v[28:31], v14, s[80:83], s24 offen
    s_mov_b32 s24, 3162112
    buffer_load_dwordx4 v[32:35], v14, s[80:83], s24 offen
    s_mov_b32 s24, 3170304
    buffer_load_dwordx4 v[36:39], v14, s[80:83], s24 offen
    s_mov_b32 s24, 3227648
    buffer_load_dwordx4 v[40:43], v14, s[80:83], s24 offen
    s_mov_b32 s24, 3235840
    buffer_load_dwordx4 v[44:47], v14, s[80:83], s24 offen
    s_waitcnt vmcnt(48)
    v_perm_b32 v240, v52, v48, s31
    v_perm_b32 v241, v60, v56, s31
    v_perm_b32 v242, v68, v64, s31
    v_perm_b32 v243, v76, v72, s31
    ds_write_b128 v8, v[240:243] offset:8192
    v_perm_b32 v244, v52, v48, s32
    v_perm_b32 v245, v60, v56, s32
    v_perm_b32 v246, v68, v64, s32
    v_perm_b32 v247, v76, v72, s32
    ds_write_b128 v8, v[244:247] offset:10240
    v_perm_b32 v248, v53, v49, s31
    v_perm_b32 v249, v61, v57, s31
    v_perm_b32 v250, v69, v65, s31
    v_perm_b32 v251, v77, v73, s31
    ds_write_b128 v8, v[248:251] offset:40960
    v_perm_b32 v252, v53, v49, s32
    v_perm_b32 v253, v61, v57, s32
    v_perm_b32 v254, v69, v65, s32
    v_perm_b32 v255, v77, v73, s32
    ds_write_b128 v8, v[252:255] offset:43008
    v_perm_b32 v240, v54, v50, s31
    v_perm_b32 v241, v62, v58, s31
    v_perm_b32 v242, v70, v66, s31
    v_perm_b32 v243, v78, v74, s31
    ds_write_b128 v8, v[240:243] offset:8208
    v_perm_b32 v244, v54, v50, s32
    v_perm_b32 v245, v62, v58, s32
    v_perm_b32 v246, v70, v66, s32
    v_perm_b32 v247, v78, v74, s32
    ds_write_b128 v8, v[244:247] offset:10256
    v_perm_b32 v248, v55, v51, s31
    v_perm_b32 v249, v63, v59, s31
    v_perm_b32 v250, v71, v67, s31
    v_perm_b32 v251, v79, v75, s31
    ds_write_b128 v8, v[248:251] offset:40976
    v_perm_b32 v252, v55, v51, s32
    v_perm_b32 v253, v63, v59, s32
    v_perm_b32 v254, v71, v67, s32
    v_perm_b32 v255, v79, v75, s32
    ds_write_b128 v8, v[252:255] offset:43024
    s_mov_b32 s24, 0
    buffer_load_dwordx4 v[48:51], v14, s[84:87], s24 offen
    s_mov_b32 s24, 8192
    buffer_load_dwordx4 v[52:55], v14, s[84:87], s24 offen
    s_mov_b32 s24, 65536
    buffer_load_dwordx4 v[56:59], v14, s[84:87], s24 offen
    s_mov_b32 s24, 73728
    buffer_load_dwordx4 v[60:63], v14, s[84:87], s24 offen
    s_mov_b32 s24, 16384
    buffer_load_dwordx4 v[64:67], v14, s[84:87], s24 offen
    s_mov_b32 s24, 24576
    buffer_load_dwordx4 v[68:71], v14, s[84:87], s24 offen
    s_mov_b32 s24, 81920
    buffer_load_dwordx4 v[72:75], v14, s[84:87], s24 offen
    s_mov_b32 s24, 90112
    buffer_load_dwordx4 v[76:79], v14, s[84:87], s24 offen
    s_waitcnt vmcnt(48)
    v_perm_b32 v240, v84, v80, s31
    v_perm_b32 v241, v92, v88, s31
    v_perm_b32 v242, v100, v96, s31
    v_perm_b32 v243, v108, v104, s31
    ds_write_b128 v8, v[240:243] offset:16384
    v_perm_b32 v244, v84, v80, s32
    v_perm_b32 v245, v92, v88, s32
    v_perm_b32 v246, v100, v96, s32
    v_perm_b32 v247, v108, v104, s32
    ds_write_b128 v8, v[244:247] offset:18432
    v_perm_b32 v248, v85, v81, s31
    v_perm_b32 v249, v93, v89, s31
    v_perm_b32 v250, v101, v97, s31
    v_perm_b32 v251, v109, v105, s31
    ds_write_b128 v8, v[248:251] offset:49152
    v_perm_b32 v252, v85, v81, s32
    v_perm_b32 v253, v93, v89, s32
    v_perm_b32 v254, v101, v97, s32
    v_perm_b32 v255, v109, v105, s32
    ds_write_b128 v8, v[252:255] offset:51200
    v_perm_b32 v240, v86, v82, s31
    v_perm_b32 v241, v94, v90, s31
    v_perm_b32 v242, v102, v98, s31
    v_perm_b32 v243, v110, v106, s31
    ds_write_b128 v8, v[240:243] offset:16400
    v_perm_b32 v244, v86, v82, s32
    v_perm_b32 v245, v94, v90, s32
    v_perm_b32 v246, v102, v98, s32
    v_perm_b32 v247, v110, v106, s32
    ds_write_b128 v8, v[244:247] offset:18448
    v_perm_b32 v248, v87, v83, s31
    v_perm_b32 v249, v95, v91, s31
    v_perm_b32 v250, v103, v99, s31
    v_perm_b32 v251, v111, v107, s31
    ds_write_b128 v8, v[248:251] offset:49168
    v_perm_b32 v252, v87, v83, s32
    v_perm_b32 v253, v95, v91, s32
    v_perm_b32 v254, v103, v99, s32
    v_perm_b32 v255, v111, v107, s32
    ds_write_b128 v8, v[252:255] offset:51216
    s_mov_b32 s24, 1048576
    buffer_load_dwordx4 v[80:83], v14, s[84:87], s24 offen
    s_mov_b32 s24, 1056768
    buffer_load_dwordx4 v[84:87], v14, s[84:87], s24 offen
    s_mov_b32 s24, 1114112
    buffer_load_dwordx4 v[88:91], v14, s[84:87], s24 offen
    s_mov_b32 s24, 1122304
    buffer_load_dwordx4 v[92:95], v14, s[84:87], s24 offen
    s_mov_b32 s24, 1064960
    buffer_load_dwordx4 v[96:99], v14, s[84:87], s24 offen
    s_mov_b32 s24, 1073152
    buffer_load_dwordx4 v[100:103], v14, s[84:87], s24 offen
    s_mov_b32 s24, 1130496
    buffer_load_dwordx4 v[104:107], v14, s[84:87], s24 offen
    s_mov_b32 s24, 1138688
    buffer_load_dwordx4 v[108:111], v14, s[84:87], s24 offen
    s_waitcnt vmcnt(48)
    v_perm_b32 v240, v116, v112, s31
    v_perm_b32 v241, v124, v120, s31
    v_perm_b32 v242, v132, v128, s31
    v_perm_b32 v243, v140, v136, s31
    ds_write_b128 v8, v[240:243] offset:24576
    v_perm_b32 v244, v116, v112, s32
    v_perm_b32 v245, v124, v120, s32
    v_perm_b32 v246, v132, v128, s32
    v_perm_b32 v247, v140, v136, s32
    ds_write_b128 v8, v[244:247] offset:26624
    v_perm_b32 v248, v117, v113, s31
    v_perm_b32 v249, v125, v121, s31
    v_perm_b32 v250, v133, v129, s31
    v_perm_b32 v251, v141, v137, s31
    ds_write_b128 v8, v[248:251] offset:57344
    v_perm_b32 v252, v117, v113, s32
    v_perm_b32 v253, v125, v121, s32
    v_perm_b32 v254, v133, v129, s32
    v_perm_b32 v255, v141, v137, s32
    ds_write_b128 v8, v[252:255] offset:59392
    v_perm_b32 v240, v118, v114, s31
    v_perm_b32 v241, v126, v122, s31
    v_perm_b32 v242, v134, v130, s31
    v_perm_b32 v243, v142, v138, s31
    ds_write_b128 v8, v[240:243] offset:24592
    v_perm_b32 v244, v118, v114, s32
    v_perm_b32 v245, v126, v122, s32
    v_perm_b32 v246, v134, v130, s32
    v_perm_b32 v247, v142, v138, s32
    ds_write_b128 v8, v[244:247] offset:26640
    v_perm_b32 v248, v119, v115, s31
    v_perm_b32 v249, v127, v123, s31
    v_perm_b32 v250, v135, v131, s31
    v_perm_b32 v251, v143, v139, s31
    ds_write_b128 v8, v[248:251] offset:57360
    v_perm_b32 v252, v119, v115, s32
    v_perm_b32 v253, v127, v123, s32
    v_perm_b32 v254, v135, v131, s32
    v_perm_b32 v255, v143, v139, s32
    ds_write_b128 v8, v[252:255] offset:59408
    s_mov_b32 s24, 2097152
    buffer_load_dwordx4 v[112:115], v14, s[84:87], s24 offen
    s_mov_b32 s24, 2105344
    buffer_load_dwordx4 v[116:119], v14, s[84:87], s24 offen
    s_mov_b32 s24, 2162688
    buffer_load_dwordx4 v[120:123], v14, s[84:87], s24 offen
    s_mov_b32 s24, 2170880
    buffer_load_dwordx4 v[124:127], v14, s[84:87], s24 offen
    s_mov_b32 s24, 2113536
    buffer_load_dwordx4 v[128:131], v14, s[84:87], s24 offen
    s_mov_b32 s24, 2121728
    buffer_load_dwordx4 v[132:135], v14, s[84:87], s24 offen
    s_mov_b32 s24, 2179072
    buffer_load_dwordx4 v[136:139], v14, s[84:87], s24 offen
    s_mov_b32 s24, 2187264
    buffer_load_dwordx4 v[140:143], v14, s[84:87], s24 offen
    s_waitcnt lgkmcnt(0)
    s_barrier
    ds_read_b128 a[0:3], v6 offset:0
    ds_read_b128 a[4:7], v6 offset:1024
    ds_read_b128 a[8:11], v6 offset:2048
    ds_read_b128 a[12:15], v6 offset:3072
    ds_read_b128 a[16:19], v6 offset:4096
    ds_read_b128 a[20:23], v6 offset:5120
    ds_read_b128 a[24:27], v6 offset:6144
    ds_read_b128 a[28:31], v6 offset:7168
    ds_read_b128 a[32:35], v6 offset:8192
    ds_read_b128 a[36:39], v6 offset:9216
    ds_read_b128 a[40:43], v6 offset:10240
    ds_read_b128 a[44:47], v6 offset:11264
    ds_read_b128 a[48:51], v6 offset:12288
    ds_read_b128 a[52:55], v6 offset:13312
    ds_read_b128 a[56:59], v6 offset:14336
    ds_read_b128 a[60:63], v6 offset:15360
    ds_read_b128 a[64:67], v6 offset:16384
    ds_read_b128 a[68:71], v6 offset:17408
    ds_read_b128 a[72:75], v6 offset:18432
    ds_read_b128 a[76:79], v6 offset:19456
    ds_read_b128 a[80:83], v6 offset:20480
    ds_read_b128 a[84:87], v6 offset:21504
    ds_read_b128 a[88:91], v6 offset:22528
    ds_read_b128 a[92:95], v6 offset:23552
    ds_read_b128 a[96:99], v6 offset:24576
    ds_read_b128 a[100:103], v6 offset:25600
    ds_read_b128 a[104:107], v6 offset:26624
    ds_read_b128 a[108:111], v6 offset:27648
    ds_read_b128 a[112:115], v6 offset:28672
    ds_read_b128 a[116:119], v6 offset:29696
    ds_read_b128 a[120:123], v6 offset:30720
    ds_read_b128 a[124:127], v6 offset:31744
    s_waitcnt lgkmcnt(0)
    s_barrier
    s_waitcnt vmcnt(48)
    v_perm_b32 v240, v148, v144, s31
    v_perm_b32 v241, v156, v152, s31
    v_perm_b32 v242, v164, v160, s31
    v_perm_b32 v243, v172, v168, s31
    ds_write_b128 v8, v[240:243] offset:0
    v_perm_b32 v244, v148, v144, s32
    v_perm_b32 v245, v156, v152, s32
    v_perm_b32 v246, v164, v160, s32
    v_perm_b32 v247, v172, v168, s32
    ds_write_b128 v8, v[244:247] offset:2048
    v_perm_b32 v248, v149, v145, s31
    v_perm_b32 v249, v157, v153, s31
    v_perm_b32 v250, v165, v161, s31
    v_perm_b32 v251, v173, v169, s31
    ds_write_b128 v8, v[248:251] offset:32768
    v_perm_b32 v252, v149, v145, s32
    v_perm_b32 v253, v157, v153, s32
    v_perm_b32 v254, v165, v161, s32
    v_perm_b32 v255, v173, v169, s32
    ds_write_b128 v8, v[252:255] offset:34816
    v_perm_b32 v240, v150, v146, s31
    v_perm_b32 v241, v158, v154, s31
    v_perm_b32 v242, v166, v162, s31
    v_perm_b32 v243, v174, v170, s31
    ds_write_b128 v8, v[240:243] offset:16
    v_perm_b32 v244, v150, v146, s32
    v_perm_b32 v245, v158, v154, s32
    v_perm_b32 v246, v166, v162, s32
    v_perm_b32 v247, v174, v170, s32
    ds_write_b128 v8, v[244:247] offset:2064
    v_perm_b32 v248, v151, v147, s31
    v_perm_b32 v249, v159, v155, s31
    v_perm_b32 v250, v167, v163, s31
    v_perm_b32 v251, v175, v171, s31
    ds_write_b128 v8, v[248:251] offset:32784
    v_perm_b32 v252, v151, v147, s32
    v_perm_b32 v253, v159, v155, s32
    v_perm_b32 v254, v167, v163, s32
    v_perm_b32 v255, v175, v171, s32
    ds_write_b128 v8, v[252:255] offset:34832
    s_mov_b32 s24, 3145728
    buffer_load_dwordx4 v[144:147], v14, s[84:87], s24 offen
    s_mov_b32 s24, 3153920
    buffer_load_dwordx4 v[148:151], v14, s[84:87], s24 offen
    s_mov_b32 s24, 3211264
    buffer_load_dwordx4 v[152:155], v14, s[84:87], s24 offen
    s_mov_b32 s24, 3219456
    buffer_load_dwordx4 v[156:159], v14, s[84:87], s24 offen
    s_mov_b32 s24, 3162112
    buffer_load_dwordx4 v[160:163], v14, s[84:87], s24 offen
    s_mov_b32 s24, 3170304
    buffer_load_dwordx4 v[164:167], v14, s[84:87], s24 offen
    s_mov_b32 s24, 3227648
    buffer_load_dwordx4 v[168:171], v14, s[84:87], s24 offen
    s_mov_b32 s24, 3235840
    buffer_load_dwordx4 v[172:175], v14, s[84:87], s24 offen
    s_waitcnt vmcnt(48)
    v_perm_b32 v240, v180, v176, s31
    v_perm_b32 v241, v188, v184, s31
    v_perm_b32 v242, v196, v192, s31
    v_perm_b32 v243, v204, v200, s31
    ds_write_b128 v8, v[240:243] offset:8192
    v_perm_b32 v244, v180, v176, s32
    v_perm_b32 v245, v188, v184, s32
    v_perm_b32 v246, v196, v192, s32
    v_perm_b32 v247, v204, v200, s32
    ds_write_b128 v8, v[244:247] offset:10240
    v_perm_b32 v248, v181, v177, s31
    v_perm_b32 v249, v189, v185, s31
    v_perm_b32 v250, v197, v193, s31
    v_perm_b32 v251, v205, v201, s31
    ds_write_b128 v8, v[248:251] offset:40960
    v_perm_b32 v252, v181, v177, s32
    v_perm_b32 v253, v189, v185, s32
    v_perm_b32 v254, v197, v193, s32
    v_perm_b32 v255, v205, v201, s32
    ds_write_b128 v8, v[252:255] offset:43008
    v_perm_b32 v240, v182, v178, s31
    v_perm_b32 v241, v190, v186, s31
    v_perm_b32 v242, v198, v194, s31
    v_perm_b32 v243, v206, v202, s31
    ds_write_b128 v8, v[240:243] offset:8208
    v_perm_b32 v244, v182, v178, s32
    v_perm_b32 v245, v190, v186, s32
    v_perm_b32 v246, v198, v194, s32
    v_perm_b32 v247, v206, v202, s32
    ds_write_b128 v8, v[244:247] offset:10256
    v_perm_b32 v248, v183, v179, s31
    v_perm_b32 v249, v191, v187, s31
    v_perm_b32 v250, v199, v195, s31
    v_perm_b32 v251, v207, v203, s31
    ds_write_b128 v8, v[248:251] offset:40976
    v_perm_b32 v252, v183, v179, s32
    v_perm_b32 v253, v191, v187, s32
    v_perm_b32 v254, v199, v195, s32
    v_perm_b32 v255, v207, v203, s32
    ds_write_b128 v8, v[252:255] offset:43024
    s_waitcnt vmcnt(40)
    v_perm_b32 v240, v212, v208, s31
    v_perm_b32 v241, v220, v216, s31
    v_perm_b32 v242, v228, v224, s31
    v_perm_b32 v243, v236, v232, s31
    ds_write_b128 v8, v[240:243] offset:16384
    v_perm_b32 v244, v212, v208, s32
    v_perm_b32 v245, v220, v216, s32
    v_perm_b32 v246, v228, v224, s32
    v_perm_b32 v247, v236, v232, s32
    ds_write_b128 v8, v[244:247] offset:18432
    v_perm_b32 v248, v213, v209, s31
    v_perm_b32 v249, v221, v217, s31
    v_perm_b32 v250, v229, v225, s31
    v_perm_b32 v251, v237, v233, s31
    ds_write_b128 v8, v[248:251] offset:49152
    v_perm_b32 v252, v213, v209, s32
    v_perm_b32 v253, v221, v217, s32
    v_perm_b32 v254, v229, v225, s32
    v_perm_b32 v255, v237, v233, s32
    ds_write_b128 v8, v[252:255] offset:51200
    v_perm_b32 v240, v214, v210, s31
    v_perm_b32 v241, v222, v218, s31
    v_perm_b32 v242, v230, v226, s31
    v_perm_b32 v243, v238, v234, s31
    ds_write_b128 v8, v[240:243] offset:16400
    v_perm_b32 v244, v214, v210, s32
    v_perm_b32 v245, v222, v218, s32
    v_perm_b32 v246, v230, v226, s32
    v_perm_b32 v247, v238, v234, s32
    ds_write_b128 v8, v[244:247] offset:18448
    v_perm_b32 v248, v215, v211, s31
    v_perm_b32 v249, v223, v219, s31
    v_perm_b32 v250, v231, v227, s31
    v_perm_b32 v251, v239, v235, s31
    ds_write_b128 v8, v[248:251] offset:49168
    v_perm_b32 v252, v215, v211, s32
    v_perm_b32 v253, v223, v219, s32
    v_perm_b32 v254, v231, v227, s32
    v_perm_b32 v255, v239, v235, s32
    ds_write_b128 v8, v[252:255] offset:51216
    s_waitcnt vmcnt(32)
    v_perm_b32 v240, v20, v16, s31
    v_perm_b32 v241, v28, v24, s31
    v_perm_b32 v242, v36, v32, s31
    v_perm_b32 v243, v44, v40, s31
    ds_write_b128 v8, v[240:243] offset:24576
    v_perm_b32 v244, v20, v16, s32
    v_perm_b32 v245, v28, v24, s32
    v_perm_b32 v246, v36, v32, s32
    v_perm_b32 v247, v44, v40, s32
    ds_write_b128 v8, v[244:247] offset:26624
    v_perm_b32 v248, v21, v17, s31
    v_perm_b32 v249, v29, v25, s31
    v_perm_b32 v250, v37, v33, s31
    v_perm_b32 v251, v45, v41, s31
    ds_write_b128 v8, v[248:251] offset:57344
    v_perm_b32 v252, v21, v17, s32
    v_perm_b32 v253, v29, v25, s32
    v_perm_b32 v254, v37, v33, s32
    v_perm_b32 v255, v45, v41, s32
    ds_write_b128 v8, v[252:255] offset:59392
    v_perm_b32 v240, v22, v18, s31
    v_perm_b32 v241, v30, v26, s31
    v_perm_b32 v242, v38, v34, s31
    v_perm_b32 v243, v46, v42, s31
    ds_write_b128 v8, v[240:243] offset:24592
    v_perm_b32 v244, v22, v18, s32
    v_perm_b32 v245, v30, v26, s32
    v_perm_b32 v246, v38, v34, s32
    v_perm_b32 v247, v46, v42, s32
    ds_write_b128 v8, v[244:247] offset:26640
    v_perm_b32 v248, v23, v19, s31
    v_perm_b32 v249, v31, v27, s31
    v_perm_b32 v250, v39, v35, s31
    v_perm_b32 v251, v47, v43, s31
    ds_write_b128 v8, v[248:251] offset:57360
    v_perm_b32 v252, v23, v19, s32
    v_perm_b32 v253, v31, v27, s32
    v_perm_b32 v254, v39, v35, s32
    v_perm_b32 v255, v47, v43, s32
    ds_write_b128 v8, v[252:255] offset:59408
    s_add_u32 s24, s34, 0
    buffer_load_dwordx4 v[16:19], v15, s[8:11], s24 offen
    s_add_u32 s24, s34, 4096
    buffer_load_dwordx4 v[20:23], v15, s[8:11], s24 offen
    s_add_u32 s24, s34, 1024
    buffer_load_dwordx4 v[24:27], v15, s[8:11], s24 offen
    s_add_u32 s24, s34, 5120
    buffer_load_dwordx4 v[28:31], v15, s[8:11], s24 offen
    s_add_u32 s24, s34, 8192
    buffer_load_dwordx4 v[32:35], v15, s[8:11], s24 offen
    s_add_u32 s24, s34, 12288
    buffer_load_dwordx4 v[36:39], v15, s[8:11], s24 offen
    s_add_u32 s24, s34, 9216
    buffer_load_dwordx4 v[40:43], v15, s[8:11], s24 offen
    s_add_u32 s24, s34, 13312
    buffer_load_dwordx4 v[44:47], v15, s[8:11], s24 offen
    s_waitcnt lgkmcnt(0)
    s_barrier
    ds_read_b128 a[128:131], v6 offset:0
    ds_read_b128 a[132:135], v6 offset:1024
    ds_read_b128 a[136:139], v6 offset:2048
    ds_read_b128 a[140:143], v6 offset:3072
    ds_read_b128 a[144:147], v6 offset:4096
    ds_read_b128 a[148:151], v6 offset:5120
    ds_read_b128 a[152:155], v6 offset:6144
    ds_read_b128 a[156:159], v6 offset:7168
    ds_read_b128 a[160:163], v6 offset:8192
    ds_read_b128 a[164:167], v6 offset:9216
    ds_read_b128 a[168:171], v6 offset:10240
    ds_read_b128 a[172:175], v6 offset:11264
    ds_read_b128 a[176:179], v6 offset:12288
    ds_read_b128 a[180:183], v6 offset:13312
    ds_read_b128 a[184:187], v6 offset:14336
    ds_read_b128 a[188:191], v6 offset:15360
    ds_read_b128 a[192:195], v6 offset:16384
    ds_read_b128 a[196:199], v6 offset:17408
    ds_read_b128 a[200:203], v6 offset:18432
    ds_read_b128 a[204:207], v6 offset:19456
    ds_read_b128 a[208:211], v6 offset:20480
    ds_read_b128 a[212:215], v6 offset:21504
    ds_read_b128 a[216:219], v6 offset:22528
    ds_read_b128 a[220:223], v6 offset:23552
    ds_read_b128 a[224:227], v6 offset:24576
    ds_read_b128 a[228:231], v6 offset:25600
    ds_read_b128 a[232:235], v6 offset:26624
    ds_read_b128 a[236:239], v6 offset:27648
    ds_read_b128 a[240:243], v6 offset:28672
    ds_read_b128 a[244:247], v6 offset:29696
    ds_read_b128 a[248:251], v6 offset:30720
    ds_read_b128 a[252:255], v6 offset:31744
    s_waitcnt lgkmcnt(0)
    s_barrier
    s_waitcnt vmcnt(32)
    v_perm_b32 v240, v52, v48, s31
    v_perm_b32 v241, v60, v56, s31
    v_perm_b32 v242, v68, v64, s31
    v_perm_b32 v243, v76, v72, s31
    ds_write_b128 v8, v[240:243] offset:0
    v_perm_b32 v244, v52, v48, s32
    v_perm_b32 v245, v60, v56, s32
    v_perm_b32 v246, v68, v64, s32
    v_perm_b32 v247, v76, v72, s32
    ds_write_b128 v8, v[244:247] offset:2048
    v_perm_b32 v248, v53, v49, s31
    v_perm_b32 v249, v61, v57, s31
    v_perm_b32 v250, v69, v65, s31
    v_perm_b32 v251, v77, v73, s31
    ds_write_b128 v8, v[248:251] offset:32768
    v_perm_b32 v252, v53, v49, s32
    v_perm_b32 v253, v61, v57, s32
    v_perm_b32 v254, v69, v65, s32
    v_perm_b32 v255, v77, v73, s32
    ds_write_b128 v8, v[252:255] offset:34816
    v_perm_b32 v240, v54, v50, s31
    v_perm_b32 v241, v62, v58, s31
    v_perm_b32 v242, v70, v66, s31
    v_perm_b32 v243, v78, v74, s31
    ds_write_b128 v8, v[240:243] offset:16
    v_perm_b32 v244, v54, v50, s32
    v_perm_b32 v245, v62, v58, s32
    v_perm_b32 v246, v70, v66, s32
    v_perm_b32 v247, v78, v74, s32
    ds_write_b128 v8, v[244:247] offset:2064
    v_perm_b32 v248, v55, v51, s31
    v_perm_b32 v249, v63, v59, s31
    v_perm_b32 v250, v71, v67, s31
    v_perm_b32 v251, v79, v75, s31
    ds_write_b128 v8, v[248:251] offset:32784
    v_perm_b32 v252, v55, v51, s32
    v_perm_b32 v253, v63, v59, s32
    v_perm_b32 v254, v71, v67, s32
    v_perm_b32 v255, v79, v75, s32
    ds_write_b128 v8, v[252:255] offset:34832
    s_add_u32 s24, s34, 32768
    buffer_load_dwordx4 v[48:51], v15, s[8:11], s24 offen
    s_add_u32 s24, s34, 36864
    buffer_load_dwordx4 v[52:55], v15, s[8:11], s24 offen
    s_add_u32 s24, s34, 33792
    buffer_load_dwordx4 v[56:59], v15, s[8:11], s24 offen
    s_add_u32 s24, s34, 37888
    buffer_load_dwordx4 v[60:63], v15, s[8:11], s24 offen
    s_add_u32 s24, s34, 40960
    buffer_load_dwordx4 v[64:67], v15, s[8:11], s24 offen
    s_add_u32 s24, s34, 45056
    buffer_load_dwordx4 v[68:71], v15, s[8:11], s24 offen
    s_add_u32 s24, s34, 41984
    buffer_load_dwordx4 v[72:75], v15, s[8:11], s24 offen
    s_add_u32 s24, s34, 46080
    buffer_load_dwordx4 v[76:79], v15, s[8:11], s24 offen
    s_waitcnt vmcnt(32)
    v_perm_b32 v240, v84, v80, s31
    v_perm_b32 v241, v92, v88, s31
    v_perm_b32 v242, v100, v96, s31
    v_perm_b32 v243, v108, v104, s31
    ds_write_b128 v8, v[240:243] offset:8192
    v_perm_b32 v244, v84, v80, s32
    v_perm_b32 v245, v92, v88, s32
    v_perm_b32 v246, v100, v96, s32
    v_perm_b32 v247, v108, v104, s32
    ds_write_b128 v8, v[244:247] offset:10240
    v_perm_b32 v248, v85, v81, s31
    v_perm_b32 v249, v93, v89, s31
    v_perm_b32 v250, v101, v97, s31
    v_perm_b32 v251, v109, v105, s31
    ds_write_b128 v8, v[248:251] offset:40960
    v_perm_b32 v252, v85, v81, s32
    v_perm_b32 v253, v93, v89, s32
    v_perm_b32 v254, v101, v97, s32
    v_perm_b32 v255, v109, v105, s32
    ds_write_b128 v8, v[252:255] offset:43008
    v_perm_b32 v240, v86, v82, s31
    v_perm_b32 v241, v94, v90, s31
    v_perm_b32 v242, v102, v98, s31
    v_perm_b32 v243, v110, v106, s31
    ds_write_b128 v8, v[240:243] offset:8208
    v_perm_b32 v244, v86, v82, s32
    v_perm_b32 v245, v94, v90, s32
    v_perm_b32 v246, v102, v98, s32
    v_perm_b32 v247, v110, v106, s32
    ds_write_b128 v8, v[244:247] offset:10256
    v_perm_b32 v248, v87, v83, s31
    v_perm_b32 v249, v95, v91, s31
    v_perm_b32 v250, v103, v99, s31
    v_perm_b32 v251, v111, v107, s31
    ds_write_b128 v8, v[248:251] offset:40976
    v_perm_b32 v252, v87, v83, s32
    v_perm_b32 v253, v95, v91, s32
    v_perm_b32 v254, v103, v99, s32
    v_perm_b32 v255, v111, v107, s32
    ds_write_b128 v8, v[252:255] offset:43024
    s_add_u32 s24, s34, 65536
    buffer_load_dwordx4 v[80:83], v15, s[8:11], s24 offen
    s_add_u32 s24, s34, 69632
    buffer_load_dwordx4 v[84:87], v15, s[8:11], s24 offen
    s_add_u32 s24, s34, 66560
    buffer_load_dwordx4 v[88:91], v15, s[8:11], s24 offen
    s_add_u32 s24, s34, 70656
    buffer_load_dwordx4 v[92:95], v15, s[8:11], s24 offen
    s_add_u32 s24, s34, 73728
    buffer_load_dwordx4 v[96:99], v15, s[8:11], s24 offen
    s_add_u32 s24, s34, 77824
    buffer_load_dwordx4 v[100:103], v15, s[8:11], s24 offen
    s_add_u32 s24, s34, 74752
    buffer_load_dwordx4 v[104:107], v15, s[8:11], s24 offen
    s_add_u32 s24, s34, 78848
    buffer_load_dwordx4 v[108:111], v15, s[8:11], s24 offen
    s_waitcnt vmcnt(32)
    v_perm_b32 v240, v116, v112, s31
    v_perm_b32 v241, v124, v120, s31
    v_perm_b32 v242, v132, v128, s31
    v_perm_b32 v243, v140, v136, s31
    ds_write_b128 v8, v[240:243] offset:16384
    v_perm_b32 v244, v116, v112, s32
    v_perm_b32 v245, v124, v120, s32
    v_perm_b32 v246, v132, v128, s32
    v_perm_b32 v247, v140, v136, s32
    ds_write_b128 v8, v[244:247] offset:18432
    v_perm_b32 v248, v117, v113, s31
    v_perm_b32 v249, v125, v121, s31
    v_perm_b32 v250, v133, v129, s31
    v_perm_b32 v251, v141, v137, s31
    ds_write_b128 v8, v[248:251] offset:49152
    v_perm_b32 v252, v117, v113, s32
    v_perm_b32 v253, v125, v121, s32
    v_perm_b32 v254, v133, v129, s32
    v_perm_b32 v255, v141, v137, s32
    ds_write_b128 v8, v[252:255] offset:51200
    v_perm_b32 v240, v118, v114, s31
    v_perm_b32 v241, v126, v122, s31
    v_perm_b32 v242, v134, v130, s31
    v_perm_b32 v243, v142, v138, s31
    ds_write_b128 v8, v[240:243] offset:16400
    v_perm_b32 v244, v118, v114, s32
    v_perm_b32 v245, v126, v122, s32
    v_perm_b32 v246, v134, v130, s32
    v_perm_b32 v247, v142, v138, s32
    ds_write_b128 v8, v[244:247] offset:18448
    v_perm_b32 v248, v119, v115, s31
    v_perm_b32 v249, v127, v123, s31
    v_perm_b32 v250, v135, v131, s31
    v_perm_b32 v251, v143, v139, s31
    ds_write_b128 v8, v[248:251] offset:49168
    v_perm_b32 v252, v119, v115, s32
    v_perm_b32 v253, v127, v123, s32
    v_perm_b32 v254, v135, v131, s32
    v_perm_b32 v255, v143, v139, s32
    ds_write_b128 v8, v[252:255] offset:51216
    s_waitcnt vmcnt(24)
    v_perm_b32 v240, v148, v144, s31
    v_perm_b32 v241, v156, v152, s31
    v_perm_b32 v242, v164, v160, s31
    v_perm_b32 v243, v172, v168, s31
    ds_write_b128 v8, v[240:243] offset:24576
    v_perm_b32 v244, v148, v144, s32
    v_perm_b32 v245, v156, v152, s32
    v_perm_b32 v246, v164, v160, s32
    v_perm_b32 v247, v172, v168, s32
    ds_write_b128 v8, v[244:247] offset:26624
    v_perm_b32 v248, v149, v145, s31
    v_perm_b32 v249, v157, v153, s31
    v_perm_b32 v250, v165, v161, s31
    v_perm_b32 v251, v173, v169, s31
    ds_write_b128 v8, v[248:251] offset:57344
    v_perm_b32 v252, v149, v145, s32
    v_perm_b32 v253, v157, v153, s32
    v_perm_b32 v254, v165, v161, s32
    v_perm_b32 v255, v173, v169, s32
    ds_write_b128 v8, v[252:255] offset:59392
    v_perm_b32 v240, v150, v146, s31
    v_perm_b32 v241, v158, v154, s31
    v_perm_b32 v242, v166, v162, s31
    v_perm_b32 v243, v174, v170, s31
    ds_write_b128 v8, v[240:243] offset:24592
    v_perm_b32 v244, v150, v146, s32
    v_perm_b32 v245, v158, v154, s32
    v_perm_b32 v246, v166, v162, s32
    v_perm_b32 v247, v174, v170, s32
    ds_write_b128 v8, v[244:247] offset:26640
    v_perm_b32 v248, v151, v147, s31
    v_perm_b32 v249, v159, v155, s31
    v_perm_b32 v250, v167, v163, s31
    v_perm_b32 v251, v175, v171, s31
    ds_write_b128 v8, v[248:251] offset:57360
    v_perm_b32 v252, v151, v147, s32
    v_perm_b32 v253, v159, v155, s32
    v_perm_b32 v254, v167, v163, s32
    v_perm_b32 v255, v175, v171, s32
    ds_write_b128 v8, v[252:255] offset:59408
    s_waitcnt lgkmcnt(0)
    s_barrier
    ds_read_b128 v[128:131], v6 offset:16384
    ds_read_b128 v[132:135], v6 offset:17408
    ds_read_b128 v[136:139], v6 offset:18432
    ds_read_b128 v[140:143], v6 offset:19456
    ds_read_b128 v[144:147], v6 offset:20480
    ds_read_b128 v[148:151], v6 offset:21504
    ds_read_b128 v[152:155], v6 offset:22528
    ds_read_b128 v[156:159], v6 offset:23552
    ds_read_b128 v[160:163], v6 offset:24576
    ds_read_b128 v[164:167], v6 offset:25600
    ds_read_b128 v[168:171], v6 offset:26624
    ds_read_b128 v[172:175], v6 offset:27648
    ds_read_b128 v[176:179], v6 offset:28672
    ds_read_b128 v[180:183], v6 offset:29696
    ds_read_b128 v[184:187], v6 offset:30720
    ds_read_b128 v[188:191], v6 offset:31744
    s_waitcnt lgkmcnt(0)
    s_waitcnt vmcnt(16)
    v_perm_b32 v192, v20, v16, s31
    v_perm_b32 v193, v28, v24, s31
    v_perm_b32 v194, v36, v32, s31
    v_perm_b32 v195, v44, v40, s31
    v_perm_b32 v208, v20, v16, s32
    v_perm_b32 v209, v28, v24, s32
    v_perm_b32 v210, v36, v32, s32
    v_perm_b32 v211, v44, v40, s32
    v_perm_b32 v224, v21, v17, s31
    v_perm_b32 v225, v29, v25, s31
    v_perm_b32 v226, v37, v33, s31
    v_perm_b32 v227, v45, v41, s31
    v_perm_b32 v240, v21, v17, s32
    v_perm_b32 v241, v29, v25, s32
    v_perm_b32 v242, v37, v33, s32
    v_perm_b32 v243, v45, v41, s32
    v_perm_b32 v120, v22, v18, s31
    v_perm_b32 v121, v30, v26, s31
    v_perm_b32 v122, v38, v34, s31
    v_perm_b32 v123, v46, v42, s31
    ds_write_b128 v6, v[120:123] offset:16384
    v_perm_b32 v124, v22, v18, s32
    v_perm_b32 v125, v30, v26, s32
    v_perm_b32 v126, v38, v34, s32
    v_perm_b32 v127, v46, v42, s32
    ds_write_b128 v6, v[124:127] offset:20480
    v_perm_b32 v120, v23, v19, s31
    v_perm_b32 v121, v31, v27, s31
    v_perm_b32 v122, v39, v35, s31
    v_perm_b32 v123, v47, v43, s31
    ds_write_b128 v6, v[120:123] offset:24576
    v_perm_b32 v124, v23, v19, s32
    v_perm_b32 v125, v31, v27, s32
    v_perm_b32 v126, v39, v35, s32
    v_perm_b32 v127, v47, v43, s32
    ds_write_b128 v6, v[124:127] offset:28672
    s_add_u32 s24, s34, 98304
    buffer_load_dwordx4 v[16:19], v15, s[8:11], s24 offen
    s_add_u32 s24, s34, 102400
    buffer_load_dwordx4 v[20:23], v15, s[8:11], s24 offen
    s_add_u32 s24, s34, 99328
    buffer_load_dwordx4 v[24:27], v15, s[8:11], s24 offen
    s_add_u32 s24, s34, 103424
    buffer_load_dwordx4 v[28:31], v15, s[8:11], s24 offen
    s_add_u32 s24, s34, 106496
    buffer_load_dwordx4 v[32:35], v15, s[8:11], s24 offen
    s_add_u32 s24, s34, 110592
    buffer_load_dwordx4 v[36:39], v15, s[8:11], s24 offen
    s_add_u32 s24, s34, 107520
    buffer_load_dwordx4 v[40:43], v15, s[8:11], s24 offen
    s_add_u32 s24, s34, 111616
    buffer_load_dwordx4 v[44:47], v15, s[8:11], s24 offen
    s_waitcnt vmcnt(16)
    v_perm_b32 v196, v52, v48, s31
    v_perm_b32 v197, v60, v56, s31
    v_perm_b32 v198, v68, v64, s31
    v_perm_b32 v199, v76, v72, s31
    v_perm_b32 v212, v52, v48, s32
    v_perm_b32 v213, v60, v56, s32
    v_perm_b32 v214, v68, v64, s32
    v_perm_b32 v215, v76, v72, s32
    v_perm_b32 v228, v53, v49, s31
    v_perm_b32 v229, v61, v57, s31
    v_perm_b32 v230, v69, v65, s31
    v_perm_b32 v231, v77, v73, s31
    v_perm_b32 v244, v53, v49, s32
    v_perm_b32 v245, v61, v57, s32
    v_perm_b32 v246, v69, v65, s32
    v_perm_b32 v247, v77, v73, s32
    v_perm_b32 v120, v54, v50, s31
    v_perm_b32 v121, v62, v58, s31
    v_perm_b32 v122, v70, v66, s31
    v_perm_b32 v123, v78, v74, s31
    ds_write_b128 v6, v[120:123] offset:17408
    v_perm_b32 v124, v54, v50, s32
    v_perm_b32 v125, v62, v58, s32
    v_perm_b32 v126, v70, v66, s32
    v_perm_b32 v127, v78, v74, s32
    ds_write_b128 v6, v[124:127] offset:21504
    v_perm_b32 v120, v55, v51, s31
    v_perm_b32 v121, v63, v59, s31
    v_perm_b32 v122, v71, v67, s31
    v_perm_b32 v123, v79, v75, s31
    ds_write_b128 v6, v[120:123] offset:25600
    v_perm_b32 v124, v55, v51, s32
    v_perm_b32 v125, v63, v59, s32
    v_perm_b32 v126, v71, v67, s32
    v_perm_b32 v127, v79, v75, s32
    ds_write_b128 v6, v[124:127] offset:29696
    s_waitcnt vmcnt(8)
    v_perm_b32 v200, v84, v80, s31
    v_perm_b32 v201, v92, v88, s31
    v_perm_b32 v202, v100, v96, s31
    v_perm_b32 v203, v108, v104, s31
    v_perm_b32 v216, v84, v80, s32
    v_perm_b32 v217, v92, v88, s32
    v_perm_b32 v218, v100, v96, s32
    v_perm_b32 v219, v108, v104, s32
    v_perm_b32 v232, v85, v81, s31
    v_perm_b32 v233, v93, v89, s31
    v_perm_b32 v234, v101, v97, s31
    v_perm_b32 v235, v109, v105, s31
    v_perm_b32 v248, v85, v81, s32
    v_perm_b32 v249, v93, v89, s32
    v_perm_b32 v250, v101, v97, s32
    v_perm_b32 v251, v109, v105, s32
    v_perm_b32 v120, v86, v82, s31
    v_perm_b32 v121, v94, v90, s31
    v_perm_b32 v122, v102, v98, s31
    v_perm_b32 v123, v110, v106, s31
    ds_write_b128 v6, v[120:123] offset:18432
    v_perm_b32 v124, v86, v82, s32
    v_perm_b32 v125, v94, v90, s32
    v_perm_b32 v126, v102, v98, s32
    v_perm_b32 v127, v110, v106, s32
    ds_write_b128 v6, v[124:127] offset:22528
    v_perm_b32 v120, v87, v83, s31
    v_perm_b32 v121, v95, v91, s31
    v_perm_b32 v122, v103, v99, s31
    v_perm_b32 v123, v111, v107, s31
    ds_write_b128 v6, v[120:123] offset:26624
    v_perm_b32 v124, v87, v83, s32
    v_perm_b32 v125, v95, v91, s32
    v_perm_b32 v126, v103, v99, s32
    v_perm_b32 v127, v111, v107, s32
    ds_write_b128 v6, v[124:127] offset:30720
    s_waitcnt vmcnt(0)
    v_perm_b32 v204, v20, v16, s31
    v_perm_b32 v205, v28, v24, s31
    v_perm_b32 v206, v36, v32, s31
    v_perm_b32 v207, v44, v40, s31
    v_perm_b32 v220, v20, v16, s32
    v_perm_b32 v221, v28, v24, s32
    v_perm_b32 v222, v36, v32, s32
    v_perm_b32 v223, v44, v40, s32
    v_perm_b32 v236, v21, v17, s31
    v_perm_b32 v237, v29, v25, s31
    v_perm_b32 v238, v37, v33, s31
    v_perm_b32 v239, v45, v41, s31
    v_perm_b32 v252, v21, v17, s32
    v_perm_b32 v253, v29, v25, s32
    v_perm_b32 v254, v37, v33, s32
    v_perm_b32 v255, v45, v41, s32
    v_perm_b32 v120, v22, v18, s31
    v_perm_b32 v121, v30, v26, s31
    v_perm_b32 v122, v38, v34, s31
    v_perm_b32 v123, v46, v42, s31
    ds_write_b128 v6, v[120:123] offset:19456
    v_perm_b32 v124, v22, v18, s32
    v_perm_b32 v125, v30, v26, s32
    v_perm_b32 v126, v38, v34, s32
    v_perm_b32 v127, v46, v42, s32
    ds_write_b128 v6, v[124:127] offset:23552
    v_perm_b32 v120, v23, v19, s31
    v_perm_b32 v121, v31, v27, s31
    v_perm_b32 v122, v39, v35, s31
    v_perm_b32 v123, v47, v43, s31
    ds_write_b128 v6, v[120:123] offset:27648
    v_perm_b32 v124, v23, v19, s32
    v_perm_b32 v125, v31, v27, s32
    v_perm_b32 v126, v39, v35, s32
    v_perm_b32 v127, v47, v43, s32
    ds_write_b128 v6, v[124:127] offset:31744
    s_load_dwordx2 s[8:9], s[0:1], 8
    s_mov_b32 s10, 8192
    s_mov_b32 s11, 0x00020000
    s_waitcnt lgkmcnt(0)
    v_lshrrev_b32 v5, 4, v0
    v_lshlrev_b32 v5, 5, v5
    v_bfe_u32 v7, v0, 1, 1
    v_lshl_add_u32 v5, v7, 4, v5
    v_bfe_u32 v7, v0, 2, 2
    v_lshl_add_u32 v5, v7, 11, v5
    v_and_b32 v7, 1, v0
    v_lshl_add_u32 v5, v7, 10, v5
    buffer_load_dwordx4 v[16:19], v5, s[8:11], 0 offen
    buffer_load_dwordx4 v[20:23], v5, s[8:11], 0 offen offset:512
    v_and_b32 v30, 63, v0
    v_lshlrev_b32 v30, 2, v30
Ldw_227:
    buffer_load_dword v3, v30, s[12:15], 0 offen sc1
    s_waitcnt vmcnt(0)
    s_mov_b32 s24, 0
    v_readlane_b32 s25, v3, 8
    s_add_u32 s24, s24, s25
    v_readlane_b32 s25, v3, 24
    s_add_u32 s24, s24, s25
    v_readlane_b32 s25, v3, 40
    s_add_u32 s24, s24, s25
    v_readlane_b32 s25, v3, 56
    s_add_u32 s24, s24, s25
    v_readlane_b32 s25, v3, 0
    s_add_u32 s24, s24, s25
    v_readlane_b32 s25, v3, 16
    s_add_u32 s24, s24, s25
    v_readlane_b32 s25, v3, 32
    s_add_u32 s24, s24, s25
    v_readlane_b32 s25, v3, 48
    s_add_u32 s24, s24, s25
    v_readlane_b32 s25, v3, 1
    s_add_u32 s24, s24, s25
    v_readlane_b32 s25, v3, 17
    s_add_u32 s24, s24, s25
    v_readlane_b32 s25, v3, 33
    s_add_u32 s24, s24, s25
    v_readlane_b32 s25, v3, 49
    s_add_u32 s24, s24, s25
    s_cmp_ge_u32 s24, 352
    s_cbranch_scc1 Ldw_228
    s_sleep 4
    s_memrealtime s[36:37]
    s_waitcnt lgkmcnt(0)
    s_sub_u32 s36, s36, s28
    s_cmp_gt_u32 s36, 3000000
    s_cbranch_scc1 E_ENG
    s_branch Ldw_227
Ldw_228:
    v_lshlrev_b32 v5, 4, v0
    v_add_u32 v5, 147456, v5
    s_waitcnt vmcnt(0)
    ds_write_b128 v5, v[16:19]
    ds_write_b128 v5, v[20:23] offset:4096
    v_lshrrev_b32 v16, 4, v1
    v_and_b32 v17, 15, v1
    v_and_b32 v18, 2, v1
    v_cmp_eq_u32 s[52:53], 0, v18
    v_cmp_ne_u32 s[54:55], 0, v18
    v_mov_b32 v4, 0xeeee
    v_mov_b32 v5, 0x4444
    v_cndmask_b32 v4, v4, v5, s[52:53]
    s_mov_b32 s58, 0x000f000f
    s_mov_b32 s59, 0
    v_lshlrev_b32 v7, 4, v1
    v_mov_b32 v13, v7
    v_add_u32 v7, 131072, v7
    v_and_b32 v21, 1, v1
    v_lshlrev_b32 v21, 4, v21
    v_mov_b32 v22, 0x3f80
    v_lshlrev_b32 v21, v21, v22
    v_lshrrev_b32 v20, 1, v17
    v_cmp_eq_u32 vcc, 0, v20
    s_nop 1
    v_cndmask_b32 v24, 0, v21, vcc
    v_cmp_eq_u32 vcc, 1, v20
    s_nop 1
    v_cndmask_b32 v25, 0, v21, vcc
    v_cmp_eq_u32 vcc, 2, v20
    s_nop 1
    v_cndmask_b32 v26, 0, v21, vcc
    v_cmp_eq_u32 vcc, 3, v20
    s_nop 1
    v_cndmask_b32 v27, 0, v21, vcc
    ds_write_b128 v7, v[24:27] offset:30976
    s_mul_i32 s24, s16, 1088
    s_add_u32 s24, s24, 147456
    v_lshlrev_b32 v8, 5, v17
    v_lshl_add_u32 v8, v16, 3, v8
    v_add_u32 v8, s24, v8
    v_lshrrev_b32 v9, 2, v17
    v_mul_u32_u24 v9, 544, v9
    v_lshl_add_u32 v9, v16, 7, v9
    v_and_b32 v5, 3, v17
    v_lshl_add_u32 v9, v5, 3, v9
    v_add_u32 v9, 147456, v9
    s_lshr_b32 s24, s16, 1
    s_lshl_b32 s24, s24, 10
    s_and_b32 s25, s16, 1
    s_lshl_b32 s25, s25, 3
    s_add_u32 s24, s24, s25
    s_add_u32 s24, s24, 160000
    v_add_u32 v10, s24, v13
    s_lshl_b32 s24, s16, 11
    v_add_u32 v11, s24, v7
    v_lshrrev_b32 v12, 1, v17
    v_lshlrev_b32 v12, 13, v12
    v_and_b32 v5, 1, v17
    v_lshl_add_u32 v12, v5, 6, v12
    v_lshl_add_u32 v12, v16, 4, v12
    s_lshl_b32 s24, s16, 16
    s_lshl_b32 s25, s41, 8
    s_add_u32 s24, s24, s25
    v_add_u32 v12, s24, v12
    s_mul_i32 s47, s40, 327680
    s_add_u32 s47, s47, 262144
    s_add_u32 s65, s47, 4096
    s_add_u32 s48, s47, 262144
    s_add_u32 s49, s48, 8192
    s_add_u32 s50, s49, 8192
    s_cmp_eq_u32 s16, 3
    s_cselect_b32 s51, 1, 0
    s_mul_i32 s60, s40, 50331648
    s_lshl_b32 s24, s41, 13
    s_add_u32 s60, s60, s24
    s_lshl_b32 s24, s16, 12
    s_add_u32 m0, s24, 131072
    s_and_b32 s24, s24, 4096
    s_add_u32 s60, s60, s24
    s_lshr_b32 s24, s16, 1
    s_lshl_b32 s24, s24, 18
    s_add_u32 s60, s60, s24
    s_add_u32 s60, s60, 35782656
    s_lshl_b32 s61, s40, 23
    s_lshl_b32 s24, s41, 12
    s_add_u32 s61, s61, s24
    s_add_u32 s61, s61, 18874368
    s_lshl_b32 s62, s40, 16
    s_lshr_b32 s24, s41, 1
    s_lshl_b32 s24, s24, 6
    s_add_u32 s62, s62, s24
    s_sub_u32 s63, s62, 2048
    s_mov_b32 s42, -1
    s_mov_b32 s46, 0
    s_mov_b64 s[66:67], 0
    v_lshrrev_b32 v13, 2, v1
    v_lshlrev_b32 v13, 8, v13
    v_and_b32 v5, 3, v1
    v_lshl_add_u32 v13, v5, 4, v13
    s_lshl_b32 s24, s41, 13
    s_and_b32 s25, s16, 1
    s_lshl_b32 s25, s25, 7
    s_add_u32 s24, s24, s25
    s_lshr_b32 s25, s16, 1
    s_lshl_b32 s25, s25, 6
    s_add_u32 s24, s24, s25
    v_add_u32 v13, s24, v13
    v_lshlrev_b32 v14, 6, v5
    v_lshl_add_u32 v14, v16, 3, v14
    s_lshl_b32 s24, s41, 8
    s_lshl_b32 s25, s16, 4
    s_add_u32 s24, s24, s25
    v_add_u32 v14, s24, v14
    s_lshl_b32 s24, s16, 11
    v_lshlrev_b32 v15, 4, v1
    v_add_u32 v15, s24, v15
    v_add_u32 v0, 147456, v15
    s_lshl_b32 s25, s40, 4
    s_nop 3
    v_readlane_b32 s24, v3, s25
    s_cmp_ge_u32 s24, 32
    s_cselect_b32 s43, 1, 0
    v_mov_b32 v3, 0
    v_lshrrev_b32 v5, 2, v17
    v_lshlrev_b32 v5, 5, v5
    v_and_b32 v18, 1, v1
    v_lshl_add_u32 v5, v18, 4, v5
    v_lshl_add_u32 v5, v16, 7, v5
    s_lshr_b32 s24, s16, 1
    s_mul_i32 s24, s24, 2176
    s_and_b32 s25, s16, 1
    s_lshl_b32 s25, s25, 6
    s_add_u32 s24, s24, s25
    v_add_u32 v1, s24, v9
    s_lshl_b32 s24, s16, 9
    s_add_u32 s61, s61, s24
    s_waitcnt lgkmcnt(0)
EN_KVA:
    v_readfirstlane_b32 s24, v3
    s_lshr_b32 s24, s24, 8
    s_cmp_eq_u32 s24, 2
    s_cbranch_scc1 EN_KVGA
    buffer_load_dword v3, v2, s[4:7], s62 offen sc1
    s_memrealtime s[36:37]
    s_waitcnt lgkmcnt(0)
    s_sub_u32 s36, s36, s28
    s_cmp_gt_u32 s36, 3000000
    s_cbranch_scc1 E_ENG
    s_waitcnt vmcnt(0)
    s_branch EN_KVA
EN_KVGA:
    buffer_load_dwordx4 v7, s[4:7], s60 offen offset:0 sc1 lds
    buffer_load_dwordx4 v7, s[4:7], s60 offen offset:1024 sc1 lds
    buffer_load_dwordx4 v7, s[4:7], s60 offen offset:2048 sc1 lds
    buffer_load_dwordx4 v7, s[4:7], s60 offen offset:3072 sc1 lds
    s_add_u32 s60, s60, 786432
    s_add_u32 s62, s62, 1024
    s_waitcnt vmcnt(0)
    ds_read_b128 v[64:67], v6 offset:0
    ds_read_b128 v[68:71], v6 offset:1024
    ds_read_b128 v[72:75], v6 offset:2048
    ds_read_b128 v[76:79], v6 offset:3072
    ds_read_b128 v[80:83], v6 offset:4096
    ds_read_b128 v[84:87], v6 offset:5120
    ds_read_b128 v[88:91], v6 offset:6144
    ds_read_b128 v[92:95], v6 offset:7168
    ds_read_b128 v[96:99], v6 offset:8192
    ds_read_b128 v[100:103], v6 offset:9216
    ds_read_b128 v[104:107], v6 offset:10240
    ds_read_b128 v[108:111], v6 offset:11264
    ds_read_b128 v[112:115], v6 offset:12288
    ds_read_b128 v[116:119], v6 offset:13312
    ds_read_b128 v[120:123], v6 offset:14336
    ds_read_b128 v[124:127], v6 offset:15360
    v_mov_b64 v[16:17], 0
    v_mov_b64 v[18:19], 0
    v_mov_b64 v[20:21], 0
    v_mov_b64 v[22:23], 0
    v_mov_b64 v[24:25], 0
    v_mov_b64 v[26:27], 0
    v_mov_b64 v[28:29], 0
    v_mov_b64 v[30:31], 0
EN_STEP:
    s_waitcnt lgkmcnt(0)
    s_barrier
    ds_read_b128 v[32:35], v7 offset:16384
    ds_read_b128 v[36:39], v7 offset:17408
    ds_read_b128 v[40:43], v7 offset:18432
    ds_read_b128 v[44:47], v7 offset:19456
    s_waitcnt vmcnt(0)
    ds_read_b128 v[48:51], v7 offset:20480
    ds_read_b128 v[52:55], v7 offset:21504
    ds_read_b128 v[56:59], v7 offset:22528
    ds_read_b128 v[60:63], v7 offset:23552
    buffer_load_dword v3, v2, s[4:7], s62 offen sc1
    s_waitcnt lgkmcnt(7)
    v_smfmac_f32_16x16x64_bf16 v[16:19], v[32:35], v[64:71], v4
    s_mov_b32 s24, s50
    s_mov_b32 s50, s48
    v_smfmac_f32_16x16x64_bf16 v[20:23], v[32:35], v[72:79], v4
    s_mov_b32 s48, s49
    s_mov_b32 s49, s24
    s_waitcnt lgkmcnt(6)
    v_smfmac_f32_16x16x64_bf16 v[16:19], v[36:39], v[80:87], v4
    s_xor_b32 s46, s46, 1
    s_add_u32 s42, s42, 1
    v_smfmac_f32_16x16x64_bf16 v[20:23], v[36:39], v[88:95], v4
    s_add_u32 s63, s63, 1024
    s_waitcnt lgkmcnt(5)
    v_smfmac_f32_16x16x64_bf16 v[16:19], v[40:43], v[96:103], v4
    ds_read_b128 v[64:67], v7 offset:0
    v_smfmac_f32_16x16x64_bf16 v[20:23], v[40:43], v[104:111], v4
    ds_read_b128 v[68:71], v7 offset:1024
    s_waitcnt lgkmcnt(6)
    v_smfmac_f32_16x16x64_bf16 v[16:19], v[44:47], v[112:119], v4
    ds_read_b128 v[72:75], v7 offset:2048
    v_smfmac_f32_16x16x64_bf16 v[20:23], v[44:47], v[120:127], v4
    ds_read_b128 v[76:79], v7 offset:3072
    s_waitcnt lgkmcnt(7)
    v_smfmac_f32_16x16x64_bf16 v[16:19], v[48:51], v[128:135], v4
    ds_read_b128 v[80:83], v7 offset:4096
    v_smfmac_f32_16x16x64_bf16 v[20:23], v[48:51], v[136:143], v4
    ds_read_b128 v[84:87], v7 offset:5120
    s_waitcnt lgkmcnt(8)
    v_smfmac_f32_16x16x64_bf16 v[16:19], v[52:55], v[144:151], v4
    ds_read_b128 v[88:91], v7 offset:6144
    v_smfmac_f32_16x16x64_bf16 v[20:23], v[52:55], v[152:159], v4
    ds_read_b128 v[92:95], v7 offset:7168
    s_waitcnt lgkmcnt(9)
    v_smfmac_f32_16x16x64_bf16 v[16:19], v[56:59], v[160:167], v4
    s_cmp_eq_u32 s66, 1
    s_cbranch_scc1 EN_SG
    buffer_load_dword v3, v2, s[4:7], s62 offen sc1
EN_SGR:
    v_smfmac_f32_16x16x64_bf16 v[20:23], v[56:59], v[168:175], v4
    s_mov_b32 s66, s51
    s_waitcnt lgkmcnt(8)
    v_smfmac_f32_16x16x64_bf16 v[16:19], v[60:63], v[176:183], v4
    v_smfmac_f32_16x16x64_bf16 v[20:23], v[60:63], v[184:191], v4
    v_smfmac_f32_16x16x64_bf16 v[24:27], v[32:35], a[0:7], v4
    v_mov_b64 v[112:113], 0
    v_smfmac_f32_16x16x64_bf16 v[28:31], v[32:35], a[8:15], v4
    v_mov_b64 v[114:115], 0
    v_smfmac_f32_16x16x64_bf16 v[24:27], v[36:39], a[16:23], v4
    v_mov_b64 v[116:117], 0
    v_smfmac_f32_16x16x64_bf16 v[28:31], v[36:39], a[24:31], v4
    v_mov_b64 v[118:119], 0
    v_smfmac_f32_16x16x64_bf16 v[112:115], v[32:35], a[128:135], v4
    v_pk_add_f32 v[16:17], v[16:17], v[18:19]
    v_smfmac_f32_16x16x64_bf16 v[116:119], v[32:35], a[136:143], v4
    v_cvt_pk_bf16_f32 v18, v16, v17
    v_smfmac_f32_16x16x64_bf16 v[112:115], v[36:39], a[144:151], v4
    v_cvt_pk_bf16_f32 v19, v16, v17
    v_smfmac_f32_16x16x64_bf16 v[116:119], v[36:39], a[152:159], v4
    ds_write_b64 v8, v[18:19] offset:8192
    v_smfmac_f32_16x16x64_bf16 v[24:27], v[40:43], a[32:39], v4
    v_pk_add_f32 v[20:21], v[20:21], v[22:23]
    v_smfmac_f32_16x16x64_bf16 v[28:31], v[40:43], a[40:47], v4
    v_cvt_pk_bf16_f32 v22, v20, v21
    v_smfmac_f32_16x16x64_bf16 v[24:27], v[44:47], a[48:55], v4
    v_cvt_pk_bf16_f32 v23, v20, v21
    v_smfmac_f32_16x16x64_bf16 v[28:31], v[44:47], a[56:63], v4
    ds_write_b64 v8, v[22:23] offset:8736
    v_smfmac_f32_16x16x64_bf16 v[24:27], v[48:51], a[64:71], v4
    ds_read_b128 v[32:35], v11 offset:8192
    v_smfmac_f32_16x16x64_bf16 v[28:31], v[48:51], a[72:79], v4
    ds_read_b128 v[36:39], v11 offset:9216
    v_smfmac_f32_16x16x64_bf16 v[24:27], v[52:55], a[80:87], v4
    s_barrier
    v_smfmac_f32_16x16x64_bf16 v[28:31], v[52:55], a[88:95], v4
    v_smfmac_f32_16x16x64_bf16 v[24:27], v[56:59], a[96:103], v4
    v_smfmac_f32_16x16x64_bf16 v[28:31], v[56:59], a[104:111], v4
    v_smfmac_f32_16x16x64_bf16 v[24:27], v[60:63], a[112:119], v4
    v_smfmac_f32_16x16x64_bf16 v[28:31], v[60:63], a[120:127], v4
    v_smfmac_f32_16x16x64_bf16 v[112:115], v[40:43], a[160:167], v4
    v_smfmac_f32_16x16x64_bf16 v[116:119], v[40:43], a[168:175], v4
    v_smfmac_f32_16x16x64_bf16 v[112:115], v[44:47], a[176:183], v4
    s_nop 3
    v_pk_add_f32 v[24:25], v[24:25], v[26:27]
    v_cvt_pk_bf16_f32 v26, v24, v25
    v_cvt_pk_bf16_f32 v27, v24, v25
    ds_write_b64 v8, v[26:27] offset:0
    v_smfmac_f32_16x16x64_bf16 v[116:119], v[44:47], a[184:191], v4
    v_pk_add_f32 v[28:29], v[28:29], v[30:31]
    v_cvt_pk_bf16_f32 v30, v28, v29
    v_cvt_pk_bf16_f32 v31, v28, v29
    ds_write_b64 v8, v[30:31] offset:544
    v_smfmac_f32_16x16x64_bf16 v[112:115], v[48:51], a[192:199], v4
    v_smfmac_f32_16x16x64_bf16 v[116:119], v[48:51], a[200:207], v4
    v_smfmac_f32_16x16x64_bf16 v[112:115], v[52:55], a[208:215], v4
    s_waitcnt lgkmcnt(0)
    s_barrier
    v_smfmac_f32_16x16x64_bf16 v[116:119], v[52:55], a[216:223], v4
    ds_read_b64_tr_b16 v[96:97], v9 offset:8192
    ds_read_b64_tr_b16 v[98:99], v9 offset:8224
    v_smfmac_f32_16x16x64_bf16 v[112:115], v[56:59], a[224:231], v4
    ds_read_b64_tr_b16 v[16:17], v9 offset:0
    ds_read_b64_tr_b16 v[18:19], v9 offset:32
    v_smfmac_f32_16x16x64_bf16 v[116:119], v[56:59], a[232:239], v4
    ds_read_b64_tr_b16 v[100:101], v9 offset:8256
    ds_read_b64_tr_b16 v[102:103], v9 offset:8288
    v_smfmac_f32_16x16x64_bf16 v[112:115], v[60:63], a[240:247], v4
    ds_read_b64_tr_b16 v[20:21], v9 offset:64
    ds_read_b64_tr_b16 v[22:23], v9 offset:96
    s_waitcnt vmcnt(1)
    v_readfirstlane_b32 s24, v3
    v_smfmac_f32_16x16x64_bf16 v[116:119], v[60:63], a[248:255], v4
    ds_read_b64_tr_b16 v[104:105], v9 offset:10368
    ds_read_b64_tr_b16 v[106:107], v9 offset:10400
    s_lshr_b32 s24, s24, 8
    s_cmp_eq_u32 s24, 2
    s_cselect_b32 s64, 1, 0
    s_cbranch_scc0 EN_ND
    s_waitcnt lgkmcnt(6)
    v_mfma_f32_16x16x32_bf16 v[120:123], v[64:67], v[96:99], 0
    ds_read_b64_tr_b16 v[24:25], v9 offset:2176
    ds_read_b64_tr_b16 v[26:27], v9 offset:2208
    v_mfma_f32_16x16x32_bf16 v[124:127], v[80:83], v[96:99], 0
    ds_read_b64_tr_b16 v[108:109], v9 offset:10432
    ds_read_b64_tr_b16 v[110:111], v9 offset:10464
    v_mfma_f32_16x16x32_bf16 v[44:47], v[16:19], v[96:99], 0
    buffer_load_dwordx4 v7, s[4:7], s60 offen offset:0 sc1 lds
    ds_read_b64_tr_b16 v[28:29], v9 offset:2240
    s_waitcnt lgkmcnt(7)
    v_mfma_f32_16x16x32_bf16 v[120:123], v[68:71], v[100:103], v[120:123]
    ds_read_b64_tr_b16 v[30:31], v9 offset:2272
    v_pk_add_f32 v[112:113], v[112:113], v[114:115]
    v_mfma_f32_16x16x32_bf16 v[124:127], v[84:87], v[100:103], v[124:127]
    v_pk_add_f32 v[116:117], v[116:117], v[118:119]
    v_cvt_pk_bf16_f32 v114, v112, v113
    v_mfma_f32_16x16x32_bf16 v[44:47], v[20:23], v[100:103], v[44:47]
    buffer_load_dwordx4 v7, s[4:7], s60 offen offset:1024 sc1 lds
    v_cvt_pk_bf16_f32 v115, v116, v117
    s_waitcnt lgkmcnt(4)
    v_mfma_f32_16x16x32_bf16 v[120:123], v[72:75], v[104:107], v[120:123]
    v_lshrrev_b32 v112, 1, v7
    ds_read_b128 v[48:51], v6 offset:16384
    v_mfma_f32_16x16x32_bf16 v[124:127], v[88:91], v[104:107], v[124:127]
    ds_read_b128 v[52:55], v6 offset:17408
    ds_read_b128 v[56:59], v6 offset:18432
    v_mfma_f32_16x16x32_bf16 v[44:47], v[24:27], v[104:107], v[44:47]
    buffer_load_dwordx4 v7, s[4:7], s60 offen offset:2048 sc1 lds
    ds_read_b128 v[60:63], v6 offset:19456
    s_waitcnt lgkmcnt(4)
    v_mfma_f32_16x16x32_bf16 v[120:123], v[76:79], v[108:111], v[120:123]
    buffer_load_dwordx4 v7, s[4:7], s60 offen offset:3072 sc1 lds
    s_add_u32 s60, s60, 786432
    s_add_u32 s62, s62, 1024
    v_mfma_f32_16x16x32_bf16 v[124:127], v[92:95], v[108:111], v[124:127]
EN_NDR:
    ds_read_b128 v[64:67], v6 offset:20480
    v_mfma_f32_16x16x32_bf16 v[44:47], v[28:31], v[108:111], v[44:47]
    ds_read_b128 v[68:71], v6 offset:21504
    ds_read_b128 v[80:83], v6 offset:22528
    v_max3_f32 v40, v120, v121, v122
    s_nop 2
    v_max3_f32 v41, v123, v124, v125
    v_max3_f32 v40, v40, v126, v127
    v_max3_f32 v41, v41, v44, v45
    v_max_f32 v40, v40, v41
    v_max_f32 v41, v40, v41
    ds_read_b128 v[84:87], v6 offset:23552
    ds_read_b128 v[96:99], v6 offset:24576
    v_permlane16_swap_b32 v40, v41
    v_max_f32 v40, v40, v41
    v_max_f32 v41, v40, v41
    v_mov_b64 v[28:29], s[68:69]
    v_mov_b64 v[30:31], s[68:69]
    v_permlane32_swap_b32 v40, v41
    v_max_f32 v40, v40, v41
    v_mul_f32 v40, s45, v40
    v_pk_fma_f32 v[44:45], v[44:45], s[44:45], v[40:41] op_sel:[0,1,0] op_sel_hi:[1,1,0] neg_lo:[0,0,1] neg_hi:[0,0,1]
    v_pk_fma_f32 v[120:121], v[120:121], s[44:45], v[40:41] op_sel:[0,1,0] op_sel_hi:[1,1,0] neg_lo:[0,0,1] neg_hi:[0,0,1]
    v_pk_fma_f32 v[122:123], v[122:123], s[44:45], v[40:41] op_sel:[0,1,0] op_sel_hi:[1,1,0] neg_lo:[0,0,1] neg_hi:[0,0,1]
    v_pk_fma_f32 v[124:125], v[124:125], s[44:45], v[40:41] op_sel:[0,1,0] op_sel_hi:[1,1,0] neg_lo:[0,0,1] neg_hi:[0,0,1]
    v_pk_fma_f32 v[126:127], v[126:127], s[44:45], v[40:41] op_sel:[0,1,0] op_sel_hi:[1,1,0] neg_lo:[0,0,1] neg_hi:[0,0,1]
    v_exp_f32 v44, v44
    v_exp_f32 v45, v45
    v_exp_f32 v120, v120
    v_cvt_pk_bf16_f32 v44, v44, v45
    v_cndmask_b32 v46, 0, v44, s[52:53]
    v_cndmask_b32 v47, 0, v44, s[54:55]
    v_exp_f32 v121, v121
    v_exp_f32 v122, v122
    v_mfma_f32_16x16x16_bf16 v[24:27], v[28:29], v[46:47], 0
    v_exp_f32 v123, v123
    v_exp_f32 v124, v124
    v_mfma_f32_16x16x16_bf16 v[16:19], v[114:115], v[46:47], 0
    v_exp_f32 v125, v125
    v_exp_f32 v126, v126
    v_mfma_f32_16x16x16_bf16 v[20:23], v[114:115], v[46:47], 0
    v_exp_f32 v127, v127
    v_cvt_pk_bf16_f32 v120, v120, v121
    v_cvt_pk_bf16_f32 v121, v122, v123
    v_cvt_pk_bf16_f32 v122, v124, v125
    v_cvt_pk_bf16_f32 v123, v126, v127
    s_nop 1
    v_mfma_f32_16x16x32_bf16 v[24:27], v[28:31], v[120:123], v[24:27]
    ds_read_b64_tr_b16 v[44:45], v1 offset:0
    ds_read_b64_tr_b16 v[46:47], v1 offset:32
    v_mfma_f32_16x16x32_bf16 v[16:19], v[32:35], v[120:123], v[16:19]
    v_mov_b64 v[124:125], 0
    v_mov_b64 v[126:127], 0
    v_mfma_f32_16x16x32_bf16 v[20:23], v[36:39], v[120:123], v[20:23]
    v_mov_b64 v[116:117], 0
    v_mov_b64 v[118:119], 0
    v_rcp_f32 v40, v24
    v_mov_b64 v[28:29], 0
    v_mov_b64 v[30:31], 0
    v_mov_b64 v[120:121], 0
    v_mov_b64 v[122:123], 0
    s_add_u32 s24, s61, -63488
    v_cndmask_b32 v16, v20, v16, s[52:53]
    v_cndmask_b32 v17, v21, v17, s[52:53]
    v_cndmask_b32 v18, v22, v18, s[52:53]
    v_cndmask_b32 v19, v23, v19, s[52:53]
    v_pk_mul_f32 v[16:17], v[16:17], v[40:41] op_sel_hi:[1,0]
    v_pk_mul_f32 v[18:19], v[18:19], v[40:41] op_sel_hi:[1,0]
    v_cvt_pk_bf16_f32 v42, v16, v17
    v_cvt_pk_bf16_f32 v43, v18, v19
    ds_write_b64 v10, v[42:43]
    buffer_store_dwordx2 v[114:115], v112, s[4:7], s24 offen sc1
    s_cmp_eq_u32 s42, 63
    v_mov_b64 v[16:17], 0
    v_mov_b64 v[18:19], 0
    v_mov_b64 v[20:21], 0
    v_mov_b64 v[22:23], 0
    v_mov_b64 v[24:25], 0
    v_mov_b64 v[26:27], 0
    v_mov_b64 v[112:113], 0
    v_mov_b64 v[114:115], 0
    s_waitcnt lgkmcnt(0)
    s_barrier
    s_cbranch_scc1 EN_LAST
    ds_read_b128 v[32:35], v7 offset:28928
    ds_read_b128 v[36:39], v7 offset:29952
    buffer_store_dwordx4 v[44:47], v5, s[4:7], s61 offen sc1
    s_add_u32 s61, s61, 131072
    s_cmp_eq_u32 s43, 0
    s_waitcnt lgkmcnt(1)
    v_smfmac_f32_16x16x64_bf16 v[16:19], v[32:35], v[192:199], v4
    ds_read_b128 v[100:103], v6 offset:25600
    v_smfmac_f32_16x16x64_bf16 v[20:23], v[32:35], v[208:215], v4
    ds_read_b128 v[72:75], v6 offset:26624
    s_waitcnt lgkmcnt(2)
    v_smfmac_f32_16x16x64_bf16 v[16:19], v[36:39], v[200:207], v4
    ds_read_b128 v[76:79], v6 offset:27648
    v_smfmac_f32_16x16x64_bf16 v[20:23], v[36:39], v[216:223], v4
    ds_read_b128 v[88:91], v6 offset:28672
    v_smfmac_f32_16x16x64_bf16 v[24:27], v[32:35], v[224:231], v4
    ds_read_b128 v[92:95], v6 offset:29696
    v_smfmac_f32_16x16x64_bf16 v[28:31], v[32:35], v[240:247], v4
    ds_read_b128 v[104:107], v6 offset:30720
    v_smfmac_f32_16x16x64_bf16 v[24:27], v[36:39], v[232:239], v4
    ds_read_b128 v[108:111], v6 offset:31744
    v_smfmac_f32_16x16x64_bf16 v[28:31], v[36:39], v[248:255], v4
    v_pk_add_f32 v[16:17], v[16:17], v[18:19]
    v_smfmac_f32_16x16x64_bf16 v[112:115], v[32:35], v[48:55], v4
    v_pk_add_f32 v[20:21], v[20:21], v[22:23]
    v_smfmac_f32_16x16x64_bf16 v[116:119], v[32:35], v[64:71], v4
    v_cvt_pk_bf16_f32 v40, v16, v20
    v_smfmac_f32_16x16x64_bf16 v[112:115], v[36:39], v[56:63], v4
    v_cvt_pk_bf16_f32 v44, v17, v21
    v_smfmac_f32_16x16x64_bf16 v[116:119], v[36:39], v[80:87], v4
    v_and_or_b32 v40, v40, -2, s46
    s_waitcnt lgkmcnt(0)
    v_smfmac_f32_16x16x64_bf16 v[120:123], v[32:35], v[96:103], v4
    v_and_or_b32 v44, v44, -2, s46
    v_pk_add_f32 v[24:25], v[24:25], v[26:27]
    v_smfmac_f32_16x16x64_bf16 v[124:127], v[32:35], v[88:95], v4
    v_pk_add_f32 v[28:29], v[28:29], v[30:31]
    v_cvt_pk_bf16_f32 v41, v24, v28
    v_smfmac_f32_16x16x64_bf16 v[120:123], v[36:39], v[72:79], v4
    v_cvt_pk_bf16_f32 v45, v25, v29
    v_smfmac_f32_16x16x64_bf16 v[124:127], v[36:39], v[104:111], v4
    v_pk_add_f32 v[112:113], v[112:113], v[114:115]
    v_pk_add_f32 v[116:117], v[116:117], v[118:119]
    v_cvt_pk_bf16_f32 v42, v112, v116
    v_cvt_pk_bf16_f32 v46, v113, v117
    s_nop 1
    v_pk_add_f32 v[120:121], v[120:121], v[122:123]
    s_nop 0
    v_pk_add_f32 v[124:125], v[124:125], v[126:127]
    v_cvt_pk_bf16_f32 v43, v120, v124
    v_cvt_pk_bf16_f32 v47, v121, v125
    s_cbranch_scc1 EN_ss_229
    buffer_store_dwordx4 v[40:43], v12, s[4:7], s47 offen offset:0
    buffer_store_dwordx4 v[44:47], v12, s[4:7], s47 offen offset:128
    s_branch EN_ss_230
EN_ss_229:
    buffer_store_dwordx4 v[40:43], v12, s[4:7], s47 offen offset:0 sc1
    buffer_store_dwordx4 v[44:47], v12, s[4:7], s47 offen offset:128 sc1
EN_ss_230:
    ds_read_b128 v[32:35], v7 offset:30976
    v_mov_b64 v[16:17], 0
    v_mov_b64 v[18:19], 0
    v_mov_b64 v[20:21], 0
    v_mov_b64 v[22:23], 0
    v_mov_b64 v[24:25], 0
    v_mov_b64 v[26:27], 0
    v_mov_b64 v[28:29], 0
    v_mov_b64 v[30:31], 0
    s_mov_b32 s27, 0
    s_waitcnt vmcnt(0)
    buffer_load_dwordx4 v[48:51], v13, s[4:7], s47 offen sc1
    buffer_load_dwordx4 v[52:55], v13, s[4:7], s65 offen sc1
    ds_read_b128 v[64:67], v6 offset:0
    ds_read_b128 v[68:71], v6 offset:1024
    ds_read_b128 v[72:75], v6 offset:2048
    ds_read_b128 v[76:79], v6 offset:3072
    ds_read_b128 v[80:83], v6 offset:4096
    ds_read_b128 v[84:87], v6 offset:5120
    ds_read_b128 v[88:91], v6 offset:6144
    ds_read_b128 v[92:95], v6 offset:7168
    ds_read_b128 v[96:99], v6 offset:8192
    ds_read_b128 v[100:103], v6 offset:9216
    ds_read_b128 v[104:107], v6 offset:10240
    ds_read_b128 v[108:111], v6 offset:11264
    v_mov_b64 v[46:47], -1
    s_waitcnt lgkmcnt(0)
    s_waitcnt lgkmcnt(0)
EN_P1:
    s_waitcnt vmcnt(1)
    v_mfma_f32_16x16x32_bf16 v[36:39], v[32:35], v[48:51], 0
    v_xor_b32 v44, s46, v48
    s_waitcnt vmcnt(0)
    v_mfma_f32_16x16x32_bf16 v[36:39], v[32:35], v[52:55], v[36:39]
    v_xor_b32 v45, s46, v52
    v_or_b32 v44, v44, v45
    v_and_b32 v44, 1, v44
    v_cmp_ne_u32 vcc, 0, v44
    s_cbranch_vccz EN_P1d
    buffer_load_dwordx4 v[48:51], v13, s[4:7], s47 offen sc1
    buffer_load_dwordx4 v[52:55], v13, s[4:7], s65 offen sc1
    s_add_u32 s27, s27, 1
    s_and_b32 s24, s27, 255
    s_cbranch_scc1 EN_P1
    s_memrealtime s[36:37]
    s_waitcnt lgkmcnt(0)
    s_sub_u32 s36, s36, s28
    s_cmp_gt_u32 s36, 3000000
    s_cbranch_scc1 E_ENG
    s_branch EN_P1
EN_P1d:
    s_nop 2
    v_add_f32_dpp v36, v36, v36 row_ror:8 row_mask:0xf bank_mask:0xf
    v_add_f32_dpp v37, v37, v37 row_ror:8 row_mask:0xf bank_mask:0xf
    v_add_f32_dpp v38, v38, v38 row_ror:8 row_mask:0xf bank_mask:0xf
    v_add_f32_dpp v39, v39, v39 row_ror:8 row_mask:0xf bank_mask:0xf
    v_add_f32_dpp v36, v36, v36 row_ror:4 row_mask:0xf bank_mask:0xf
    v_add_f32_dpp v37, v37, v37 row_ror:4 row_mask:0xf bank_mask:0xf
    v_add_f32_dpp v38, v38, v38 row_ror:4 row_mask:0xf bank_mask:0xf
    v_add_f32_dpp v39, v39, v39 row_ror:4 row_mask:0xf bank_mask:0xf
    v_cvt_pk_bf16_f32 v36, v36, v37
    v_cvt_pk_bf16_f32 v37, v38, v39
    s_mov_b64 exec, s[58:59]
    s_cmp_eq_u32 s43, 0
    s_cbranch_scc1 EN_ss_231
    buffer_store_dwordx2 v[36:37], v14, s[4:7], s48 offen
    buffer_store_dwordx2 v[46:47], v14, s[4:7], s50 offen
    s_branch EN_ss_232
EN_ss_231:
    buffer_store_dwordx2 v[36:37], v14, s[4:7], s48 offen sc1
    buffer_store_dwordx2 v[46:47], v14, s[4:7], s50 offen sc1
EN_ss_232:
    s_mov_b64 exec, -1
    s_mov_b32 s27, 0
    s_waitcnt vmcnt(0)
    buffer_load_dwordx4 v[48:51], v15, s[4:7], s48 offen offset:0 sc1
    buffer_load_dwordx4 v[52:55], v15, s[4:7], s48 offen offset:1024 sc1
    ds_read_b128 v[112:115], v6 offset:12288
    ds_read_b128 v[116:119], v6 offset:13312
    ds_read_b128 v[120:123], v6 offset:14336
    ds_read_b128 v[124:127], v6 offset:15360
    s_waitcnt lgkmcnt(0)
    buffer_load_dwordx4 v[56:59], v15, s[4:7], s48 offen offset:0 sc1
    buffer_load_dwordx4 v[60:63], v15, s[4:7], s48 offen offset:1024 sc1
EN_P2:
    s_waitcnt vmcnt(3)
    ds_write_b128 v0, v[48:51] offset:0
    v_max_u32 v44, v48, v50
    s_waitcnt vmcnt(2)
    ds_write_b128 v0, v[52:55] offset:1024
    v_max3_u32 v44, v44, v52, v54
    v_cmp_eq_u32 vcc, -1, v44
    s_cbranch_vccz EN_NEXT
    buffer_load_dwordx4 v[48:51], v15, s[4:7], s48 offen offset:0 sc1
    buffer_load_dwordx4 v[52:55], v15, s[4:7], s48 offen offset:1024 sc1
    s_waitcnt vmcnt(3)
    ds_write_b128 v0, v[56:59] offset:0
    v_max_u32 v44, v56, v58
    s_waitcnt vmcnt(2)
    ds_write_b128 v0, v[60:63] offset:1024
    v_max3_u32 v44, v44, v60, v62
    v_cmp_eq_u32 vcc, -1, v44
    s_cbranch_vccz EN_NEXT
    buffer_load_dwordx4 v[56:59], v15, s[4:7], s48 offen offset:0 sc1
    buffer_load_dwordx4 v[60:63], v15, s[4:7], s48 offen offset:1024 sc1
    s_add_u32 s27, s27, 1
    s_and_b32 s24, s27, 255
    s_cbranch_scc1 EN_P2
    s_memrealtime s[36:37]
    s_waitcnt lgkmcnt(0)
    s_sub_u32 s36, s36, s28
    s_cmp_gt_u32 s36, 3000000
    s_cbranch_scc1 E_ENG
    s_branch EN_P2
EN_NEXT:
    s_cmp_lg_u32 s64, 0
    s_cbranch_scc1 EN_STEP
EN_KVB:
    v_readfirstlane_b32 s24, v3
    s_lshr_b32 s24, s24, 8
    s_cmp_eq_u32 s24, 2
    s_cbranch_scc1 EN_KVGB
    buffer_load_dword v3, v2, s[4:7], s62 offen sc1
    s_memrealtime s[36:37]
    s_waitcnt lgkmcnt(0)
    s_sub_u32 s36, s36, s28
    s_cmp_gt_u32 s36, 3000000
    s_cbranch_scc1 E_ENG
    s_waitcnt vmcnt(0)
    s_branch EN_KVB
EN_KVGB:
    buffer_load_dwordx4 v7, s[4:7], s60 offen offset:0 sc1 lds
    buffer_load_dwordx4 v7, s[4:7], s60 offen offset:1024 sc1 lds
    buffer_load_dwordx4 v7, s[4:7], s60 offen offset:2048 sc1 lds
    buffer_load_dwordx4 v7, s[4:7], s60 offen offset:3072 sc1 lds
    s_add_u32 s60, s60, 786432
    s_add_u32 s62, s62, 1024
    s_waitcnt vmcnt(0)
    s_branch EN_STEP
EN_ND:
    s_waitcnt lgkmcnt(6)
    v_mfma_f32_16x16x32_bf16 v[120:123], v[64:67], v[96:99], 0
    ds_read_b64_tr_b16 v[24:25], v9 offset:2176
    ds_read_b64_tr_b16 v[26:27], v9 offset:2208
    v_mfma_f32_16x16x32_bf16 v[124:127], v[80:83], v[96:99], 0
    ds_read_b64_tr_b16 v[108:109], v9 offset:10432
    ds_read_b64_tr_b16 v[110:111], v9 offset:10464
    v_mfma_f32_16x16x32_bf16 v[44:47], v[16:19], v[96:99], 0
    ds_read_b64_tr_b16 v[28:29], v9 offset:2240
    s_waitcnt lgkmcnt(7)
    v_mfma_f32_16x16x32_bf16 v[120:123], v[68:71], v[100:103], v[120:123]
    ds_read_b64_tr_b16 v[30:31], v9 offset:2272
    v_pk_add_f32 v[112:113], v[112:113], v[114:115]
    v_mfma_f32_16x16x32_bf16 v[124:127], v[84:87], v[100:103], v[124:127]
    v_pk_add_f32 v[116:117], v[116:117], v[118:119]
    v_cvt_pk_bf16_f32 v114, v112, v113
    v_mfma_f32_16x16x32_bf16 v[44:47], v[20:23], v[100:103], v[44:47]
    v_cvt_pk_bf16_f32 v115, v116, v117
    s_waitcnt lgkmcnt(4)
    v_mfma_f32_16x16x32_bf16 v[120:123], v[72:75], v[104:107], v[120:123]
    v_lshrrev_b32 v112, 1, v7
    ds_read_b128 v[48:51], v6 offset:16384
    v_mfma_f32_16x16x32_bf16 v[124:127], v[88:91], v[104:107], v[124:127]
    ds_read_b128 v[52:55], v6 offset:17408
    ds_read_b128 v[56:59], v6 offset:18432
    v_mfma_f32_16x16x32_bf16 v[44:47], v[24:27], v[104:107], v[44:47]
    ds_read_b128 v[60:63], v6 offset:19456
    s_waitcnt lgkmcnt(4)
    v_mfma_f32_16x16x32_bf16 v[120:123], v[76:79], v[108:111], v[120:123]
    v_mfma_f32_16x16x32_bf16 v[124:127], v[92:95], v[108:111], v[124:127]
    s_nop 1
    s_branch EN_NDR
EN_SG:
    v_mov_b32 v127, 1
    s_mov_b64 exec, 1
    buffer_atomic_add v127, v2, s[4:7], s63 offen
    s_mov_b64 exec, -1
    s_branch EN_SGR
EN_LAST:
    buffer_store_dwordx4 v[44:47], v5, s[4:7], s61 offen sc1
    s_add_u32 s61, s61, 131072
    s_waitcnt vmcnt(0)
    s_barrier
    s_add_u32 s63, s63, 1024
    s_cmp_lg_u32 s16, 3
    s_cbranch_scc1 E_ENG
    v_mov_b32 v16, 1
    s_mov_b64 exec, 1
    buffer_atomic_add v16, v2, s[4:7], s63 offen
    s_mov_b64 exec, -1
E_ENG:
    s_endpgm
.section .rodata,"a"
.p2align 6
.amdhsa_kernel main_kernel
  .amdhsa_next_free_vgpr 512
  .amdhsa_next_free_sgpr 102
  .amdhsa_accum_offset 256
  .amdhsa_group_segment_fixed_size 0
  .amdhsa_kernarg_size 104
  .amdhsa_user_sgpr_count 2
  .amdhsa_user_sgpr_kernarg_segment_ptr 1
  .amdhsa_system_sgpr_workgroup_id_x 1
.end_amdhsa_kernel
```
